```python
import torch

def _softmax(x, axis=-1):
    return torch.softmax(x, dim=axis)

def _gelu(x):
    return torch.nn.functional.gelu(x, approximate='tanh')

def _silu(x):
    return torch.nn.functional.silu(x)

def _sigmoid(x):
    return torch.sigmoid(x)

def _layernorm(x, axis=-1, eps=1e-05):
    m = x.mean(dim=axis, keepdim=True)
    v = x.var(dim=axis, keepdim=True, unbiased=False)
    return (x - m) / torch.sqrt(v + eps)

def _scatter_add(tgt, idx, src, axis=0):
    return tgt.clone().index_add_(axis, idx, src)

def _segment_sum(src, seg, n):
    out = torch.zeros((n,) + src.shape[1:], dtype=src.dtype)
    return out.index_add_(0, seg, src)

def _pad(x, pw):
    flat = tuple((v for pair in reversed(pw) for v in pair))
    return torch.nn.functional.pad(x, flat)
kernel_name = 'concat_heads__ssm_conv_h3__memory_aug_recurrent_mem_tr__prompt'

def setup_inputs():

    _w = lambda a: (lambda t: t.to(torch.bfloat16) if t.is_floating_point() else t)(torch.as_tensor(a))

    def _A_setup():
        B, S, D = (1, 2048, 512)
        ks = 4
        return {'q': _w((lambda *s: torch.randn(*s, dtype=torch.bfloat16) * 0.05)(B, S, D)), 'k': _w((lambda *s: torch.randn(*s, dtype=torch.bfloat16) * 0.4)(B, S, D)), 'v': _w((lambda *s: torch.randn(*s, dtype=torch.bfloat16) * 0.4)(B, S, D)), 'shift_k': _w((lambda *s: torch.randn(*s, dtype=torch.bfloat16) * 0.4)(D, ks) * 0.5), 'ssm_k': _w((lambda *s: torch.randn(*s, dtype=torch.bfloat16) * 0.4)(D, S) * (1.0 / S ** 0.5)), 'ssm_D': _w((lambda *s: torch.randn(*s, dtype=torch.bfloat16) * 0.4)(D))}
    _A_in = _A_setup()

    def _B_setup():
        B, S, Dm = (1, 2048, 512)
        H, Dh = (32, 128)
        M, seg = (8, 32)
        seg = min(seg, S)
        S = S // seg * seg
        return {'x': _w((lambda *s: torch.randn(*s, dtype=torch.bfloat16) * 0.05)(B, S, Dm)), 'mem0': _w((lambda *s: torch.randn(*s, dtype=torch.bfloat16) * 0.4)(B, M, Dm)), 'Wq': _w((lambda *s: torch.randn(*s, dtype=torch.bfloat16) * 6.4)(Dm, H, Dh) * Dm ** (-0.5)), 'Wk': _w((lambda *s: torch.randn(*s, dtype=torch.bfloat16) * 6.4)(Dm, H, Dh) * Dm ** (-0.5)), 'Wv': _w((lambda *s: torch.randn(*s, dtype=torch.bfloat16) * 0.4)(Dm, H, Dh) * Dm ** (-0.5)), 'Wo': _w((lambda *s: torch.randn(*s, dtype=torch.bfloat16) * 0.4)(H, Dh, Dm) * (H * Dh) ** (-0.5)), 'seg_len': seg}
    _B_in = _B_setup()
    return {'A_q': _A_in['q'], 'A_k': _A_in['k'], 'A_v': _A_in['v'], 'A_shift_k': _A_in['shift_k'], 'A_ssm_k': _A_in['ssm_k'], 'A_ssm_D': _A_in['ssm_D'], 'B_x': _B_in['x'], 'B_mem0': _B_in['mem0'], 'B_Wq': _B_in['Wq'], 'B_Wk': _B_in['Wk'], 'B_Wv': _B_in['Wv'], 'B_Wo': _B_in['Wo'], 'B_seg_len': _B_in['seg_len']}

def reference(A_q, A_k, A_v, A_shift_k, A_ssm_k, A_ssm_D, B_x, B_mem0, B_Wq, B_Wk, B_Wv, B_Wo, B_seg_len):

    def _A_ref(q, k, v, shift_k, ssm_k, ssm_D):
        B, S, D = q.shape
        ks = shift_k.shape[-1]
        k_pad = _pad(k, ((0, 0), (ks - 1, 0), (0, 0)))
        k_shift = torch.zeros_like(k)
        for t in range(ks):
            k_shift = k_shift + k_pad[:, t:t + S, :] * shift_k[:, ks - 1 - t][None, None, :]
        kv = k_shift * v
        L = 2 * S
        kv_pad = _pad(kv, ((0, 0), (0, S), (0, 0)))
        kf_pad = _pad(ssm_k, ((0, 0), (0, S)))
        kv_f = (lambda x, axes=(-2, -1): torch.fft.rfft2(x.float(), dim=axes))(kv_pad[:, None, :, :], axes=(1, 2))
        kf_f = (lambda x, axes=(-2, -1): torch.fft.rfft2(x.float(), dim=axes))(kf_pad[:, None, :], axes=(1, 2))
        kf_f = (lambda x, *d: x.permute(*d))(kf_f, 1, 2, 0)
        y_f = kv_f * kf_f[None, :, :, :]
        y = (lambda x, s, axes=(-2, -1): torch.fft.irfft2(x, s=s, dim=axes).to(torch.bfloat16))(y_f, (1, L), axes=(1, 2))[:, 0, :S, :]
        y = y + kv * ssm_D[None, None, :]
        return q * y

    def _B_ref(x, mem0, Wq, Wk, Wv, Wo, seg_len):
        B, S, Dm = x.shape
        H, Dh = (Wq.shape[1], Wq.shape[2])
        M = mem0.shape[1]
        scale = Dh ** (-0.5)
        n_seg = S // seg_len
        L = M + seg_len
        idx = torch.arange(L)
        mask = (idx[:, None] < M) | (idx[:, None] >= idx[None, :])
        mem = mem0
        outs = []
        for s in range(n_seg):
            xs = x[:, s * seg_len:(s + 1) * seg_len, :].clone()
            h = torch.concatenate([mem, xs], axis=1)
            q = torch.einsum('btd,dhe->bhte', h, Wq)
            k = torch.einsum('btd,dhe->bhte', h, Wk)
            v = torch.einsum('btd,dhe->bhte', h, Wv)
            scores = torch.einsum('bhqe,bhke->bhqk', q, k) * scale
            scores = torch.where(mask[None, None], scores, -1000000000.0)
            p = _softmax(scores, axis=-1)
            o = torch.einsum('bhqk,bhke->bhqe', p, v)
            o = torch.einsum('bhte,hed->btd', o, Wo)
            mem = o[:, :M, :].clone()
            outs.append(o[:, M:, :])
        return torch.concatenate(outs, axis=1)
    a = _A_ref(A_q, A_k, A_v, A_shift_k, A_ssm_k, A_ssm_D)
    b = _B_ref(B_x, B_mem0, B_Wq, B_Wk, B_Wv, B_Wo, B_seg_len)
    return torch.concatenate([a, b], axis=-1)
```

```asm
; @launch grid=(256,1,1) block=(256,1,1) lds=163840
.amdgcn_target "amdgcn-amd-amdhsa--gfx950"
.text
.globl concat_heads__ssm_conv_h3__memory_aug_recurrent_mem_tr__prompt_kernel
.p2align 8
.type concat_heads__ssm_conv_h3__memory_aug_recurrent_mem_tr__prompt_kernel,@function
concat_heads__ssm_conv_h3__memory_aug_recurrent_mem_tr__prompt_kernel:
  s_cmp_ge_u32 s2, 256
  s_cbranch_scc1 L_endF
  s_load_dwordx2 s[6:7], s[0:1], 112
  s_load_dwordx2 s[8:9], s[0:1], 120
  s_load_dwordx2 s[12:13], s[0:1], 48
  s_getreg_b32 s3, hwreg(HW_REG_XCC_ID)
  s_and_b32 s3, s3, 15
  v_lshrrev_b32 v2, 6, v0
  v_mov_b32 v1, v0
  v_and_b32 v0, 63, v0
  v_readfirstlane_b32 s17, v2
  s_mov_b32 s10, 268435456
  s_mov_b32 s11, 0x20000
  s_waitcnt lgkmcnt(0)
  s_cmp_lg_u32 s17, 0
  s_nop 0
  s_cbranch_scc1 L_norankF
  s_mov_b64 exec, 1
  v_mov_b32 v4, 1
  s_cmp_gt_u32 s3, 7
  s_nop 0
  s_cbranch_scc1 L_ovfF
  s_lshl_b32 s4, s3, 2
  s_add_u32 s4, s4, 128
  s_cmp_eq_u32 s3, 0
  s_cselect_b32 s4, 0, s4
  v_mov_b32 v3, s4
  global_atomic_add v5, v3, v4, s[6:7] sc0
  s_waitcnt vmcnt(0)
  v_readfirstlane_b32 s4, v5
  s_cmp_ge_u32 s4, 32
  s_nop 3
  s_cbranch_scc1 L_ovf2F
  s_lshl_b32 s5, s3, 5
  s_add_u32 s4, s4, s5
  s_branch L_gotF
L_ovfF:
  v_mov_b32 v3, 160
  global_atomic_add v5, v3, v4, s[6:7] sc0
  s_waitcnt vmcnt(0)
L_ovf2F:
  v_mov_b32 v3, 12
  global_store_dword v3, v4, s[6:7] sc1
  s_waitcnt vmcnt(0)
  v_mov_b32 v3, 8
  global_atomic_add v5, v3, v4, s[6:7] sc0
  s_waitcnt vmcnt(0)
  v_readfirstlane_b32 s5, v5
  s_nop 4
L_ovwF:
  v_mov_b32 v3, 0
  global_load_dword v6, v3, s[6:7] sc1
  global_load_dwordx4 v[8:11], v3, s[6:7] offset:128 sc1
  global_load_dwordx4 v[12:15], v3, s[6:7] offset:144 sc1
  global_load_dword v7, v3, s[6:7] offset:160 sc1
  s_waitcnt vmcnt(0)
  v_mov_b32 v8, v6
  v_add3_u32 v6, v8, v9, v10
  v_add3_u32 v6, v6, v11, v12
  v_add3_u32 v6, v6, v13, v14
  v_add3_u32 v6, v6, v15, v7
  v_cmp_ne_u32 vcc, 256, v6
  s_nop 4
  s_cbranch_vccnz L_ovwF
  s_mov_b32 s4, 0
  v_readfirstlane_b32 s12, v8
  s_min_u32 s12, s12, 32
  s_sub_u32 s13, 32, s12
  s_cmp_lt_u32 s5, s13
  s_nop 1
  s_cbranch_scc1 L_ofF_0
  s_sub_u32 s5, s5, s13
  v_readfirstlane_b32 s12, v9
  s_min_u32 s12, s12, 32
  s_sub_u32 s13, 32, s12
  s_cmp_lt_u32 s5, s13
  s_nop 1
  s_cbranch_scc1 L_ofF_1
  s_sub_u32 s5, s5, s13
  v_readfirstlane_b32 s12, v10
  s_min_u32 s12, s12, 32
  s_sub_u32 s13, 32, s12
  s_cmp_lt_u32 s5, s13
  s_nop 1
  s_cbranch_scc1 L_ofF_2
  s_sub_u32 s5, s5, s13
  v_readfirstlane_b32 s12, v11
  s_min_u32 s12, s12, 32
  s_sub_u32 s13, 32, s12
  s_cmp_lt_u32 s5, s13
  s_nop 1
  s_cbranch_scc1 L_ofF_3
  s_sub_u32 s5, s5, s13
  v_readfirstlane_b32 s12, v12
  s_min_u32 s12, s12, 32
  s_sub_u32 s13, 32, s12
  s_cmp_lt_u32 s5, s13
  s_nop 1
  s_cbranch_scc1 L_ofF_4
  s_sub_u32 s5, s5, s13
  v_readfirstlane_b32 s12, v13
  s_min_u32 s12, s12, 32
  s_sub_u32 s13, 32, s12
  s_cmp_lt_u32 s5, s13
  s_nop 1
  s_cbranch_scc1 L_ofF_5
  s_sub_u32 s5, s5, s13
  v_readfirstlane_b32 s12, v14
  s_min_u32 s12, s12, 32
  s_sub_u32 s13, 32, s12
  s_cmp_lt_u32 s5, s13
  s_nop 1
  s_cbranch_scc1 L_ofF_6
  s_sub_u32 s5, s5, s13
  v_readfirstlane_b32 s12, v15
  s_min_u32 s12, s12, 32
  s_sub_u32 s13, 32, s12
  s_cmp_lt_u32 s5, s13
  s_nop 1
  s_cbranch_scc1 L_ofF_7
  s_sub_u32 s5, s5, s13
  s_branch L_gotF
L_ofF_0:
  s_add_u32 s4, s12, s5
  s_add_u32 s4, s4, 0
  s_branch L_gotF
L_ofF_1:
  s_add_u32 s4, s12, s5
  s_add_u32 s4, s4, 32
  s_branch L_gotF
L_ofF_2:
  s_add_u32 s4, s12, s5
  s_add_u32 s4, s4, 64
  s_branch L_gotF
L_ofF_3:
  s_add_u32 s4, s12, s5
  s_add_u32 s4, s4, 96
  s_branch L_gotF
L_ofF_4:
  s_add_u32 s4, s12, s5
  s_add_u32 s4, s4, 128
  s_branch L_gotF
L_ofF_5:
  s_add_u32 s4, s12, s5
  s_add_u32 s4, s4, 160
  s_branch L_gotF
L_ofF_6:
  s_add_u32 s4, s12, s5
  s_add_u32 s4, s4, 192
  s_branch L_gotF
L_ofF_7:
  s_add_u32 s4, s12, s5
  s_add_u32 s4, s4, 224
  s_branch L_gotF
L_gotF:
  v_mov_b32 v3, 149504
  v_mov_b32 v5, s4
  ds_write_b32 v3, v5
  s_mov_b64 exec, -1
L_norankF:
  s_waitcnt lgkmcnt(0)
  s_barrier
  v_mov_b32 v3, 149504
  ds_read_b32 v5, v3
  s_waitcnt lgkmcnt(0)
  v_readfirstlane_b32 s16, v5
  s_barrier
  s_cmp_ge_u32 s16, 32
  s_nop 2
  s_cbranch_scc1 L_par
  s_mul_i32 s3, s16, 3584
  s_add_u32 s3, s3, 327680
  s_cmp_eq_u32 s17, 0
  s_cselect_b32 s3, s3, 0x7f000000
  v_lshlrev_b32 v2, 7, v0
  v_mov_b32 v3, 0x7fff0000
  v_cmp_gt_u32 vcc, 28, v0
  s_nop 1
  v_cndmask_b32 v2, v3, v2, vcc
  v_mov_b32 v3, 0
  buffer_store_dword v3, v2, s[8:11], s3 offen sc1
  v_and_b32 v32, 15, v0
  v_lshrrev_b32 v33, 4, v0
  v_bfe_u32 v34, v32, 1, 1
  v_mov_b32 v35, 0x4444
  v_mov_b32 v36, 0xeeee
  v_cmp_eq_u32 vcc, 1, v34
  s_nop 1
  v_cndmask_b32 v1, v35, v36, vcc
  v_and_b32 v34, 7, v32
  v_lshrrev_b32 v35, 1, v34
  v_and_b32 v36, 1, v32
  v_lshlrev_b32 v36, 4, v36
  v_mov_b32 v37, 0x3f80
  v_lshlrev_b32 v37, v36, v37
  v_mov_b32 v38, v37
  v_cmp_eq_u32 vcc, v35, v33
  s_nop 1
  v_cndmask_b32 v37, 0, v37, vcc
  v_cmp_gt_u32 vcc, 8, v32
  s_nop 1
  v_cndmask_b32 v2, 0, v37, vcc
  v_cndmask_b32 v3, 0, v37, vcc
  v_cndmask_b32 v4, v37, 0, vcc
  v_cndmask_b32 v5, v37, 0, vcc
  v_lshrrev_b32 v35, 1, v32
  v_cmp_eq_u32 vcc, 0, v35
  s_nop 1
  v_cndmask_b32 v6, 0, v38, vcc
  v_cmp_eq_u32 vcc, 1, v35
  s_nop 1
  v_cndmask_b32 v7, 0, v38, vcc
  v_cmp_eq_u32 vcc, 2, v35
  s_nop 1
  v_cndmask_b32 v8, 0, v38, vcc
  v_cmp_eq_u32 vcc, 3, v35
  s_nop 1
  v_cndmask_b32 v9, 0, v38, vcc
  v_mov_b32 v10, 0x3f803f80
  v_mov_b32 v11, 0x3f803f80
  v_mov_b32 v12, 0x3f803f80
  v_mov_b32 v13, 0x3f803f80
  v_lshlrev_b32 v18, 4, v0
  v_mov_b32 v15, 0x7fff0000
  v_cmp_eq_u32 vcc, 0, v0
  s_nop 1
  v_cndmask_b32 v15, v15, 0, vcc
  v_add_u32 v20, 131072, v18
  v_lshlrev_b32 v34, 13, v33
  v_lshrrev_b32 v35, 2, v32
  v_lshlrev_b32 v35, 11, v35
  v_and_b32 v36, 3, v32
  v_lshlrev_b32 v36, 4, v36
  v_add3_u32 v14, v34, v35, v36
  s_lshl_b32 s25, s17, 16
  s_lshl_b32 s26, s16, 6
  s_add_u32 s25, s25, s26
  s_add_u32 s32, s25, 0
  s_add_u32 s33, s32, 0x8000
  s_lshl_b32 s25, s16, 13
  s_lshl_b32 s26, s17, 11
  s_add_u32 s25, s25, s26
  s_add_u32 s34, s25, 0
  v_lshrrev_b32 v34, 2, v32
  v_lshlrev_b32 v34, 9, v34
  v_and_b32 v35, 1, v32
  v_lshlrev_b32 v35, 4, v35
  v_and_b32 v36, 1, v33
  v_lshlrev_b32 v36, 1, v36
  v_lshrrev_b32 v37, 1, v33
  v_or_b32 v36, v36, v37
  v_lshlrev_b32 v36, 2, v36
  v_add3_u32 v34, v34, v35, v36
  v_mov_b32 v35, 0x7fff0000
  v_and_b32 v36, 10, v32
  v_cmp_eq_u32 vcc, 0, v36
  s_nop 1
  v_cndmask_b32 v16, v35, v34, vcc
  s_lshr_b32 s25, s16, 2
  s_lshl_b32 s25, s25, 10
  s_and_b32 s26, s16, 3
  s_lshl_b32 s26, s26, 6
  s_add_u32 s25, s25, s26
  s_lshr_b32 s26, s17, 1
  s_lshl_b32 s26, s26, 8
  s_add_u32 s25, s25, s26
  s_and_b32 s26, s17, 1
  s_lshl_b32 s26, s26, 5
  s_add_u32 s25, s25, s26
  s_add_u32 s35, s25, 262144
  v_lshrrev_b32 v34, 2, v32
  v_lshlrev_b32 v34, 1, v34
  v_and_b32 v35, 1, v32
  v_add_u32 v40, v34, v35
  v_bfe_u32 v41, v32, 1, 1
  s_lshl_b32 s25, s17, 11
  s_add_u32 s36, s25, 262144
  s_lshl_b32 s25, s17, 11
  v_add_u32 v19, s25, v20
  v_and_b32 v42, 7, v32
  v_and_b32 v43, 1, v42
  v_bfe_u32 v44, v42, 2, 1
  v_lshlrev_b32 v45, 1, v44
  v_or_b32 v43, v43, v45
  v_bfe_u32 v45, v42, 1, 1
  v_xor_b32 v44, v44, v45
  v_lshlrev_b32 v44, 2, v44
  v_or_b32 v43, v43, v44
  s_lshl_b32 s25, s17, 10
  s_add_u32 s25, s25, 139264
  v_lshlrev_b32 v44, 1, v33
  v_lshrrev_b32 v45, 3, v32
  v_add_u32 v44, v44, v45
  v_xor_b32 v44, v44, v43
  v_lshlrev_b32 v44, 4, v44
  v_lshlrev_b32 v45, 7, v42
  v_add3_u32 v21, v44, v45, s25
  v_add_u32 v46, 147456, v18
  v_cmp_gt_u32 vcc, 8, v32
  s_lshl_b32 s25, s17, 8
  s_add_u32 s25, s25, 143328
  v_lshlrev_b32 v44, 5, v42
  v_lshlrev_b32 v45, 4, v33
  v_add3_u32 v44, v44, v45, s25
  v_cmp_lt_u32 s[56:57], 1, v33
  s_nop 1
  s_and_b64 vcc, vcc, s[56:57]
  v_cndmask_b32 v23, v46, v44, vcc
  v_and_b32 v43, 1, v40
  v_bfe_u32 v44, v40, 2, 1
  v_lshlrev_b32 v45, 1, v44
  v_or_b32 v43, v43, v45
  v_bfe_u32 v45, v40, 1, 1
  v_xor_b32 v44, v44, v45
  v_lshlrev_b32 v44, 2, v44
  v_or_b32 v43, v43, v44
  v_lshlrev_b32 v44, 1, v33
  v_add_u32 v44, v44, v41
  v_xor_b32 v45, v44, v43
  v_lshlrev_b32 v45, 4, v45
  v_lshlrev_b32 v47, 7, v40
  v_add_u32 v45, v45, v47
  v_add_u32 v24, 139264, v45
  v_lshlrev_b32 v44, 2, v44
  v_lshlrev_b32 v47, 5, v40
  v_add_u32 v44, v44, v47
  v_add_u32 v25, 143360, v44
  s_lshr_b32 s25, s17, 1
  s_lshl_b32 s25, s25, 10
  s_and_b32 s26, s17, 1
  s_lshl_b32 s26, s26, 9
  s_add_u32 s25, s25, s26
  s_add_u32 s25, s25, 145408
  v_lshrrev_b32 v34, 1, v33
  v_lshlrev_b32 v34, 8, v34
  v_and_b32 v35, 1, v33
  v_lshlrev_b32 v35, 1, v35
  v_or_b32 v35, v35, v32
  v_lshlrev_b32 v35, 4, v35
  v_add3_u32 v34, v34, v35, s25
  v_cmp_eq_u32 vcc, 0, v41
  s_nop 1
  v_cndmask_b32 v26, v46, v34, vcc
  v_and_b32 v34, 7, v32
  v_lshlrev_b32 v34, 6, v34
  v_lshlrev_b32 v35, 4, v33
  v_add_u32 v34, v34, v35
  v_mov_b32 v35, 0x7fff0000
  v_cmp_lt_u32 vcc, 7, v32
  s_nop 1
  v_cndmask_b32 v29, v35, v34, vcc
  v_and_b32 v60, 15, v0
  v_lshrrev_b32 v61, 4, v0
  v_and_b32 v62, 1, v61
  v_lshlrev_b32 v63, 4, v62
  v_lshrrev_b32 v64, 5, v0
  v_add_u32 v63, v63, v64
  v_lshlrev_b32 v63, 13, v63
  s_lshl_b32 s25, s16, 8
  v_add_u32 v63, s25, v63
  v_lshlrev_b32 v62, 1, v62
  v_xor_b32 v62, v60, v62
  v_xor_b32 v64, 0, v62
  v_lshlrev_b32 v64, 4, v64
  v_add_u32 v32, v63, v64
  v_xor_b32 v64, 4, v62
  v_lshlrev_b32 v64, 4, v64
  v_add_u32 v33, v63, v64
  v_xor_b32 v64, 8, v62
  v_lshlrev_b32 v64, 4, v64
  v_add_u32 v34, v63, v64
  v_xor_b32 v64, 12, v62
  v_lshlrev_b32 v64, 4, v64
  v_add_u32 v35, v63, v64
  v_lshlrev_b32 v63, 10, v61
  s_lshl_b32 s25, s16, 17
  s_lshl_b32 s26, s17, 8
  s_add_u32 s25, s25, s26
  v_add_u32 v63, s25, v63
  v_xor_b32 v64, 0, v62
  v_lshlrev_b32 v64, 4, v64
  v_add_u32 v36, v63, v64
  v_xor_b32 v64, 4, v62
  v_lshlrev_b32 v64, 4, v64
  v_add_u32 v37, v63, v64
  v_xor_b32 v64, 8, v62
  v_lshlrev_b32 v64, 4, v64
  v_add_u32 v38, v63, v64
  v_xor_b32 v64, 12, v62
  v_lshlrev_b32 v64, 4, v64
  v_add_u32 v39, v63, v64
  v_bfe_u32 v64, v0, 2, 2
  v_and_b32 v65, 3, v0
  v_and_b32 v66, 1, v64
  v_lshrrev_b32 v67, 1, v64
  v_lshrrev_b32 v68, 1, v61
  v_and_b32 v69, 1, v61
  v_lshlrev_b32 v70, 4, v68
  v_lshlrev_b32 v71, 2, v69
  v_add_u32 v70, v70, v71
  v_lshlrev_b32 v71, 3, v67
  v_add3_u32 v70, v70, v71, v66
  v_lshlrev_b32 v70, 8, v70
  v_lshlrev_b32 v71, 1, v69
  v_lshlrev_b32 v72, 2, v67
  v_or3_b32 v71, v66, v71, v72
  v_lshlrev_b32 v71, 1, v71
  s_lshl_b32 s25, s17, 2
  v_lshrrev_b32 v72, 1, v65
  v_add_u32 v72, s25, v72
  v_and_b32 v73, 1, v65
  v_lshlrev_b32 v73, 3, v73
  v_add_u32 v70, v70, v73
  v_xor_b32 v74, v72, v71
  v_lshlrev_b32 v74, 4, v74
  v_add_u32 v40, v70, v74
  v_add_u32 v72, 2, v72
  v_xor_b32 v74, v72, v71
  v_lshlrev_b32 v74, 4, v74
  v_add_u32 v41, v70, v74
  v_add_u32 v42, 0x10000, v40
  v_add_u32 v43, 0x10000, v41
  v_lshlrev_b32 v70, 3, v68
  v_lshlrev_b32 v71, 4, v69
  v_add_u32 v70, v70, v71
  v_lshlrev_b32 v71, 2, v67
  v_add3_u32 v70, v70, v71, v66
  v_lshlrev_b32 v70, 8, v70
  v_add_u32 v70, v70, v73
  s_lshl_b32 s25, s17, 14
  v_add_u32 v70, s25, v70
  v_lshlrev_b32 v71, 1, v67
  v_lshlrev_b32 v72, 2, v69
  v_or3_b32 v71, v66, v71, v72
  v_lshlrev_b32 v71, 1, v71
  v_lshrrev_b32 v72, 1, v65
  v_add_u32 v74, 0, v72
  v_xor_b32 v74, v74, v71
  v_lshlrev_b32 v74, 4, v74
  v_add_u32 v44, v70, v74
  v_add_u32 v52, 0x10000, v44
  v_add_u32 v74, 2, v72
  v_xor_b32 v74, v74, v71
  v_lshlrev_b32 v74, 4, v74
  v_add_u32 v45, v70, v74
  v_add_u32 v53, 0x10000, v45
  v_add_u32 v74, 4, v72
  v_xor_b32 v74, v74, v71
  v_lshlrev_b32 v74, 4, v74
  v_add_u32 v46, v70, v74
  v_add_u32 v54, 0x10000, v46
  v_add_u32 v74, 6, v72
  v_xor_b32 v74, v74, v71
  v_lshlrev_b32 v74, 4, v74
  v_add_u32 v47, v70, v74
  v_add_u32 v55, 0x10000, v47
  v_add_u32 v74, 8, v72
  v_xor_b32 v74, v74, v71
  v_lshlrev_b32 v74, 4, v74
  v_add_u32 v48, v70, v74
  v_add_u32 v56, 0x10000, v48
  v_add_u32 v74, 10, v72
  v_xor_b32 v74, v74, v71
  v_lshlrev_b32 v74, 4, v74
  v_add_u32 v49, v70, v74
  v_add_u32 v57, 0x10000, v49
  v_add_u32 v74, 12, v72
  v_xor_b32 v74, v74, v71
  v_lshlrev_b32 v74, 4, v74
  v_add_u32 v50, v70, v74
  v_add_u32 v58, 0x10000, v50
  v_add_u32 v74, 14, v72
  v_xor_b32 v74, v74, v71
  v_lshlrev_b32 v74, 4, v74
  v_add_u32 v51, v70, v74
  v_add_u32 v59, 0x10000, v51
  v_mov_b64 v[96:97], 0
  v_mov_b64 v[98:99], 0
  buffer_store_dwordx4 v[96:99], v18, s[8:11], s34 offen sc1
  buffer_store_dwordx4 v[96:99], v18, s[8:11], s34 offen offset:1024 sc1
  s_load_dwordx2 s[72:73], s[0:1], 56
  s_mov_b32 s74, 8192
  s_mov_b32 s75, 0x20000
  v_and_b32 v100, 15, v0
  v_lshrrev_b32 v101, 4, v0
  v_and_b32 v102, 1, v100
  v_lshlrev_b32 v102, 10, v102
  v_lshrrev_b32 v103, 1, v100
  v_lshlrev_b32 v103, 5, v103
  v_and_b32 v104, 1, v101
  v_lshlrev_b32 v104, 1, v104
  v_lshrrev_b32 v101, 1, v101
  v_or_b32 v104, v104, v101
  v_lshlrev_b32 v104, 1, v104
  v_add3_u32 v102, v102, v103, v104
  s_lshr_b32 s76, s16, 2
  s_lshl_b32 s76, s76, 7
  s_and_b32 s77, s16, 3
  s_lshl_b32 s77, s77, 11
  s_add_u32 s76, s76, s77
  s_lshl_b32 s77, s17, 3
  s_add_u32 s76, s76, s77
  v_and_b32 v102, 0xfff, v102
  s_waitcnt lgkmcnt(0)
  buffer_load_ushort v105, v102, s[72:75], s76 offen
  buffer_load_ushort v106, v102, s[72:75], s76 offen offset:32
  v_mov_b32 v107, -1
  s_add_u32 s76, s35, 8192
  s_add_u32 s77, s35, 16384
  buffer_store_dword v107, v16, s[8:11], s76 offen sc1
  buffer_store_dword v107, v16, s[8:11], s77 offen sc1
  s_load_dwordx2 s[12:13], s[0:1], 64
  s_waitcnt lgkmcnt(0)
  s_mov_b32 s14, 0x400000
  s_mov_b32 s15, 0x20000
  s_lshl_b32 s26, s17, 14
  s_lshl_b32 s27, s17, 19
  s_add_u32 s25, s27, 0
  s_add_u32 m0, s26, 0
  s_nop 0
  buffer_load_dwordx4 v32, s[12:15], s25 offen lds
  s_add_u32 s25, s27, 16384
  s_add_u32 m0, s26, 1024
  s_nop 0
  buffer_load_dwordx4 v33, s[12:15], s25 offen lds
  s_add_u32 s25, s27, 32768
  s_add_u32 m0, s26, 2048
  s_nop 0
  buffer_load_dwordx4 v34, s[12:15], s25 offen lds
  s_add_u32 s25, s27, 49152
  s_add_u32 m0, s26, 3072
  s_nop 0
  buffer_load_dwordx4 v35, s[12:15], s25 offen lds
  s_add_u32 s25, s27, 65536
  s_add_u32 m0, s26, 4096
  s_nop 0
  buffer_load_dwordx4 v32, s[12:15], s25 offen lds
  s_add_u32 s25, s27, 81920
  s_add_u32 m0, s26, 5120
  s_nop 0
  buffer_load_dwordx4 v33, s[12:15], s25 offen lds
  s_add_u32 s25, s27, 98304
  s_add_u32 m0, s26, 6144
  s_nop 0
  buffer_load_dwordx4 v34, s[12:15], s25 offen lds
  s_add_u32 s25, s27, 114688
  s_add_u32 m0, s26, 7168
  s_nop 0
  buffer_load_dwordx4 v35, s[12:15], s25 offen lds
  s_add_u32 s25, s27, 262144
  s_add_u32 m0, s26, 8192
  s_nop 0
  buffer_load_dwordx4 v32, s[12:15], s25 offen lds
  s_add_u32 s25, s27, 278528
  s_add_u32 m0, s26, 9216
  s_nop 0
  buffer_load_dwordx4 v33, s[12:15], s25 offen lds
  s_add_u32 s25, s27, 294912
  s_add_u32 m0, s26, 10240
  s_nop 0
  buffer_load_dwordx4 v34, s[12:15], s25 offen lds
  s_add_u32 s25, s27, 311296
  s_add_u32 m0, s26, 11264
  s_nop 0
  buffer_load_dwordx4 v35, s[12:15], s25 offen lds
  s_add_u32 s25, s27, 327680
  s_add_u32 m0, s26, 12288
  s_nop 0
  buffer_load_dwordx4 v32, s[12:15], s25 offen lds
  s_add_u32 s25, s27, 344064
  s_add_u32 m0, s26, 13312
  s_nop 0
  buffer_load_dwordx4 v33, s[12:15], s25 offen lds
  s_add_u32 s25, s27, 360448
  s_add_u32 m0, s26, 14336
  s_nop 0
  buffer_load_dwordx4 v34, s[12:15], s25 offen lds
  s_add_u32 s25, s27, 376832
  s_add_u32 m0, s26, 15360
  s_nop 0
  buffer_load_dwordx4 v35, s[12:15], s25 offen lds
  s_lshl_b32 s26, s17, 14
  s_lshl_b32 s27, s17, 19
  s_add_u32 s25, s27, 2097152
  s_add_u32 m0, s26, 65536
  s_nop 0
  buffer_load_dwordx4 v32, s[12:15], s25 offen lds
  s_add_u32 s25, s27, 2113536
  s_add_u32 m0, s26, 66560
  s_nop 0
  buffer_load_dwordx4 v33, s[12:15], s25 offen lds
  s_add_u32 s25, s27, 2129920
  s_add_u32 m0, s26, 67584
  s_nop 0
  buffer_load_dwordx4 v34, s[12:15], s25 offen lds
  s_add_u32 s25, s27, 2146304
  s_add_u32 m0, s26, 68608
  s_nop 0
  buffer_load_dwordx4 v35, s[12:15], s25 offen lds
  s_add_u32 s25, s27, 2162688
  s_add_u32 m0, s26, 69632
  s_nop 0
  buffer_load_dwordx4 v32, s[12:15], s25 offen lds
  s_add_u32 s25, s27, 2179072
  s_add_u32 m0, s26, 70656
  s_nop 0
  buffer_load_dwordx4 v33, s[12:15], s25 offen lds
  s_add_u32 s25, s27, 2195456
  s_add_u32 m0, s26, 71680
  s_nop 0
  buffer_load_dwordx4 v34, s[12:15], s25 offen lds
  s_add_u32 s25, s27, 2211840
  s_add_u32 m0, s26, 72704
  s_nop 0
  buffer_load_dwordx4 v35, s[12:15], s25 offen lds
  s_add_u32 s25, s27, 2359296
  s_add_u32 m0, s26, 73728
  s_nop 0
  buffer_load_dwordx4 v32, s[12:15], s25 offen lds
  s_add_u32 s25, s27, 2375680
  s_add_u32 m0, s26, 74752
  s_nop 0
  buffer_load_dwordx4 v33, s[12:15], s25 offen lds
  s_add_u32 s25, s27, 2392064
  s_add_u32 m0, s26, 75776
  s_nop 0
  buffer_load_dwordx4 v34, s[12:15], s25 offen lds
  s_add_u32 s25, s27, 2408448
  s_add_u32 m0, s26, 76800
  s_nop 0
  buffer_load_dwordx4 v35, s[12:15], s25 offen lds
  s_add_u32 s25, s27, 2424832
  s_add_u32 m0, s26, 77824
  s_nop 0
  buffer_load_dwordx4 v32, s[12:15], s25 offen lds
  s_add_u32 s25, s27, 2441216
  s_add_u32 m0, s26, 78848
  s_nop 0
  buffer_load_dwordx4 v33, s[12:15], s25 offen lds
  s_add_u32 s25, s27, 2457600
  s_add_u32 m0, s26, 79872
  s_nop 0
  buffer_load_dwordx4 v34, s[12:15], s25 offen lds
  s_add_u32 s25, s27, 2473984
  s_add_u32 m0, s26, 80896
  s_nop 0
  buffer_load_dwordx4 v35, s[12:15], s25 offen lds
  s_waitcnt vmcnt(16)
  s_cmp_lg_u32 s17, 0
  s_cbranch_scc1 L_noinitarr
  v_mov_b32 v100, 16
  v_mov_b32 v101, 1
  s_mov_b64 exec, 1
  global_atomic_add v100, v101, s[6:7]
  s_mov_b64 exec, -1
L_noinitarr:
  s_barrier
  ds_read_b64_tr_b16 a[0:1], v40 offset:0
  ds_read_b64_tr_b16 a[2:3], v40 offset:512
  ds_read_b64_tr_b16 a[4:5], v40 offset:8192
  ds_read_b64_tr_b16 a[6:7], v40 offset:8704
  ds_read_b64_tr_b16 a[8:9], v40 offset:16384
  ds_read_b64_tr_b16 a[10:11], v40 offset:16896
  ds_read_b64_tr_b16 a[12:13], v40 offset:24576
  ds_read_b64_tr_b16 a[14:15], v40 offset:25088
  ds_read_b64_tr_b16 a[16:17], v40 offset:32768
  ds_read_b64_tr_b16 a[18:19], v40 offset:33280
  ds_read_b64_tr_b16 a[20:21], v40 offset:40960
  ds_read_b64_tr_b16 a[22:23], v40 offset:41472
  ds_read_b64_tr_b16 a[24:25], v40 offset:49152
  ds_read_b64_tr_b16 a[26:27], v40 offset:49664
  ds_read_b64_tr_b16 a[28:29], v40 offset:57344
  ds_read_b64_tr_b16 a[30:31], v40 offset:57856
  ds_read_b64_tr_b16 a[64:65], v41 offset:0
  ds_read_b64_tr_b16 a[66:67], v41 offset:512
  ds_read_b64_tr_b16 a[68:69], v41 offset:8192
  ds_read_b64_tr_b16 a[70:71], v41 offset:8704
  ds_read_b64_tr_b16 a[72:73], v41 offset:16384
  ds_read_b64_tr_b16 a[74:75], v41 offset:16896
  ds_read_b64_tr_b16 a[76:77], v41 offset:24576
  ds_read_b64_tr_b16 a[78:79], v41 offset:25088
  ds_read_b64_tr_b16 a[80:81], v41 offset:32768
  ds_read_b64_tr_b16 a[82:83], v41 offset:33280
  ds_read_b64_tr_b16 a[84:85], v41 offset:40960
  ds_read_b64_tr_b16 a[86:87], v41 offset:41472
  ds_read_b64_tr_b16 a[88:89], v41 offset:49152
  ds_read_b64_tr_b16 a[90:91], v41 offset:49664
  ds_read_b64_tr_b16 a[92:93], v41 offset:57344
  ds_read_b64_tr_b16 a[94:95], v41 offset:57856
  s_waitcnt lgkmcnt(0)
  s_barrier
  s_load_dwordx2 s[12:13], s[0:1], 72
  s_waitcnt lgkmcnt(0)
  s_mov_b32 s14, 0x400000
  s_mov_b32 s15, 0x20000
  s_lshl_b32 s26, s17, 14
  s_lshl_b32 s27, s17, 19
  s_add_u32 s25, s27, 0
  s_add_u32 m0, s26, 0
  s_nop 0
  buffer_load_dwordx4 v32, s[12:15], s25 offen lds
  s_add_u32 s25, s27, 16384
  s_add_u32 m0, s26, 1024
  s_nop 0
  buffer_load_dwordx4 v33, s[12:15], s25 offen lds
  s_add_u32 s25, s27, 32768
  s_add_u32 m0, s26, 2048
  s_nop 0
  buffer_load_dwordx4 v34, s[12:15], s25 offen lds
  s_add_u32 s25, s27, 49152
  s_add_u32 m0, s26, 3072
  s_nop 0
  buffer_load_dwordx4 v35, s[12:15], s25 offen lds
  s_add_u32 s25, s27, 65536
  s_add_u32 m0, s26, 4096
  s_nop 0
  buffer_load_dwordx4 v32, s[12:15], s25 offen lds
  s_add_u32 s25, s27, 81920
  s_add_u32 m0, s26, 5120
  s_nop 0
  buffer_load_dwordx4 v33, s[12:15], s25 offen lds
  s_add_u32 s25, s27, 98304
  s_add_u32 m0, s26, 6144
  s_nop 0
  buffer_load_dwordx4 v34, s[12:15], s25 offen lds
  s_add_u32 s25, s27, 114688
  s_add_u32 m0, s26, 7168
  s_nop 0
  buffer_load_dwordx4 v35, s[12:15], s25 offen lds
  s_add_u32 s25, s27, 262144
  s_add_u32 m0, s26, 8192
  s_nop 0
  buffer_load_dwordx4 v32, s[12:15], s25 offen lds
  s_add_u32 s25, s27, 278528
  s_add_u32 m0, s26, 9216
  s_nop 0
  buffer_load_dwordx4 v33, s[12:15], s25 offen lds
  s_add_u32 s25, s27, 294912
  s_add_u32 m0, s26, 10240
  s_nop 0
  buffer_load_dwordx4 v34, s[12:15], s25 offen lds
  s_add_u32 s25, s27, 311296
  s_add_u32 m0, s26, 11264
  s_nop 0
  buffer_load_dwordx4 v35, s[12:15], s25 offen lds
  s_add_u32 s25, s27, 327680
  s_add_u32 m0, s26, 12288
  s_nop 0
  buffer_load_dwordx4 v32, s[12:15], s25 offen lds
  s_add_u32 s25, s27, 344064
  s_add_u32 m0, s26, 13312
  s_nop 0
  buffer_load_dwordx4 v33, s[12:15], s25 offen lds
  s_add_u32 s25, s27, 360448
  s_add_u32 m0, s26, 14336
  s_nop 0
  buffer_load_dwordx4 v34, s[12:15], s25 offen lds
  s_add_u32 s25, s27, 376832
  s_add_u32 m0, s26, 15360
  s_nop 0
  buffer_load_dwordx4 v35, s[12:15], s25 offen lds
  s_waitcnt vmcnt(16)
  s_barrier
  ds_read_b64_tr_b16 a[32:33], v42 offset:0
  ds_read_b64_tr_b16 a[34:35], v42 offset:512
  ds_read_b64_tr_b16 a[36:37], v42 offset:8192
  ds_read_b64_tr_b16 a[38:39], v42 offset:8704
  ds_read_b64_tr_b16 a[40:41], v42 offset:16384
  ds_read_b64_tr_b16 a[42:43], v42 offset:16896
  ds_read_b64_tr_b16 a[44:45], v42 offset:24576
  ds_read_b64_tr_b16 a[46:47], v42 offset:25088
  ds_read_b64_tr_b16 a[48:49], v42 offset:32768
  ds_read_b64_tr_b16 a[50:51], v42 offset:33280
  ds_read_b64_tr_b16 a[52:53], v42 offset:40960
  ds_read_b64_tr_b16 a[54:55], v42 offset:41472
  ds_read_b64_tr_b16 a[56:57], v42 offset:49152
  ds_read_b64_tr_b16 a[58:59], v42 offset:49664
  ds_read_b64_tr_b16 a[60:61], v42 offset:57344
  ds_read_b64_tr_b16 a[62:63], v42 offset:57856
  ds_read_b64_tr_b16 a[96:97], v43 offset:0
  ds_read_b64_tr_b16 a[98:99], v43 offset:512
  ds_read_b64_tr_b16 a[100:101], v43 offset:8192
  ds_read_b64_tr_b16 a[102:103], v43 offset:8704
  ds_read_b64_tr_b16 a[104:105], v43 offset:16384
  ds_read_b64_tr_b16 a[106:107], v43 offset:16896
  ds_read_b64_tr_b16 a[108:109], v43 offset:24576
  ds_read_b64_tr_b16 a[110:111], v43 offset:25088
  ds_read_b64_tr_b16 a[112:113], v43 offset:32768
  ds_read_b64_tr_b16 a[114:115], v43 offset:33280
  ds_read_b64_tr_b16 a[116:117], v43 offset:40960
  ds_read_b64_tr_b16 a[118:119], v43 offset:41472
  ds_read_b64_tr_b16 a[120:121], v43 offset:49152
  ds_read_b64_tr_b16 a[122:123], v43 offset:49664
  ds_read_b64_tr_b16 a[124:125], v43 offset:57344
  ds_read_b64_tr_b16 a[126:127], v43 offset:57856
  s_waitcnt lgkmcnt(0)
  s_barrier
  s_lshl_b32 s26, s17, 14
  s_lshl_b32 s27, s17, 19
  s_add_u32 s25, s27, 2097152
  s_add_u32 m0, s26, 65536
  s_nop 0
  buffer_load_dwordx4 v32, s[12:15], s25 offen lds
  s_add_u32 s25, s27, 2113536
  s_add_u32 m0, s26, 66560
  s_nop 0
  buffer_load_dwordx4 v33, s[12:15], s25 offen lds
  s_add_u32 s25, s27, 2129920
  s_add_u32 m0, s26, 67584
  s_nop 0
  buffer_load_dwordx4 v34, s[12:15], s25 offen lds
  s_add_u32 s25, s27, 2146304
  s_add_u32 m0, s26, 68608
  s_nop 0
  buffer_load_dwordx4 v35, s[12:15], s25 offen lds
  s_add_u32 s25, s27, 2162688
  s_add_u32 m0, s26, 69632
  s_nop 0
  buffer_load_dwordx4 v32, s[12:15], s25 offen lds
  s_add_u32 s25, s27, 2179072
  s_add_u32 m0, s26, 70656
  s_nop 0
  buffer_load_dwordx4 v33, s[12:15], s25 offen lds
  s_add_u32 s25, s27, 2195456
  s_add_u32 m0, s26, 71680
  s_nop 0
  buffer_load_dwordx4 v34, s[12:15], s25 offen lds
  s_add_u32 s25, s27, 2211840
  s_add_u32 m0, s26, 72704
  s_nop 0
  buffer_load_dwordx4 v35, s[12:15], s25 offen lds
  s_add_u32 s25, s27, 2359296
  s_add_u32 m0, s26, 73728
  s_nop 0
  buffer_load_dwordx4 v32, s[12:15], s25 offen lds
  s_add_u32 s25, s27, 2375680
  s_add_u32 m0, s26, 74752
  s_nop 0
  buffer_load_dwordx4 v33, s[12:15], s25 offen lds
  s_add_u32 s25, s27, 2392064
  s_add_u32 m0, s26, 75776
  s_nop 0
  buffer_load_dwordx4 v34, s[12:15], s25 offen lds
  s_add_u32 s25, s27, 2408448
  s_add_u32 m0, s26, 76800
  s_nop 0
  buffer_load_dwordx4 v35, s[12:15], s25 offen lds
  s_add_u32 s25, s27, 2424832
  s_add_u32 m0, s26, 77824
  s_nop 0
  buffer_load_dwordx4 v32, s[12:15], s25 offen lds
  s_add_u32 s25, s27, 2441216
  s_add_u32 m0, s26, 78848
  s_nop 0
  buffer_load_dwordx4 v33, s[12:15], s25 offen lds
  s_add_u32 s25, s27, 2457600
  s_add_u32 m0, s26, 79872
  s_nop 0
  buffer_load_dwordx4 v34, s[12:15], s25 offen lds
  s_add_u32 s25, s27, 2473984
  s_add_u32 m0, s26, 80896
  s_nop 0
  buffer_load_dwordx4 v35, s[12:15], s25 offen lds
  s_waitcnt vmcnt(16)
  s_barrier
  ds_read_b64_tr_b16 a[128:129], v40 offset:0
  ds_read_b64_tr_b16 a[130:131], v40 offset:512
  ds_read_b64_tr_b16 a[132:133], v40 offset:8192
  ds_read_b64_tr_b16 a[134:135], v40 offset:8704
  ds_read_b64_tr_b16 a[136:137], v40 offset:16384
  ds_read_b64_tr_b16 a[138:139], v40 offset:16896
  ds_read_b64_tr_b16 a[140:141], v40 offset:24576
  ds_read_b64_tr_b16 a[142:143], v40 offset:25088
  ds_read_b64_tr_b16 a[144:145], v40 offset:32768
  ds_read_b64_tr_b16 a[146:147], v40 offset:33280
  ds_read_b64_tr_b16 a[148:149], v40 offset:40960
  ds_read_b64_tr_b16 a[150:151], v40 offset:41472
  ds_read_b64_tr_b16 a[152:153], v40 offset:49152
  ds_read_b64_tr_b16 a[154:155], v40 offset:49664
  ds_read_b64_tr_b16 a[156:157], v40 offset:57344
  ds_read_b64_tr_b16 a[158:159], v40 offset:57856
  ds_read_b64_tr_b16 a[192:193], v41 offset:0
  ds_read_b64_tr_b16 a[194:195], v41 offset:512
  ds_read_b64_tr_b16 a[196:197], v41 offset:8192
  ds_read_b64_tr_b16 a[198:199], v41 offset:8704
  ds_read_b64_tr_b16 a[200:201], v41 offset:16384
  ds_read_b64_tr_b16 a[202:203], v41 offset:16896
  ds_read_b64_tr_b16 a[204:205], v41 offset:24576
  ds_read_b64_tr_b16 a[206:207], v41 offset:25088
  ds_read_b64_tr_b16 a[208:209], v41 offset:32768
  ds_read_b64_tr_b16 a[210:211], v41 offset:33280
  ds_read_b64_tr_b16 a[212:213], v41 offset:40960
  ds_read_b64_tr_b16 a[214:215], v41 offset:41472
  ds_read_b64_tr_b16 a[216:217], v41 offset:49152
  ds_read_b64_tr_b16 a[218:219], v41 offset:49664
  ds_read_b64_tr_b16 a[220:221], v41 offset:57344
  ds_read_b64_tr_b16 a[222:223], v41 offset:57856
  s_waitcnt lgkmcnt(0)
  s_barrier
  v_lshlrev_b32 v106, 16, v106
  v_or_b32 v105, v105, v106
  v_min_u32 v105, -2, v105
  buffer_store_dword v105, v16, s[8:11], s35 offen sc1
  s_load_dwordx2 s[12:13], s[0:1], 88
  s_waitcnt lgkmcnt(0)
  s_mov_b32 s14, 0x400000
  s_mov_b32 s15, 0x20000
  s_lshl_b32 s26, s17, 14
  s_mov_b32 s25, 0
  s_add_u32 m0, s26, 0
  s_nop 0
  buffer_load_dwordx4 v36, s[12:15], s25 offen lds
  s_mov_b32 s25, 4096
  s_add_u32 m0, s26, 1024
  s_nop 0
  buffer_load_dwordx4 v37, s[12:15], s25 offen lds
  s_mov_b32 s25, 8192
  s_add_u32 m0, s26, 2048
  s_nop 0
  buffer_load_dwordx4 v36, s[12:15], s25 offen lds
  s_mov_b32 s25, 12288
  s_add_u32 m0, s26, 3072
  s_nop 0
  buffer_load_dwordx4 v37, s[12:15], s25 offen lds
  s_mov_b32 s25, 16384
  s_add_u32 m0, s26, 4096
  s_nop 0
  buffer_load_dwordx4 v38, s[12:15], s25 offen lds
  s_mov_b32 s25, 20480
  s_add_u32 m0, s26, 5120
  s_nop 0
  buffer_load_dwordx4 v39, s[12:15], s25 offen lds
  s_mov_b32 s25, 24576
  s_add_u32 m0, s26, 6144
  s_nop 0
  buffer_load_dwordx4 v38, s[12:15], s25 offen lds
  s_mov_b32 s25, 28672
  s_add_u32 m0, s26, 7168
  s_nop 0
  buffer_load_dwordx4 v39, s[12:15], s25 offen lds
  s_mov_b32 s25, 32768
  s_add_u32 m0, s26, 8192
  s_nop 0
  buffer_load_dwordx4 v36, s[12:15], s25 offen lds
  s_mov_b32 s25, 36864
  s_add_u32 m0, s26, 9216
  s_nop 0
  buffer_load_dwordx4 v37, s[12:15], s25 offen lds
  s_mov_b32 s25, 40960
  s_add_u32 m0, s26, 10240
  s_nop 0
  buffer_load_dwordx4 v36, s[12:15], s25 offen lds
  s_mov_b32 s25, 45056
  s_add_u32 m0, s26, 11264
  s_nop 0
  buffer_load_dwordx4 v37, s[12:15], s25 offen lds
  s_mov_b32 s25, 49152
  s_add_u32 m0, s26, 12288
  s_nop 0
  buffer_load_dwordx4 v38, s[12:15], s25 offen lds
  s_mov_b32 s25, 53248
  s_add_u32 m0, s26, 13312
  s_nop 0
  buffer_load_dwordx4 v39, s[12:15], s25 offen lds
  s_mov_b32 s25, 57344
  s_add_u32 m0, s26, 14336
  s_nop 0
  buffer_load_dwordx4 v38, s[12:15], s25 offen lds
  s_mov_b32 s25, 61440
  s_add_u32 m0, s26, 15360
  s_nop 0
  buffer_load_dwordx4 v39, s[12:15], s25 offen lds
  s_waitcnt vmcnt(17)
  s_barrier
  ds_read_b64_tr_b16 a[160:161], v42 offset:0
  ds_read_b64_tr_b16 a[162:163], v42 offset:512
  ds_read_b64_tr_b16 a[164:165], v42 offset:8192
  ds_read_b64_tr_b16 a[166:167], v42 offset:8704
  ds_read_b64_tr_b16 a[168:169], v42 offset:16384
  ds_read_b64_tr_b16 a[170:171], v42 offset:16896
  ds_read_b64_tr_b16 a[172:173], v42 offset:24576
  ds_read_b64_tr_b16 a[174:175], v42 offset:25088
  ds_read_b64_tr_b16 a[176:177], v42 offset:32768
  ds_read_b64_tr_b16 a[178:179], v42 offset:33280
  ds_read_b64_tr_b16 a[180:181], v42 offset:40960
  ds_read_b64_tr_b16 a[182:183], v42 offset:41472
  ds_read_b64_tr_b16 a[184:185], v42 offset:49152
  ds_read_b64_tr_b16 a[186:187], v42 offset:49664
  ds_read_b64_tr_b16 a[188:189], v42 offset:57344
  ds_read_b64_tr_b16 a[190:191], v42 offset:57856
  ds_read_b64_tr_b16 a[224:225], v43 offset:0
  ds_read_b64_tr_b16 a[226:227], v43 offset:512
  ds_read_b64_tr_b16 a[228:229], v43 offset:8192
  ds_read_b64_tr_b16 a[230:231], v43 offset:8704
  ds_read_b64_tr_b16 a[232:233], v43 offset:16384
  ds_read_b64_tr_b16 a[234:235], v43 offset:16896
  ds_read_b64_tr_b16 a[236:237], v43 offset:24576
  ds_read_b64_tr_b16 a[238:239], v43 offset:25088
  ds_read_b64_tr_b16 a[240:241], v43 offset:32768
  ds_read_b64_tr_b16 a[242:243], v43 offset:33280
  ds_read_b64_tr_b16 a[244:245], v43 offset:40960
  ds_read_b64_tr_b16 a[246:247], v43 offset:41472
  ds_read_b64_tr_b16 a[248:249], v43 offset:49152
  ds_read_b64_tr_b16 a[250:251], v43 offset:49664
  ds_read_b64_tr_b16 a[252:253], v43 offset:57344
  ds_read_b64_tr_b16 a[254:255], v43 offset:57856
  s_waitcnt lgkmcnt(0)
  s_barrier
  s_lshl_b32 s26, s17, 14
  s_mov_b32 s25, 65536
  s_add_u32 m0, s26, 65536
  s_nop 0
  buffer_load_dwordx4 v36, s[12:15], s25 offen lds
  s_mov_b32 s25, 69632
  s_add_u32 m0, s26, 66560
  s_nop 0
  buffer_load_dwordx4 v37, s[12:15], s25 offen lds
  s_mov_b32 s25, 73728
  s_add_u32 m0, s26, 67584
  s_nop 0
  buffer_load_dwordx4 v36, s[12:15], s25 offen lds
  s_mov_b32 s25, 77824
  s_add_u32 m0, s26, 68608
  s_nop 0
  buffer_load_dwordx4 v37, s[12:15], s25 offen lds
  s_mov_b32 s25, 81920
  s_add_u32 m0, s26, 69632
  s_nop 0
  buffer_load_dwordx4 v38, s[12:15], s25 offen lds
  s_mov_b32 s25, 86016
  s_add_u32 m0, s26, 70656
  s_nop 0
  buffer_load_dwordx4 v39, s[12:15], s25 offen lds
  s_mov_b32 s25, 90112
  s_add_u32 m0, s26, 71680
  s_nop 0
  buffer_load_dwordx4 v38, s[12:15], s25 offen lds
  s_mov_b32 s25, 94208
  s_add_u32 m0, s26, 72704
  s_nop 0
  buffer_load_dwordx4 v39, s[12:15], s25 offen lds
  s_mov_b32 s25, 98304
  s_add_u32 m0, s26, 73728
  s_nop 0
  buffer_load_dwordx4 v36, s[12:15], s25 offen lds
  s_mov_b32 s25, 102400
  s_add_u32 m0, s26, 74752
  s_nop 0
  buffer_load_dwordx4 v37, s[12:15], s25 offen lds
  s_mov_b32 s25, 106496
  s_add_u32 m0, s26, 75776
  s_nop 0
  buffer_load_dwordx4 v36, s[12:15], s25 offen lds
  s_mov_b32 s25, 110592
  s_add_u32 m0, s26, 76800
  s_nop 0
  buffer_load_dwordx4 v37, s[12:15], s25 offen lds
  s_mov_b32 s25, 114688
  s_add_u32 m0, s26, 77824
  s_nop 0
  buffer_load_dwordx4 v38, s[12:15], s25 offen lds
  s_mov_b32 s25, 118784
  s_add_u32 m0, s26, 78848
  s_nop 0
  buffer_load_dwordx4 v39, s[12:15], s25 offen lds
  s_mov_b32 s25, 122880
  s_add_u32 m0, s26, 79872
  s_nop 0
  buffer_load_dwordx4 v38, s[12:15], s25 offen lds
  s_mov_b32 s25, 126976
  s_add_u32 m0, s26, 80896
  s_nop 0
  buffer_load_dwordx4 v39, s[12:15], s25 offen lds
  s_waitcnt vmcnt(16)
  s_barrier
  s_cmp_lg_u32 s17, 0
  s_cbranch_scc1 L_noarrR
  v_mov_b32 v100, 4
  v_mov_b32 v101, 1
  s_mov_b64 exec, 1
  global_atomic_add v100, v101, s[6:7]
  s_mov_b64 exec, -1
L_noarrR:
  ds_read_b64_tr_b16 v[128:129], v44 offset:0
  ds_read_b64_tr_b16 v[130:131], v44 offset:512
  ds_read_b64_tr_b16 v[132:133], v44 offset:8192
  ds_read_b64_tr_b16 v[134:135], v44 offset:8704
  ds_read_b64_tr_b16 v[144:145], v45 offset:0
  ds_read_b64_tr_b16 v[146:147], v45 offset:512
  ds_read_b64_tr_b16 v[148:149], v45 offset:8192
  ds_read_b64_tr_b16 v[150:151], v45 offset:8704
  ds_read_b64_tr_b16 v[160:161], v46 offset:0
  ds_read_b64_tr_b16 v[162:163], v46 offset:512
  ds_read_b64_tr_b16 v[164:165], v46 offset:8192
  ds_read_b64_tr_b16 v[166:167], v46 offset:8704
  ds_read_b64_tr_b16 v[176:177], v47 offset:0
  ds_read_b64_tr_b16 v[178:179], v47 offset:512
  ds_read_b64_tr_b16 v[180:181], v47 offset:8192
  ds_read_b64_tr_b16 v[182:183], v47 offset:8704
  ds_read_b64_tr_b16 v[192:193], v48 offset:0
  ds_read_b64_tr_b16 v[194:195], v48 offset:512
  ds_read_b64_tr_b16 v[196:197], v48 offset:8192
  ds_read_b64_tr_b16 v[198:199], v48 offset:8704
  ds_read_b64_tr_b16 v[208:209], v49 offset:0
  ds_read_b64_tr_b16 v[210:211], v49 offset:512
  ds_read_b64_tr_b16 v[212:213], v49 offset:8192
  ds_read_b64_tr_b16 v[214:215], v49 offset:8704
  ds_read_b64_tr_b16 v[224:225], v50 offset:0
  ds_read_b64_tr_b16 v[226:227], v50 offset:512
  ds_read_b64_tr_b16 v[228:229], v50 offset:8192
  ds_read_b64_tr_b16 v[230:231], v50 offset:8704
  ds_read_b64_tr_b16 v[240:241], v51 offset:0
  ds_read_b64_tr_b16 v[242:243], v51 offset:512
  ds_read_b64_tr_b16 v[244:245], v51 offset:8192
  ds_read_b64_tr_b16 v[246:247], v51 offset:8704
  s_waitcnt lgkmcnt(0)
  s_barrier
  s_load_dwordx2 s[12:13], s[0:1], 80
  s_waitcnt lgkmcnt(0)
  s_mov_b32 s14, 0x400000
  s_mov_b32 s15, 0x20000
  s_lshl_b32 s26, s17, 14
  s_lshl_b32 s27, s17, 19
  s_add_u32 s25, s27, 0
  s_add_u32 m0, s26, 0
  s_nop 0
  buffer_load_dwordx4 v32, s[12:15], s25 offen lds
  s_add_u32 s25, s27, 16384
  s_add_u32 m0, s26, 1024
  s_nop 0
  buffer_load_dwordx4 v33, s[12:15], s25 offen lds
  s_add_u32 s25, s27, 32768
  s_add_u32 m0, s26, 2048
  s_nop 0
  buffer_load_dwordx4 v34, s[12:15], s25 offen lds
  s_add_u32 s25, s27, 49152
  s_add_u32 m0, s26, 3072
  s_nop 0
  buffer_load_dwordx4 v35, s[12:15], s25 offen lds
  s_add_u32 s25, s27, 65536
  s_add_u32 m0, s26, 4096
  s_nop 0
  buffer_load_dwordx4 v32, s[12:15], s25 offen lds
  s_add_u32 s25, s27, 81920
  s_add_u32 m0, s26, 5120
  s_nop 0
  buffer_load_dwordx4 v33, s[12:15], s25 offen lds
  s_add_u32 s25, s27, 98304
  s_add_u32 m0, s26, 6144
  s_nop 0
  buffer_load_dwordx4 v34, s[12:15], s25 offen lds
  s_add_u32 s25, s27, 114688
  s_add_u32 m0, s26, 7168
  s_nop 0
  buffer_load_dwordx4 v35, s[12:15], s25 offen lds
  s_add_u32 s25, s27, 262144
  s_add_u32 m0, s26, 8192
  s_nop 0
  buffer_load_dwordx4 v32, s[12:15], s25 offen lds
  s_add_u32 s25, s27, 278528
  s_add_u32 m0, s26, 9216
  s_nop 0
  buffer_load_dwordx4 v33, s[12:15], s25 offen lds
  s_add_u32 s25, s27, 294912
  s_add_u32 m0, s26, 10240
  s_nop 0
  buffer_load_dwordx4 v34, s[12:15], s25 offen lds
  s_add_u32 s25, s27, 311296
  s_add_u32 m0, s26, 11264
  s_nop 0
  buffer_load_dwordx4 v35, s[12:15], s25 offen lds
  s_add_u32 s25, s27, 327680
  s_add_u32 m0, s26, 12288
  s_nop 0
  buffer_load_dwordx4 v32, s[12:15], s25 offen lds
  s_add_u32 s25, s27, 344064
  s_add_u32 m0, s26, 13312
  s_nop 0
  buffer_load_dwordx4 v33, s[12:15], s25 offen lds
  s_add_u32 s25, s27, 360448
  s_add_u32 m0, s26, 14336
  s_nop 0
  buffer_load_dwordx4 v34, s[12:15], s25 offen lds
  s_add_u32 s25, s27, 376832
  s_add_u32 m0, s26, 15360
  s_nop 0
  buffer_load_dwordx4 v35, s[12:15], s25 offen lds
  s_waitcnt vmcnt(16)
  s_barrier
  ds_read_b64_tr_b16 v[136:137], v52 offset:0
  ds_read_b64_tr_b16 v[138:139], v52 offset:512
  ds_read_b64_tr_b16 v[140:141], v52 offset:8192
  ds_read_b64_tr_b16 v[142:143], v52 offset:8704
  ds_read_b64_tr_b16 v[152:153], v53 offset:0
  ds_read_b64_tr_b16 v[154:155], v53 offset:512
  ds_read_b64_tr_b16 v[156:157], v53 offset:8192
  ds_read_b64_tr_b16 v[158:159], v53 offset:8704
  ds_read_b64_tr_b16 v[168:169], v54 offset:0
  ds_read_b64_tr_b16 v[170:171], v54 offset:512
  ds_read_b64_tr_b16 v[172:173], v54 offset:8192
  ds_read_b64_tr_b16 v[174:175], v54 offset:8704
  ds_read_b64_tr_b16 v[184:185], v55 offset:0
  ds_read_b64_tr_b16 v[186:187], v55 offset:512
  ds_read_b64_tr_b16 v[188:189], v55 offset:8192
  ds_read_b64_tr_b16 v[190:191], v55 offset:8704
  ds_read_b64_tr_b16 v[200:201], v56 offset:0
  ds_read_b64_tr_b16 v[202:203], v56 offset:512
  ds_read_b64_tr_b16 v[204:205], v56 offset:8192
  ds_read_b64_tr_b16 v[206:207], v56 offset:8704
  ds_read_b64_tr_b16 v[216:217], v57 offset:0
  ds_read_b64_tr_b16 v[218:219], v57 offset:512
  ds_read_b64_tr_b16 v[220:221], v57 offset:8192
  ds_read_b64_tr_b16 v[222:223], v57 offset:8704
  ds_read_b64_tr_b16 v[232:233], v58 offset:0
  ds_read_b64_tr_b16 v[234:235], v58 offset:512
  ds_read_b64_tr_b16 v[236:237], v58 offset:8192
  ds_read_b64_tr_b16 v[238:239], v58 offset:8704
  ds_read_b64_tr_b16 v[248:249], v59 offset:0
  ds_read_b64_tr_b16 v[250:251], v59 offset:512
  ds_read_b64_tr_b16 v[252:253], v59 offset:8192
  ds_read_b64_tr_b16 v[254:255], v59 offset:8704
  s_waitcnt lgkmcnt(0)
  s_barrier
  s_lshl_b32 s26, s17, 14
  s_lshl_b32 s27, s17, 19
  s_add_u32 s25, s27, 2097152
  s_add_u32 m0, s26, 65536
  s_nop 0
  buffer_load_dwordx4 v32, s[12:15], s25 offen lds
  s_add_u32 s25, s27, 2113536
  s_add_u32 m0, s26, 66560
  s_nop 0
  buffer_load_dwordx4 v33, s[12:15], s25 offen lds
  s_add_u32 s25, s27, 2129920
  s_add_u32 m0, s26, 67584
  s_nop 0
  buffer_load_dwordx4 v34, s[12:15], s25 offen lds
  s_add_u32 s25, s27, 2146304
  s_add_u32 m0, s26, 68608
  s_nop 0
  buffer_load_dwordx4 v35, s[12:15], s25 offen lds
  s_add_u32 s25, s27, 2162688
  s_add_u32 m0, s26, 69632
  s_nop 0
  buffer_load_dwordx4 v32, s[12:15], s25 offen lds
  s_add_u32 s25, s27, 2179072
  s_add_u32 m0, s26, 70656
  s_nop 0
  buffer_load_dwordx4 v33, s[12:15], s25 offen lds
  s_add_u32 s25, s27, 2195456
  s_add_u32 m0, s26, 71680
  s_nop 0
  buffer_load_dwordx4 v34, s[12:15], s25 offen lds
  s_add_u32 s25, s27, 2211840
  s_add_u32 m0, s26, 72704
  s_nop 0
  buffer_load_dwordx4 v35, s[12:15], s25 offen lds
  s_add_u32 s25, s27, 2359296
  s_add_u32 m0, s26, 73728
  s_nop 0
  buffer_load_dwordx4 v32, s[12:15], s25 offen lds
  s_add_u32 s25, s27, 2375680
  s_add_u32 m0, s26, 74752
  s_nop 0
  buffer_load_dwordx4 v33, s[12:15], s25 offen lds
  s_add_u32 s25, s27, 2392064
  s_add_u32 m0, s26, 75776
  s_nop 0
  buffer_load_dwordx4 v34, s[12:15], s25 offen lds
  s_add_u32 s25, s27, 2408448
  s_add_u32 m0, s26, 76800
  s_nop 0
  buffer_load_dwordx4 v35, s[12:15], s25 offen lds
  s_add_u32 s25, s27, 2424832
  s_add_u32 m0, s26, 77824
  s_nop 0
  buffer_load_dwordx4 v32, s[12:15], s25 offen lds
  s_add_u32 s25, s27, 2441216
  s_add_u32 m0, s26, 78848
  s_nop 0
  buffer_load_dwordx4 v33, s[12:15], s25 offen lds
  s_add_u32 s25, s27, 2457600
  s_add_u32 m0, s26, 79872
  s_nop 0
  buffer_load_dwordx4 v34, s[12:15], s25 offen lds
  s_add_u32 s25, s27, 2473984
  s_add_u32 m0, s26, 80896
  s_nop 0
  buffer_load_dwordx4 v35, s[12:15], s25 offen lds
  s_waitcnt vmcnt(16)
  s_barrier
  ds_read_b64_tr_b16 v[64:65], v40 offset:0
  ds_read_b64_tr_b16 v[66:67], v40 offset:512
  ds_read_b64_tr_b16 v[68:69], v40 offset:8192
  ds_read_b64_tr_b16 v[70:71], v40 offset:8704
  ds_read_b64_tr_b16 v[72:73], v40 offset:16384
  ds_read_b64_tr_b16 v[74:75], v40 offset:16896
  ds_read_b64_tr_b16 v[76:77], v40 offset:24576
  ds_read_b64_tr_b16 v[78:79], v40 offset:25088
  ds_read_b64_tr_b16 v[80:81], v40 offset:32768
  ds_read_b64_tr_b16 v[82:83], v40 offset:33280
  ds_read_b64_tr_b16 v[84:85], v40 offset:40960
  ds_read_b64_tr_b16 v[86:87], v40 offset:41472
  ds_read_b64_tr_b16 v[88:89], v40 offset:49152
  ds_read_b64_tr_b16 v[90:91], v40 offset:49664
  ds_read_b64_tr_b16 v[92:93], v40 offset:57344
  ds_read_b64_tr_b16 v[94:95], v40 offset:57856
  ds_read_b64_tr_b16 v[96:97], v41 offset:0
  ds_read_b64_tr_b16 v[98:99], v41 offset:512
  ds_read_b64_tr_b16 v[100:101], v41 offset:8192
  ds_read_b64_tr_b16 v[102:103], v41 offset:8704
  ds_read_b64_tr_b16 v[104:105], v41 offset:16384
  ds_read_b64_tr_b16 v[106:107], v41 offset:16896
  ds_read_b64_tr_b16 v[108:109], v41 offset:24576
  ds_read_b64_tr_b16 v[110:111], v41 offset:25088
  ds_read_b64_tr_b16 v[112:113], v41 offset:32768
  ds_read_b64_tr_b16 v[114:115], v41 offset:33280
  ds_read_b64_tr_b16 v[116:117], v41 offset:40960
  ds_read_b64_tr_b16 v[118:119], v41 offset:41472
  ds_read_b64_tr_b16 v[120:121], v41 offset:49152
  ds_read_b64_tr_b16 v[122:123], v41 offset:49664
  ds_read_b64_tr_b16 v[124:125], v41 offset:57344
  ds_read_b64_tr_b16 v[126:127], v41 offset:57856
  s_waitcnt lgkmcnt(0)
  s_barrier
  s_lshl_b32 s25, s17, 14
  s_add_u32 s25, s25, 0
  v_add_u32 v60, s25, v18
  ds_write_b128 v60, v[64:67] offset:0
  ds_write_b128 v60, v[68:71] offset:1024
  ds_write_b128 v60, v[72:75] offset:2048
  ds_write_b128 v60, v[76:79] offset:3072
  ds_write_b128 v60, v[80:83] offset:4096
  ds_write_b128 v60, v[84:87] offset:5120
  ds_write_b128 v60, v[88:91] offset:6144
  ds_write_b128 v60, v[92:95] offset:7168
  ds_write_b128 v60, v[96:99] offset:8192
  ds_write_b128 v60, v[100:103] offset:9216
  ds_write_b128 v60, v[104:107] offset:10240
  ds_write_b128 v60, v[108:111] offset:11264
  ds_write_b128 v60, v[112:115] offset:12288
  ds_write_b128 v60, v[116:119] offset:13312
  ds_write_b128 v60, v[120:123] offset:14336
  ds_write_b128 v60, v[124:127] offset:15360
  s_waitcnt lgkmcnt(0)
  s_barrier
  s_waitcnt vmcnt(0)
  s_barrier
  ds_read_b64_tr_b16 v[64:65], v42 offset:0
  ds_read_b64_tr_b16 v[66:67], v42 offset:512
  ds_read_b64_tr_b16 v[68:69], v42 offset:8192
  ds_read_b64_tr_b16 v[70:71], v42 offset:8704
  ds_read_b64_tr_b16 v[72:73], v42 offset:16384
  ds_read_b64_tr_b16 v[74:75], v42 offset:16896
  ds_read_b64_tr_b16 v[76:77], v42 offset:24576
  ds_read_b64_tr_b16 v[78:79], v42 offset:25088
  ds_read_b64_tr_b16 v[80:81], v42 offset:32768
  ds_read_b64_tr_b16 v[82:83], v42 offset:33280
  ds_read_b64_tr_b16 v[84:85], v42 offset:40960
  ds_read_b64_tr_b16 v[86:87], v42 offset:41472
  ds_read_b64_tr_b16 v[88:89], v42 offset:49152
  ds_read_b64_tr_b16 v[90:91], v42 offset:49664
  ds_read_b64_tr_b16 v[92:93], v42 offset:57344
  ds_read_b64_tr_b16 v[94:95], v42 offset:57856
  ds_read_b64_tr_b16 v[96:97], v43 offset:0
  ds_read_b64_tr_b16 v[98:99], v43 offset:512
  ds_read_b64_tr_b16 v[100:101], v43 offset:8192
  ds_read_b64_tr_b16 v[102:103], v43 offset:8704
  ds_read_b64_tr_b16 v[104:105], v43 offset:16384
  ds_read_b64_tr_b16 v[106:107], v43 offset:16896
  ds_read_b64_tr_b16 v[108:109], v43 offset:24576
  ds_read_b64_tr_b16 v[110:111], v43 offset:25088
  ds_read_b64_tr_b16 v[112:113], v43 offset:32768
  ds_read_b64_tr_b16 v[114:115], v43 offset:33280
  ds_read_b64_tr_b16 v[116:117], v43 offset:40960
  ds_read_b64_tr_b16 v[118:119], v43 offset:41472
  ds_read_b64_tr_b16 v[120:121], v43 offset:49152
  ds_read_b64_tr_b16 v[122:123], v43 offset:49664
  ds_read_b64_tr_b16 v[124:125], v43 offset:57344
  ds_read_b64_tr_b16 v[126:127], v43 offset:57856
  s_waitcnt lgkmcnt(0)
  s_barrier
  s_lshl_b32 s25, s17, 14
  s_add_u32 s25, s25, 65536
  v_add_u32 v60, s25, v18
  ds_write_b128 v60, v[64:67] offset:0
  ds_write_b128 v60, v[68:71] offset:1024
  ds_write_b128 v60, v[72:75] offset:2048
  ds_write_b128 v60, v[76:79] offset:3072
  ds_write_b128 v60, v[80:83] offset:4096
  ds_write_b128 v60, v[84:87] offset:5120
  ds_write_b128 v60, v[88:91] offset:6144
  ds_write_b128 v60, v[92:95] offset:7168
  ds_write_b128 v60, v[96:99] offset:8192
  ds_write_b128 v60, v[100:103] offset:9216
  ds_write_b128 v60, v[104:107] offset:10240
  ds_write_b128 v60, v[108:111] offset:11264
  ds_write_b128 v60, v[112:115] offset:12288
  ds_write_b128 v60, v[116:119] offset:13312
  ds_write_b128 v60, v[120:123] offset:14336
  ds_write_b128 v60, v[124:127] offset:15360
  s_waitcnt lgkmcnt(0)
  s_barrier
  s_lshl_b32 s25, s17, 14
  v_add_u32 v27, s25, v18
  v_add_u32 v28, 0x10000, v27
  v_mov_b32 v32, 4
  s_nop 1
L_wait32R:
  global_load_dwordx4 v[36:39], v32, s[6:7] sc1
  s_waitcnt vmcnt(0)
  v_cmp_gt_u32 vcc, 32, v36
  s_nop 4
  s_cbranch_vccnz L_wait32R
  v_cmp_gt_u32 vcc, 256, v39
  s_nop 4
  s_cbranch_vccnz L_wait32R
  v_readfirstlane_b32 s57, v38
  s_mov_b32 s18, 0
  s_mov_b32 s19, s36
  s_mov_b32 s20, 8192
  s_mov_b32 s21, 0
  s_mov_b32 s22, 1
  s_mov_b32 s23, -1
  s_mov_b32 s30, 0x3e0293ee
  s_mov_b32 s31, 13639680
  s_lshl_b32 s25, s16, 11
  s_lshl_b32 s26, s17, 9
  s_add_u32 s25, s25, s26
  s_add_u32 s39, s25, 1310720
  s_lshl_b32 s25, s16, 12
  s_lshl_b32 s26, s17, 10
  s_add_u32 s25, s25, s26
  s_add_u32 s38, s25, 5505024
  s_lshl_b32 s25, s16, 14
  s_lshl_b32 s26, s17, 12
  s_add_u32 s25, s25, s26
  s_add_u32 s37, s25, 16777216
  s_mov_b32 s78, 2
  s_mov_b32 s79, 2
  s_mov_b32 s80, 0
  s_mov_b32 s81, 0
  s_lshl_b32 s25, s16, 7
  s_add_u32 s25, s25, 458752
  s_mov_b32 s66, 0x7f000000
  s_sub_u32 s69, s25, 0x7f000000
  s_cmp_eq_u32 s17, 0
  s_cselect_b32 s69, s69, 0
  s_cselect_b32 s71, 4096, 0
  s_lshl_b32 s25, s16, 7
  s_add_u32 s68, s25, 327680
  s_mov_b32 s67, s68
L_wkv0R:
  buffer_load_dword v31, v15, s[8:11], s67 offen sc1
  s_waitcnt vmcnt(0)
  v_readfirstlane_b32 s26, v31
  s_cmp_eq_u32 s26, 0
  s_nop 3
  s_cbranch_scc1 L_wkv0R
  v_mov_b32 v32, 149568
  v_mov_b32 v33, 1
  ds_write_b32 v32, v33
  s_waitcnt lgkmcnt(0)
  s_mov_b32 m0, 147456
  v_lshlrev_b32 v32, 3, v18
  v_mov_b64 v[62:63], 0
  v_mov_b64 v[64:65], 0
  v_mov_b64 v[66:67], 0
  v_mov_b64 v[68:69], 0
  v_mov_b64 v[70:71], 0
  v_mov_b64 v[72:73], 0
  v_mov_b64 v[74:75], 0
  v_mov_b64 v[76:77], 0
  v_mov_b64 v[78:79], 0
  v_mov_b64 v[80:81], 0
  v_mov_b64 v[82:83], 0
  v_mov_b64 v[84:85], 0
  ds_read_b128 v[102:105], v27 offset:0
  ds_read_b128 v[106:109], v27 offset:1024
  ds_read_b128 v[110:113], v27 offset:8192
  ds_read_b128 v[114:117], v27 offset:9216
  ds_read_b128 v[118:121], v27 offset:2048
  ds_read_b128 v[122:125], v27 offset:3072
  s_cmp_lg_u32 s57, 0
  s_cbranch_scc1 L_slowloopR
L_stepRf:
  buffer_load_dwordx4 v[86:89], v18, s[8:11], s19 offen sc1
  buffer_load_dwordx4 v[90:93], v18, s[8:11], s19 offen offset:1024 sc1
  s_sleep 3
  buffer_load_dwordx4 v[94:97], v18, s[8:11], s19 offen sc1
  buffer_load_dwordx4 v[98:101], v18, s[8:11], s19 offen offset:1024 sc1
L_gatRf:
  s_waitcnt vmcnt(2)
  ds_write_b128 v19, v[86:89]
  ds_write_b128 v19, v[90:93] offset:1024
  v_max3_u32 v126, v86, v87, v88
  v_max3_u32 v127, v89, v90, v91
  v_max3_u32 v126, v126, v92, v93
  v_max_u32 v126, v126, v127
  v_cmp_eq_u32 vcc, -1, v126
  s_cbranch_vccz L_gokRf
  buffer_load_dwordx4 v[86:89], v18, s[8:11], s19 offen sc1
  buffer_load_dwordx4 v[90:93], v18, s[8:11], s19 offen offset:1024 sc1
  s_waitcnt vmcnt(2)
  ds_write_b128 v19, v[94:97]
  ds_write_b128 v19, v[98:101] offset:1024
  v_max3_u32 v126, v94, v95, v96
  v_max3_u32 v127, v97, v98, v99
  v_max3_u32 v126, v126, v100, v101
  v_max_u32 v126, v126, v127
  v_cmp_eq_u32 vcc, -1, v126
  s_cbranch_vccz L_gokRf
  buffer_load_dwordx4 v[94:97], v18, s[8:11], s19 offen sc1
  buffer_load_dwordx4 v[98:101], v18, s[8:11], s19 offen offset:1024 sc1
  s_branch L_gatRf
L_gokRf:
  s_waitcnt lgkmcnt(0)
  s_barrier
  ds_read_b128 v[30:33], v20 offset:0
  ds_read_b128 v[34:37], v20 offset:1024
  ds_read_b128 v[38:41], v20 offset:2048
  s_waitcnt lgkmcnt(2)
  v_smfmac_f32_16x16x64_bf16 v[62:65], v[30:33], a[0:7], v1
  buffer_load_dwordx4 v[86:89], v18, s[8:11], s37 offen offset:0 sc1
  v_smfmac_f32_16x16x64_bf16 v[70:73], v[30:33], a[64:71], v1
  ds_read_b128 v[42:45], v20 offset:3072
  v_smfmac_f32_16x16x64_bf16 v[66:69], v[30:33], a[128:135], v1
  v_smfmac_f32_16x16x64_bf16 v[74:77], v[30:33], a[192:199], v1
  v_smfmac_f32_16x16x64_bf16 v[78:81], v[30:33], v[102:109], v1
  ds_read_b128 v[102:105], v27 offset:10240
  ds_read_b128 v[106:109], v27 offset:11264
  v_smfmac_f32_16x16x64_bf16 v[82:85], v[30:33], v[110:117], v1
  ds_read_b128 v[110:113], v27 offset:4096
  ds_read_b128 v[114:117], v27 offset:5120
  s_waitcnt lgkmcnt(6)
  v_smfmac_f32_16x16x64_bf16 v[62:65], v[34:37], a[8:15], v1
  buffer_load_dwordx4 v[90:93], v18, s[8:11], s37 offen offset:1024 sc1
  v_smfmac_f32_16x16x64_bf16 v[70:73], v[34:37], a[72:79], v1
  ds_read_b128 v[46:49], v20 offset:4096
  v_smfmac_f32_16x16x64_bf16 v[66:69], v[34:37], a[136:143], v1
  v_smfmac_f32_16x16x64_bf16 v[74:77], v[34:37], a[200:207], v1
  v_smfmac_f32_16x16x64_bf16 v[78:81], v[34:37], v[118:125], v1
  ds_read_b128 v[118:121], v27 offset:12288
  ds_read_b128 v[122:125], v27 offset:13312
  s_waitcnt lgkmcnt(5)
  v_smfmac_f32_16x16x64_bf16 v[82:85], v[34:37], v[102:109], v1
  ds_read_b128 v[102:105], v27 offset:6144
  ds_read_b128 v[106:109], v27 offset:7168
  s_waitcnt lgkmcnt(10)
  v_smfmac_f32_16x16x64_bf16 v[62:65], v[38:41], a[16:23], v1
  buffer_load_dwordx4 v[94:97], v18, s[8:11], s37 offen offset:2048 sc1
  v_smfmac_f32_16x16x64_bf16 v[70:73], v[38:41], a[80:87], v1
  ds_read_b128 v[50:53], v20 offset:5120
  v_smfmac_f32_16x16x64_bf16 v[66:69], v[38:41], a[144:151], v1
  v_smfmac_f32_16x16x64_bf16 v[74:77], v[38:41], a[208:215], v1
  s_waitcnt lgkmcnt(6)
  v_smfmac_f32_16x16x64_bf16 v[78:81], v[38:41], v[110:117], v1
  ds_read_b128 v[110:113], v27 offset:14336
  ds_read_b128 v[114:117], v27 offset:15360
  s_waitcnt lgkmcnt(5)
  v_smfmac_f32_16x16x64_bf16 v[82:85], v[38:41], v[118:125], v1
  ds_read_b128 v[118:121], v28 offset:0
  ds_read_b128 v[122:125], v28 offset:1024
  s_waitcnt lgkmcnt(14)
  v_smfmac_f32_16x16x64_bf16 v[62:65], v[42:45], a[24:31], v1
  buffer_load_dwordx4 v[98:101], v18, s[8:11], s37 offen offset:3072 sc1
  v_smfmac_f32_16x16x64_bf16 v[70:73], v[42:45], a[88:95], v1
  ds_read_b128 v[54:57], v20 offset:6144
  v_smfmac_f32_16x16x64_bf16 v[66:69], v[42:45], a[152:159], v1
  v_smfmac_f32_16x16x64_bf16 v[74:77], v[42:45], a[216:223], v1
  s_waitcnt lgkmcnt(10)
  v_smfmac_f32_16x16x64_bf16 v[62:65], v[46:49], a[32:39], v1
  s_and_b32 s25, s18, 3
  s_cmp_eq_u32 s25, 1
  s_cbranch_scc1 L_kvldRf
L_kvld_rRf:
  s_cmp_eq_u32 s25, 2
  s_cbranch_scc1 L_kvckRf
L_kvokRf:
  s_add_u32 s37, s37, 0x80000
  s_mov_b32 m0, 147456
  v_lshlrev_b32 v126, 3, v18
  buffer_load_dword v126, s[8:11], s37 offen sc1 lds
  v_smfmac_f32_16x16x64_bf16 v[70:73], v[46:49], a[96:103], v1
  ds_read_b128 v[58:61], v20 offset:7168
  v_smfmac_f32_16x16x64_bf16 v[66:69], v[46:49], a[160:167], v1
  v_smfmac_f32_16x16x64_bf16 v[74:77], v[46:49], a[224:231], v1
  s_waitcnt lgkmcnt(6)
  v_smfmac_f32_16x16x64_bf16 v[62:65], v[50:53], a[40:47], v1
  v_smfmac_f32_16x16x64_bf16 v[70:73], v[50:53], a[104:111], v1
  v_smfmac_f32_16x16x64_bf16 v[66:69], v[50:53], a[168:175], v1
  v_smfmac_f32_16x16x64_bf16 v[74:77], v[50:53], a[232:239], v1
  s_waitcnt lgkmcnt(1)
  v_smfmac_f32_16x16x64_bf16 v[62:65], v[54:57], a[48:55], v1
  v_smfmac_f32_16x16x64_bf16 v[70:73], v[54:57], a[112:119], v1
  v_smfmac_f32_16x16x64_bf16 v[66:69], v[54:57], a[176:183], v1
  v_smfmac_f32_16x16x64_bf16 v[74:77], v[54:57], a[240:247], v1
  s_waitcnt lgkmcnt(0)
  v_smfmac_f32_16x16x64_bf16 v[62:65], v[58:61], a[56:63], v1
  v_smfmac_f32_16x16x64_bf16 v[70:73], v[58:61], a[120:127], v1
  v_smfmac_f32_16x16x64_bf16 v[66:69], v[58:61], a[184:191], v1
  v_smfmac_f32_16x16x64_bf16 v[74:77], v[58:61], a[248:255], v1
  s_waitcnt lgkmcnt(7)
  v_smfmac_f32_16x16x64_bf16 v[78:81], v[42:45], v[102:109], v1
  ds_read_b128 v[102:105], v28 offset:8192
  ds_read_b128 v[106:109], v28 offset:9216
  s_nop 0
  v_cvt_pk_bf16_f32 v62, v62, v63
  v_cvt_pk_bf16_f32 v63, v64, v65
  v_cvt_pk_bf16_f32 v70, v70, v71
  v_cvt_pk_bf16_f32 v71, v72, v73
  v_cvt_pk_bf16_f32 v64, v66, v67
  v_cvt_pk_bf16_f32 v65, v68, v69
  v_cvt_pk_bf16_f32 v72, v74, v75
  v_cvt_pk_bf16_f32 v73, v76, v77
  v_mfma_f32_16x16x32_bf16 v[66:69], v[62:65], v[2:5], 0
  s_nop 0
  v_mfma_f32_16x16x32_bf16 v[74:77], v[70:73], v[2:5], 0
  v_mov_b32 v126, 1
  buffer_store_dword v126, v15, s[8:11], s66 offen sc1
  s_waitcnt lgkmcnt(6)
  v_smfmac_f32_16x16x64_bf16 v[82:85], v[42:45], v[110:117], v1
  ds_read_b128 v[110:113], v28 offset:2048
  ds_read_b128 v[114:117], v28 offset:3072
  v_cvt_pk_bf16_f32 v62, v66, v67
  v_cvt_pk_bf16_f32 v63, v68, v69
  v_cvt_pk_bf16_f32 v64, v74, v75
  v_cvt_pk_bf16_f32 v65, v76, v77
  s_waitcnt vmcnt(4)
  s_nop 0
  v_mfma_f32_16x16x32_bf16 v[66:69], v[62:65], v[62:65], 0
  v_mfma_f32_16x16x32_bf16 v[70:73], v[86:89], v[62:65], 0
  v_mfma_f32_16x16x32_bf16 v[74:77], v[90:93], v[62:65], 0
  buffer_store_dwordx4 v[62:65], v29, s[8:11], s39 offen sc1
  s_nop 4
  ds_write_b128 v23, v[66:69]
  s_nop 0
  v_mov_b32_dpp v70, v74 row_ror:8 row_mask:0xf bank_mask:0xc
  v_mov_b32_dpp v71, v75 row_ror:8 row_mask:0xf bank_mask:0xc
  v_mov_b32_dpp v72, v76 row_ror:8 row_mask:0xf bank_mask:0xc
  v_mov_b32_dpp v73, v77 row_ror:8 row_mask:0xf bank_mask:0xc
  ds_write_b128 v21, v[70:73]
  s_waitcnt lgkmcnt(8)
  v_smfmac_f32_16x16x64_bf16 v[78:81], v[46:49], v[118:125], v1
  ds_read_b128 v[118:121], v28 offset:10240
  ds_read_b128 v[122:125], v28 offset:11264
  s_waitcnt lgkmcnt(6)
  v_smfmac_f32_16x16x64_bf16 v[82:85], v[46:49], v[102:109], v1
  ds_read_b128 v[102:105], v28 offset:4096
  ds_read_b128 v[106:109], v28 offset:5120
  s_waitcnt lgkmcnt(6)
  v_smfmac_f32_16x16x64_bf16 v[78:81], v[50:53], v[110:117], v1
  ds_read_b128 v[110:113], v28 offset:12288
  ds_read_b128 v[114:117], v28 offset:13312
  s_waitcnt lgkmcnt(6)
  s_barrier
  ds_read_b128 v[86:89], v24 offset:0
  ds_read_b128 v[90:93], v24 offset:1024
  ds_read_b128 v[70:73], v24 offset:2048
  ds_read_b128 v[74:77], v24 offset:3072
  ds_read2_b32 v[66:67], v25 offset0:0 offset1:64
  ds_read2_b32 v[68:69], v25 offset0:128 offset1:192
  s_waitcnt lgkmcnt(10)
  v_smfmac_f32_16x16x64_bf16 v[82:85], v[50:53], v[118:125], v1
  ds_read_b128 v[118:121], v28 offset:6144
  ds_read_b128 v[122:125], v28 offset:7168
  s_waitcnt lgkmcnt(10)
  v_smfmac_f32_16x16x64_bf16 v[78:81], v[54:57], v[102:109], v1
  ds_read_b128 v[102:105], v28 offset:14336
  ds_read_b128 v[106:109], v28 offset:15360
  s_waitcnt lgkmcnt(4)
  v_pk_add_f32 v[86:87], v[86:87], v[90:91]
  v_pk_add_f32 v[70:71], v[70:71], v[74:75]
  v_pk_add_f32 v[88:89], v[88:89], v[92:93]
  v_pk_add_f32 v[72:73], v[72:73], v[76:77]
  v_pk_add_f32 v[66:67], v[66:67], v[68:69]
  v_pk_add_f32 v[86:87], v[86:87], v[70:71]
  v_pk_add_f32 v[88:89], v[88:89], v[72:73]
  v_add_f32 v66, v66, v67
  v_max3_f32 v67, v86, v87, v88
  v_max3_f32 v67, v67, v89, v66
  s_waitcnt lgkmcnt(10)
  v_smfmac_f32_16x16x64_bf16 v[82:85], v[54:57], v[110:117], v1
  v_max_f32_dpp v67, v67, v67 quad_perm:[2,3,0,1] row_mask:0xf bank_mask:0xf
  v_mov_b32 v68, v67
  s_waitcnt lgkmcnt(2)
  v_smfmac_f32_16x16x64_bf16 v[78:81], v[58:61], v[118:125], v1
  v_permlane16_swap_b32 v67, v68
  v_max_f32 v67, v67, v68
  v_mov_b32 v68, v67
  s_nop 1
  v_permlane32_swap_b32 v67, v68
  v_max_f32 v67, v67, v68
  v_mul_f32 v67, s30, v67
  v_fma_f32 v86, v86, s30, -v67
  v_fma_f32 v87, v87, s30, -v67
  v_fma_f32 v88, v88, s30, -v67
  v_fma_f32 v89, v89, s30, -v67
  v_fma_f32 v66, v66, s30, -v67
  v_exp_f32 v86, v86
  v_exp_f32 v87, v87
  v_exp_f32 v88, v88
  v_exp_f32 v89, v89
  v_exp_f32 v66, v66
  v_cvt_pk_bf16_f32 v62, v86, v87
  v_cvt_pk_bf16_f32 v63, v88, v89
  v_mov_b32_dpp v67, v66 quad_perm:[2,3,0,1] row_mask:0xf bank_mask:0xf
  v_mov_b32_dpp v64, v62 quad_perm:[2,3,0,1] row_mask:0xf bank_mask:0xf
  v_mov_b32_dpp v65, v63 quad_perm:[2,3,0,1] row_mask:0xf bank_mask:0xf
  v_cvt_pk_bf16_f32 v126, v66, v67
  s_waitcnt vmcnt(3)
  s_waitcnt lgkmcnt(0)
  v_smfmac_f32_16x16x64_bf16 v[82:85], v[58:61], v[102:109], v1
  v_mfma_f32_16x16x32_bf16 v[70:73], v[10:13], v[62:65], 0
  v_mov_b32 v127, v126
  v_mfma_f32_16x16x32_bf16 v[86:89], v[94:97], v[62:65], 0
  v_mov_b32 v67, 0
  v_mfma_f32_16x16x32_bf16 v[90:93], v[98:101], v[62:65], 0
  v_mov_b32 v66, v126
  v_cvt_pk_bf16_f32 v78, v78, v79
  v_cvt_pk_bf16_f32 v79, v80, v81
  v_cvt_pk_bf16_f32 v80, v82, v83
  v_cvt_pk_bf16_f32 v81, v84, v85
  v_mfma_f32_16x16x16_bf16 v[70:73], v[10:11], v[66:67], v[70:73]
  v_mfma_f32_16x16x16_bf16 v[86:89], v[78:79], v[126:127], v[86:89]
  v_mfma_f32_16x16x16_bf16 v[90:93], v[80:81], v[126:127], v[90:93]
  buffer_store_dwordx4 v[78:81], v18, s[8:11], s38 offen sc1
  v_mov_b64 v[30:31], 0
  v_mov_b64 v[32:33], 0
  v_mov_b64 v[34:35], 0
  v_mov_b64 v[36:37], 0
  v_mov_b64 v[38:39], 0
  v_mov_b64 v[40:41], 0
  v_rcp_f32 v66, v70
  v_mov_b64 v[42:43], 0
  v_mov_b32 v67, v66
  v_pk_mul_f32 v[86:87], v[86:87], v[66:67]
  v_pk_mul_f32 v[88:89], v[88:89], v[66:67]
  v_pk_mul_f32 v[90:91], v[90:91], v[66:67]
  v_pk_mul_f32 v[92:93], v[92:93], v[66:67]
  v_cvt_pk_bf16_f32 v74, v86, v87
  v_cvt_pk_bf16_f32 v75, v88, v89
  v_cvt_pk_bf16_f32 v76, v90, v91
  v_cvt_pk_bf16_f32 v77, v92, v93
  ds_write_b128 v26, v[74:77]
  v_mov_b64 v[44:45], 0
  v_mov_b64 v[46:47], 0
  v_mov_b64 v[48:49], 0
  v_mov_b64 v[50:51], 0
  v_mov_b64 v[52:53], 0
  v_mov_b64 v[54:55], 0
  v_mov_b64 v[56:57], 0
  v_mov_b64 v[58:59], 0
  v_mov_b64 v[60:61], 0
  s_waitcnt lgkmcnt(0)
  s_barrier
  ds_read_b128 v[62:65], v20 offset:14336
  ds_read_b128 v[66:69], v20 offset:15360
  s_waitcnt lgkmcnt(1)
  v_smfmac_f32_16x16x64_bf16 v[30:33], v[62:65], v[128:135], v1
  s_waitcnt lgkmcnt(0)
  v_smfmac_f32_16x16x64_bf16 v[30:33], v[66:69], v[136:143], v1
  v_smfmac_f32_16x16x64_bf16 v[34:37], v[62:65], v[144:151], v1
  v_smfmac_f32_16x16x64_bf16 v[34:37], v[66:69], v[152:159], v1
  v_smfmac_f32_16x16x64_bf16 v[38:41], v[62:65], v[160:167], v1
  v_smfmac_f32_16x16x64_bf16 v[38:41], v[66:69], v[168:175], v1
  v_smfmac_f32_16x16x64_bf16 v[42:45], v[62:65], v[176:183], v1
  v_smfmac_f32_16x16x64_bf16 v[42:45], v[66:69], v[184:191], v1
  v_smfmac_f32_16x16x64_bf16 v[46:49], v[62:65], v[192:199], v1
  v_smfmac_f32_16x16x64_bf16 v[46:49], v[66:69], v[200:207], v1
  v_smfmac_f32_16x16x64_bf16 v[50:53], v[62:65], v[208:215], v1
  v_smfmac_f32_16x16x64_bf16 v[50:53], v[66:69], v[216:223], v1
  v_add_f32 v30, v30, v32
  v_add_f32 v31, v31, v33
  v_cvt_pk_bf16_f32 v102, v30, v31
  v_add_f32 v34, v34, v36
  v_add_f32 v35, v35, v37
  v_cvt_pk_bf16_f32 v103, v34, v35
  v_add_f32 v38, v38, v40
  v_add_f32 v39, v39, v41
  v_cvt_pk_bf16_f32 v104, v38, v39
  v_add_f32 v42, v42, v44
  v_add_f32 v43, v43, v45
  v_cvt_pk_bf16_f32 v105, v42, v43
  v_and_or_b32 v102, v102, -2, s22
  buffer_store_dwordx4 v[102:105], v14, s[8:11], s32 offen
  v_smfmac_f32_16x16x64_bf16 v[54:57], v[62:65], v[224:231], v1
  v_smfmac_f32_16x16x64_bf16 v[54:57], v[66:69], v[232:239], v1
  v_smfmac_f32_16x16x64_bf16 v[58:61], v[62:65], v[240:247], v1
  v_smfmac_f32_16x16x64_bf16 v[58:61], v[66:69], v[248:255], v1
  v_pk_add_f32 v[46:47], v[46:47], v[48:49]
  v_pk_add_f32 v[50:51], v[50:51], v[52:53]
  s_nop 3
  v_pk_add_f32 v[54:55], v[54:55], v[56:57]
  s_nop 0
  v_pk_add_f32 v[58:59], v[58:59], v[60:61]
  v_cvt_pk_bf16_f32 v106, v46, v47
  v_cvt_pk_bf16_f32 v107, v50, v51
  v_cvt_pk_bf16_f32 v108, v54, v55
  v_cvt_pk_bf16_f32 v109, v58, v59
  v_and_or_b32 v106, v106, -2, s22
  buffer_store_dwordx4 v[106:109], v14, s[8:11], s33 offen
  v_mov_b64 v[62:63], 0
  v_mov_b64 v[64:65], 0
  v_mov_b64 v[66:67], 0
  v_mov_b64 v[68:69], 0
  v_mov_b64 v[70:71], 0
  v_mov_b64 v[72:73], 0
  v_mov_b64 v[74:75], 0
  v_mov_b64 v[76:77], 0
  v_mov_b64 v[78:79], 0
  v_mov_b64 v[80:81], 0
  v_mov_b64 v[82:83], 0
  v_mov_b64 v[84:85], 0
  ds_read_b128 v[102:105], v27 offset:0
  ds_read_b128 v[106:109], v27 offset:1024
  ds_read_b128 v[110:113], v27 offset:8192
  ds_read_b128 v[114:117], v27 offset:9216
  ds_read_b128 v[118:121], v27 offset:2048
  ds_read_b128 v[122:125], v27 offset:3072
  s_sleep 3
  buffer_load_dwordx4 v[30:33], v18, s[8:11], s34 offen sc1
  buffer_load_dwordx4 v[34:37], v18, s[8:11], s34 offen offset:1024 sc1
  s_sleep 3
  buffer_load_dwordx4 v[38:41], v18, s[8:11], s34 offen sc1
  buffer_load_dwordx4 v[42:45], v18, s[8:11], s34 offen offset:1024 sc1
L_redRf:
  s_waitcnt vmcnt(3)
  v_mfma_f32_16x16x32_bf16 v[46:49], v[30:33], v[6:9], 0
  s_waitcnt vmcnt(2)
  v_mfma_f32_16x16x32_bf16 v[46:49], v[34:37], v[6:9], v[46:49]
  v_bitop3_b32 v50, v30, v34, s23 bitop3:0x7e
  v_and_b32 v50, 1, v50
  v_cmp_ne_u32 vcc, 0, v50
  s_cbranch_vccz L_rokRf
  s_nop 3
  buffer_load_dwordx4 v[30:33], v18, s[8:11], s34 offen sc1
  buffer_load_dwordx4 v[34:37], v18, s[8:11], s34 offen offset:1024 sc1
  s_waitcnt vmcnt(3)
  v_mfma_f32_16x16x32_bf16 v[46:49], v[38:41], v[6:9], 0
  s_waitcnt vmcnt(2)
  v_mfma_f32_16x16x32_bf16 v[46:49], v[42:45], v[6:9], v[46:49]
  v_bitop3_b32 v50, v38, v42, s23 bitop3:0x7e
  v_and_b32 v50, 1, v50
  v_cmp_ne_u32 vcc, 0, v50
  s_cbranch_vccz L_rokRf
  s_nop 3
  buffer_load_dwordx4 v[38:41], v18, s[8:11], s34 offen sc1
  buffer_load_dwordx4 v[42:45], v18, s[8:11], s34 offen offset:1024 sc1
  s_branch L_redRf
L_rokRf:
  s_nop 3
  v_mov_b32 v51, -1
  v_permlane32_swap_b32 v46, v47
  v_permlane32_swap_b32 v48, v49
  v_add_f32 v46, v46, v47
  v_add_f32 v48, v48, v49
  s_nop 1
  v_permlane16_swap_b32 v46, v48
  v_add_f32 v46, v46, v48
  s_nop 1
  v_mov_b32_dpp v47, v46 quad_perm:[2,3,0,1] row_mask:0xf bank_mask:0xf
  v_cvt_pk_bf16_f32 v50, v46, v47
  v_min_u32 v50, -2, v50
  s_add_u32 s25, s35, s20
  buffer_store_dword v50, v16, s[8:11], s25 offen
  s_add_u32 s26, s35, s21
  buffer_store_dword v51, v16, s[8:11], s26 offen
  s_sleep 2
  s_add_u32 s18, s18, 1
  s_add_u32 s19, s36, s20
  s_mov_b32 s21, s20
  s_add_u32 s20, s20, 8192
  s_cmp_ge_u32 s20, 24576
  s_cselect_b32 s20, 0, s20
  s_xor_b32 s22, s22, 1
  s_not_b32 s23, s23
  s_add_u32 s39, s39, 0x10000
  s_add_u32 s38, s38, 0x20000
  s_add_u32 s31, s31, 8192
  s_add_u32 s66, s66, s69
  s_mov_b32 s69, s71
  s_cmp_lt_u32 s18, 63
  s_cbranch_scc1 L_stepRf
  buffer_load_dwordx4 v[86:89], v18, s[8:11], s19 offen sc1
  buffer_load_dwordx4 v[90:93], v18, s[8:11], s19 offen offset:1024 sc1
  s_sleep 3
  buffer_load_dwordx4 v[94:97], v18, s[8:11], s19 offen sc1
  buffer_load_dwordx4 v[98:101], v18, s[8:11], s19 offen offset:1024 sc1
L_gatRfz:
  s_waitcnt vmcnt(2)
  ds_write_b128 v19, v[86:89]
  ds_write_b128 v19, v[90:93] offset:1024
  v_max3_u32 v126, v86, v87, v88
  v_max3_u32 v127, v89, v90, v91
  v_max3_u32 v126, v126, v92, v93
  v_max_u32 v126, v126, v127
  v_cmp_eq_u32 vcc, -1, v126
  s_cbranch_vccz L_gokRfz
  buffer_load_dwordx4 v[86:89], v18, s[8:11], s19 offen sc1
  buffer_load_dwordx4 v[90:93], v18, s[8:11], s19 offen offset:1024 sc1
  s_waitcnt vmcnt(2)
  ds_write_b128 v19, v[94:97]
  ds_write_b128 v19, v[98:101] offset:1024
  v_max3_u32 v126, v94, v95, v96
  v_max3_u32 v127, v97, v98, v99
  v_max3_u32 v126, v126, v100, v101
  v_max_u32 v126, v126, v127
  v_cmp_eq_u32 vcc, -1, v126
  s_cbranch_vccz L_gokRfz
  buffer_load_dwordx4 v[94:97], v18, s[8:11], s19 offen sc1
  buffer_load_dwordx4 v[98:101], v18, s[8:11], s19 offen offset:1024 sc1
  s_branch L_gatRfz
L_gokRfz:
  s_waitcnt lgkmcnt(0)
  s_barrier
  ds_read_b128 v[30:33], v20 offset:0
  ds_read_b128 v[34:37], v20 offset:1024
  ds_read_b128 v[38:41], v20 offset:2048
  s_waitcnt lgkmcnt(2)
  v_smfmac_f32_16x16x64_bf16 v[62:65], v[30:33], a[0:7], v1
  v_smfmac_f32_16x16x64_bf16 v[70:73], v[30:33], a[64:71], v1
  ds_read_b128 v[42:45], v20 offset:3072
  v_smfmac_f32_16x16x64_bf16 v[66:69], v[30:33], a[128:135], v1
  v_smfmac_f32_16x16x64_bf16 v[74:77], v[30:33], a[192:199], v1
  v_smfmac_f32_16x16x64_bf16 v[78:81], v[30:33], v[102:109], v1
  ds_read_b128 v[102:105], v27 offset:10240
  ds_read_b128 v[106:109], v27 offset:11264
  v_smfmac_f32_16x16x64_bf16 v[82:85], v[30:33], v[110:117], v1
  ds_read_b128 v[110:113], v27 offset:4096
  ds_read_b128 v[114:117], v27 offset:5120
  s_waitcnt lgkmcnt(6)
  v_smfmac_f32_16x16x64_bf16 v[62:65], v[34:37], a[8:15], v1
  v_smfmac_f32_16x16x64_bf16 v[70:73], v[34:37], a[72:79], v1
  ds_read_b128 v[46:49], v20 offset:4096
  v_smfmac_f32_16x16x64_bf16 v[66:69], v[34:37], a[136:143], v1
  v_smfmac_f32_16x16x64_bf16 v[74:77], v[34:37], a[200:207], v1
  v_smfmac_f32_16x16x64_bf16 v[78:81], v[34:37], v[118:125], v1
  ds_read_b128 v[118:121], v27 offset:12288
  ds_read_b128 v[122:125], v27 offset:13312
  s_waitcnt lgkmcnt(5)
  v_smfmac_f32_16x16x64_bf16 v[82:85], v[34:37], v[102:109], v1
  ds_read_b128 v[102:105], v27 offset:6144
  ds_read_b128 v[106:109], v27 offset:7168
  s_waitcnt lgkmcnt(10)
  v_smfmac_f32_16x16x64_bf16 v[62:65], v[38:41], a[16:23], v1
  v_smfmac_f32_16x16x64_bf16 v[70:73], v[38:41], a[80:87], v1
  ds_read_b128 v[50:53], v20 offset:5120
  v_smfmac_f32_16x16x64_bf16 v[66:69], v[38:41], a[144:151], v1
  v_smfmac_f32_16x16x64_bf16 v[74:77], v[38:41], a[208:215], v1
  s_waitcnt lgkmcnt(6)
  v_smfmac_f32_16x16x64_bf16 v[78:81], v[38:41], v[110:117], v1
  ds_read_b128 v[110:113], v27 offset:14336
  ds_read_b128 v[114:117], v27 offset:15360
  s_waitcnt lgkmcnt(5)
  v_smfmac_f32_16x16x64_bf16 v[82:85], v[38:41], v[118:125], v1
  ds_read_b128 v[118:121], v28 offset:0
  ds_read_b128 v[122:125], v28 offset:1024
  s_waitcnt lgkmcnt(14)
  v_smfmac_f32_16x16x64_bf16 v[62:65], v[42:45], a[24:31], v1
  v_smfmac_f32_16x16x64_bf16 v[70:73], v[42:45], a[88:95], v1
  ds_read_b128 v[54:57], v20 offset:6144
  v_smfmac_f32_16x16x64_bf16 v[66:69], v[42:45], a[152:159], v1
  v_smfmac_f32_16x16x64_bf16 v[74:77], v[42:45], a[216:223], v1
  s_waitcnt lgkmcnt(10)
  v_smfmac_f32_16x16x64_bf16 v[62:65], v[46:49], a[32:39], v1
  v_smfmac_f32_16x16x64_bf16 v[70:73], v[46:49], a[96:103], v1
  ds_read_b128 v[58:61], v20 offset:7168
  v_smfmac_f32_16x16x64_bf16 v[66:69], v[46:49], a[160:167], v1
  v_smfmac_f32_16x16x64_bf16 v[74:77], v[46:49], a[224:231], v1
  s_waitcnt lgkmcnt(6)
  v_smfmac_f32_16x16x64_bf16 v[62:65], v[50:53], a[40:47], v1
  v_smfmac_f32_16x16x64_bf16 v[70:73], v[50:53], a[104:111], v1
  v_smfmac_f32_16x16x64_bf16 v[66:69], v[50:53], a[168:175], v1
  v_smfmac_f32_16x16x64_bf16 v[74:77], v[50:53], a[232:239], v1
  s_waitcnt lgkmcnt(1)
  v_smfmac_f32_16x16x64_bf16 v[62:65], v[54:57], a[48:55], v1
  v_smfmac_f32_16x16x64_bf16 v[70:73], v[54:57], a[112:119], v1
  v_smfmac_f32_16x16x64_bf16 v[66:69], v[54:57], a[176:183], v1
  v_smfmac_f32_16x16x64_bf16 v[74:77], v[54:57], a[240:247], v1
  s_waitcnt lgkmcnt(0)
  v_smfmac_f32_16x16x64_bf16 v[62:65], v[58:61], a[56:63], v1
  v_smfmac_f32_16x16x64_bf16 v[70:73], v[58:61], a[120:127], v1
  v_smfmac_f32_16x16x64_bf16 v[66:69], v[58:61], a[184:191], v1
  v_smfmac_f32_16x16x64_bf16 v[74:77], v[58:61], a[248:255], v1
  s_waitcnt lgkmcnt(7)
  v_smfmac_f32_16x16x64_bf16 v[78:81], v[42:45], v[102:109], v1
  ds_read_b128 v[102:105], v28 offset:8192
  ds_read_b128 v[106:109], v28 offset:9216
  s_nop 0
  v_cvt_pk_bf16_f32 v62, v62, v63
  v_cvt_pk_bf16_f32 v63, v64, v65
  v_cvt_pk_bf16_f32 v70, v70, v71
  v_cvt_pk_bf16_f32 v71, v72, v73
  v_cvt_pk_bf16_f32 v64, v66, v67
  v_cvt_pk_bf16_f32 v65, v68, v69
  v_cvt_pk_bf16_f32 v72, v74, v75
  v_cvt_pk_bf16_f32 v73, v76, v77
  v_mfma_f32_16x16x32_bf16 v[66:69], v[62:65], v[2:5], 0
  s_nop 0
  v_mfma_f32_16x16x32_bf16 v[74:77], v[70:73], v[2:5], 0
  v_mov_b32 v126, 1
  buffer_store_dword v126, v15, s[8:11], s66 offen sc1
  s_waitcnt lgkmcnt(6)
  v_smfmac_f32_16x16x64_bf16 v[82:85], v[42:45], v[110:117], v1
  ds_read_b128 v[110:113], v28 offset:2048
  ds_read_b128 v[114:117], v28 offset:3072
  v_cvt_pk_bf16_f32 v62, v66, v67
  v_cvt_pk_bf16_f32 v63, v68, v69
  v_cvt_pk_bf16_f32 v64, v74, v75
  v_cvt_pk_bf16_f32 v65, v76, v77
  buffer_store_dwordx4 v[62:65], v29, s[8:11], s39 offen sc1
  s_waitcnt lgkmcnt(6)
  v_smfmac_f32_16x16x64_bf16 v[78:81], v[46:49], v[118:125], v1
  ds_read_b128 v[118:121], v28 offset:10240
  ds_read_b128 v[122:125], v28 offset:11264
  s_waitcnt lgkmcnt(4)
  v_smfmac_f32_16x16x64_bf16 v[82:85], v[46:49], v[102:109], v1
  ds_read_b128 v[102:105], v28 offset:4096
  ds_read_b128 v[106:109], v28 offset:5120
  s_waitcnt lgkmcnt(4)
  v_smfmac_f32_16x16x64_bf16 v[78:81], v[50:53], v[110:117], v1
  ds_read_b128 v[110:113], v28 offset:12288
  ds_read_b128 v[114:117], v28 offset:13312
  s_waitcnt lgkmcnt(4)
  v_smfmac_f32_16x16x64_bf16 v[82:85], v[50:53], v[118:125], v1
  ds_read_b128 v[118:121], v28 offset:6144
  ds_read_b128 v[122:125], v28 offset:7168
  s_waitcnt lgkmcnt(4)
  v_smfmac_f32_16x16x64_bf16 v[78:81], v[54:57], v[102:109], v1
  ds_read_b128 v[102:105], v28 offset:14336
  ds_read_b128 v[106:109], v28 offset:15360
  s_waitcnt lgkmcnt(4)
  v_smfmac_f32_16x16x64_bf16 v[82:85], v[54:57], v[110:117], v1
  s_waitcnt lgkmcnt(2)
  v_smfmac_f32_16x16x64_bf16 v[78:81], v[58:61], v[118:125], v1
  s_waitcnt lgkmcnt(0)
  v_smfmac_f32_16x16x64_bf16 v[82:85], v[58:61], v[102:109], v1
  s_nop 5
  v_cvt_pk_bf16_f32 v78, v78, v79
  v_cvt_pk_bf16_f32 v79, v80, v81
  v_cvt_pk_bf16_f32 v80, v82, v83
  v_cvt_pk_bf16_f32 v81, v84, v85
  buffer_store_dwordx4 v[78:81], v18, s[8:11], s38 offen sc1
  s_add_u32 s66, s66, s69
  s_nop 0
  s_branch L_loopendRf
L_kvldRf:
  s_add_u32 s26, s18, 3
  s_lshr_b32 s26, s26, 2
  s_min_u32 s26, s26, 15
  s_lshl_b32 s26, s26, 12
  s_add_u32 s67, s26, s68
  s_mov_b32 m0, 149568
  s_nop 0
  buffer_load_dword v15, s[8:11], s67 offen sc1 lds
  s_branch L_kvld_rRf
L_kvckRf:
  v_mov_b32 v126, 149568
  ds_read_b32 v127, v126
  s_waitcnt lgkmcnt(0)
  v_readfirstlane_b32 s26, v127
  s_cmp_lg_u32 s26, 0
  s_nop 3
  s_cbranch_scc1 L_kvokRf
L_kvspinRf:
  buffer_load_dword v127, v15, s[8:11], s67 offen sc1
  s_waitcnt vmcnt(0)
  v_readfirstlane_b32 s26, v127
  s_cmp_eq_u32 s26, 0
  s_nop 3
  s_cbranch_scc1 L_kvspinRf
  s_branch L_kvokRf
L_loopendRf:
  s_branch L_recdoneR
L_slowloopR:
L_stepRs:
  buffer_load_dwordx4 v[86:89], v18, s[8:11], s19 offen sc1
  buffer_load_dwordx4 v[90:93], v18, s[8:11], s19 offen offset:1024 sc1
  s_sleep 3
  buffer_load_dwordx4 v[94:97], v18, s[8:11], s19 offen sc1
  buffer_load_dwordx4 v[98:101], v18, s[8:11], s19 offen offset:1024 sc1
L_gatRs:
  s_waitcnt vmcnt(2)
  ds_write_b128 v19, v[86:89]
  ds_write_b128 v19, v[90:93] offset:1024
  v_max3_u32 v126, v86, v87, v88
  v_max3_u32 v127, v89, v90, v91
  v_max3_u32 v126, v126, v92, v93
  v_max_u32 v126, v126, v127
  v_cmp_eq_u32 vcc, -1, v126
  s_cbranch_vccz L_gokRs
  buffer_load_dwordx4 v[86:89], v18, s[8:11], s19 offen sc1
  buffer_load_dwordx4 v[90:93], v18, s[8:11], s19 offen offset:1024 sc1
  s_waitcnt vmcnt(2)
  ds_write_b128 v19, v[94:97]
  ds_write_b128 v19, v[98:101] offset:1024
  v_max3_u32 v126, v94, v95, v96
  v_max3_u32 v127, v97, v98, v99
  v_max3_u32 v126, v126, v100, v101
  v_max_u32 v126, v126, v127
  v_cmp_eq_u32 vcc, -1, v126
  s_cbranch_vccz L_gokRs
  buffer_load_dwordx4 v[94:97], v18, s[8:11], s19 offen sc1
  buffer_load_dwordx4 v[98:101], v18, s[8:11], s19 offen offset:1024 sc1
  s_branch L_gatRs
L_gokRs:
  s_waitcnt lgkmcnt(0)
  s_barrier
  ds_read_b128 v[30:33], v20 offset:0
  ds_read_b128 v[34:37], v20 offset:1024
  ds_read_b128 v[38:41], v20 offset:2048
  s_waitcnt lgkmcnt(2)
  v_smfmac_f32_16x16x64_bf16 v[62:65], v[30:33], a[0:7], v1
  buffer_load_dwordx4 v[86:89], v18, s[8:11], s37 offen offset:0 sc1
  v_smfmac_f32_16x16x64_bf16 v[70:73], v[30:33], a[64:71], v1
  ds_read_b128 v[42:45], v20 offset:3072
  v_smfmac_f32_16x16x64_bf16 v[66:69], v[30:33], a[128:135], v1
  v_smfmac_f32_16x16x64_bf16 v[74:77], v[30:33], a[192:199], v1
  v_smfmac_f32_16x16x64_bf16 v[78:81], v[30:33], v[102:109], v1
  ds_read_b128 v[102:105], v27 offset:10240
  ds_read_b128 v[106:109], v27 offset:11264
  v_smfmac_f32_16x16x64_bf16 v[82:85], v[30:33], v[110:117], v1
  ds_read_b128 v[110:113], v27 offset:4096
  ds_read_b128 v[114:117], v27 offset:5120
  s_waitcnt lgkmcnt(6)
  v_smfmac_f32_16x16x64_bf16 v[62:65], v[34:37], a[8:15], v1
  buffer_load_dwordx4 v[90:93], v18, s[8:11], s37 offen offset:1024 sc1
  v_smfmac_f32_16x16x64_bf16 v[70:73], v[34:37], a[72:79], v1
  ds_read_b128 v[46:49], v20 offset:4096
  v_smfmac_f32_16x16x64_bf16 v[66:69], v[34:37], a[136:143], v1
  v_smfmac_f32_16x16x64_bf16 v[74:77], v[34:37], a[200:207], v1
  v_smfmac_f32_16x16x64_bf16 v[78:81], v[34:37], v[118:125], v1
  ds_read_b128 v[118:121], v27 offset:12288
  ds_read_b128 v[122:125], v27 offset:13312
  s_waitcnt lgkmcnt(5)
  v_smfmac_f32_16x16x64_bf16 v[82:85], v[34:37], v[102:109], v1
  ds_read_b128 v[102:105], v27 offset:6144
  ds_read_b128 v[106:109], v27 offset:7168
  s_waitcnt lgkmcnt(10)
  v_smfmac_f32_16x16x64_bf16 v[62:65], v[38:41], a[16:23], v1
  buffer_load_dwordx4 v[94:97], v18, s[8:11], s37 offen offset:2048 sc1
  v_smfmac_f32_16x16x64_bf16 v[70:73], v[38:41], a[80:87], v1
  ds_read_b128 v[50:53], v20 offset:5120
  v_smfmac_f32_16x16x64_bf16 v[66:69], v[38:41], a[144:151], v1
  v_smfmac_f32_16x16x64_bf16 v[74:77], v[38:41], a[208:215], v1
  s_waitcnt lgkmcnt(6)
  v_smfmac_f32_16x16x64_bf16 v[78:81], v[38:41], v[110:117], v1
  ds_read_b128 v[110:113], v27 offset:14336
  ds_read_b128 v[114:117], v27 offset:15360
  s_waitcnt lgkmcnt(5)
  v_smfmac_f32_16x16x64_bf16 v[82:85], v[38:41], v[118:125], v1
  ds_read_b128 v[118:121], v28 offset:0
  ds_read_b128 v[122:125], v28 offset:1024
  s_waitcnt lgkmcnt(14)
  v_smfmac_f32_16x16x64_bf16 v[62:65], v[42:45], a[24:31], v1
  buffer_load_dwordx4 v[98:101], v18, s[8:11], s37 offen offset:3072 sc1
  v_smfmac_f32_16x16x64_bf16 v[70:73], v[42:45], a[88:95], v1
  ds_read_b128 v[54:57], v20 offset:6144
  v_smfmac_f32_16x16x64_bf16 v[66:69], v[42:45], a[152:159], v1
  v_smfmac_f32_16x16x64_bf16 v[74:77], v[42:45], a[216:223], v1
  s_waitcnt lgkmcnt(10)
  v_smfmac_f32_16x16x64_bf16 v[62:65], v[46:49], a[32:39], v1
  s_and_b32 s25, s18, 3
  s_cmp_eq_u32 s25, 1
  s_cbranch_scc1 L_kvldRs
L_kvld_rRs:
  s_cmp_eq_u32 s25, 2
  s_cbranch_scc1 L_kvckRs
L_kvokRs:
  s_add_u32 s37, s37, 0x80000
  s_mov_b32 m0, 147456
  v_lshlrev_b32 v126, 3, v18
  buffer_load_dword v126, s[8:11], s37 offen sc1 lds
  v_smfmac_f32_16x16x64_bf16 v[70:73], v[46:49], a[96:103], v1
  ds_read_b128 v[58:61], v20 offset:7168
  v_smfmac_f32_16x16x64_bf16 v[66:69], v[46:49], a[160:167], v1
  v_smfmac_f32_16x16x64_bf16 v[74:77], v[46:49], a[224:231], v1
  s_waitcnt lgkmcnt(6)
  v_smfmac_f32_16x16x64_bf16 v[62:65], v[50:53], a[40:47], v1
  v_smfmac_f32_16x16x64_bf16 v[70:73], v[50:53], a[104:111], v1
  v_smfmac_f32_16x16x64_bf16 v[66:69], v[50:53], a[168:175], v1
  v_smfmac_f32_16x16x64_bf16 v[74:77], v[50:53], a[232:239], v1
  s_waitcnt lgkmcnt(1)
  v_smfmac_f32_16x16x64_bf16 v[62:65], v[54:57], a[48:55], v1
  v_smfmac_f32_16x16x64_bf16 v[70:73], v[54:57], a[112:119], v1
  v_smfmac_f32_16x16x64_bf16 v[66:69], v[54:57], a[176:183], v1
  v_smfmac_f32_16x16x64_bf16 v[74:77], v[54:57], a[240:247], v1
  s_waitcnt lgkmcnt(0)
  v_smfmac_f32_16x16x64_bf16 v[62:65], v[58:61], a[56:63], v1
  v_smfmac_f32_16x16x64_bf16 v[70:73], v[58:61], a[120:127], v1
  v_smfmac_f32_16x16x64_bf16 v[66:69], v[58:61], a[184:191], v1
  v_smfmac_f32_16x16x64_bf16 v[74:77], v[58:61], a[248:255], v1
  s_waitcnt lgkmcnt(7)
  v_smfmac_f32_16x16x64_bf16 v[78:81], v[42:45], v[102:109], v1
  ds_read_b128 v[102:105], v28 offset:8192
  ds_read_b128 v[106:109], v28 offset:9216
  s_nop 0
  v_cvt_pk_bf16_f32 v62, v62, v63
  v_cvt_pk_bf16_f32 v63, v64, v65
  v_cvt_pk_bf16_f32 v70, v70, v71
  v_cvt_pk_bf16_f32 v71, v72, v73
  v_cvt_pk_bf16_f32 v64, v66, v67
  v_cvt_pk_bf16_f32 v65, v68, v69
  v_cvt_pk_bf16_f32 v72, v74, v75
  v_cvt_pk_bf16_f32 v73, v76, v77
  v_mfma_f32_16x16x32_bf16 v[66:69], v[62:65], v[2:5], 0
  s_nop 0
  v_mfma_f32_16x16x32_bf16 v[74:77], v[70:73], v[2:5], 0
  v_mov_b32 v126, 1
  buffer_store_dword v126, v15, s[8:11], s66 offen sc1
  s_waitcnt lgkmcnt(6)
  v_smfmac_f32_16x16x64_bf16 v[82:85], v[42:45], v[110:117], v1
  ds_read_b128 v[110:113], v28 offset:2048
  ds_read_b128 v[114:117], v28 offset:3072
  v_cvt_pk_bf16_f32 v62, v66, v67
  v_cvt_pk_bf16_f32 v63, v68, v69
  v_cvt_pk_bf16_f32 v64, v74, v75
  v_cvt_pk_bf16_f32 v65, v76, v77
  s_waitcnt vmcnt(4)
  s_nop 0
  v_mfma_f32_16x16x32_bf16 v[66:69], v[62:65], v[62:65], 0
  v_mfma_f32_16x16x32_bf16 v[70:73], v[86:89], v[62:65], 0
  v_mfma_f32_16x16x32_bf16 v[74:77], v[90:93], v[62:65], 0
  buffer_store_dwordx4 v[62:65], v29, s[8:11], s39 offen sc1
  s_nop 4
  ds_write_b128 v23, v[66:69]
  s_nop 0
  v_mov_b32_dpp v70, v74 row_ror:8 row_mask:0xf bank_mask:0xc
  v_mov_b32_dpp v71, v75 row_ror:8 row_mask:0xf bank_mask:0xc
  v_mov_b32_dpp v72, v76 row_ror:8 row_mask:0xf bank_mask:0xc
  v_mov_b32_dpp v73, v77 row_ror:8 row_mask:0xf bank_mask:0xc
  ds_write_b128 v21, v[70:73]
  s_waitcnt lgkmcnt(8)
  v_smfmac_f32_16x16x64_bf16 v[78:81], v[46:49], v[118:125], v1
  ds_read_b128 v[118:121], v28 offset:10240
  ds_read_b128 v[122:125], v28 offset:11264
  s_waitcnt lgkmcnt(6)
  v_smfmac_f32_16x16x64_bf16 v[82:85], v[46:49], v[102:109], v1
  ds_read_b128 v[102:105], v28 offset:4096
  ds_read_b128 v[106:109], v28 offset:5120
  s_waitcnt lgkmcnt(6)
  v_smfmac_f32_16x16x64_bf16 v[78:81], v[50:53], v[110:117], v1
  ds_read_b128 v[110:113], v28 offset:12288
  ds_read_b128 v[114:117], v28 offset:13312
  s_waitcnt lgkmcnt(6)
  s_barrier
  ds_read_b128 v[86:89], v24 offset:0
  ds_read_b128 v[90:93], v24 offset:1024
  ds_read_b128 v[70:73], v24 offset:2048
  ds_read_b128 v[74:77], v24 offset:3072
  ds_read2_b32 v[66:67], v25 offset0:0 offset1:64
  ds_read2_b32 v[68:69], v25 offset0:128 offset1:192
  s_waitcnt lgkmcnt(10)
  v_smfmac_f32_16x16x64_bf16 v[82:85], v[50:53], v[118:125], v1
  ds_read_b128 v[118:121], v28 offset:6144
  ds_read_b128 v[122:125], v28 offset:7168
  s_waitcnt lgkmcnt(10)
  v_smfmac_f32_16x16x64_bf16 v[78:81], v[54:57], v[102:109], v1
  ds_read_b128 v[102:105], v28 offset:14336
  ds_read_b128 v[106:109], v28 offset:15360
  s_waitcnt lgkmcnt(4)
  v_pk_add_f32 v[86:87], v[86:87], v[90:91]
  v_pk_add_f32 v[70:71], v[70:71], v[74:75]
  v_pk_add_f32 v[88:89], v[88:89], v[92:93]
  v_pk_add_f32 v[72:73], v[72:73], v[76:77]
  v_pk_add_f32 v[66:67], v[66:67], v[68:69]
  v_pk_add_f32 v[86:87], v[86:87], v[70:71]
  v_pk_add_f32 v[88:89], v[88:89], v[72:73]
  v_add_f32 v66, v66, v67
  v_max3_f32 v67, v86, v87, v88
  v_max3_f32 v67, v67, v89, v66
  s_waitcnt lgkmcnt(10)
  v_smfmac_f32_16x16x64_bf16 v[82:85], v[54:57], v[110:117], v1
  v_max_f32_dpp v67, v67, v67 quad_perm:[2,3,0,1] row_mask:0xf bank_mask:0xf
  v_mov_b32 v68, v67
  s_waitcnt lgkmcnt(2)
  v_smfmac_f32_16x16x64_bf16 v[78:81], v[58:61], v[118:125], v1
  v_permlane16_swap_b32 v67, v68
  v_max_f32 v67, v67, v68
  v_mov_b32 v68, v67
  s_nop 1
  v_permlane32_swap_b32 v67, v68
  v_max_f32 v67, v67, v68
  v_mul_f32 v67, s30, v67
  v_fma_f32 v86, v86, s30, -v67
  v_fma_f32 v87, v87, s30, -v67
  v_fma_f32 v88, v88, s30, -v67
  v_fma_f32 v89, v89, s30, -v67
  v_fma_f32 v66, v66, s30, -v67
  v_exp_f32 v86, v86
  v_exp_f32 v87, v87
  v_exp_f32 v88, v88
  v_exp_f32 v89, v89
  v_exp_f32 v66, v66
  v_cvt_pk_bf16_f32 v62, v86, v87
  v_cvt_pk_bf16_f32 v63, v88, v89
  v_mov_b32_dpp v67, v66 quad_perm:[2,3,0,1] row_mask:0xf bank_mask:0xf
  v_mov_b32_dpp v64, v62 quad_perm:[2,3,0,1] row_mask:0xf bank_mask:0xf
  v_mov_b32_dpp v65, v63 quad_perm:[2,3,0,1] row_mask:0xf bank_mask:0xf
  v_cvt_pk_bf16_f32 v126, v66, v67
  s_waitcnt vmcnt(3)
  s_waitcnt lgkmcnt(0)
  v_smfmac_f32_16x16x64_bf16 v[82:85], v[58:61], v[102:109], v1
  v_mfma_f32_16x16x32_bf16 v[70:73], v[10:13], v[62:65], 0
  v_mov_b32 v127, v126
  v_mfma_f32_16x16x32_bf16 v[86:89], v[94:97], v[62:65], 0
  v_mov_b32 v67, 0
  v_mfma_f32_16x16x32_bf16 v[90:93], v[98:101], v[62:65], 0
  v_mov_b32 v66, v126
  v_cvt_pk_bf16_f32 v78, v78, v79
  v_cvt_pk_bf16_f32 v79, v80, v81
  v_cvt_pk_bf16_f32 v80, v82, v83
  v_cvt_pk_bf16_f32 v81, v84, v85
  v_mfma_f32_16x16x16_bf16 v[70:73], v[10:11], v[66:67], v[70:73]
  v_mfma_f32_16x16x16_bf16 v[86:89], v[78:79], v[126:127], v[86:89]
  v_mfma_f32_16x16x16_bf16 v[90:93], v[80:81], v[126:127], v[90:93]
  buffer_store_dwordx4 v[78:81], v18, s[8:11], s38 offen sc1
  v_mov_b64 v[30:31], 0
  v_mov_b64 v[32:33], 0
  v_mov_b64 v[34:35], 0
  v_mov_b64 v[36:37], 0
  v_mov_b64 v[38:39], 0
  v_mov_b64 v[40:41], 0
  v_rcp_f32 v66, v70
  v_mov_b64 v[42:43], 0
  v_mov_b32 v67, v66
  v_pk_mul_f32 v[86:87], v[86:87], v[66:67]
  v_pk_mul_f32 v[88:89], v[88:89], v[66:67]
  v_pk_mul_f32 v[90:91], v[90:91], v[66:67]
  v_pk_mul_f32 v[92:93], v[92:93], v[66:67]
  v_cvt_pk_bf16_f32 v74, v86, v87
  v_cvt_pk_bf16_f32 v75, v88, v89
  v_cvt_pk_bf16_f32 v76, v90, v91
  v_cvt_pk_bf16_f32 v77, v92, v93
  ds_write_b128 v26, v[74:77]
  v_mov_b64 v[44:45], 0
  v_mov_b64 v[46:47], 0
  v_mov_b64 v[48:49], 0
  v_mov_b64 v[50:51], 0
  v_mov_b64 v[52:53], 0
  v_mov_b64 v[54:55], 0
  v_mov_b64 v[56:57], 0
  v_mov_b64 v[58:59], 0
  v_mov_b64 v[60:61], 0
  s_waitcnt lgkmcnt(0)
  s_barrier
  ds_read_b128 v[62:65], v20 offset:14336
  ds_read_b128 v[66:69], v20 offset:15360
  s_waitcnt lgkmcnt(1)
  v_smfmac_f32_16x16x64_bf16 v[30:33], v[62:65], v[128:135], v1
  s_waitcnt lgkmcnt(0)
  v_smfmac_f32_16x16x64_bf16 v[30:33], v[66:69], v[136:143], v1
  v_smfmac_f32_16x16x64_bf16 v[34:37], v[62:65], v[144:151], v1
  v_smfmac_f32_16x16x64_bf16 v[34:37], v[66:69], v[152:159], v1
  v_smfmac_f32_16x16x64_bf16 v[38:41], v[62:65], v[160:167], v1
  v_smfmac_f32_16x16x64_bf16 v[38:41], v[66:69], v[168:175], v1
  v_smfmac_f32_16x16x64_bf16 v[42:45], v[62:65], v[176:183], v1
  v_smfmac_f32_16x16x64_bf16 v[42:45], v[66:69], v[184:191], v1
  v_smfmac_f32_16x16x64_bf16 v[46:49], v[62:65], v[192:199], v1
  v_smfmac_f32_16x16x64_bf16 v[46:49], v[66:69], v[200:207], v1
  v_smfmac_f32_16x16x64_bf16 v[50:53], v[62:65], v[208:215], v1
  v_smfmac_f32_16x16x64_bf16 v[50:53], v[66:69], v[216:223], v1
  v_add_f32 v30, v30, v32
  v_add_f32 v31, v31, v33
  v_cvt_pk_bf16_f32 v102, v30, v31
  v_add_f32 v34, v34, v36
  v_add_f32 v35, v35, v37
  v_cvt_pk_bf16_f32 v103, v34, v35
  v_add_f32 v38, v38, v40
  v_add_f32 v39, v39, v41
  v_cvt_pk_bf16_f32 v104, v38, v39
  v_add_f32 v42, v42, v44
  v_add_f32 v43, v43, v45
  v_cvt_pk_bf16_f32 v105, v42, v43
  v_and_or_b32 v102, v102, -2, s22
  buffer_store_dwordx4 v[102:105], v14, s[8:11], s32 offen sc1
  v_smfmac_f32_16x16x64_bf16 v[54:57], v[62:65], v[224:231], v1
  v_smfmac_f32_16x16x64_bf16 v[54:57], v[66:69], v[232:239], v1
  v_smfmac_f32_16x16x64_bf16 v[58:61], v[62:65], v[240:247], v1
  v_smfmac_f32_16x16x64_bf16 v[58:61], v[66:69], v[248:255], v1
  v_pk_add_f32 v[46:47], v[46:47], v[48:49]
  v_pk_add_f32 v[50:51], v[50:51], v[52:53]
  s_nop 3
  v_pk_add_f32 v[54:55], v[54:55], v[56:57]
  s_nop 0
  v_pk_add_f32 v[58:59], v[58:59], v[60:61]
  v_cvt_pk_bf16_f32 v106, v46, v47
  v_cvt_pk_bf16_f32 v107, v50, v51
  v_cvt_pk_bf16_f32 v108, v54, v55
  v_cvt_pk_bf16_f32 v109, v58, v59
  v_and_or_b32 v106, v106, -2, s22
  buffer_store_dwordx4 v[106:109], v14, s[8:11], s33 offen sc1
  v_mov_b64 v[62:63], 0
  v_mov_b64 v[64:65], 0
  v_mov_b64 v[66:67], 0
  v_mov_b64 v[68:69], 0
  v_mov_b64 v[70:71], 0
  v_mov_b64 v[72:73], 0
  v_mov_b64 v[74:75], 0
  v_mov_b64 v[76:77], 0
  v_mov_b64 v[78:79], 0
  v_mov_b64 v[80:81], 0
  v_mov_b64 v[82:83], 0
  v_mov_b64 v[84:85], 0
  ds_read_b128 v[102:105], v27 offset:0
  ds_read_b128 v[106:109], v27 offset:1024
  ds_read_b128 v[110:113], v27 offset:8192
  ds_read_b128 v[114:117], v27 offset:9216
  ds_read_b128 v[118:121], v27 offset:2048
  ds_read_b128 v[122:125], v27 offset:3072
  s_sleep 3
  buffer_load_dwordx4 v[30:33], v18, s[8:11], s34 offen sc1
  buffer_load_dwordx4 v[34:37], v18, s[8:11], s34 offen offset:1024 sc1
  s_sleep 3
  buffer_load_dwordx4 v[38:41], v18, s[8:11], s34 offen sc1
  buffer_load_dwordx4 v[42:45], v18, s[8:11], s34 offen offset:1024 sc1
L_redRs:
  s_waitcnt vmcnt(3)
  v_mfma_f32_16x16x32_bf16 v[46:49], v[30:33], v[6:9], 0
  s_waitcnt vmcnt(2)
  v_mfma_f32_16x16x32_bf16 v[46:49], v[34:37], v[6:9], v[46:49]
  v_bitop3_b32 v50, v30, v34, s23 bitop3:0x7e
  v_and_b32 v50, 1, v50
  v_cmp_ne_u32 vcc, 0, v50
  s_cbranch_vccz L_rokRs
  s_nop 3
  buffer_load_dwordx4 v[30:33], v18, s[8:11], s34 offen sc1
  buffer_load_dwordx4 v[34:37], v18, s[8:11], s34 offen offset:1024 sc1
  s_waitcnt vmcnt(3)
  v_mfma_f32_16x16x32_bf16 v[46:49], v[38:41], v[6:9], 0
  s_waitcnt vmcnt(2)
  v_mfma_f32_16x16x32_bf16 v[46:49], v[42:45], v[6:9], v[46:49]
  v_bitop3_b32 v50, v38, v42, s23 bitop3:0x7e
  v_and_b32 v50, 1, v50
  v_cmp_ne_u32 vcc, 0, v50
  s_cbranch_vccz L_rokRs
  s_nop 3
  buffer_load_dwordx4 v[38:41], v18, s[8:11], s34 offen sc1
  buffer_load_dwordx4 v[42:45], v18, s[8:11], s34 offen offset:1024 sc1
  s_branch L_redRs
L_rokRs:
  s_nop 3
  v_mov_b32 v51, -1
  v_permlane32_swap_b32 v46, v47
  v_permlane32_swap_b32 v48, v49
  v_add_f32 v46, v46, v47
  v_add_f32 v48, v48, v49
  s_nop 1
  v_permlane16_swap_b32 v46, v48
  v_add_f32 v46, v46, v48
  s_nop 1
  v_mov_b32_dpp v47, v46 quad_perm:[2,3,0,1] row_mask:0xf bank_mask:0xf
  v_cvt_pk_bf16_f32 v50, v46, v47
  v_min_u32 v50, -2, v50
  s_add_u32 s25, s35, s20
  buffer_store_dword v50, v16, s[8:11], s25 offen sc1
  s_add_u32 s26, s35, s21
  buffer_store_dword v51, v16, s[8:11], s26 offen sc1
  s_sleep 2
  s_add_u32 s18, s18, 1
  s_add_u32 s19, s36, s20
  s_mov_b32 s21, s20
  s_add_u32 s20, s20, 8192
  s_cmp_ge_u32 s20, 24576
  s_cselect_b32 s20, 0, s20
  s_xor_b32 s22, s22, 1
  s_not_b32 s23, s23
  s_add_u32 s39, s39, 0x10000
  s_add_u32 s38, s38, 0x20000
  s_add_u32 s31, s31, 8192
  s_add_u32 s66, s66, s69
  s_mov_b32 s69, s71
  s_cmp_lt_u32 s18, 63
  s_cbranch_scc1 L_stepRs
  buffer_load_dwordx4 v[86:89], v18, s[8:11], s19 offen sc1
  buffer_load_dwordx4 v[90:93], v18, s[8:11], s19 offen offset:1024 sc1
  s_sleep 3
  buffer_load_dwordx4 v[94:97], v18, s[8:11], s19 offen sc1
  buffer_load_dwordx4 v[98:101], v18, s[8:11], s19 offen offset:1024 sc1
L_gatRsz:
  s_waitcnt vmcnt(2)
  ds_write_b128 v19, v[86:89]
  ds_write_b128 v19, v[90:93] offset:1024
  v_max3_u32 v126, v86, v87, v88
  v_max3_u32 v127, v89, v90, v91
  v_max3_u32 v126, v126, v92, v93
  v_max_u32 v126, v126, v127
  v_cmp_eq_u32 vcc, -1, v126
  s_cbranch_vccz L_gokRsz
  buffer_load_dwordx4 v[86:89], v18, s[8:11], s19 offen sc1
  buffer_load_dwordx4 v[90:93], v18, s[8:11], s19 offen offset:1024 sc1
  s_waitcnt vmcnt(2)
  ds_write_b128 v19, v[94:97]
  ds_write_b128 v19, v[98:101] offset:1024
  v_max3_u32 v126, v94, v95, v96
  v_max3_u32 v127, v97, v98, v99
  v_max3_u32 v126, v126, v100, v101
  v_max_u32 v126, v126, v127
  v_cmp_eq_u32 vcc, -1, v126
  s_cbranch_vccz L_gokRsz
  buffer_load_dwordx4 v[94:97], v18, s[8:11], s19 offen sc1
  buffer_load_dwordx4 v[98:101], v18, s[8:11], s19 offen offset:1024 sc1
  s_branch L_gatRsz
L_gokRsz:
  s_waitcnt lgkmcnt(0)
  s_barrier
  ds_read_b128 v[30:33], v20 offset:0
  ds_read_b128 v[34:37], v20 offset:1024
  ds_read_b128 v[38:41], v20 offset:2048
  s_waitcnt lgkmcnt(2)
  v_smfmac_f32_16x16x64_bf16 v[62:65], v[30:33], a[0:7], v1
  v_smfmac_f32_16x16x64_bf16 v[70:73], v[30:33], a[64:71], v1
  ds_read_b128 v[42:45], v20 offset:3072
  v_smfmac_f32_16x16x64_bf16 v[66:69], v[30:33], a[128:135], v1
  v_smfmac_f32_16x16x64_bf16 v[74:77], v[30:33], a[192:199], v1
  v_smfmac_f32_16x16x64_bf16 v[78:81], v[30:33], v[102:109], v1
  ds_read_b128 v[102:105], v27 offset:10240
  ds_read_b128 v[106:109], v27 offset:11264
  v_smfmac_f32_16x16x64_bf16 v[82:85], v[30:33], v[110:117], v1
  ds_read_b128 v[110:113], v27 offset:4096
  ds_read_b128 v[114:117], v27 offset:5120
  s_waitcnt lgkmcnt(6)
  v_smfmac_f32_16x16x64_bf16 v[62:65], v[34:37], a[8:15], v1
  v_smfmac_f32_16x16x64_bf16 v[70:73], v[34:37], a[72:79], v1
  ds_read_b128 v[46:49], v20 offset:4096
  v_smfmac_f32_16x16x64_bf16 v[66:69], v[34:37], a[136:143], v1
  v_smfmac_f32_16x16x64_bf16 v[74:77], v[34:37], a[200:207], v1
  v_smfmac_f32_16x16x64_bf16 v[78:81], v[34:37], v[118:125], v1
  ds_read_b128 v[118:121], v27 offset:12288
  ds_read_b128 v[122:125], v27 offset:13312
  s_waitcnt lgkmcnt(5)
  v_smfmac_f32_16x16x64_bf16 v[82:85], v[34:37], v[102:109], v1
  ds_read_b128 v[102:105], v27 offset:6144
  ds_read_b128 v[106:109], v27 offset:7168
  s_waitcnt lgkmcnt(10)
  v_smfmac_f32_16x16x64_bf16 v[62:65], v[38:41], a[16:23], v1
  v_smfmac_f32_16x16x64_bf16 v[70:73], v[38:41], a[80:87], v1
  ds_read_b128 v[50:53], v20 offset:5120
  v_smfmac_f32_16x16x64_bf16 v[66:69], v[38:41], a[144:151], v1
  v_smfmac_f32_16x16x64_bf16 v[74:77], v[38:41], a[208:215], v1
  s_waitcnt lgkmcnt(6)
  v_smfmac_f32_16x16x64_bf16 v[78:81], v[38:41], v[110:117], v1
  ds_read_b128 v[110:113], v27 offset:14336
  ds_read_b128 v[114:117], v27 offset:15360
  s_waitcnt lgkmcnt(5)
  v_smfmac_f32_16x16x64_bf16 v[82:85], v[38:41], v[118:125], v1
  ds_read_b128 v[118:121], v28 offset:0
  ds_read_b128 v[122:125], v28 offset:1024
  s_waitcnt lgkmcnt(14)
  v_smfmac_f32_16x16x64_bf16 v[62:65], v[42:45], a[24:31], v1
  v_smfmac_f32_16x16x64_bf16 v[70:73], v[42:45], a[88:95], v1
  ds_read_b128 v[54:57], v20 offset:6144
  v_smfmac_f32_16x16x64_bf16 v[66:69], v[42:45], a[152:159], v1
  v_smfmac_f32_16x16x64_bf16 v[74:77], v[42:45], a[216:223], v1
  s_waitcnt lgkmcnt(10)
  v_smfmac_f32_16x16x64_bf16 v[62:65], v[46:49], a[32:39], v1
  v_smfmac_f32_16x16x64_bf16 v[70:73], v[46:49], a[96:103], v1
  ds_read_b128 v[58:61], v20 offset:7168
  v_smfmac_f32_16x16x64_bf16 v[66:69], v[46:49], a[160:167], v1
  v_smfmac_f32_16x16x64_bf16 v[74:77], v[46:49], a[224:231], v1
  s_waitcnt lgkmcnt(6)
  v_smfmac_f32_16x16x64_bf16 v[62:65], v[50:53], a[40:47], v1
  v_smfmac_f32_16x16x64_bf16 v[70:73], v[50:53], a[104:111], v1
  v_smfmac_f32_16x16x64_bf16 v[66:69], v[50:53], a[168:175], v1
  v_smfmac_f32_16x16x64_bf16 v[74:77], v[50:53], a[232:239], v1
  s_waitcnt lgkmcnt(1)
  v_smfmac_f32_16x16x64_bf16 v[62:65], v[54:57], a[48:55], v1
  v_smfmac_f32_16x16x64_bf16 v[70:73], v[54:57], a[112:119], v1
  v_smfmac_f32_16x16x64_bf16 v[66:69], v[54:57], a[176:183], v1
  v_smfmac_f32_16x16x64_bf16 v[74:77], v[54:57], a[240:247], v1
  s_waitcnt lgkmcnt(0)
  v_smfmac_f32_16x16x64_bf16 v[62:65], v[58:61], a[56:63], v1
  v_smfmac_f32_16x16x64_bf16 v[70:73], v[58:61], a[120:127], v1
  v_smfmac_f32_16x16x64_bf16 v[66:69], v[58:61], a[184:191], v1
  v_smfmac_f32_16x16x64_bf16 v[74:77], v[58:61], a[248:255], v1
  s_waitcnt lgkmcnt(7)
  v_smfmac_f32_16x16x64_bf16 v[78:81], v[42:45], v[102:109], v1
  ds_read_b128 v[102:105], v28 offset:8192
  ds_read_b128 v[106:109], v28 offset:9216
  s_nop 0
  v_cvt_pk_bf16_f32 v62, v62, v63
  v_cvt_pk_bf16_f32 v63, v64, v65
  v_cvt_pk_bf16_f32 v70, v70, v71
  v_cvt_pk_bf16_f32 v71, v72, v73
  v_cvt_pk_bf16_f32 v64, v66, v67
  v_cvt_pk_bf16_f32 v65, v68, v69
  v_cvt_pk_bf16_f32 v72, v74, v75
  v_cvt_pk_bf16_f32 v73, v76, v77
  v_mfma_f32_16x16x32_bf16 v[66:69], v[62:65], v[2:5], 0
  s_nop 0
  v_mfma_f32_16x16x32_bf16 v[74:77], v[70:73], v[2:5], 0
  v_mov_b32 v126, 1
  buffer_store_dword v126, v15, s[8:11], s66 offen sc1
  s_waitcnt lgkmcnt(6)
  v_smfmac_f32_16x16x64_bf16 v[82:85], v[42:45], v[110:117], v1
  ds_read_b128 v[110:113], v28 offset:2048
  ds_read_b128 v[114:117], v28 offset:3072
  v_cvt_pk_bf16_f32 v62, v66, v67
  v_cvt_pk_bf16_f32 v63, v68, v69
  v_cvt_pk_bf16_f32 v64, v74, v75
  v_cvt_pk_bf16_f32 v65, v76, v77
  buffer_store_dwordx4 v[62:65], v29, s[8:11], s39 offen sc1
  s_waitcnt lgkmcnt(6)
  v_smfmac_f32_16x16x64_bf16 v[78:81], v[46:49], v[118:125], v1
  ds_read_b128 v[118:121], v28 offset:10240
  ds_read_b128 v[122:125], v28 offset:11264
  s_waitcnt lgkmcnt(4)
  v_smfmac_f32_16x16x64_bf16 v[82:85], v[46:49], v[102:109], v1
  ds_read_b128 v[102:105], v28 offset:4096
  ds_read_b128 v[106:109], v28 offset:5120
  s_waitcnt lgkmcnt(4)
  v_smfmac_f32_16x16x64_bf16 v[78:81], v[50:53], v[110:117], v1
  ds_read_b128 v[110:113], v28 offset:12288
  ds_read_b128 v[114:117], v28 offset:13312
  s_waitcnt lgkmcnt(4)
  v_smfmac_f32_16x16x64_bf16 v[82:85], v[50:53], v[118:125], v1
  ds_read_b128 v[118:121], v28 offset:6144
  ds_read_b128 v[122:125], v28 offset:7168
  s_waitcnt lgkmcnt(4)
  v_smfmac_f32_16x16x64_bf16 v[78:81], v[54:57], v[102:109], v1
  ds_read_b128 v[102:105], v28 offset:14336
  ds_read_b128 v[106:109], v28 offset:15360
  s_waitcnt lgkmcnt(4)
  v_smfmac_f32_16x16x64_bf16 v[82:85], v[54:57], v[110:117], v1
  s_waitcnt lgkmcnt(2)
  v_smfmac_f32_16x16x64_bf16 v[78:81], v[58:61], v[118:125], v1
  s_waitcnt lgkmcnt(0)
  v_smfmac_f32_16x16x64_bf16 v[82:85], v[58:61], v[102:109], v1
  s_nop 5
  v_cvt_pk_bf16_f32 v78, v78, v79
  v_cvt_pk_bf16_f32 v79, v80, v81
  v_cvt_pk_bf16_f32 v80, v82, v83
  v_cvt_pk_bf16_f32 v81, v84, v85
  buffer_store_dwordx4 v[78:81], v18, s[8:11], s38 offen sc1
  s_add_u32 s66, s66, s69
  s_nop 0
  s_branch L_loopendRs
L_kvldRs:
  s_add_u32 s26, s18, 3
  s_lshr_b32 s26, s26, 2
  s_min_u32 s26, s26, 15
  s_lshl_b32 s26, s26, 12
  s_add_u32 s67, s26, s68
  s_mov_b32 m0, 149568
  s_nop 0
  buffer_load_dword v15, s[8:11], s67 offen sc1 lds
  s_branch L_kvld_rRs
L_kvckRs:
  v_mov_b32 v126, 149568
  ds_read_b32 v127, v126
  s_waitcnt lgkmcnt(0)
  v_readfirstlane_b32 s26, v127
  s_cmp_lg_u32 s26, 0
  s_nop 3
  s_cbranch_scc1 L_kvokRs
L_kvspinRs:
  buffer_load_dword v127, v15, s[8:11], s67 offen sc1
  s_waitcnt vmcnt(0)
  v_readfirstlane_b32 s26, v127
  s_cmp_eq_u32 s26, 0
  s_nop 3
  s_cbranch_scc1 L_kvspinRs
  s_branch L_kvokRs
L_loopendRs:
L_recdoneR:
  s_waitcnt vmcnt(0)
  s_barrier
  v_mov_b32 v126, 1
  buffer_store_dword v126, v15, s[8:11], s66 offen sc1
  s_waitcnt vmcnt(0)
  s_nop 0
  s_branch L_endF
L_par:
  s_mul_i32 s3, s16, 3584
  s_add_u32 s3, s3, 327680
  s_cmp_eq_u32 s17, 0
  s_cselect_b32 s3, s3, 0x7f000000
  v_lshlrev_b32 v2, 7, v0
  v_mov_b32 v3, 0x7fff0000
  v_cmp_gt_u32 vcc, 28, v0
  s_nop 1
  v_cndmask_b32 v2, v3, v2, vcc
  v_mov_b32 v3, 0
  buffer_store_dword v3, v2, s[8:11], s3 offen sc1
  s_sub_u32 s96, s16, 32
  s_mov_b32 s97, s17
  s_mov_b32 s28, s17
  s_lshr_b32 s90, s96, 5
  s_and_b32 s91, s96, 31
  s_cmp_lt_u32 s90, 4
  s_cselect_b32 s89, 5, 4
  s_mul_i32 s88, s90, 5
  s_lshl_b32 s3, s90, 2
  s_add_u32 s3, s3, 4
  s_cselect_b32 s88, s88, s88
  s_cmp_lt_u32 s90, 4
  s_cselect_b32 s88, s88, s3
  s_load_dwordx2 s[12:13], s[0:1], 48
  s_load_dwordx2 s[16:17], s[0:1], 64
  s_load_dwordx2 s[20:21], s[0:1], 72
  s_load_dwordx2 s[24:25], s[0:1], 80
  s_mov_b32 s14, 0x200000
  s_mov_b32 s15, 0x20000
  s_mov_b32 s18, 0x400000
  s_mov_b32 s19, 0x20000
  s_mov_b32 s22, 0x400000
  s_mov_b32 s23, 0x20000
  s_mov_b32 s26, 0x400000
  s_mov_b32 s27, 0x20000
  v_and_b32 v20, 15, v0
  v_lshrrev_b32 v21, 4, v0
  v_lshlrev_b32 v6, 4, v0
  v_mov_b32 v7, 0x7fff0000
  v_cmp_eq_u32 vcc, 0, v0
  s_nop 1
  v_cndmask_b32 v7, v7, 0, vcc
  v_bfe_u32 v22, v20, 1, 2
  v_xor_b32 v22, v22, v21
  v_lshlrev_b32 v22, 4, v22
  v_lshlrev_b32 v23, 6, v20
  v_add_u32 v1, v22, v23
  v_bfe_u32 v22, v0, 2, 2
  v_lshlrev_b32 v23, 3, v21
  v_add_u32 v23, v23, v22
  v_lshlrev_b32 v23, 8, v23
  v_and_b32 v24, 1, v21
  v_lshlrev_b32 v24, 2, v24
  v_or_b32 v24, v24, v22
  v_lshlrev_b32 v24, 1, v24
  s_lshl_b32 s32, s28, 2
  v_bfe_u32 v25, v0, 1, 1
  v_add_u32 v25, s32, v25
  v_xor_b32 v25, v25, v24
  v_lshlrev_b32 v25, 4, v25
  v_and_b32 v26, 1, v0
  v_lshlrev_b32 v26, 3, v26
  v_add3_u32 v23, v23, v25, v26
  v_add_u32 v2, 8192, v23
  v_xor_b32 v3, 32, v2
  v_lshrrev_b32 v22, 2, v0
  v_lshlrev_b32 v22, 10, v22
  v_and_b32 v23, 3, v0
  v_bfe_u32 v24, v0, 3, 2
  v_xor_b32 v23, v23, v24
  v_lshlrev_b32 v23, 4, v23
  v_add_u32 v4, v22, v23
  v_lshlrev_b32 v22, 1, v21
  s_and_b32 s32, s28, 1
  s_lshl_b32 s32, s32, 3
  v_xor_b32 v22, s32, v22
  v_xor_b32 v22, v22, v20
  v_lshlrev_b32 v22, 4, v22
  v_lshlrev_b32 v23, 13, v21
  v_add_u32 v5, v22, v23
  s_lshl_b32 s39, s28, 11
  s_add_u32 s40, s39, 8192
  v_add_u32 v8, 0x10000, v1
  v_add_u32 v9, 0x10000, v2
  v_add_u32 v10, 0x10000, v3
  v_mov_b32 v11, 1
  s_waitcnt lgkmcnt(0)
  s_mov_b32 s95, 0
  s_lshl_b32 s3, s95, 5
  s_add_u32 s3, s3, s91
  s_mul_i32 s4, s3, 52429
  s_lshr_b32 s4, s4, 18
  s_lshr_b32 s5, s3, 2
  s_cmp_eq_u32 s89, 5
  s_cselect_b32 s4, s4, s5
  s_mul_i32 s5, s4, s89
  s_sub_u32 s5, s3, s5
  s_add_u32 s5, s5, s88
  s_lshl_b32 s92, s4, 5
  s_add_u32 s92, s92, s5
  s_cmp_lt_u32 s4, 16
  s_cselect_b32 s92, s92, -1
  s_mov_b32 s95, 1
  s_lshl_b32 s3, s95, 5
  s_add_u32 s3, s3, s91
  s_mul_i32 s4, s3, 52429
  s_lshr_b32 s4, s4, 18
  s_lshr_b32 s5, s3, 2
  s_cmp_eq_u32 s89, 5
  s_cselect_b32 s4, s4, s5
  s_mul_i32 s5, s4, s89
  s_sub_u32 s5, s3, s5
  s_add_u32 s5, s5, s88
  s_lshl_b32 s93, s4, 5
  s_add_u32 s93, s93, s5
  s_cmp_lt_u32 s4, 16
  s_cselect_b32 s93, s93, -1
  s_mov_b32 s95, 2
  s_lshl_b32 s3, s95, 5
  s_add_u32 s3, s3, s91
  s_mul_i32 s4, s3, 52429
  s_lshr_b32 s4, s4, 18
  s_lshr_b32 s5, s3, 2
  s_cmp_eq_u32 s89, 5
  s_cselect_b32 s4, s4, s5
  s_mul_i32 s5, s4, s89
  s_sub_u32 s5, s3, s5
  s_add_u32 s5, s5, s88
  s_lshl_b32 s94, s4, 5
  s_add_u32 s94, s94, s5
  s_cmp_lt_u32 s4, 16
  s_cselect_b32 s94, s94, -1
  v_lshrrev_b32 v32, 1, v0
  v_and_b32 v32, 31, v32
  v_lshlrev_b32 v32, 13, v32
  v_and_b32 v33, 1, v0
  v_lshlrev_b32 v33, 7, v33
  v_add_u32 v32, v32, v33
  s_lshl_b32 s3, s91, 17
  s_add_u32 s4, s88, s97
  s_lshl_b32 s4, s4, 8
  s_add_u32 s3, s3, s4
  s_mov_b32 m0, 131072
  v_mov_b32 v34, 0x7fff0000
  v_cmp_gt_u32 vcc, 32, v0
  s_nop 1
  v_cndmask_b32 v32, v34, v32, vcc
  buffer_load_dword v32, s[20:23], s3 offen lds
  buffer_load_dword v32, s[24:27], s3 offen lds
  s_add_u32 s3, s3, 1024
  s_lshl_b32 s4, s97, 8
  s_sub_u32 s3, s3, s4
  s_cmp_eq_u32 s89, 5
  s_cselect_b32 s4, 0, 1
  s_or_b32 s4, s4, s97
  s_cmp_eq_u32 s4, 0
  s_cselect_b32 s3, s3, 0x7f000000
  buffer_load_dword v32, s[20:23], s3 offen lds
  buffer_load_dword v32, s[24:27], s3 offen lds
  v_lshrrev_b32 v33, 3, v0
  v_lshlrev_b32 v33, 10, v33
  v_and_b32 v34, 7, v0
  v_lshlrev_b32 v34, 7, v34
  v_add_u32 v33, v33, v34
  s_lshl_b32 s3, s91, 15
  s_lshl_b32 s4, s97, 13
  s_add_u32 s3, s3, s4
  buffer_load_dword v33, s[12:15], s3 offen lds
  s_barrier
  v_add_u32 v156, 0, v1
  v_add_u32 v157, 0, v2
  v_add_u32 v158, 0, v3
  v_add_u32 v159, 49152, v1
  v_add_u32 v160, 49152, v2
  v_add_u32 v161, 49152, v3
  v_add_u32 v162, 98304, v1
  v_add_u32 v163, 98304, v2
  v_add_u32 v164, 98304, v3
  s_lshr_b32 s32, s92, 5
  s_lshl_b32 s35, s32, 17
  s_lshl_b32 s32, s28, 15
  s_add_u32 s35, s35, s32
  s_and_b32 s32, s92, 31
  s_lshl_b32 s36, s32, 8
  s_lshl_b32 s32, s28, 16
  s_add_u32 s36, s36, s32
  s_add_u32 m0, s39, 0
  s_add_u32 s34, s35, 0
  buffer_load_dwordx4 v4, s[12:15], s34 offen lds
  s_add_u32 m0, s39, 1024
  s_add_u32 s34, s35, 16384
  buffer_load_dwordx4 v4, s[12:15], s34 offen lds
  s_add_u32 m0, s40, 0
  s_add_u32 s34, s36, 0
  buffer_load_dwordx4 v5, s[20:23], s34 offen lds
  s_add_u32 m0, s40, 1024
  s_add_u32 s34, s36, 32768
  buffer_load_dwordx4 v5, s[20:23], s34 offen lds
  s_add_u32 m0, s40, 8192
  s_add_u32 s34, s36, 0
  buffer_load_dwordx4 v5, s[24:27], s34 offen lds
  s_add_u32 m0, s40, 9216
  s_add_u32 s34, s36, 32768
  buffer_load_dwordx4 v5, s[24:27], s34 offen lds
  s_add_u32 s35, s35, 64
  s_add_u32 s36, s36, 262144
  s_add_u32 m0, s39, 24576
  s_add_u32 s34, s35, 0
  buffer_load_dwordx4 v4, s[12:15], s34 offen lds
  s_add_u32 m0, s39, 25600
  s_add_u32 s34, s35, 16384
  buffer_load_dwordx4 v4, s[12:15], s34 offen lds
  s_add_u32 m0, s40, 24576
  s_add_u32 s34, s36, 0
  buffer_load_dwordx4 v5, s[20:23], s34 offen lds
  s_add_u32 m0, s40, 25600
  s_add_u32 s34, s36, 32768
  buffer_load_dwordx4 v5, s[20:23], s34 offen lds
  s_add_u32 m0, s40, 32768
  s_add_u32 s34, s36, 0
  buffer_load_dwordx4 v5, s[24:27], s34 offen lds
  s_add_u32 m0, s40, 33792
  s_add_u32 s34, s36, 32768
  buffer_load_dwordx4 v5, s[24:27], s34 offen lds
  s_add_u32 s35, s35, 64
  s_add_u32 s36, s36, 262144
  s_add_u32 m0, s39, 49152
  s_add_u32 s34, s35, 0
  buffer_load_dwordx4 v4, s[12:15], s34 offen lds
  s_add_u32 m0, s39, 50176
  s_add_u32 s34, s35, 16384
  buffer_load_dwordx4 v4, s[12:15], s34 offen lds
  s_add_u32 m0, s40, 49152
  s_add_u32 s34, s36, 0
  buffer_load_dwordx4 v5, s[20:23], s34 offen lds
  s_add_u32 m0, s40, 50176
  s_add_u32 s34, s36, 32768
  buffer_load_dwordx4 v5, s[20:23], s34 offen lds
  s_add_u32 m0, s40, 57344
  s_add_u32 s34, s36, 0
  buffer_load_dwordx4 v5, s[24:27], s34 offen lds
  s_add_u32 m0, s40, 58368
  s_add_u32 s34, s36, 32768
  buffer_load_dwordx4 v5, s[24:27], s34 offen lds
  s_add_u32 s35, s35, 64
  s_add_u32 s36, s36, 262144
  s_add_u32 m0, s39, 73728
  s_add_u32 s34, s35, 0
  buffer_load_dwordx4 v4, s[12:15], s34 offen lds
  s_add_u32 m0, s39, 74752
  s_add_u32 s34, s35, 16384
  buffer_load_dwordx4 v4, s[12:15], s34 offen lds
  s_add_u32 m0, s40, 73728
  s_add_u32 s34, s36, 0
  buffer_load_dwordx4 v5, s[20:23], s34 offen lds
  s_add_u32 m0, s40, 74752
  s_add_u32 s34, s36, 32768
  buffer_load_dwordx4 v5, s[20:23], s34 offen lds
  s_add_u32 m0, s40, 81920
  s_add_u32 s34, s36, 0
  buffer_load_dwordx4 v5, s[24:27], s34 offen lds
  s_add_u32 m0, s40, 82944
  s_add_u32 s34, s36, 32768
  buffer_load_dwordx4 v5, s[24:27], s34 offen lds
  s_add_u32 s35, s35, 64
  s_add_u32 s36, s36, 262144
  s_add_u32 m0, s39, 98304
  s_add_u32 s34, s35, 0
  buffer_load_dwordx4 v4, s[12:15], s34 offen lds
  s_add_u32 m0, s39, 99328
  s_add_u32 s34, s35, 16384
  buffer_load_dwordx4 v4, s[12:15], s34 offen lds
  s_add_u32 m0, s40, 98304
  s_add_u32 s34, s36, 0
  buffer_load_dwordx4 v5, s[20:23], s34 offen lds
  s_add_u32 m0, s40, 99328
  s_add_u32 s34, s36, 32768
  buffer_load_dwordx4 v5, s[20:23], s34 offen lds
  s_add_u32 m0, s40, 106496
  s_add_u32 s34, s36, 0
  buffer_load_dwordx4 v5, s[24:27], s34 offen lds
  s_add_u32 m0, s40, 107520
  s_add_u32 s34, s36, 32768
  buffer_load_dwordx4 v5, s[24:27], s34 offen lds
  s_add_u32 s35, s35, 64
  s_add_u32 s36, s36, 262144
  s_waitcnt vmcnt(24)
  s_barrier
  ds_read_b64_tr_b16 v[96:97], v157 offset:0
  ds_read_b64_tr_b16 v[98:99], v157 offset:1024
  ds_read_b64_tr_b16 v[100:101], v158 offset:0
  ds_read_b64_tr_b16 v[102:103], v158 offset:1024
  ds_read_b64_tr_b16 v[104:105], v157 offset:8192
  ds_read_b64_tr_b16 v[106:107], v157 offset:9216
  ds_read_b64_tr_b16 v[108:109], v158 offset:8192
  ds_read_b64_tr_b16 v[110:111], v158 offset:9216
  ds_read_b128 v[32:35], v156 offset:0
  ds_read_b128 v[36:39], v156 offset:1024
  ds_read_b128 v[40:43], v156 offset:2048
  ds_read_b128 v[44:47], v156 offset:3072
  ds_read_b128 v[48:51], v156 offset:4096
  ds_read_b128 v[52:55], v156 offset:5120
  ds_read_b128 v[56:59], v156 offset:6144
  ds_read_b128 v[60:63], v156 offset:7168
  s_cmp_lg_u32 s97, 0
  s_cbranch_scc1 L_noinitp
  v_mov_b32 v128, 16
  v_mov_b32 v129, 1
  s_mov_b64 exec, 1
  global_atomic_add v128, v129, s[6:7]
  s_mov_b64 exec, -1
L_noinitp:
  s_lshr_b32 s32, s93, 5
  s_lshl_b32 s37, s32, 17
  s_lshl_b32 s32, s28, 15
  s_add_u32 s37, s37, s32
  s_and_b32 s32, s93, 31
  s_lshl_b32 s38, s32, 8
  s_lshl_b32 s32, s28, 16
  s_add_u32 s38, s38, s32
  s_waitcnt vmcnt(18) lgkmcnt(0)
  s_barrier
  v_mfma_f32_16x16x32_bf16 a[0:3], v[96:99], v[32:35], 0
  ds_read_b64_tr_b16 v[112:113], v157 offset:24576
  v_mfma_f32_16x16x32_bf16 a[32:35], v[100:103], v[32:35], 0
  ds_read_b64_tr_b16 v[114:115], v157 offset:25600
  v_mfma_f32_16x16x32_bf16 a[64:67], v[32:35], v[104:107], 0
  ds_read_b64_tr_b16 v[116:117], v158 offset:24576
  v_mfma_f32_16x16x32_bf16 a[96:99], v[32:35], v[108:111], 0
  s_add_u32 m0, s39, 122880
  s_add_u32 s34, s35, 0
  buffer_load_dwordx4 v4, s[12:15], s34 offen lds
  v_mfma_f32_16x16x32_bf16 a[4:7], v[96:99], v[36:39], 0
  ds_read_b64_tr_b16 v[118:119], v158 offset:25600
  v_mfma_f32_16x16x32_bf16 a[36:39], v[100:103], v[36:39], 0
  ds_read_b64_tr_b16 v[120:121], v157 offset:32768
  v_mfma_f32_16x16x32_bf16 a[68:71], v[36:39], v[104:107], 0
  ds_read_b64_tr_b16 v[122:123], v157 offset:33792
  v_mfma_f32_16x16x32_bf16 a[100:103], v[36:39], v[108:111], 0
  s_add_u32 m0, s39, 123904
  s_add_u32 s34, s35, 16384
  buffer_load_dwordx4 v4, s[12:15], s34 offen lds
  v_mfma_f32_16x16x32_bf16 a[8:11], v[96:99], v[40:43], 0
  ds_read_b64_tr_b16 v[124:125], v158 offset:32768
  v_mfma_f32_16x16x32_bf16 a[40:43], v[100:103], v[40:43], 0
  ds_read_b64_tr_b16 v[126:127], v158 offset:33792
  v_mfma_f32_16x16x32_bf16 a[72:75], v[40:43], v[104:107], 0
  ds_read_b128 v[64:67], v156 offset:24576
  v_mfma_f32_16x16x32_bf16 a[104:107], v[40:43], v[108:111], 0
  s_add_u32 m0, s40, 122880
  s_add_u32 s34, s36, 0
  buffer_load_dwordx4 v5, s[20:23], s34 offen lds
  v_mfma_f32_16x16x32_bf16 a[12:15], v[96:99], v[44:47], 0
  ds_read_b128 v[68:71], v156 offset:25600
  v_mfma_f32_16x16x32_bf16 a[44:47], v[100:103], v[44:47], 0
  ds_read_b128 v[72:75], v156 offset:26624
  v_mfma_f32_16x16x32_bf16 a[76:79], v[44:47], v[104:107], 0
  ds_read_b128 v[76:79], v156 offset:27648
  v_mfma_f32_16x16x32_bf16 a[108:111], v[44:47], v[108:111], 0
  s_add_u32 m0, s40, 123904
  s_add_u32 s34, s36, 32768
  buffer_load_dwordx4 v5, s[20:23], s34 offen lds
  v_mfma_f32_16x16x32_bf16 a[16:19], v[96:99], v[48:51], 0
  ds_read_b128 v[80:83], v156 offset:28672
  v_mfma_f32_16x16x32_bf16 a[48:51], v[100:103], v[48:51], 0
  ds_read_b128 v[84:87], v156 offset:29696
  v_mfma_f32_16x16x32_bf16 a[80:83], v[48:51], v[104:107], 0
  ds_read_b128 v[88:91], v156 offset:30720
  v_mfma_f32_16x16x32_bf16 a[112:115], v[48:51], v[108:111], 0
  s_add_u32 m0, s40, 131072
  s_add_u32 s34, s36, 0
  buffer_load_dwordx4 v5, s[24:27], s34 offen lds
  v_mfma_f32_16x16x32_bf16 a[20:23], v[96:99], v[52:55], 0
  ds_read_b128 v[92:95], v156 offset:31744
  v_mfma_f32_16x16x32_bf16 a[52:55], v[100:103], v[52:55], 0
  v_mfma_f32_16x16x32_bf16 a[84:87], v[52:55], v[104:107], 0
  v_mfma_f32_16x16x32_bf16 a[116:119], v[52:55], v[108:111], 0
  s_add_u32 m0, s40, 132096
  s_add_u32 s34, s36, 32768
  buffer_load_dwordx4 v5, s[24:27], s34 offen lds
  s_add_u32 s35, s35, 64
  s_add_u32 s36, s36, 262144
  v_mfma_f32_16x16x32_bf16 a[24:27], v[96:99], v[56:59], 0
  v_mfma_f32_16x16x32_bf16 a[56:59], v[100:103], v[56:59], 0
  v_mfma_f32_16x16x32_bf16 a[88:91], v[56:59], v[104:107], 0
  v_mfma_f32_16x16x32_bf16 a[120:123], v[56:59], v[108:111], 0
  v_mfma_f32_16x16x32_bf16 a[28:31], v[96:99], v[60:63], 0
  v_mfma_f32_16x16x32_bf16 a[60:63], v[100:103], v[60:63], 0
  v_mfma_f32_16x16x32_bf16 a[92:95], v[60:63], v[104:107], 0
  v_mfma_f32_16x16x32_bf16 a[124:127], v[60:63], v[108:111], 0
  s_waitcnt vmcnt(18) lgkmcnt(0)
  s_barrier
  v_mfma_f32_16x16x32_bf16 a[0:3], v[112:115], v[64:67], a[0:3]
  ds_read_b64_tr_b16 v[96:97], v160 offset:0
  v_mfma_f32_16x16x32_bf16 a[32:35], v[116:119], v[64:67], a[32:35]
  ds_read_b64_tr_b16 v[98:99], v160 offset:1024
  v_mfma_f32_16x16x32_bf16 a[64:67], v[64:67], v[120:123], a[64:67]
  ds_read_b64_tr_b16 v[100:101], v161 offset:0
  v_mfma_f32_16x16x32_bf16 a[96:99], v[64:67], v[124:127], a[96:99]
  s_add_u32 m0, s39, 0
  s_add_u32 s34, s35, 0
  buffer_load_dwordx4 v4, s[12:15], s34 offen lds
  v_mfma_f32_16x16x32_bf16 a[4:7], v[112:115], v[68:71], a[4:7]
  ds_read_b64_tr_b16 v[102:103], v161 offset:1024
  v_mfma_f32_16x16x32_bf16 a[36:39], v[116:119], v[68:71], a[36:39]
  ds_read_b64_tr_b16 v[104:105], v160 offset:8192
  v_mfma_f32_16x16x32_bf16 a[68:71], v[68:71], v[120:123], a[68:71]
  ds_read_b64_tr_b16 v[106:107], v160 offset:9216
  v_mfma_f32_16x16x32_bf16 a[100:103], v[68:71], v[124:127], a[100:103]
  s_add_u32 m0, s39, 1024
  s_add_u32 s34, s35, 16384
  buffer_load_dwordx4 v4, s[12:15], s34 offen lds
  v_mfma_f32_16x16x32_bf16 a[8:11], v[112:115], v[72:75], a[8:11]
  ds_read_b64_tr_b16 v[108:109], v161 offset:8192
  v_mfma_f32_16x16x32_bf16 a[40:43], v[116:119], v[72:75], a[40:43]
  ds_read_b64_tr_b16 v[110:111], v161 offset:9216
  v_mfma_f32_16x16x32_bf16 a[72:75], v[72:75], v[120:123], a[72:75]
  ds_read_b128 v[32:35], v159 offset:0
  v_mfma_f32_16x16x32_bf16 a[104:107], v[72:75], v[124:127], a[104:107]
  s_add_u32 m0, s40, 0
  s_add_u32 s34, s36, 0
  buffer_load_dwordx4 v5, s[20:23], s34 offen lds
  v_mfma_f32_16x16x32_bf16 a[12:15], v[112:115], v[76:79], a[12:15]
  ds_read_b128 v[36:39], v159 offset:1024
  v_mfma_f32_16x16x32_bf16 a[44:47], v[116:119], v[76:79], a[44:47]
  ds_read_b128 v[40:43], v159 offset:2048
  v_mfma_f32_16x16x32_bf16 a[76:79], v[76:79], v[120:123], a[76:79]
  ds_read_b128 v[44:47], v159 offset:3072
  v_mfma_f32_16x16x32_bf16 a[108:111], v[76:79], v[124:127], a[108:111]
  s_add_u32 m0, s40, 1024
  s_add_u32 s34, s36, 32768
  buffer_load_dwordx4 v5, s[20:23], s34 offen lds
  v_mfma_f32_16x16x32_bf16 a[16:19], v[112:115], v[80:83], a[16:19]
  ds_read_b128 v[48:51], v159 offset:4096
  v_mfma_f32_16x16x32_bf16 a[48:51], v[116:119], v[80:83], a[48:51]
  ds_read_b128 v[52:55], v159 offset:5120
  v_mfma_f32_16x16x32_bf16 a[80:83], v[80:83], v[120:123], a[80:83]
  ds_read_b128 v[56:59], v159 offset:6144
  v_mfma_f32_16x16x32_bf16 a[112:115], v[80:83], v[124:127], a[112:115]
  s_add_u32 m0, s40, 8192
  s_add_u32 s34, s36, 0
  buffer_load_dwordx4 v5, s[24:27], s34 offen lds
  v_mfma_f32_16x16x32_bf16 a[20:23], v[112:115], v[84:87], a[20:23]
  ds_read_b128 v[60:63], v159 offset:7168
  v_mfma_f32_16x16x32_bf16 a[52:55], v[116:119], v[84:87], a[52:55]
  v_mfma_f32_16x16x32_bf16 a[84:87], v[84:87], v[120:123], a[84:87]
  v_mfma_f32_16x16x32_bf16 a[116:119], v[84:87], v[124:127], a[116:119]
  s_add_u32 m0, s40, 9216
  s_add_u32 s34, s36, 32768
  buffer_load_dwordx4 v5, s[24:27], s34 offen lds
  s_add_u32 s35, s35, 64
  s_add_u32 s36, s36, 262144
  v_mfma_f32_16x16x32_bf16 a[24:27], v[112:115], v[88:91], a[24:27]
  v_mfma_f32_16x16x32_bf16 a[56:59], v[116:119], v[88:91], a[56:59]
  v_mfma_f32_16x16x32_bf16 a[88:91], v[88:91], v[120:123], a[88:91]
  v_mfma_f32_16x16x32_bf16 a[120:123], v[88:91], v[124:127], a[120:123]
  v_mfma_f32_16x16x32_bf16 a[28:31], v[112:115], v[92:95], a[28:31]
  v_mfma_f32_16x16x32_bf16 a[60:63], v[116:119], v[92:95], a[60:63]
  v_mfma_f32_16x16x32_bf16 a[92:95], v[92:95], v[120:123], a[92:95]
  v_mfma_f32_16x16x32_bf16 a[124:127], v[92:95], v[124:127], a[124:127]
  s_waitcnt vmcnt(18) lgkmcnt(0)
  s_barrier
  v_mfma_f32_16x16x32_bf16 a[0:3], v[96:99], v[32:35], a[0:3]
  ds_read_b64_tr_b16 v[112:113], v160 offset:24576
  v_mfma_f32_16x16x32_bf16 a[32:35], v[100:103], v[32:35], a[32:35]
  ds_read_b64_tr_b16 v[114:115], v160 offset:25600
  v_mfma_f32_16x16x32_bf16 a[64:67], v[32:35], v[104:107], a[64:67]
  ds_read_b64_tr_b16 v[116:117], v161 offset:24576
  v_mfma_f32_16x16x32_bf16 a[96:99], v[32:35], v[108:111], a[96:99]
  s_add_u32 m0, s39, 24576
  s_add_u32 s34, s35, 0
  buffer_load_dwordx4 v4, s[12:15], s34 offen lds
  v_mfma_f32_16x16x32_bf16 a[4:7], v[96:99], v[36:39], a[4:7]
  ds_read_b64_tr_b16 v[118:119], v161 offset:25600
  v_mfma_f32_16x16x32_bf16 a[36:39], v[100:103], v[36:39], a[36:39]
  ds_read_b64_tr_b16 v[120:121], v160 offset:32768
  v_mfma_f32_16x16x32_bf16 a[68:71], v[36:39], v[104:107], a[68:71]
  ds_read_b64_tr_b16 v[122:123], v160 offset:33792
  v_mfma_f32_16x16x32_bf16 a[100:103], v[36:39], v[108:111], a[100:103]
  s_add_u32 m0, s39, 25600
  s_add_u32 s34, s35, 16384
  buffer_load_dwordx4 v4, s[12:15], s34 offen lds
  v_mfma_f32_16x16x32_bf16 a[8:11], v[96:99], v[40:43], a[8:11]
  ds_read_b64_tr_b16 v[124:125], v161 offset:32768
  v_mfma_f32_16x16x32_bf16 a[40:43], v[100:103], v[40:43], a[40:43]
  ds_read_b64_tr_b16 v[126:127], v161 offset:33792
  v_mfma_f32_16x16x32_bf16 a[72:75], v[40:43], v[104:107], a[72:75]
  ds_read_b128 v[64:67], v159 offset:24576
  v_mfma_f32_16x16x32_bf16 a[104:107], v[40:43], v[108:111], a[104:107]
  s_add_u32 m0, s40, 24576
  s_add_u32 s34, s36, 0
  buffer_load_dwordx4 v5, s[20:23], s34 offen lds
  v_mfma_f32_16x16x32_bf16 a[12:15], v[96:99], v[44:47], a[12:15]
  ds_read_b128 v[68:71], v159 offset:25600
  v_mfma_f32_16x16x32_bf16 a[44:47], v[100:103], v[44:47], a[44:47]
  ds_read_b128 v[72:75], v159 offset:26624
  v_mfma_f32_16x16x32_bf16 a[76:79], v[44:47], v[104:107], a[76:79]
  ds_read_b128 v[76:79], v159 offset:27648
  v_mfma_f32_16x16x32_bf16 a[108:111], v[44:47], v[108:111], a[108:111]
  s_add_u32 m0, s40, 25600
  s_add_u32 s34, s36, 32768
  buffer_load_dwordx4 v5, s[20:23], s34 offen lds
  v_mfma_f32_16x16x32_bf16 a[16:19], v[96:99], v[48:51], a[16:19]
  ds_read_b128 v[80:83], v159 offset:28672
  v_mfma_f32_16x16x32_bf16 a[48:51], v[100:103], v[48:51], a[48:51]
  ds_read_b128 v[84:87], v159 offset:29696
  v_mfma_f32_16x16x32_bf16 a[80:83], v[48:51], v[104:107], a[80:83]
  ds_read_b128 v[88:91], v159 offset:30720
  v_mfma_f32_16x16x32_bf16 a[112:115], v[48:51], v[108:111], a[112:115]
  s_add_u32 m0, s40, 32768
  s_add_u32 s34, s36, 0
  buffer_load_dwordx4 v5, s[24:27], s34 offen lds
  v_mfma_f32_16x16x32_bf16 a[20:23], v[96:99], v[52:55], a[20:23]
  ds_read_b128 v[92:95], v159 offset:31744
  v_mfma_f32_16x16x32_bf16 a[52:55], v[100:103], v[52:55], a[52:55]
  v_mfma_f32_16x16x32_bf16 a[84:87], v[52:55], v[104:107], a[84:87]
  v_mfma_f32_16x16x32_bf16 a[116:119], v[52:55], v[108:111], a[116:119]
  s_add_u32 m0, s40, 33792
  s_add_u32 s34, s36, 32768
  buffer_load_dwordx4 v5, s[24:27], s34 offen lds
  s_add_u32 s35, s35, 64
  s_add_u32 s36, s36, 262144
  v_mfma_f32_16x16x32_bf16 a[24:27], v[96:99], v[56:59], a[24:27]
  v_mfma_f32_16x16x32_bf16 a[56:59], v[100:103], v[56:59], a[56:59]
  v_mfma_f32_16x16x32_bf16 a[88:91], v[56:59], v[104:107], a[88:91]
  v_mfma_f32_16x16x32_bf16 a[120:123], v[56:59], v[108:111], a[120:123]
  v_mfma_f32_16x16x32_bf16 a[28:31], v[96:99], v[60:63], a[28:31]
  v_mfma_f32_16x16x32_bf16 a[60:63], v[100:103], v[60:63], a[60:63]
  v_mfma_f32_16x16x32_bf16 a[92:95], v[60:63], v[104:107], a[92:95]
  v_mfma_f32_16x16x32_bf16 a[124:127], v[60:63], v[108:111], a[124:127]
  s_waitcnt vmcnt(18) lgkmcnt(0)
  s_barrier
  v_mfma_f32_16x16x32_bf16 a[0:3], v[112:115], v[64:67], a[0:3]
  ds_read_b64_tr_b16 v[96:97], v163 offset:0
  v_mfma_f32_16x16x32_bf16 a[32:35], v[116:119], v[64:67], a[32:35]
  ds_read_b64_tr_b16 v[98:99], v163 offset:1024
  v_mfma_f32_16x16x32_bf16 a[64:67], v[64:67], v[120:123], a[64:67]
  ds_read_b64_tr_b16 v[100:101], v164 offset:0
  v_mfma_f32_16x16x32_bf16 a[96:99], v[64:67], v[124:127], a[96:99]
  s_add_u32 m0, s39, 49152
  s_add_u32 s34, s35, 0
  buffer_load_dwordx4 v4, s[12:15], s34 offen lds
  v_mfma_f32_16x16x32_bf16 a[4:7], v[112:115], v[68:71], a[4:7]
  ds_read_b64_tr_b16 v[102:103], v164 offset:1024
  v_mfma_f32_16x16x32_bf16 a[36:39], v[116:119], v[68:71], a[36:39]
  ds_read_b64_tr_b16 v[104:105], v163 offset:8192
  v_mfma_f32_16x16x32_bf16 a[68:71], v[68:71], v[120:123], a[68:71]
  ds_read_b64_tr_b16 v[106:107], v163 offset:9216
  v_mfma_f32_16x16x32_bf16 a[100:103], v[68:71], v[124:127], a[100:103]
  s_add_u32 m0, s39, 50176
  s_add_u32 s34, s35, 16384
  buffer_load_dwordx4 v4, s[12:15], s34 offen lds
  v_mfma_f32_16x16x32_bf16 a[8:11], v[112:115], v[72:75], a[8:11]
  ds_read_b64_tr_b16 v[108:109], v164 offset:8192
  v_mfma_f32_16x16x32_bf16 a[40:43], v[116:119], v[72:75], a[40:43]
  ds_read_b64_tr_b16 v[110:111], v164 offset:9216
  v_mfma_f32_16x16x32_bf16 a[72:75], v[72:75], v[120:123], a[72:75]
  ds_read_b128 v[32:35], v162 offset:0
  v_mfma_f32_16x16x32_bf16 a[104:107], v[72:75], v[124:127], a[104:107]
  s_add_u32 m0, s40, 49152
  s_add_u32 s34, s36, 0
  buffer_load_dwordx4 v5, s[20:23], s34 offen lds
  v_mfma_f32_16x16x32_bf16 a[12:15], v[112:115], v[76:79], a[12:15]
  ds_read_b128 v[36:39], v162 offset:1024
  v_mfma_f32_16x16x32_bf16 a[44:47], v[116:119], v[76:79], a[44:47]
  ds_read_b128 v[40:43], v162 offset:2048
  v_mfma_f32_16x16x32_bf16 a[76:79], v[76:79], v[120:123], a[76:79]
  ds_read_b128 v[44:47], v162 offset:3072
  v_mfma_f32_16x16x32_bf16 a[108:111], v[76:79], v[124:127], a[108:111]
  s_add_u32 m0, s40, 50176
  s_add_u32 s34, s36, 32768
  buffer_load_dwordx4 v5, s[20:23], s34 offen lds
  v_mfma_f32_16x16x32_bf16 a[16:19], v[112:115], v[80:83], a[16:19]
  ds_read_b128 v[48:51], v162 offset:4096
  v_mfma_f32_16x16x32_bf16 a[48:51], v[116:119], v[80:83], a[48:51]
  ds_read_b128 v[52:55], v162 offset:5120
  v_mfma_f32_16x16x32_bf16 a[80:83], v[80:83], v[120:123], a[80:83]
  ds_read_b128 v[56:59], v162 offset:6144
  v_mfma_f32_16x16x32_bf16 a[112:115], v[80:83], v[124:127], a[112:115]
  s_add_u32 m0, s40, 57344
  s_add_u32 s34, s36, 0
  buffer_load_dwordx4 v5, s[24:27], s34 offen lds
  v_mfma_f32_16x16x32_bf16 a[20:23], v[112:115], v[84:87], a[20:23]
  ds_read_b128 v[60:63], v162 offset:7168
  v_mfma_f32_16x16x32_bf16 a[52:55], v[116:119], v[84:87], a[52:55]
  v_mfma_f32_16x16x32_bf16 a[84:87], v[84:87], v[120:123], a[84:87]
  v_mfma_f32_16x16x32_bf16 a[116:119], v[84:87], v[124:127], a[116:119]
  s_add_u32 m0, s40, 58368
  s_add_u32 s34, s36, 32768
  buffer_load_dwordx4 v5, s[24:27], s34 offen lds
  s_add_u32 s35, s35, 64
  s_add_u32 s36, s36, 262144
  v_mfma_f32_16x16x32_bf16 a[24:27], v[112:115], v[88:91], a[24:27]
  v_mfma_f32_16x16x32_bf16 a[56:59], v[116:119], v[88:91], a[56:59]
  v_mfma_f32_16x16x32_bf16 a[88:91], v[88:91], v[120:123], a[88:91]
  v_mfma_f32_16x16x32_bf16 a[120:123], v[88:91], v[124:127], a[120:123]
  v_mfma_f32_16x16x32_bf16 a[28:31], v[112:115], v[92:95], a[28:31]
  v_mfma_f32_16x16x32_bf16 a[60:63], v[116:119], v[92:95], a[60:63]
  v_mfma_f32_16x16x32_bf16 a[92:95], v[92:95], v[120:123], a[92:95]
  v_mfma_f32_16x16x32_bf16 a[124:127], v[92:95], v[124:127], a[124:127]
  s_waitcnt vmcnt(18) lgkmcnt(0)
  s_barrier
  v_mfma_f32_16x16x32_bf16 a[0:3], v[96:99], v[32:35], a[0:3]
  ds_read_b64_tr_b16 v[112:113], v163 offset:24576
  v_mfma_f32_16x16x32_bf16 a[32:35], v[100:103], v[32:35], a[32:35]
  ds_read_b64_tr_b16 v[114:115], v163 offset:25600
  v_mfma_f32_16x16x32_bf16 a[64:67], v[32:35], v[104:107], a[64:67]
  ds_read_b64_tr_b16 v[116:117], v164 offset:24576
  v_mfma_f32_16x16x32_bf16 a[96:99], v[32:35], v[108:111], a[96:99]
  s_add_u32 m0, s39, 73728
  s_add_u32 s34, s35, 0
  buffer_load_dwordx4 v4, s[12:15], s34 offen lds
  v_mfma_f32_16x16x32_bf16 a[4:7], v[96:99], v[36:39], a[4:7]
  ds_read_b64_tr_b16 v[118:119], v164 offset:25600
  v_mfma_f32_16x16x32_bf16 a[36:39], v[100:103], v[36:39], a[36:39]
  ds_read_b64_tr_b16 v[120:121], v163 offset:32768
  v_mfma_f32_16x16x32_bf16 a[68:71], v[36:39], v[104:107], a[68:71]
  ds_read_b64_tr_b16 v[122:123], v163 offset:33792
  v_mfma_f32_16x16x32_bf16 a[100:103], v[36:39], v[108:111], a[100:103]
  s_add_u32 m0, s39, 74752
  s_add_u32 s34, s35, 16384
  buffer_load_dwordx4 v4, s[12:15], s34 offen lds
  v_mfma_f32_16x16x32_bf16 a[8:11], v[96:99], v[40:43], a[8:11]
  ds_read_b64_tr_b16 v[124:125], v164 offset:32768
  v_mfma_f32_16x16x32_bf16 a[40:43], v[100:103], v[40:43], a[40:43]
  ds_read_b64_tr_b16 v[126:127], v164 offset:33792
  v_mfma_f32_16x16x32_bf16 a[72:75], v[40:43], v[104:107], a[72:75]
  ds_read_b128 v[64:67], v162 offset:24576
  v_mfma_f32_16x16x32_bf16 a[104:107], v[40:43], v[108:111], a[104:107]
  s_add_u32 m0, s40, 73728
  s_add_u32 s34, s36, 0
  buffer_load_dwordx4 v5, s[20:23], s34 offen lds
  v_mfma_f32_16x16x32_bf16 a[12:15], v[96:99], v[44:47], a[12:15]
  ds_read_b128 v[68:71], v162 offset:25600
  v_mfma_f32_16x16x32_bf16 a[44:47], v[100:103], v[44:47], a[44:47]
  ds_read_b128 v[72:75], v162 offset:26624
  v_mfma_f32_16x16x32_bf16 a[76:79], v[44:47], v[104:107], a[76:79]
  ds_read_b128 v[76:79], v162 offset:27648
  v_mfma_f32_16x16x32_bf16 a[108:111], v[44:47], v[108:111], a[108:111]
  s_add_u32 m0, s40, 74752
  s_add_u32 s34, s36, 32768
  buffer_load_dwordx4 v5, s[20:23], s34 offen lds
  v_mfma_f32_16x16x32_bf16 a[16:19], v[96:99], v[48:51], a[16:19]
  ds_read_b128 v[80:83], v162 offset:28672
  v_mfma_f32_16x16x32_bf16 a[48:51], v[100:103], v[48:51], a[48:51]
  ds_read_b128 v[84:87], v162 offset:29696
  v_mfma_f32_16x16x32_bf16 a[80:83], v[48:51], v[104:107], a[80:83]
  ds_read_b128 v[88:91], v162 offset:30720
  v_mfma_f32_16x16x32_bf16 a[112:115], v[48:51], v[108:111], a[112:115]
  s_add_u32 m0, s40, 81920
  s_add_u32 s34, s36, 0
  buffer_load_dwordx4 v5, s[24:27], s34 offen lds
  v_mfma_f32_16x16x32_bf16 a[20:23], v[96:99], v[52:55], a[20:23]
  ds_read_b128 v[92:95], v162 offset:31744
  v_mfma_f32_16x16x32_bf16 a[52:55], v[100:103], v[52:55], a[52:55]
  v_mfma_f32_16x16x32_bf16 a[84:87], v[52:55], v[104:107], a[84:87]
  v_mfma_f32_16x16x32_bf16 a[116:119], v[52:55], v[108:111], a[116:119]
  s_add_u32 m0, s40, 82944
  s_add_u32 s34, s36, 32768
  buffer_load_dwordx4 v5, s[24:27], s34 offen lds
  s_add_u32 s35, s35, 64
  s_add_u32 s36, s36, 262144
  v_mfma_f32_16x16x32_bf16 a[24:27], v[96:99], v[56:59], a[24:27]
  v_mfma_f32_16x16x32_bf16 a[56:59], v[100:103], v[56:59], a[56:59]
  v_mfma_f32_16x16x32_bf16 a[88:91], v[56:59], v[104:107], a[88:91]
  v_mfma_f32_16x16x32_bf16 a[120:123], v[56:59], v[108:111], a[120:123]
  v_mfma_f32_16x16x32_bf16 a[28:31], v[96:99], v[60:63], a[28:31]
  v_mfma_f32_16x16x32_bf16 a[60:63], v[100:103], v[60:63], a[60:63]
  v_mfma_f32_16x16x32_bf16 a[92:95], v[60:63], v[104:107], a[92:95]
  v_mfma_f32_16x16x32_bf16 a[124:127], v[60:63], v[108:111], a[124:127]
  s_waitcnt vmcnt(18) lgkmcnt(0)
  s_barrier
  v_mfma_f32_16x16x32_bf16 a[0:3], v[112:115], v[64:67], a[0:3]
  ds_read_b64_tr_b16 v[96:97], v157 offset:0
  v_mfma_f32_16x16x32_bf16 a[32:35], v[116:119], v[64:67], a[32:35]
  ds_read_b64_tr_b16 v[98:99], v157 offset:1024
  v_mfma_f32_16x16x32_bf16 a[64:67], v[64:67], v[120:123], a[64:67]
  ds_read_b64_tr_b16 v[100:101], v158 offset:0
  v_mfma_f32_16x16x32_bf16 a[96:99], v[64:67], v[124:127], a[96:99]
  s_add_u32 m0, s39, 98304
  s_add_u32 s34, s35, 0
  buffer_load_dwordx4 v4, s[12:15], s34 offen lds
  v_mfma_f32_16x16x32_bf16 a[4:7], v[112:115], v[68:71], a[4:7]
  ds_read_b64_tr_b16 v[102:103], v158 offset:1024
  v_mfma_f32_16x16x32_bf16 a[36:39], v[116:119], v[68:71], a[36:39]
  ds_read_b64_tr_b16 v[104:105], v157 offset:8192
  v_mfma_f32_16x16x32_bf16 a[68:71], v[68:71], v[120:123], a[68:71]
  ds_read_b64_tr_b16 v[106:107], v157 offset:9216
  v_mfma_f32_16x16x32_bf16 a[100:103], v[68:71], v[124:127], a[100:103]
  s_add_u32 m0, s39, 99328
  s_add_u32 s34, s35, 16384
  buffer_load_dwordx4 v4, s[12:15], s34 offen lds
  v_mfma_f32_16x16x32_bf16 a[8:11], v[112:115], v[72:75], a[8:11]
  ds_read_b64_tr_b16 v[108:109], v158 offset:8192
  v_mfma_f32_16x16x32_bf16 a[40:43], v[116:119], v[72:75], a[40:43]
  ds_read_b64_tr_b16 v[110:111], v158 offset:9216
  v_mfma_f32_16x16x32_bf16 a[72:75], v[72:75], v[120:123], a[72:75]
  ds_read_b128 v[32:35], v156 offset:0
  v_mfma_f32_16x16x32_bf16 a[104:107], v[72:75], v[124:127], a[104:107]
  s_add_u32 m0, s40, 98304
  s_add_u32 s34, s36, 0
  buffer_load_dwordx4 v5, s[20:23], s34 offen lds
  v_mfma_f32_16x16x32_bf16 a[12:15], v[112:115], v[76:79], a[12:15]
  ds_read_b128 v[36:39], v156 offset:1024
  v_mfma_f32_16x16x32_bf16 a[44:47], v[116:119], v[76:79], a[44:47]
  ds_read_b128 v[40:43], v156 offset:2048
  v_mfma_f32_16x16x32_bf16 a[76:79], v[76:79], v[120:123], a[76:79]
  ds_read_b128 v[44:47], v156 offset:3072
  v_mfma_f32_16x16x32_bf16 a[108:111], v[76:79], v[124:127], a[108:111]
  s_add_u32 m0, s40, 99328
  s_add_u32 s34, s36, 32768
  buffer_load_dwordx4 v5, s[20:23], s34 offen lds
  v_mfma_f32_16x16x32_bf16 a[16:19], v[112:115], v[80:83], a[16:19]
  ds_read_b128 v[48:51], v156 offset:4096
  v_mfma_f32_16x16x32_bf16 a[48:51], v[116:119], v[80:83], a[48:51]
  ds_read_b128 v[52:55], v156 offset:5120
  v_mfma_f32_16x16x32_bf16 a[80:83], v[80:83], v[120:123], a[80:83]
  ds_read_b128 v[56:59], v156 offset:6144
  v_mfma_f32_16x16x32_bf16 a[112:115], v[80:83], v[124:127], a[112:115]
  s_add_u32 m0, s40, 106496
  s_add_u32 s34, s36, 0
  buffer_load_dwordx4 v5, s[24:27], s34 offen lds
  v_mfma_f32_16x16x32_bf16 a[20:23], v[112:115], v[84:87], a[20:23]
  ds_read_b128 v[60:63], v156 offset:7168
  v_mfma_f32_16x16x32_bf16 a[52:55], v[116:119], v[84:87], a[52:55]
  v_mfma_f32_16x16x32_bf16 a[84:87], v[84:87], v[120:123], a[84:87]
  v_mfma_f32_16x16x32_bf16 a[116:119], v[84:87], v[124:127], a[116:119]
  s_add_u32 m0, s40, 107520
  s_add_u32 s34, s36, 32768
  buffer_load_dwordx4 v5, s[24:27], s34 offen lds
  s_add_u32 s35, s35, 64
  s_add_u32 s36, s36, 262144
  v_mfma_f32_16x16x32_bf16 a[24:27], v[112:115], v[88:91], a[24:27]
  v_mfma_f32_16x16x32_bf16 a[56:59], v[116:119], v[88:91], a[56:59]
  v_mfma_f32_16x16x32_bf16 a[88:91], v[88:91], v[120:123], a[88:91]
  v_mfma_f32_16x16x32_bf16 a[120:123], v[88:91], v[124:127], a[120:123]
  v_mfma_f32_16x16x32_bf16 a[28:31], v[112:115], v[92:95], a[28:31]
  v_mfma_f32_16x16x32_bf16 a[60:63], v[116:119], v[92:95], a[60:63]
  v_mfma_f32_16x16x32_bf16 a[92:95], v[92:95], v[120:123], a[92:95]
  v_mfma_f32_16x16x32_bf16 a[124:127], v[92:95], v[124:127], a[124:127]
  s_waitcnt vmcnt(18) lgkmcnt(0)
  s_barrier
  v_mfma_f32_16x16x32_bf16 a[0:3], v[96:99], v[32:35], a[0:3]
  ds_read_b64_tr_b16 v[112:113], v157 offset:24576
  v_mfma_f32_16x16x32_bf16 a[32:35], v[100:103], v[32:35], a[32:35]
  ds_read_b64_tr_b16 v[114:115], v157 offset:25600
  v_mfma_f32_16x16x32_bf16 a[64:67], v[32:35], v[104:107], a[64:67]
  ds_read_b64_tr_b16 v[116:117], v158 offset:24576
  v_mfma_f32_16x16x32_bf16 a[96:99], v[32:35], v[108:111], a[96:99]
  s_add_u32 m0, s39, 122880
  s_add_u32 s34, s35, 0
  buffer_load_dwordx4 v4, s[12:15], s34 offen lds
  v_mfma_f32_16x16x32_bf16 a[4:7], v[96:99], v[36:39], a[4:7]
  ds_read_b64_tr_b16 v[118:119], v158 offset:25600
  v_mfma_f32_16x16x32_bf16 a[36:39], v[100:103], v[36:39], a[36:39]
  ds_read_b64_tr_b16 v[120:121], v157 offset:32768
  v_mfma_f32_16x16x32_bf16 a[68:71], v[36:39], v[104:107], a[68:71]
  ds_read_b64_tr_b16 v[122:123], v157 offset:33792
  v_mfma_f32_16x16x32_bf16 a[100:103], v[36:39], v[108:111], a[100:103]
  s_add_u32 m0, s39, 123904
  s_add_u32 s34, s35, 16384
  buffer_load_dwordx4 v4, s[12:15], s34 offen lds
  v_mfma_f32_16x16x32_bf16 a[8:11], v[96:99], v[40:43], a[8:11]
  ds_read_b64_tr_b16 v[124:125], v158 offset:32768
  v_mfma_f32_16x16x32_bf16 a[40:43], v[100:103], v[40:43], a[40:43]
  ds_read_b64_tr_b16 v[126:127], v158 offset:33792
  v_mfma_f32_16x16x32_bf16 a[72:75], v[40:43], v[104:107], a[72:75]
  ds_read_b128 v[64:67], v156 offset:24576
  v_mfma_f32_16x16x32_bf16 a[104:107], v[40:43], v[108:111], a[104:107]
  s_add_u32 m0, s40, 122880
  s_add_u32 s34, s36, 0
  buffer_load_dwordx4 v5, s[20:23], s34 offen lds
  v_mfma_f32_16x16x32_bf16 a[12:15], v[96:99], v[44:47], a[12:15]
  ds_read_b128 v[68:71], v156 offset:25600
  v_mfma_f32_16x16x32_bf16 a[44:47], v[100:103], v[44:47], a[44:47]
  ds_read_b128 v[72:75], v156 offset:26624
  v_mfma_f32_16x16x32_bf16 a[76:79], v[44:47], v[104:107], a[76:79]
  ds_read_b128 v[76:79], v156 offset:27648
  v_mfma_f32_16x16x32_bf16 a[108:111], v[44:47], v[108:111], a[108:111]
  s_add_u32 m0, s40, 123904
  s_add_u32 s34, s36, 32768
  buffer_load_dwordx4 v5, s[20:23], s34 offen lds
  v_mfma_f32_16x16x32_bf16 a[16:19], v[96:99], v[48:51], a[16:19]
  ds_read_b128 v[80:83], v156 offset:28672
  v_mfma_f32_16x16x32_bf16 a[48:51], v[100:103], v[48:51], a[48:51]
  ds_read_b128 v[84:87], v156 offset:29696
  v_mfma_f32_16x16x32_bf16 a[80:83], v[48:51], v[104:107], a[80:83]
  ds_read_b128 v[88:91], v156 offset:30720
  v_mfma_f32_16x16x32_bf16 a[112:115], v[48:51], v[108:111], a[112:115]
  s_add_u32 m0, s40, 131072
  s_add_u32 s34, s36, 0
  buffer_load_dwordx4 v5, s[24:27], s34 offen lds
  v_mfma_f32_16x16x32_bf16 a[20:23], v[96:99], v[52:55], a[20:23]
  ds_read_b128 v[92:95], v156 offset:31744
  v_mfma_f32_16x16x32_bf16 a[52:55], v[100:103], v[52:55], a[52:55]
  v_mfma_f32_16x16x32_bf16 a[84:87], v[52:55], v[104:107], a[84:87]
  v_mfma_f32_16x16x32_bf16 a[116:119], v[52:55], v[108:111], a[116:119]
  s_add_u32 m0, s40, 132096
  s_add_u32 s34, s36, 32768
  buffer_load_dwordx4 v5, s[24:27], s34 offen lds
  s_add_u32 s35, s35, 64
  s_add_u32 s36, s36, 262144
  v_mfma_f32_16x16x32_bf16 a[24:27], v[96:99], v[56:59], a[24:27]
  v_mfma_f32_16x16x32_bf16 a[56:59], v[100:103], v[56:59], a[56:59]
  v_mfma_f32_16x16x32_bf16 a[88:91], v[56:59], v[104:107], a[88:91]
  v_mfma_f32_16x16x32_bf16 a[120:123], v[56:59], v[108:111], a[120:123]
  v_mfma_f32_16x16x32_bf16 a[28:31], v[96:99], v[60:63], a[28:31]
  v_mfma_f32_16x16x32_bf16 a[60:63], v[100:103], v[60:63], a[60:63]
  v_mfma_f32_16x16x32_bf16 a[92:95], v[60:63], v[104:107], a[92:95]
  v_mfma_f32_16x16x32_bf16 a[124:127], v[60:63], v[108:111], a[124:127]
  s_waitcnt vmcnt(18) lgkmcnt(0)
  s_barrier
  v_mfma_f32_16x16x32_bf16 a[0:3], v[112:115], v[64:67], a[0:3]
  ds_read_b64_tr_b16 v[96:97], v160 offset:0
  v_mfma_f32_16x16x32_bf16 a[32:35], v[116:119], v[64:67], a[32:35]
  ds_read_b64_tr_b16 v[98:99], v160 offset:1024
  v_mfma_f32_16x16x32_bf16 a[64:67], v[64:67], v[120:123], a[64:67]
  ds_read_b64_tr_b16 v[100:101], v161 offset:0
  v_mfma_f32_16x16x32_bf16 a[96:99], v[64:67], v[124:127], a[96:99]
  s_add_u32 m0, s39, 0
  s_add_u32 s34, s35, 0
  buffer_load_dwordx4 v4, s[12:15], s34 offen lds
  v_mfma_f32_16x16x32_bf16 a[4:7], v[112:115], v[68:71], a[4:7]
  ds_read_b64_tr_b16 v[102:103], v161 offset:1024
  v_mfma_f32_16x16x32_bf16 a[36:39], v[116:119], v[68:71], a[36:39]
  ds_read_b64_tr_b16 v[104:105], v160 offset:8192
  v_mfma_f32_16x16x32_bf16 a[68:71], v[68:71], v[120:123], a[68:71]
  ds_read_b64_tr_b16 v[106:107], v160 offset:9216
  v_mfma_f32_16x16x32_bf16 a[100:103], v[68:71], v[124:127], a[100:103]
  s_add_u32 m0, s39, 1024
  s_add_u32 s34, s35, 16384
  buffer_load_dwordx4 v4, s[12:15], s34 offen lds
  v_mfma_f32_16x16x32_bf16 a[8:11], v[112:115], v[72:75], a[8:11]
  ds_read_b64_tr_b16 v[108:109], v161 offset:8192
  v_mfma_f32_16x16x32_bf16 a[40:43], v[116:119], v[72:75], a[40:43]
  ds_read_b64_tr_b16 v[110:111], v161 offset:9216
  v_mfma_f32_16x16x32_bf16 a[72:75], v[72:75], v[120:123], a[72:75]
  ds_read_b128 v[32:35], v159 offset:0
  v_mfma_f32_16x16x32_bf16 a[104:107], v[72:75], v[124:127], a[104:107]
  s_add_u32 m0, s40, 0
  s_add_u32 s34, s36, 0
  buffer_load_dwordx4 v5, s[20:23], s34 offen lds
  v_mfma_f32_16x16x32_bf16 a[12:15], v[112:115], v[76:79], a[12:15]
  ds_read_b128 v[36:39], v159 offset:1024
  v_mfma_f32_16x16x32_bf16 a[44:47], v[116:119], v[76:79], a[44:47]
  ds_read_b128 v[40:43], v159 offset:2048
  v_mfma_f32_16x16x32_bf16 a[76:79], v[76:79], v[120:123], a[76:79]
  ds_read_b128 v[44:47], v159 offset:3072
  v_mfma_f32_16x16x32_bf16 a[108:111], v[76:79], v[124:127], a[108:111]
  s_add_u32 m0, s40, 1024
  s_add_u32 s34, s36, 32768
  buffer_load_dwordx4 v5, s[20:23], s34 offen lds
  v_mfma_f32_16x16x32_bf16 a[16:19], v[112:115], v[80:83], a[16:19]
  ds_read_b128 v[48:51], v159 offset:4096
  v_mfma_f32_16x16x32_bf16 a[48:51], v[116:119], v[80:83], a[48:51]
  ds_read_b128 v[52:55], v159 offset:5120
  v_mfma_f32_16x16x32_bf16 a[80:83], v[80:83], v[120:123], a[80:83]
  ds_read_b128 v[56:59], v159 offset:6144
  v_mfma_f32_16x16x32_bf16 a[112:115], v[80:83], v[124:127], a[112:115]
  s_add_u32 m0, s40, 8192
  s_add_u32 s34, s36, 0
  buffer_load_dwordx4 v5, s[24:27], s34 offen lds
  v_mfma_f32_16x16x32_bf16 a[20:23], v[112:115], v[84:87], a[20:23]
  ds_read_b128 v[60:63], v159 offset:7168
  v_mfma_f32_16x16x32_bf16 a[52:55], v[116:119], v[84:87], a[52:55]
  v_mfma_f32_16x16x32_bf16 a[84:87], v[84:87], v[120:123], a[84:87]
  v_mfma_f32_16x16x32_bf16 a[116:119], v[84:87], v[124:127], a[116:119]
  s_add_u32 m0, s40, 9216
  s_add_u32 s34, s36, 32768
  buffer_load_dwordx4 v5, s[24:27], s34 offen lds
  s_add_u32 s35, s35, 64
  s_add_u32 s36, s36, 262144
  v_mfma_f32_16x16x32_bf16 a[24:27], v[112:115], v[88:91], a[24:27]
  v_mfma_f32_16x16x32_bf16 a[56:59], v[116:119], v[88:91], a[56:59]
  v_mfma_f32_16x16x32_bf16 a[88:91], v[88:91], v[120:123], a[88:91]
  v_mfma_f32_16x16x32_bf16 a[120:123], v[88:91], v[124:127], a[120:123]
  v_mfma_f32_16x16x32_bf16 a[28:31], v[112:115], v[92:95], a[28:31]
  v_mfma_f32_16x16x32_bf16 a[60:63], v[116:119], v[92:95], a[60:63]
  v_mfma_f32_16x16x32_bf16 a[92:95], v[92:95], v[120:123], a[92:95]
  v_mfma_f32_16x16x32_bf16 a[124:127], v[92:95], v[124:127], a[124:127]
  s_waitcnt vmcnt(18) lgkmcnt(0)
  s_barrier
  v_mfma_f32_16x16x32_bf16 a[0:3], v[96:99], v[32:35], a[0:3]
  ds_read_b64_tr_b16 v[112:113], v160 offset:24576
  v_mfma_f32_16x16x32_bf16 a[32:35], v[100:103], v[32:35], a[32:35]
  ds_read_b64_tr_b16 v[114:115], v160 offset:25600
  v_mfma_f32_16x16x32_bf16 a[64:67], v[32:35], v[104:107], a[64:67]
  ds_read_b64_tr_b16 v[116:117], v161 offset:24576
  v_mfma_f32_16x16x32_bf16 a[96:99], v[32:35], v[108:111], a[96:99]
  s_add_u32 m0, s39, 24576
  s_add_u32 s34, s35, 0
  buffer_load_dwordx4 v4, s[12:15], s34 offen lds
  v_mfma_f32_16x16x32_bf16 a[4:7], v[96:99], v[36:39], a[4:7]
  ds_read_b64_tr_b16 v[118:119], v161 offset:25600
  v_mfma_f32_16x16x32_bf16 a[36:39], v[100:103], v[36:39], a[36:39]
  ds_read_b64_tr_b16 v[120:121], v160 offset:32768
  v_mfma_f32_16x16x32_bf16 a[68:71], v[36:39], v[104:107], a[68:71]
  ds_read_b64_tr_b16 v[122:123], v160 offset:33792
  v_mfma_f32_16x16x32_bf16 a[100:103], v[36:39], v[108:111], a[100:103]
  s_add_u32 m0, s39, 25600
  s_add_u32 s34, s35, 16384
  buffer_load_dwordx4 v4, s[12:15], s34 offen lds
  v_mfma_f32_16x16x32_bf16 a[8:11], v[96:99], v[40:43], a[8:11]
  ds_read_b64_tr_b16 v[124:125], v161 offset:32768
  v_mfma_f32_16x16x32_bf16 a[40:43], v[100:103], v[40:43], a[40:43]
  ds_read_b64_tr_b16 v[126:127], v161 offset:33792
  v_mfma_f32_16x16x32_bf16 a[72:75], v[40:43], v[104:107], a[72:75]
  ds_read_b128 v[64:67], v159 offset:24576
  v_mfma_f32_16x16x32_bf16 a[104:107], v[40:43], v[108:111], a[104:107]
  s_add_u32 m0, s40, 24576
  s_add_u32 s34, s36, 0
  buffer_load_dwordx4 v5, s[20:23], s34 offen lds
  v_mfma_f32_16x16x32_bf16 a[12:15], v[96:99], v[44:47], a[12:15]
  ds_read_b128 v[68:71], v159 offset:25600
  v_mfma_f32_16x16x32_bf16 a[44:47], v[100:103], v[44:47], a[44:47]
  ds_read_b128 v[72:75], v159 offset:26624
  v_mfma_f32_16x16x32_bf16 a[76:79], v[44:47], v[104:107], a[76:79]
  ds_read_b128 v[76:79], v159 offset:27648
  v_mfma_f32_16x16x32_bf16 a[108:111], v[44:47], v[108:111], a[108:111]
  s_add_u32 m0, s40, 25600
  s_add_u32 s34, s36, 32768
  buffer_load_dwordx4 v5, s[20:23], s34 offen lds
  v_mfma_f32_16x16x32_bf16 a[16:19], v[96:99], v[48:51], a[16:19]
  ds_read_b128 v[80:83], v159 offset:28672
  v_mfma_f32_16x16x32_bf16 a[48:51], v[100:103], v[48:51], a[48:51]
  ds_read_b128 v[84:87], v159 offset:29696
  v_mfma_f32_16x16x32_bf16 a[80:83], v[48:51], v[104:107], a[80:83]
  ds_read_b128 v[88:91], v159 offset:30720
  v_mfma_f32_16x16x32_bf16 a[112:115], v[48:51], v[108:111], a[112:115]
  s_add_u32 m0, s40, 32768
  s_add_u32 s34, s36, 0
  buffer_load_dwordx4 v5, s[24:27], s34 offen lds
  v_mfma_f32_16x16x32_bf16 a[20:23], v[96:99], v[52:55], a[20:23]
  ds_read_b128 v[92:95], v159 offset:31744
  v_mfma_f32_16x16x32_bf16 a[52:55], v[100:103], v[52:55], a[52:55]
  v_mfma_f32_16x16x32_bf16 a[84:87], v[52:55], v[104:107], a[84:87]
  v_mfma_f32_16x16x32_bf16 a[116:119], v[52:55], v[108:111], a[116:119]
  s_add_u32 m0, s40, 33792
  s_add_u32 s34, s36, 32768
  buffer_load_dwordx4 v5, s[24:27], s34 offen lds
  s_add_u32 s35, s35, 64
  s_add_u32 s36, s36, 262144
  v_mfma_f32_16x16x32_bf16 a[24:27], v[96:99], v[56:59], a[24:27]
  v_mfma_f32_16x16x32_bf16 a[56:59], v[100:103], v[56:59], a[56:59]
  v_mfma_f32_16x16x32_bf16 a[88:91], v[56:59], v[104:107], a[88:91]
  v_mfma_f32_16x16x32_bf16 a[120:123], v[56:59], v[108:111], a[120:123]
  v_mfma_f32_16x16x32_bf16 a[28:31], v[96:99], v[60:63], a[28:31]
  v_mfma_f32_16x16x32_bf16 a[60:63], v[100:103], v[60:63], a[60:63]
  v_mfma_f32_16x16x32_bf16 a[92:95], v[60:63], v[104:107], a[92:95]
  v_mfma_f32_16x16x32_bf16 a[124:127], v[60:63], v[108:111], a[124:127]
  s_waitcnt vmcnt(18) lgkmcnt(0)
  s_barrier
  v_mfma_f32_16x16x32_bf16 a[0:3], v[112:115], v[64:67], a[0:3]
  ds_read_b64_tr_b16 v[96:97], v163 offset:0
  v_mfma_f32_16x16x32_bf16 a[32:35], v[116:119], v[64:67], a[32:35]
  ds_read_b64_tr_b16 v[98:99], v163 offset:1024
  v_mfma_f32_16x16x32_bf16 a[64:67], v[64:67], v[120:123], a[64:67]
  ds_read_b64_tr_b16 v[100:101], v164 offset:0
  v_mfma_f32_16x16x32_bf16 a[96:99], v[64:67], v[124:127], a[96:99]
  s_add_u32 m0, s39, 49152
  s_add_u32 s34, s35, 0
  buffer_load_dwordx4 v4, s[12:15], s34 offen lds
  v_mfma_f32_16x16x32_bf16 a[4:7], v[112:115], v[68:71], a[4:7]
  ds_read_b64_tr_b16 v[102:103], v164 offset:1024
  v_mfma_f32_16x16x32_bf16 a[36:39], v[116:119], v[68:71], a[36:39]
  ds_read_b64_tr_b16 v[104:105], v163 offset:8192
  v_mfma_f32_16x16x32_bf16 a[68:71], v[68:71], v[120:123], a[68:71]
  ds_read_b64_tr_b16 v[106:107], v163 offset:9216
  v_mfma_f32_16x16x32_bf16 a[100:103], v[68:71], v[124:127], a[100:103]
  s_add_u32 m0, s39, 50176
  s_add_u32 s34, s35, 16384
  buffer_load_dwordx4 v4, s[12:15], s34 offen lds
  v_mfma_f32_16x16x32_bf16 a[8:11], v[112:115], v[72:75], a[8:11]
  ds_read_b64_tr_b16 v[108:109], v164 offset:8192
  v_mfma_f32_16x16x32_bf16 a[40:43], v[116:119], v[72:75], a[40:43]
  ds_read_b64_tr_b16 v[110:111], v164 offset:9216
  v_mfma_f32_16x16x32_bf16 a[72:75], v[72:75], v[120:123], a[72:75]
  ds_read_b128 v[32:35], v162 offset:0
  v_mfma_f32_16x16x32_bf16 a[104:107], v[72:75], v[124:127], a[104:107]
  s_add_u32 m0, s40, 49152
  s_add_u32 s34, s36, 0
  buffer_load_dwordx4 v5, s[20:23], s34 offen lds
  v_mfma_f32_16x16x32_bf16 a[12:15], v[112:115], v[76:79], a[12:15]
  ds_read_b128 v[36:39], v162 offset:1024
  v_mfma_f32_16x16x32_bf16 a[44:47], v[116:119], v[76:79], a[44:47]
  ds_read_b128 v[40:43], v162 offset:2048
  v_mfma_f32_16x16x32_bf16 a[76:79], v[76:79], v[120:123], a[76:79]
  ds_read_b128 v[44:47], v162 offset:3072
  v_mfma_f32_16x16x32_bf16 a[108:111], v[76:79], v[124:127], a[108:111]
  s_add_u32 m0, s40, 50176
  s_add_u32 s34, s36, 32768
  buffer_load_dwordx4 v5, s[20:23], s34 offen lds
  v_mfma_f32_16x16x32_bf16 a[16:19], v[112:115], v[80:83], a[16:19]
  ds_read_b128 v[48:51], v162 offset:4096
  v_mfma_f32_16x16x32_bf16 a[48:51], v[116:119], v[80:83], a[48:51]
  ds_read_b128 v[52:55], v162 offset:5120
  v_mfma_f32_16x16x32_bf16 a[80:83], v[80:83], v[120:123], a[80:83]
  ds_read_b128 v[56:59], v162 offset:6144
  v_mfma_f32_16x16x32_bf16 a[112:115], v[80:83], v[124:127], a[112:115]
  s_add_u32 m0, s40, 57344
  s_add_u32 s34, s36, 0
  buffer_load_dwordx4 v5, s[24:27], s34 offen lds
  v_mfma_f32_16x16x32_bf16 a[20:23], v[112:115], v[84:87], a[20:23]
  ds_read_b128 v[60:63], v162 offset:7168
  v_mfma_f32_16x16x32_bf16 a[52:55], v[116:119], v[84:87], a[52:55]
  v_mfma_f32_16x16x32_bf16 a[84:87], v[84:87], v[120:123], a[84:87]
  v_mfma_f32_16x16x32_bf16 a[116:119], v[84:87], v[124:127], a[116:119]
  s_add_u32 m0, s40, 58368
  s_add_u32 s34, s36, 32768
  buffer_load_dwordx4 v5, s[24:27], s34 offen lds
  s_add_u32 s35, s35, 64
  s_add_u32 s36, s36, 262144
  v_mfma_f32_16x16x32_bf16 a[24:27], v[112:115], v[88:91], a[24:27]
  v_mfma_f32_16x16x32_bf16 a[56:59], v[116:119], v[88:91], a[56:59]
  v_mfma_f32_16x16x32_bf16 a[88:91], v[88:91], v[120:123], a[88:91]
  v_mfma_f32_16x16x32_bf16 a[120:123], v[88:91], v[124:127], a[120:123]
  v_mfma_f32_16x16x32_bf16 a[28:31], v[112:115], v[92:95], a[28:31]
  v_mfma_f32_16x16x32_bf16 a[60:63], v[116:119], v[92:95], a[60:63]
  v_mfma_f32_16x16x32_bf16 a[92:95], v[92:95], v[120:123], a[92:95]
  v_mfma_f32_16x16x32_bf16 a[124:127], v[92:95], v[124:127], a[124:127]
  s_waitcnt vmcnt(18) lgkmcnt(0)
  s_barrier
  v_mfma_f32_16x16x32_bf16 a[0:3], v[96:99], v[32:35], a[0:3]
  ds_read_b64_tr_b16 v[112:113], v163 offset:24576
  v_mfma_f32_16x16x32_bf16 a[32:35], v[100:103], v[32:35], a[32:35]
  ds_read_b64_tr_b16 v[114:115], v163 offset:25600
  v_mfma_f32_16x16x32_bf16 a[64:67], v[32:35], v[104:107], a[64:67]
  ds_read_b64_tr_b16 v[116:117], v164 offset:24576
  v_mfma_f32_16x16x32_bf16 a[96:99], v[32:35], v[108:111], a[96:99]
  s_add_u32 m0, s39, 73728
  s_add_u32 s34, s35, 0
  buffer_load_dwordx4 v4, s[12:15], s34 offen lds
  v_mfma_f32_16x16x32_bf16 a[4:7], v[96:99], v[36:39], a[4:7]
  ds_read_b64_tr_b16 v[118:119], v164 offset:25600
  v_mfma_f32_16x16x32_bf16 a[36:39], v[100:103], v[36:39], a[36:39]
  ds_read_b64_tr_b16 v[120:121], v163 offset:32768
  v_mfma_f32_16x16x32_bf16 a[68:71], v[36:39], v[104:107], a[68:71]
  ds_read_b64_tr_b16 v[122:123], v163 offset:33792
  v_mfma_f32_16x16x32_bf16 a[100:103], v[36:39], v[108:111], a[100:103]
  s_add_u32 m0, s39, 74752
  s_add_u32 s34, s35, 16384
  buffer_load_dwordx4 v4, s[12:15], s34 offen lds
  v_mfma_f32_16x16x32_bf16 a[8:11], v[96:99], v[40:43], a[8:11]
  ds_read_b64_tr_b16 v[124:125], v164 offset:32768
  v_mfma_f32_16x16x32_bf16 a[40:43], v[100:103], v[40:43], a[40:43]
  ds_read_b64_tr_b16 v[126:127], v164 offset:33792
  v_mfma_f32_16x16x32_bf16 a[72:75], v[40:43], v[104:107], a[72:75]
  ds_read_b128 v[64:67], v162 offset:24576
  v_mfma_f32_16x16x32_bf16 a[104:107], v[40:43], v[108:111], a[104:107]
  s_add_u32 m0, s40, 73728
  s_add_u32 s34, s36, 0
  buffer_load_dwordx4 v5, s[20:23], s34 offen lds
  v_mfma_f32_16x16x32_bf16 a[12:15], v[96:99], v[44:47], a[12:15]
  ds_read_b128 v[68:71], v162 offset:25600
  v_mfma_f32_16x16x32_bf16 a[44:47], v[100:103], v[44:47], a[44:47]
  ds_read_b128 v[72:75], v162 offset:26624
  v_mfma_f32_16x16x32_bf16 a[76:79], v[44:47], v[104:107], a[76:79]
  ds_read_b128 v[76:79], v162 offset:27648
  v_mfma_f32_16x16x32_bf16 a[108:111], v[44:47], v[108:111], a[108:111]
  s_add_u32 m0, s40, 74752
  s_add_u32 s34, s36, 32768
  buffer_load_dwordx4 v5, s[20:23], s34 offen lds
  v_mfma_f32_16x16x32_bf16 a[16:19], v[96:99], v[48:51], a[16:19]
  ds_read_b128 v[80:83], v162 offset:28672
  v_mfma_f32_16x16x32_bf16 a[48:51], v[100:103], v[48:51], a[48:51]
  ds_read_b128 v[84:87], v162 offset:29696
  v_mfma_f32_16x16x32_bf16 a[80:83], v[48:51], v[104:107], a[80:83]
  ds_read_b128 v[88:91], v162 offset:30720
  v_mfma_f32_16x16x32_bf16 a[112:115], v[48:51], v[108:111], a[112:115]
  s_add_u32 m0, s40, 81920
  s_add_u32 s34, s36, 0
  buffer_load_dwordx4 v5, s[24:27], s34 offen lds
  v_mfma_f32_16x16x32_bf16 a[20:23], v[96:99], v[52:55], a[20:23]
  ds_read_b128 v[92:95], v162 offset:31744
  v_mfma_f32_16x16x32_bf16 a[52:55], v[100:103], v[52:55], a[52:55]
  v_mfma_f32_16x16x32_bf16 a[84:87], v[52:55], v[104:107], a[84:87]
  v_mfma_f32_16x16x32_bf16 a[116:119], v[52:55], v[108:111], a[116:119]
  s_add_u32 m0, s40, 82944
  s_add_u32 s34, s36, 32768
  buffer_load_dwordx4 v5, s[24:27], s34 offen lds
  s_add_u32 s35, s35, 64
  s_add_u32 s36, s36, 262144
  v_mfma_f32_16x16x32_bf16 a[24:27], v[96:99], v[56:59], a[24:27]
  v_mfma_f32_16x16x32_bf16 a[56:59], v[100:103], v[56:59], a[56:59]
  v_mfma_f32_16x16x32_bf16 a[88:91], v[56:59], v[104:107], a[88:91]
  v_mfma_f32_16x16x32_bf16 a[120:123], v[56:59], v[108:111], a[120:123]
  v_mfma_f32_16x16x32_bf16 a[28:31], v[96:99], v[60:63], a[28:31]
  v_mfma_f32_16x16x32_bf16 a[60:63], v[100:103], v[60:63], a[60:63]
  v_mfma_f32_16x16x32_bf16 a[92:95], v[60:63], v[104:107], a[92:95]
  v_mfma_f32_16x16x32_bf16 a[124:127], v[60:63], v[108:111], a[124:127]
  s_waitcnt vmcnt(18) lgkmcnt(0)
  s_barrier
  s_mov_b32 s35, s37
  s_mov_b32 s36, s38
  v_mfma_f32_16x16x32_bf16 a[0:3], v[112:115], v[64:67], a[0:3]
  ds_read_b64_tr_b16 v[96:97], v157 offset:0
  v_mfma_f32_16x16x32_bf16 a[32:35], v[116:119], v[64:67], a[32:35]
  ds_read_b64_tr_b16 v[98:99], v157 offset:1024
  v_mfma_f32_16x16x32_bf16 a[64:67], v[64:67], v[120:123], a[64:67]
  ds_read_b64_tr_b16 v[100:101], v158 offset:0
  v_mfma_f32_16x16x32_bf16 a[96:99], v[64:67], v[124:127], a[96:99]
  s_add_u32 m0, s39, 98304
  s_add_u32 s34, s35, 0
  buffer_load_dwordx4 v4, s[12:15], s34 offen lds
  v_mfma_f32_16x16x32_bf16 a[4:7], v[112:115], v[68:71], a[4:7]
  ds_read_b64_tr_b16 v[102:103], v158 offset:1024
  v_mfma_f32_16x16x32_bf16 a[36:39], v[116:119], v[68:71], a[36:39]
  ds_read_b64_tr_b16 v[104:105], v157 offset:8192
  v_mfma_f32_16x16x32_bf16 a[68:71], v[68:71], v[120:123], a[68:71]
  ds_read_b64_tr_b16 v[106:107], v157 offset:9216
  v_mfma_f32_16x16x32_bf16 a[100:103], v[68:71], v[124:127], a[100:103]
  s_add_u32 m0, s39, 99328
  s_add_u32 s34, s35, 16384
  buffer_load_dwordx4 v4, s[12:15], s34 offen lds
  v_mfma_f32_16x16x32_bf16 a[8:11], v[112:115], v[72:75], a[8:11]
  ds_read_b64_tr_b16 v[108:109], v158 offset:8192
  v_mfma_f32_16x16x32_bf16 a[40:43], v[116:119], v[72:75], a[40:43]
  ds_read_b64_tr_b16 v[110:111], v158 offset:9216
  v_mfma_f32_16x16x32_bf16 a[72:75], v[72:75], v[120:123], a[72:75]
  ds_read_b128 v[32:35], v156 offset:0
  v_mfma_f32_16x16x32_bf16 a[104:107], v[72:75], v[124:127], a[104:107]
  s_add_u32 m0, s40, 98304
  s_add_u32 s34, s36, 0
  buffer_load_dwordx4 v5, s[20:23], s34 offen lds
  v_mfma_f32_16x16x32_bf16 a[12:15], v[112:115], v[76:79], a[12:15]
  ds_read_b128 v[36:39], v156 offset:1024
  v_mfma_f32_16x16x32_bf16 a[44:47], v[116:119], v[76:79], a[44:47]
  ds_read_b128 v[40:43], v156 offset:2048
  v_mfma_f32_16x16x32_bf16 a[76:79], v[76:79], v[120:123], a[76:79]
  ds_read_b128 v[44:47], v156 offset:3072
  v_mfma_f32_16x16x32_bf16 a[108:111], v[76:79], v[124:127], a[108:111]
  s_add_u32 m0, s40, 99328
  s_add_u32 s34, s36, 32768
  buffer_load_dwordx4 v5, s[20:23], s34 offen lds
  v_mfma_f32_16x16x32_bf16 a[16:19], v[112:115], v[80:83], a[16:19]
  ds_read_b128 v[48:51], v156 offset:4096
  v_mfma_f32_16x16x32_bf16 a[48:51], v[116:119], v[80:83], a[48:51]
  ds_read_b128 v[52:55], v156 offset:5120
  v_mfma_f32_16x16x32_bf16 a[80:83], v[80:83], v[120:123], a[80:83]
  ds_read_b128 v[56:59], v156 offset:6144
  v_mfma_f32_16x16x32_bf16 a[112:115], v[80:83], v[124:127], a[112:115]
  s_add_u32 m0, s40, 106496
  s_add_u32 s34, s36, 0
  buffer_load_dwordx4 v5, s[24:27], s34 offen lds
  v_mfma_f32_16x16x32_bf16 a[20:23], v[112:115], v[84:87], a[20:23]
  ds_read_b128 v[60:63], v156 offset:7168
  v_mfma_f32_16x16x32_bf16 a[52:55], v[116:119], v[84:87], a[52:55]
  v_mfma_f32_16x16x32_bf16 a[84:87], v[84:87], v[120:123], a[84:87]
  v_mfma_f32_16x16x32_bf16 a[116:119], v[84:87], v[124:127], a[116:119]
  s_add_u32 m0, s40, 107520
  s_add_u32 s34, s36, 32768
  buffer_load_dwordx4 v5, s[24:27], s34 offen lds
  s_add_u32 s35, s35, 64
  s_add_u32 s36, s36, 262144
  v_mfma_f32_16x16x32_bf16 a[24:27], v[112:115], v[88:91], a[24:27]
  v_mfma_f32_16x16x32_bf16 a[56:59], v[116:119], v[88:91], a[56:59]
  v_mfma_f32_16x16x32_bf16 a[88:91], v[88:91], v[120:123], a[88:91]
  v_mfma_f32_16x16x32_bf16 a[120:123], v[88:91], v[124:127], a[120:123]
  v_mfma_f32_16x16x32_bf16 a[28:31], v[112:115], v[92:95], a[28:31]
  v_mfma_f32_16x16x32_bf16 a[60:63], v[116:119], v[92:95], a[60:63]
  v_mfma_f32_16x16x32_bf16 a[92:95], v[92:95], v[120:123], a[92:95]
  v_mfma_f32_16x16x32_bf16 a[124:127], v[92:95], v[124:127], a[124:127]
  s_waitcnt vmcnt(18) lgkmcnt(0)
  s_barrier
  v_mfma_f32_16x16x32_bf16 a[0:3], v[96:99], v[32:35], a[0:3]
  ds_read_b64_tr_b16 v[112:113], v157 offset:24576
  v_mfma_f32_16x16x32_bf16 a[32:35], v[100:103], v[32:35], a[32:35]
  ds_read_b64_tr_b16 v[114:115], v157 offset:25600
  v_mfma_f32_16x16x32_bf16 a[64:67], v[32:35], v[104:107], a[64:67]
  ds_read_b64_tr_b16 v[116:117], v158 offset:24576
  v_mfma_f32_16x16x32_bf16 a[96:99], v[32:35], v[108:111], a[96:99]
  s_add_u32 m0, s39, 122880
  s_add_u32 s34, s35, 0
  buffer_load_dwordx4 v4, s[12:15], s34 offen lds
  v_mfma_f32_16x16x32_bf16 a[4:7], v[96:99], v[36:39], a[4:7]
  ds_read_b64_tr_b16 v[118:119], v158 offset:25600
  v_mfma_f32_16x16x32_bf16 a[36:39], v[100:103], v[36:39], a[36:39]
  ds_read_b64_tr_b16 v[120:121], v157 offset:32768
  v_mfma_f32_16x16x32_bf16 a[68:71], v[36:39], v[104:107], a[68:71]
  ds_read_b64_tr_b16 v[122:123], v157 offset:33792
  v_mfma_f32_16x16x32_bf16 a[100:103], v[36:39], v[108:111], a[100:103]
  s_add_u32 m0, s39, 123904
  s_add_u32 s34, s35, 16384
  buffer_load_dwordx4 v4, s[12:15], s34 offen lds
  v_mfma_f32_16x16x32_bf16 a[8:11], v[96:99], v[40:43], a[8:11]
  ds_read_b64_tr_b16 v[124:125], v158 offset:32768
  v_mfma_f32_16x16x32_bf16 a[40:43], v[100:103], v[40:43], a[40:43]
  ds_read_b64_tr_b16 v[126:127], v158 offset:33792
  v_mfma_f32_16x16x32_bf16 a[72:75], v[40:43], v[104:107], a[72:75]
  ds_read_b128 v[64:67], v156 offset:24576
  v_mfma_f32_16x16x32_bf16 a[104:107], v[40:43], v[108:111], a[104:107]
  s_add_u32 m0, s40, 122880
  s_add_u32 s34, s36, 0
  buffer_load_dwordx4 v5, s[20:23], s34 offen lds
  v_mfma_f32_16x16x32_bf16 a[12:15], v[96:99], v[44:47], a[12:15]
  ds_read_b128 v[68:71], v156 offset:25600
  v_mfma_f32_16x16x32_bf16 a[44:47], v[100:103], v[44:47], a[44:47]
  ds_read_b128 v[72:75], v156 offset:26624
  v_mfma_f32_16x16x32_bf16 a[76:79], v[44:47], v[104:107], a[76:79]
  ds_read_b128 v[76:79], v156 offset:27648
  v_mfma_f32_16x16x32_bf16 a[108:111], v[44:47], v[108:111], a[108:111]
  s_add_u32 m0, s40, 123904
  s_add_u32 s34, s36, 32768
  buffer_load_dwordx4 v5, s[20:23], s34 offen lds
  v_mfma_f32_16x16x32_bf16 a[16:19], v[96:99], v[48:51], a[16:19]
  ds_read_b128 v[80:83], v156 offset:28672
  v_mfma_f32_16x16x32_bf16 a[48:51], v[100:103], v[48:51], a[48:51]
  ds_read_b128 v[84:87], v156 offset:29696
  v_mfma_f32_16x16x32_bf16 a[80:83], v[48:51], v[104:107], a[80:83]
  ds_read_b128 v[88:91], v156 offset:30720
  v_mfma_f32_16x16x32_bf16 a[112:115], v[48:51], v[108:111], a[112:115]
  s_add_u32 m0, s40, 131072
  s_add_u32 s34, s36, 0
  buffer_load_dwordx4 v5, s[24:27], s34 offen lds
  v_mfma_f32_16x16x32_bf16 a[20:23], v[96:99], v[52:55], a[20:23]
  ds_read_b128 v[92:95], v156 offset:31744
  v_mfma_f32_16x16x32_bf16 a[52:55], v[100:103], v[52:55], a[52:55]
  v_mfma_f32_16x16x32_bf16 a[84:87], v[52:55], v[104:107], a[84:87]
  v_mfma_f32_16x16x32_bf16 a[116:119], v[52:55], v[108:111], a[116:119]
  s_add_u32 m0, s40, 132096
  s_add_u32 s34, s36, 32768
  buffer_load_dwordx4 v5, s[24:27], s34 offen lds
  s_add_u32 s35, s35, 64
  s_add_u32 s36, s36, 262144
  v_mfma_f32_16x16x32_bf16 a[24:27], v[96:99], v[56:59], a[24:27]
  v_mfma_f32_16x16x32_bf16 a[56:59], v[100:103], v[56:59], a[56:59]
  v_mfma_f32_16x16x32_bf16 a[88:91], v[56:59], v[104:107], a[88:91]
  v_mfma_f32_16x16x32_bf16 a[120:123], v[56:59], v[108:111], a[120:123]
  v_mfma_f32_16x16x32_bf16 a[28:31], v[96:99], v[60:63], a[28:31]
  v_mfma_f32_16x16x32_bf16 a[60:63], v[100:103], v[60:63], a[60:63]
  v_mfma_f32_16x16x32_bf16 a[92:95], v[60:63], v[104:107], a[92:95]
  v_mfma_f32_16x16x32_bf16 a[124:127], v[60:63], v[108:111], a[124:127]
  s_waitcnt vmcnt(18) lgkmcnt(0)
  s_barrier
  v_mfma_f32_16x16x32_bf16 a[0:3], v[112:115], v[64:67], a[0:3]
  ds_read_b64_tr_b16 v[96:97], v160 offset:0
  v_mfma_f32_16x16x32_bf16 a[32:35], v[116:119], v[64:67], a[32:35]
  ds_read_b64_tr_b16 v[98:99], v160 offset:1024
  v_mfma_f32_16x16x32_bf16 a[64:67], v[64:67], v[120:123], a[64:67]
  ds_read_b64_tr_b16 v[100:101], v161 offset:0
  v_mfma_f32_16x16x32_bf16 a[96:99], v[64:67], v[124:127], a[96:99]
  s_add_u32 m0, s39, 0
  s_add_u32 s34, s35, 0
  buffer_load_dwordx4 v4, s[12:15], s34 offen lds
  v_mfma_f32_16x16x32_bf16 a[4:7], v[112:115], v[68:71], a[4:7]
  ds_read_b64_tr_b16 v[102:103], v161 offset:1024
  v_mfma_f32_16x16x32_bf16 a[36:39], v[116:119], v[68:71], a[36:39]
  ds_read_b64_tr_b16 v[104:105], v160 offset:8192
  v_mfma_f32_16x16x32_bf16 a[68:71], v[68:71], v[120:123], a[68:71]
  ds_read_b64_tr_b16 v[106:107], v160 offset:9216
  v_mfma_f32_16x16x32_bf16 a[100:103], v[68:71], v[124:127], a[100:103]
  s_add_u32 m0, s39, 1024
  s_add_u32 s34, s35, 16384
  buffer_load_dwordx4 v4, s[12:15], s34 offen lds
  v_mfma_f32_16x16x32_bf16 a[8:11], v[112:115], v[72:75], a[8:11]
  ds_read_b64_tr_b16 v[108:109], v161 offset:8192
  v_mfma_f32_16x16x32_bf16 a[40:43], v[116:119], v[72:75], a[40:43]
  ds_read_b64_tr_b16 v[110:111], v161 offset:9216
  v_mfma_f32_16x16x32_bf16 a[72:75], v[72:75], v[120:123], a[72:75]
  ds_read_b128 v[32:35], v159 offset:0
  v_mfma_f32_16x16x32_bf16 a[104:107], v[72:75], v[124:127], a[104:107]
  s_add_u32 m0, s40, 0
  s_add_u32 s34, s36, 0
  buffer_load_dwordx4 v5, s[20:23], s34 offen lds
  v_mfma_f32_16x16x32_bf16 a[12:15], v[112:115], v[76:79], a[12:15]
  ds_read_b128 v[36:39], v159 offset:1024
  v_mfma_f32_16x16x32_bf16 a[44:47], v[116:119], v[76:79], a[44:47]
  ds_read_b128 v[40:43], v159 offset:2048
  v_mfma_f32_16x16x32_bf16 a[76:79], v[76:79], v[120:123], a[76:79]
  ds_read_b128 v[44:47], v159 offset:3072
  v_mfma_f32_16x16x32_bf16 a[108:111], v[76:79], v[124:127], a[108:111]
  s_add_u32 m0, s40, 1024
  s_add_u32 s34, s36, 32768
  buffer_load_dwordx4 v5, s[20:23], s34 offen lds
  v_mfma_f32_16x16x32_bf16 a[16:19], v[112:115], v[80:83], a[16:19]
  ds_read_b128 v[48:51], v159 offset:4096
  v_mfma_f32_16x16x32_bf16 a[48:51], v[116:119], v[80:83], a[48:51]
  ds_read_b128 v[52:55], v159 offset:5120
  v_mfma_f32_16x16x32_bf16 a[80:83], v[80:83], v[120:123], a[80:83]
  ds_read_b128 v[56:59], v159 offset:6144
  v_mfma_f32_16x16x32_bf16 a[112:115], v[80:83], v[124:127], a[112:115]
  s_add_u32 m0, s40, 8192
  s_add_u32 s34, s36, 0
  buffer_load_dwordx4 v5, s[24:27], s34 offen lds
  v_mfma_f32_16x16x32_bf16 a[20:23], v[112:115], v[84:87], a[20:23]
  ds_read_b128 v[60:63], v159 offset:7168
  v_mfma_f32_16x16x32_bf16 a[52:55], v[116:119], v[84:87], a[52:55]
  v_mfma_f32_16x16x32_bf16 a[84:87], v[84:87], v[120:123], a[84:87]
  v_mfma_f32_16x16x32_bf16 a[116:119], v[84:87], v[124:127], a[116:119]
  s_add_u32 m0, s40, 9216
  s_add_u32 s34, s36, 32768
  buffer_load_dwordx4 v5, s[24:27], s34 offen lds
  s_add_u32 s35, s35, 64
  s_add_u32 s36, s36, 262144
  v_mfma_f32_16x16x32_bf16 a[24:27], v[112:115], v[88:91], a[24:27]
  v_mfma_f32_16x16x32_bf16 a[56:59], v[116:119], v[88:91], a[56:59]
  v_mfma_f32_16x16x32_bf16 a[88:91], v[88:91], v[120:123], a[88:91]
  v_mfma_f32_16x16x32_bf16 a[120:123], v[88:91], v[124:127], a[120:123]
  v_mfma_f32_16x16x32_bf16 a[28:31], v[112:115], v[92:95], a[28:31]
  v_mfma_f32_16x16x32_bf16 a[60:63], v[116:119], v[92:95], a[60:63]
  v_mfma_f32_16x16x32_bf16 a[92:95], v[92:95], v[120:123], a[92:95]
  v_mfma_f32_16x16x32_bf16 a[124:127], v[92:95], v[124:127], a[124:127]
  s_waitcnt vmcnt(18) lgkmcnt(0)
  s_barrier
  v_mfma_f32_16x16x32_bf16 a[0:3], v[96:99], v[32:35], a[0:3]
  ds_read_b64_tr_b16 v[112:113], v160 offset:24576
  v_mfma_f32_16x16x32_bf16 a[32:35], v[100:103], v[32:35], a[32:35]
  ds_read_b64_tr_b16 v[114:115], v160 offset:25600
  v_mfma_f32_16x16x32_bf16 a[64:67], v[32:35], v[104:107], a[64:67]
  ds_read_b64_tr_b16 v[116:117], v161 offset:24576
  v_mfma_f32_16x16x32_bf16 a[96:99], v[32:35], v[108:111], a[96:99]
  s_add_u32 m0, s39, 24576
  s_add_u32 s34, s35, 0
  buffer_load_dwordx4 v4, s[12:15], s34 offen lds
  v_mfma_f32_16x16x32_bf16 a[4:7], v[96:99], v[36:39], a[4:7]
  ds_read_b64_tr_b16 v[118:119], v161 offset:25600
  v_mfma_f32_16x16x32_bf16 a[36:39], v[100:103], v[36:39], a[36:39]
  ds_read_b64_tr_b16 v[120:121], v160 offset:32768
  v_mfma_f32_16x16x32_bf16 a[68:71], v[36:39], v[104:107], a[68:71]
  ds_read_b64_tr_b16 v[122:123], v160 offset:33792
  v_mfma_f32_16x16x32_bf16 a[100:103], v[36:39], v[108:111], a[100:103]
  s_add_u32 m0, s39, 25600
  s_add_u32 s34, s35, 16384
  buffer_load_dwordx4 v4, s[12:15], s34 offen lds
  v_mfma_f32_16x16x32_bf16 a[8:11], v[96:99], v[40:43], a[8:11]
  ds_read_b64_tr_b16 v[124:125], v161 offset:32768
  v_mfma_f32_16x16x32_bf16 a[40:43], v[100:103], v[40:43], a[40:43]
  ds_read_b64_tr_b16 v[126:127], v161 offset:33792
  v_mfma_f32_16x16x32_bf16 a[72:75], v[40:43], v[104:107], a[72:75]
  ds_read_b128 v[64:67], v159 offset:24576
  v_mfma_f32_16x16x32_bf16 a[104:107], v[40:43], v[108:111], a[104:107]
  s_add_u32 m0, s40, 24576
  s_add_u32 s34, s36, 0
  buffer_load_dwordx4 v5, s[20:23], s34 offen lds
  v_mfma_f32_16x16x32_bf16 a[12:15], v[96:99], v[44:47], a[12:15]
  ds_read_b128 v[68:71], v159 offset:25600
  v_mfma_f32_16x16x32_bf16 a[44:47], v[100:103], v[44:47], a[44:47]
  ds_read_b128 v[72:75], v159 offset:26624
  v_mfma_f32_16x16x32_bf16 a[76:79], v[44:47], v[104:107], a[76:79]
  ds_read_b128 v[76:79], v159 offset:27648
  v_mfma_f32_16x16x32_bf16 a[108:111], v[44:47], v[108:111], a[108:111]
  s_add_u32 m0, s40, 25600
  s_add_u32 s34, s36, 32768
  buffer_load_dwordx4 v5, s[20:23], s34 offen lds
  v_mfma_f32_16x16x32_bf16 a[16:19], v[96:99], v[48:51], a[16:19]
  ds_read_b128 v[80:83], v159 offset:28672
  v_mfma_f32_16x16x32_bf16 a[48:51], v[100:103], v[48:51], a[48:51]
  ds_read_b128 v[84:87], v159 offset:29696
  v_mfma_f32_16x16x32_bf16 a[80:83], v[48:51], v[104:107], a[80:83]
  ds_read_b128 v[88:91], v159 offset:30720
  v_mfma_f32_16x16x32_bf16 a[112:115], v[48:51], v[108:111], a[112:115]
  s_add_u32 m0, s40, 32768
  s_add_u32 s34, s36, 0
  buffer_load_dwordx4 v5, s[24:27], s34 offen lds
  v_mfma_f32_16x16x32_bf16 a[20:23], v[96:99], v[52:55], a[20:23]
  ds_read_b128 v[92:95], v159 offset:31744
  v_mfma_f32_16x16x32_bf16 a[52:55], v[100:103], v[52:55], a[52:55]
  v_mfma_f32_16x16x32_bf16 a[84:87], v[52:55], v[104:107], a[84:87]
  v_mfma_f32_16x16x32_bf16 a[116:119], v[52:55], v[108:111], a[116:119]
  s_add_u32 m0, s40, 33792
  s_add_u32 s34, s36, 32768
  buffer_load_dwordx4 v5, s[24:27], s34 offen lds
  s_add_u32 s35, s35, 64
  s_add_u32 s36, s36, 262144
  v_mfma_f32_16x16x32_bf16 a[24:27], v[96:99], v[56:59], a[24:27]
  v_mfma_f32_16x16x32_bf16 a[56:59], v[100:103], v[56:59], a[56:59]
  v_mfma_f32_16x16x32_bf16 a[88:91], v[56:59], v[104:107], a[88:91]
  v_mfma_f32_16x16x32_bf16 a[120:123], v[56:59], v[108:111], a[120:123]
  v_mfma_f32_16x16x32_bf16 a[28:31], v[96:99], v[60:63], a[28:31]
  v_mfma_f32_16x16x32_bf16 a[60:63], v[100:103], v[60:63], a[60:63]
  v_mfma_f32_16x16x32_bf16 a[92:95], v[60:63], v[104:107], a[92:95]
  v_mfma_f32_16x16x32_bf16 a[124:127], v[60:63], v[108:111], a[124:127]
  s_waitcnt vmcnt(18) lgkmcnt(0)
  s_barrier
  v_mfma_f32_16x16x32_bf16 a[0:3], v[112:115], v[64:67], a[0:3]
  ds_read_b64_tr_b16 v[96:97], v163 offset:0
  v_mfma_f32_16x16x32_bf16 a[32:35], v[116:119], v[64:67], a[32:35]
  ds_read_b64_tr_b16 v[98:99], v163 offset:1024
  v_mfma_f32_16x16x32_bf16 a[64:67], v[64:67], v[120:123], a[64:67]
  ds_read_b64_tr_b16 v[100:101], v164 offset:0
  v_mfma_f32_16x16x32_bf16 a[96:99], v[64:67], v[124:127], a[96:99]
  s_add_u32 m0, s39, 49152
  s_add_u32 s34, s35, 0
  buffer_load_dwordx4 v4, s[12:15], s34 offen lds
  v_mfma_f32_16x16x32_bf16 a[4:7], v[112:115], v[68:71], a[4:7]
  ds_read_b64_tr_b16 v[102:103], v164 offset:1024
  v_mfma_f32_16x16x32_bf16 a[36:39], v[116:119], v[68:71], a[36:39]
  ds_read_b64_tr_b16 v[104:105], v163 offset:8192
  v_mfma_f32_16x16x32_bf16 a[68:71], v[68:71], v[120:123], a[68:71]
  ds_read_b64_tr_b16 v[106:107], v163 offset:9216
  v_mfma_f32_16x16x32_bf16 a[100:103], v[68:71], v[124:127], a[100:103]
  s_add_u32 m0, s39, 50176
  s_add_u32 s34, s35, 16384
  buffer_load_dwordx4 v4, s[12:15], s34 offen lds
  v_mfma_f32_16x16x32_bf16 a[8:11], v[112:115], v[72:75], a[8:11]
  ds_read_b64_tr_b16 v[108:109], v164 offset:8192
  v_mfma_f32_16x16x32_bf16 a[40:43], v[116:119], v[72:75], a[40:43]
  ds_read_b64_tr_b16 v[110:111], v164 offset:9216
  v_mfma_f32_16x16x32_bf16 a[72:75], v[72:75], v[120:123], a[72:75]
  ds_read_b128 v[32:35], v162 offset:0
  v_mfma_f32_16x16x32_bf16 a[104:107], v[72:75], v[124:127], a[104:107]
  s_add_u32 m0, s40, 49152
  s_add_u32 s34, s36, 0
  buffer_load_dwordx4 v5, s[20:23], s34 offen lds
  v_mfma_f32_16x16x32_bf16 a[12:15], v[112:115], v[76:79], a[12:15]
  ds_read_b128 v[36:39], v162 offset:1024
  v_mfma_f32_16x16x32_bf16 a[44:47], v[116:119], v[76:79], a[44:47]
  ds_read_b128 v[40:43], v162 offset:2048
  v_mfma_f32_16x16x32_bf16 a[76:79], v[76:79], v[120:123], a[76:79]
  ds_read_b128 v[44:47], v162 offset:3072
  v_mfma_f32_16x16x32_bf16 a[108:111], v[76:79], v[124:127], a[108:111]
  s_add_u32 m0, s40, 50176
  s_add_u32 s34, s36, 32768
  buffer_load_dwordx4 v5, s[20:23], s34 offen lds
  v_mfma_f32_16x16x32_bf16 a[16:19], v[112:115], v[80:83], a[16:19]
  ds_read_b128 v[48:51], v162 offset:4096
  v_mfma_f32_16x16x32_bf16 a[48:51], v[116:119], v[80:83], a[48:51]
  ds_read_b128 v[52:55], v162 offset:5120
  v_mfma_f32_16x16x32_bf16 a[80:83], v[80:83], v[120:123], a[80:83]
  ds_read_b128 v[56:59], v162 offset:6144
  v_mfma_f32_16x16x32_bf16 a[112:115], v[80:83], v[124:127], a[112:115]
  s_add_u32 m0, s40, 57344
  s_add_u32 s34, s36, 0
  buffer_load_dwordx4 v5, s[24:27], s34 offen lds
  v_mfma_f32_16x16x32_bf16 a[20:23], v[112:115], v[84:87], a[20:23]
  ds_read_b128 v[60:63], v162 offset:7168
  v_mfma_f32_16x16x32_bf16 a[52:55], v[116:119], v[84:87], a[52:55]
  v_mfma_f32_16x16x32_bf16 a[84:87], v[84:87], v[120:123], a[84:87]
  v_mfma_f32_16x16x32_bf16 a[116:119], v[84:87], v[124:127], a[116:119]
  s_add_u32 m0, s40, 58368
  s_add_u32 s34, s36, 32768
  buffer_load_dwordx4 v5, s[24:27], s34 offen lds
  s_add_u32 s35, s35, 64
  s_add_u32 s36, s36, 262144
  v_mfma_f32_16x16x32_bf16 a[24:27], v[112:115], v[88:91], a[24:27]
  v_mfma_f32_16x16x32_bf16 a[56:59], v[116:119], v[88:91], a[56:59]
  v_mfma_f32_16x16x32_bf16 a[88:91], v[88:91], v[120:123], a[88:91]
  v_mfma_f32_16x16x32_bf16 a[120:123], v[88:91], v[124:127], a[120:123]
  v_mfma_f32_16x16x32_bf16 a[28:31], v[112:115], v[92:95], a[28:31]
  v_mfma_f32_16x16x32_bf16 a[60:63], v[116:119], v[92:95], a[60:63]
  v_mfma_f32_16x16x32_bf16 a[92:95], v[92:95], v[120:123], a[92:95]
  v_mfma_f32_16x16x32_bf16 a[124:127], v[92:95], v[124:127], a[124:127]
  s_cmp_eq_u32 s94, -1
  s_cselect_b32 s87, s93, s94
  s_lshr_b32 s32, s87, 5
  s_lshl_b32 s37, s32, 17
  s_lshl_b32 s32, s28, 15
  s_add_u32 s37, s37, s32
  s_and_b32 s32, s87, 31
  s_lshl_b32 s38, s32, 8
  s_lshl_b32 s32, s28, 16
  s_add_u32 s38, s38, s32
  s_lshr_b32 s32, s92, 5
  s_lshl_b32 s32, s32, 21
  s_and_b32 s33, s92, 31
  s_lshl_b32 s33, s33, 14
  s_add_u32 s32, s32, s33
  s_lshl_b32 s33, s28, 12
  s_add_u32 s32, s32, s33
  s_add_u32 s41, s32, 16777216
  s_lshl_b32 s43, s92, 7
  s_add_u32 s43, s43, 327680
  s_cmp_eq_u32 s97, 0
  s_cselect_b32 s43, s43, 0x7f000000
  v_accvgpr_read_b32 v128, a0
  v_accvgpr_read_b32 v129, a1
  v_accvgpr_read_b32 v130, a2
  v_accvgpr_read_b32 v131, a3
  v_accvgpr_read_b32 v132, a32
  v_accvgpr_read_b32 v133, a33
  v_accvgpr_read_b32 v134, a34
  v_accvgpr_read_b32 v135, a35
  v_cvt_pk_bf16_f32 v136, v128, v129
  v_cvt_pk_bf16_f32 v137, v130, v131
  v_cvt_pk_bf16_f32 v138, v132, v133
  v_cvt_pk_bf16_f32 v139, v134, v135
  s_add_u32 s33, s41, 0
  buffer_store_dwordx4 v[136:139], v6, s[8:11], s33 offen offset:0 sc1
  v_accvgpr_read_b32 v140, a4
  v_accvgpr_read_b32 v141, a5
  v_accvgpr_read_b32 v142, a6
  v_accvgpr_read_b32 v143, a7
  v_accvgpr_read_b32 v144, a36
  v_accvgpr_read_b32 v145, a37
  v_accvgpr_read_b32 v146, a38
  v_accvgpr_read_b32 v147, a39
  v_cvt_pk_bf16_f32 v148, v140, v141
  v_cvt_pk_bf16_f32 v149, v142, v143
  v_cvt_pk_bf16_f32 v150, v144, v145
  v_cvt_pk_bf16_f32 v151, v146, v147
  s_add_u32 s33, s41, 0
  buffer_store_dwordx4 v[148:151], v6, s[8:11], s33 offen offset:1024 sc1
  v_accvgpr_read_b32 v128, a64
  v_accvgpr_read_b32 v129, a65
  v_accvgpr_read_b32 v130, a66
  v_accvgpr_read_b32 v131, a67
  v_accvgpr_read_b32 v132, a68
  v_accvgpr_read_b32 v133, a69
  v_accvgpr_read_b32 v134, a70
  v_accvgpr_read_b32 v135, a71
  v_cvt_pk_bf16_f32 v136, v128, v129
  v_cvt_pk_bf16_f32 v137, v130, v131
  v_cvt_pk_bf16_f32 v138, v132, v133
  v_cvt_pk_bf16_f32 v139, v134, v135
  s_add_u32 s33, s41, 0
  buffer_store_dwordx4 v[136:139], v6, s[8:11], s33 offen offset:2048 sc1
  v_accvgpr_read_b32 v140, a96
  v_accvgpr_read_b32 v141, a97
  v_accvgpr_read_b32 v142, a98
  v_accvgpr_read_b32 v143, a99
  v_accvgpr_read_b32 v144, a100
  v_accvgpr_read_b32 v145, a101
  v_accvgpr_read_b32 v146, a102
  v_accvgpr_read_b32 v147, a103
  v_cvt_pk_bf16_f32 v148, v140, v141
  v_cvt_pk_bf16_f32 v149, v142, v143
  v_cvt_pk_bf16_f32 v150, v144, v145
  v_cvt_pk_bf16_f32 v151, v146, v147
  s_add_u32 s33, s41, 0
  buffer_store_dwordx4 v[148:151], v6, s[8:11], s33 offen offset:3072 sc1
  v_accvgpr_read_b32 v128, a8
  v_accvgpr_read_b32 v129, a9
  v_accvgpr_read_b32 v130, a10
  v_accvgpr_read_b32 v131, a11
  v_accvgpr_read_b32 v132, a40
  v_accvgpr_read_b32 v133, a41
  v_accvgpr_read_b32 v134, a42
  v_accvgpr_read_b32 v135, a43
  v_cvt_pk_bf16_f32 v136, v128, v129
  v_cvt_pk_bf16_f32 v137, v130, v131
  v_cvt_pk_bf16_f32 v138, v132, v133
  v_cvt_pk_bf16_f32 v139, v134, v135
  s_add_u32 s33, s41, 524288
  buffer_store_dwordx4 v[136:139], v6, s[8:11], s33 offen offset:0 sc1
  v_accvgpr_read_b32 v140, a12
  v_accvgpr_read_b32 v141, a13
  v_accvgpr_read_b32 v142, a14
  v_accvgpr_read_b32 v143, a15
  v_accvgpr_read_b32 v144, a44
  v_accvgpr_read_b32 v145, a45
  v_accvgpr_read_b32 v146, a46
  v_accvgpr_read_b32 v147, a47
  v_cvt_pk_bf16_f32 v148, v140, v141
  v_cvt_pk_bf16_f32 v149, v142, v143
  v_cvt_pk_bf16_f32 v150, v144, v145
  v_cvt_pk_bf16_f32 v151, v146, v147
  s_add_u32 s33, s41, 524288
  buffer_store_dwordx4 v[148:151], v6, s[8:11], s33 offen offset:1024 sc1
  v_accvgpr_read_b32 v128, a72
  v_accvgpr_read_b32 v129, a73
  v_accvgpr_read_b32 v130, a74
  v_accvgpr_read_b32 v131, a75
  v_accvgpr_read_b32 v132, a76
  v_accvgpr_read_b32 v133, a77
  v_accvgpr_read_b32 v134, a78
  v_accvgpr_read_b32 v135, a79
  v_cvt_pk_bf16_f32 v136, v128, v129
  v_cvt_pk_bf16_f32 v137, v130, v131
  v_cvt_pk_bf16_f32 v138, v132, v133
  v_cvt_pk_bf16_f32 v139, v134, v135
  s_add_u32 s33, s41, 524288
  buffer_store_dwordx4 v[136:139], v6, s[8:11], s33 offen offset:2048 sc1
  v_accvgpr_read_b32 v140, a104
  v_accvgpr_read_b32 v141, a105
  v_accvgpr_read_b32 v142, a106
  v_accvgpr_read_b32 v143, a107
  v_accvgpr_read_b32 v144, a108
  v_accvgpr_read_b32 v145, a109
  v_accvgpr_read_b32 v146, a110
  v_accvgpr_read_b32 v147, a111
  v_cvt_pk_bf16_f32 v148, v140, v141
  v_cvt_pk_bf16_f32 v149, v142, v143
  v_cvt_pk_bf16_f32 v150, v144, v145
  v_cvt_pk_bf16_f32 v151, v146, v147
  s_add_u32 s33, s41, 524288
  buffer_store_dwordx4 v[148:151], v6, s[8:11], s33 offen offset:3072 sc1
  v_accvgpr_read_b32 v128, a16
  v_accvgpr_read_b32 v129, a17
  v_accvgpr_read_b32 v130, a18
  v_accvgpr_read_b32 v131, a19
  v_accvgpr_read_b32 v132, a48
  v_accvgpr_read_b32 v133, a49
  v_accvgpr_read_b32 v134, a50
  v_accvgpr_read_b32 v135, a51
  v_cvt_pk_bf16_f32 v136, v128, v129
  v_cvt_pk_bf16_f32 v137, v130, v131
  v_cvt_pk_bf16_f32 v138, v132, v133
  v_cvt_pk_bf16_f32 v139, v134, v135
  s_add_u32 s33, s41, 1048576
  buffer_store_dwordx4 v[136:139], v6, s[8:11], s33 offen offset:0 sc1
  v_accvgpr_read_b32 v140, a20
  v_accvgpr_read_b32 v141, a21
  v_accvgpr_read_b32 v142, a22
  v_accvgpr_read_b32 v143, a23
  v_accvgpr_read_b32 v144, a52
  v_accvgpr_read_b32 v145, a53
  v_accvgpr_read_b32 v146, a54
  v_accvgpr_read_b32 v147, a55
  v_cvt_pk_bf16_f32 v148, v140, v141
  v_cvt_pk_bf16_f32 v149, v142, v143
  v_cvt_pk_bf16_f32 v150, v144, v145
  v_cvt_pk_bf16_f32 v151, v146, v147
  s_add_u32 s33, s41, 1048576
  buffer_store_dwordx4 v[148:151], v6, s[8:11], s33 offen offset:1024 sc1
  v_accvgpr_read_b32 v128, a80
  v_accvgpr_read_b32 v129, a81
  v_accvgpr_read_b32 v130, a82
  v_accvgpr_read_b32 v131, a83
  v_accvgpr_read_b32 v132, a84
  v_accvgpr_read_b32 v133, a85
  v_accvgpr_read_b32 v134, a86
  v_accvgpr_read_b32 v135, a87
  v_cvt_pk_bf16_f32 v136, v128, v129
  v_cvt_pk_bf16_f32 v137, v130, v131
  v_cvt_pk_bf16_f32 v138, v132, v133
  v_cvt_pk_bf16_f32 v139, v134, v135
  s_add_u32 s33, s41, 1048576
  buffer_store_dwordx4 v[136:139], v6, s[8:11], s33 offen offset:2048 sc1
  v_accvgpr_read_b32 v140, a112
  v_accvgpr_read_b32 v141, a113
  v_accvgpr_read_b32 v142, a114
  v_accvgpr_read_b32 v143, a115
  v_accvgpr_read_b32 v144, a116
  v_accvgpr_read_b32 v145, a117
  v_accvgpr_read_b32 v146, a118
  v_accvgpr_read_b32 v147, a119
  v_cvt_pk_bf16_f32 v148, v140, v141
  v_cvt_pk_bf16_f32 v149, v142, v143
  v_cvt_pk_bf16_f32 v150, v144, v145
  v_cvt_pk_bf16_f32 v151, v146, v147
  s_add_u32 s33, s41, 1048576
  buffer_store_dwordx4 v[148:151], v6, s[8:11], s33 offen offset:3072 sc1
  v_accvgpr_read_b32 v128, a24
  v_accvgpr_read_b32 v129, a25
  v_accvgpr_read_b32 v130, a26
  v_accvgpr_read_b32 v131, a27
  v_accvgpr_read_b32 v132, a56
  v_accvgpr_read_b32 v133, a57
  v_accvgpr_read_b32 v134, a58
  v_accvgpr_read_b32 v135, a59
  v_cvt_pk_bf16_f32 v136, v128, v129
  v_cvt_pk_bf16_f32 v137, v130, v131
  v_cvt_pk_bf16_f32 v138, v132, v133
  v_cvt_pk_bf16_f32 v139, v134, v135
  s_add_u32 s33, s41, 1572864
  buffer_store_dwordx4 v[136:139], v6, s[8:11], s33 offen offset:0 sc1
  v_accvgpr_read_b32 v140, a28
  v_accvgpr_read_b32 v141, a29
  v_accvgpr_read_b32 v142, a30
  v_accvgpr_read_b32 v143, a31
  v_accvgpr_read_b32 v144, a60
  v_accvgpr_read_b32 v145, a61
  v_accvgpr_read_b32 v146, a62
  v_accvgpr_read_b32 v147, a63
  v_cvt_pk_bf16_f32 v148, v140, v141
  v_cvt_pk_bf16_f32 v149, v142, v143
  v_cvt_pk_bf16_f32 v150, v144, v145
  v_cvt_pk_bf16_f32 v151, v146, v147
  s_add_u32 s33, s41, 1572864
  buffer_store_dwordx4 v[148:151], v6, s[8:11], s33 offen offset:1024 sc1
  v_accvgpr_read_b32 v128, a88
  v_accvgpr_read_b32 v129, a89
  v_accvgpr_read_b32 v130, a90
  v_accvgpr_read_b32 v131, a91
  v_accvgpr_read_b32 v132, a92
  v_accvgpr_read_b32 v133, a93
  v_accvgpr_read_b32 v134, a94
  v_accvgpr_read_b32 v135, a95
  v_cvt_pk_bf16_f32 v136, v128, v129
  v_cvt_pk_bf16_f32 v137, v130, v131
  v_cvt_pk_bf16_f32 v138, v132, v133
  v_cvt_pk_bf16_f32 v139, v134, v135
  s_add_u32 s33, s41, 1572864
  buffer_store_dwordx4 v[136:139], v6, s[8:11], s33 offen offset:2048 sc1
  v_accvgpr_read_b32 v140, a120
  v_accvgpr_read_b32 v141, a121
  v_accvgpr_read_b32 v142, a122
  v_accvgpr_read_b32 v143, a123
  v_accvgpr_read_b32 v144, a124
  v_accvgpr_read_b32 v145, a125
  v_accvgpr_read_b32 v146, a126
  v_accvgpr_read_b32 v147, a127
  v_cvt_pk_bf16_f32 v148, v140, v141
  v_cvt_pk_bf16_f32 v149, v142, v143
  v_cvt_pk_bf16_f32 v150, v144, v145
  v_cvt_pk_bf16_f32 v151, v146, v147
  s_add_u32 s33, s41, 1572864
  buffer_store_dwordx4 v[148:151], v6, s[8:11], s33 offen offset:3072 sc1
  v_mov_b32 v128, 16
  s_nop 1
L_wiw1:
  global_load_dword v129, v128, s[6:7] sc1
  s_waitcnt vmcnt(0)
  v_cmp_gt_u32 vcc, 256, v129
  s_nop 4
  s_cbranch_vccnz L_wiw1
  s_barrier
  buffer_store_dword v11, v7, s[8:11], s43 offen sc1
  s_waitcnt vmcnt(35) lgkmcnt(0)
  s_barrier
  v_mfma_f32_16x16x32_bf16 a[128:131], v[96:99], v[32:35], 0
  ds_read_b64_tr_b16 v[112:113], v163 offset:24576
  v_mfma_f32_16x16x32_bf16 a[160:163], v[100:103], v[32:35], 0
  ds_read_b64_tr_b16 v[114:115], v163 offset:25600
  v_mfma_f32_16x16x32_bf16 a[192:195], v[32:35], v[104:107], 0
  ds_read_b64_tr_b16 v[116:117], v164 offset:24576
  v_mfma_f32_16x16x32_bf16 a[224:227], v[32:35], v[108:111], 0
  s_add_u32 m0, s39, 73728
  s_add_u32 s34, s35, 0
  buffer_load_dwordx4 v4, s[12:15], s34 offen lds
  v_mfma_f32_16x16x32_bf16 a[132:135], v[96:99], v[36:39], 0
  ds_read_b64_tr_b16 v[118:119], v164 offset:25600
  v_mfma_f32_16x16x32_bf16 a[164:167], v[100:103], v[36:39], 0
  ds_read_b64_tr_b16 v[120:121], v163 offset:32768
  v_mfma_f32_16x16x32_bf16 a[196:199], v[36:39], v[104:107], 0
  ds_read_b64_tr_b16 v[122:123], v163 offset:33792
  v_mfma_f32_16x16x32_bf16 a[228:231], v[36:39], v[108:111], 0
  s_add_u32 m0, s39, 74752
  s_add_u32 s34, s35, 16384
  buffer_load_dwordx4 v4, s[12:15], s34 offen lds
  v_mfma_f32_16x16x32_bf16 a[136:139], v[96:99], v[40:43], 0
  ds_read_b64_tr_b16 v[124:125], v164 offset:32768
  v_mfma_f32_16x16x32_bf16 a[168:171], v[100:103], v[40:43], 0
  ds_read_b64_tr_b16 v[126:127], v164 offset:33792
  v_mfma_f32_16x16x32_bf16 a[200:203], v[40:43], v[104:107], 0
  ds_read_b128 v[64:67], v162 offset:24576
  v_mfma_f32_16x16x32_bf16 a[232:235], v[40:43], v[108:111], 0
  s_add_u32 m0, s40, 73728
  s_add_u32 s34, s36, 0
  buffer_load_dwordx4 v5, s[20:23], s34 offen lds
  v_mfma_f32_16x16x32_bf16 a[140:143], v[96:99], v[44:47], 0
  ds_read_b128 v[68:71], v162 offset:25600
  v_mfma_f32_16x16x32_bf16 a[172:175], v[100:103], v[44:47], 0
  ds_read_b128 v[72:75], v162 offset:26624
  v_mfma_f32_16x16x32_bf16 a[204:207], v[44:47], v[104:107], 0
  ds_read_b128 v[76:79], v162 offset:27648
  v_mfma_f32_16x16x32_bf16 a[236:239], v[44:47], v[108:111], 0
  s_add_u32 m0, s40, 74752
  s_add_u32 s34, s36, 32768
  buffer_load_dwordx4 v5, s[20:23], s34 offen lds
  v_mfma_f32_16x16x32_bf16 a[144:147], v[96:99], v[48:51], 0
  ds_read_b128 v[80:83], v162 offset:28672
  v_mfma_f32_16x16x32_bf16 a[176:179], v[100:103], v[48:51], 0
  ds_read_b128 v[84:87], v162 offset:29696
  v_mfma_f32_16x16x32_bf16 a[208:211], v[48:51], v[104:107], 0
  ds_read_b128 v[88:91], v162 offset:30720
  v_mfma_f32_16x16x32_bf16 a[240:243], v[48:51], v[108:111], 0
  s_add_u32 m0, s40, 81920
  s_add_u32 s34, s36, 0
  buffer_load_dwordx4 v5, s[24:27], s34 offen lds
  v_mfma_f32_16x16x32_bf16 a[148:151], v[96:99], v[52:55], 0
  ds_read_b128 v[92:95], v162 offset:31744
  v_mfma_f32_16x16x32_bf16 a[180:183], v[100:103], v[52:55], 0
  v_mfma_f32_16x16x32_bf16 a[212:215], v[52:55], v[104:107], 0
  v_mfma_f32_16x16x32_bf16 a[244:247], v[52:55], v[108:111], 0
  s_add_u32 m0, s40, 82944
  s_add_u32 s34, s36, 32768
  buffer_load_dwordx4 v5, s[24:27], s34 offen lds
  s_add_u32 s35, s35, 64
  s_add_u32 s36, s36, 262144
  v_mfma_f32_16x16x32_bf16 a[152:155], v[96:99], v[56:59], 0
  v_mfma_f32_16x16x32_bf16 a[184:187], v[100:103], v[56:59], 0
  v_mfma_f32_16x16x32_bf16 a[216:219], v[56:59], v[104:107], 0
  v_mfma_f32_16x16x32_bf16 a[248:251], v[56:59], v[108:111], 0
  v_mfma_f32_16x16x32_bf16 a[156:159], v[96:99], v[60:63], 0
  v_mfma_f32_16x16x32_bf16 a[188:191], v[100:103], v[60:63], 0
  v_mfma_f32_16x16x32_bf16 a[220:223], v[60:63], v[104:107], 0
  v_mfma_f32_16x16x32_bf16 a[252:255], v[60:63], v[108:111], 0
  s_waitcnt vmcnt(35) lgkmcnt(0)
  s_barrier
  v_mfma_f32_16x16x32_bf16 a[128:131], v[112:115], v[64:67], a[128:131]
  ds_read_b64_tr_b16 v[96:97], v157 offset:0
  v_mfma_f32_16x16x32_bf16 a[160:163], v[116:119], v[64:67], a[160:163]
  ds_read_b64_tr_b16 v[98:99], v157 offset:1024
  v_mfma_f32_16x16x32_bf16 a[192:195], v[64:67], v[120:123], a[192:195]
  ds_read_b64_tr_b16 v[100:101], v158 offset:0
  v_mfma_f32_16x16x32_bf16 a[224:227], v[64:67], v[124:127], a[224:227]
  s_add_u32 m0, s39, 98304
  s_add_u32 s34, s35, 0
  buffer_load_dwordx4 v4, s[12:15], s34 offen lds
  v_mfma_f32_16x16x32_bf16 a[132:135], v[112:115], v[68:71], a[132:135]
  ds_read_b64_tr_b16 v[102:103], v158 offset:1024
  v_mfma_f32_16x16x32_bf16 a[164:167], v[116:119], v[68:71], a[164:167]
  ds_read_b64_tr_b16 v[104:105], v157 offset:8192
  v_mfma_f32_16x16x32_bf16 a[196:199], v[68:71], v[120:123], a[196:199]
  ds_read_b64_tr_b16 v[106:107], v157 offset:9216
  v_mfma_f32_16x16x32_bf16 a[228:231], v[68:71], v[124:127], a[228:231]
  s_add_u32 m0, s39, 99328
  s_add_u32 s34, s35, 16384
  buffer_load_dwordx4 v4, s[12:15], s34 offen lds
  v_mfma_f32_16x16x32_bf16 a[136:139], v[112:115], v[72:75], a[136:139]
  ds_read_b64_tr_b16 v[108:109], v158 offset:8192
  v_mfma_f32_16x16x32_bf16 a[168:171], v[116:119], v[72:75], a[168:171]
  ds_read_b64_tr_b16 v[110:111], v158 offset:9216
  v_mfma_f32_16x16x32_bf16 a[200:203], v[72:75], v[120:123], a[200:203]
  ds_read_b128 v[32:35], v156 offset:0
  v_mfma_f32_16x16x32_bf16 a[232:235], v[72:75], v[124:127], a[232:235]
  s_add_u32 m0, s40, 98304
  s_add_u32 s34, s36, 0
  buffer_load_dwordx4 v5, s[20:23], s34 offen lds
  v_mfma_f32_16x16x32_bf16 a[140:143], v[112:115], v[76:79], a[140:143]
  ds_read_b128 v[36:39], v156 offset:1024
  v_mfma_f32_16x16x32_bf16 a[172:175], v[116:119], v[76:79], a[172:175]
  ds_read_b128 v[40:43], v156 offset:2048
  v_mfma_f32_16x16x32_bf16 a[204:207], v[76:79], v[120:123], a[204:207]
  ds_read_b128 v[44:47], v156 offset:3072
  v_mfma_f32_16x16x32_bf16 a[236:239], v[76:79], v[124:127], a[236:239]
  s_add_u32 m0, s40, 99328
  s_add_u32 s34, s36, 32768
  buffer_load_dwordx4 v5, s[20:23], s34 offen lds
  v_mfma_f32_16x16x32_bf16 a[144:147], v[112:115], v[80:83], a[144:147]
  ds_read_b128 v[48:51], v156 offset:4096
  v_mfma_f32_16x16x32_bf16 a[176:179], v[116:119], v[80:83], a[176:179]
  ds_read_b128 v[52:55], v156 offset:5120
  v_mfma_f32_16x16x32_bf16 a[208:211], v[80:83], v[120:123], a[208:211]
  ds_read_b128 v[56:59], v156 offset:6144
  v_mfma_f32_16x16x32_bf16 a[240:243], v[80:83], v[124:127], a[240:243]
  s_add_u32 m0, s40, 106496
  s_add_u32 s34, s36, 0
  buffer_load_dwordx4 v5, s[24:27], s34 offen lds
  v_mfma_f32_16x16x32_bf16 a[148:151], v[112:115], v[84:87], a[148:151]
  ds_read_b128 v[60:63], v156 offset:7168
  v_mfma_f32_16x16x32_bf16 a[180:183], v[116:119], v[84:87], a[180:183]
  v_mfma_f32_16x16x32_bf16 a[212:215], v[84:87], v[120:123], a[212:215]
  v_mfma_f32_16x16x32_bf16 a[244:247], v[84:87], v[124:127], a[244:247]
  s_add_u32 m0, s40, 107520
  s_add_u32 s34, s36, 32768
  buffer_load_dwordx4 v5, s[24:27], s34 offen lds
  s_add_u32 s35, s35, 64
  s_add_u32 s36, s36, 262144
  v_mfma_f32_16x16x32_bf16 a[152:155], v[112:115], v[88:91], a[152:155]
  v_mfma_f32_16x16x32_bf16 a[184:187], v[116:119], v[88:91], a[184:187]
  v_mfma_f32_16x16x32_bf16 a[216:219], v[88:91], v[120:123], a[216:219]
  v_mfma_f32_16x16x32_bf16 a[248:251], v[88:91], v[124:127], a[248:251]
  v_mfma_f32_16x16x32_bf16 a[156:159], v[112:115], v[92:95], a[156:159]
  v_mfma_f32_16x16x32_bf16 a[188:191], v[116:119], v[92:95], a[188:191]
  v_mfma_f32_16x16x32_bf16 a[220:223], v[92:95], v[120:123], a[220:223]
  v_mfma_f32_16x16x32_bf16 a[252:255], v[92:95], v[124:127], a[252:255]
  s_waitcnt vmcnt(35) lgkmcnt(0)
  s_barrier
  v_mfma_f32_16x16x32_bf16 a[128:131], v[96:99], v[32:35], a[128:131]
  ds_read_b64_tr_b16 v[112:113], v157 offset:24576
  v_mfma_f32_16x16x32_bf16 a[160:163], v[100:103], v[32:35], a[160:163]
  ds_read_b64_tr_b16 v[114:115], v157 offset:25600
  v_mfma_f32_16x16x32_bf16 a[192:195], v[32:35], v[104:107], a[192:195]
  ds_read_b64_tr_b16 v[116:117], v158 offset:24576
  v_mfma_f32_16x16x32_bf16 a[224:227], v[32:35], v[108:111], a[224:227]
  s_add_u32 m0, s39, 122880
  s_add_u32 s34, s35, 0
  buffer_load_dwordx4 v4, s[12:15], s34 offen lds
  v_mfma_f32_16x16x32_bf16 a[132:135], v[96:99], v[36:39], a[132:135]
  ds_read_b64_tr_b16 v[118:119], v158 offset:25600
  v_mfma_f32_16x16x32_bf16 a[164:167], v[100:103], v[36:39], a[164:167]
  ds_read_b64_tr_b16 v[120:121], v157 offset:32768
  v_mfma_f32_16x16x32_bf16 a[196:199], v[36:39], v[104:107], a[196:199]
  ds_read_b64_tr_b16 v[122:123], v157 offset:33792
  v_mfma_f32_16x16x32_bf16 a[228:231], v[36:39], v[108:111], a[228:231]
  s_add_u32 m0, s39, 123904
  s_add_u32 s34, s35, 16384
  buffer_load_dwordx4 v4, s[12:15], s34 offen lds
  v_mfma_f32_16x16x32_bf16 a[136:139], v[96:99], v[40:43], a[136:139]
  ds_read_b64_tr_b16 v[124:125], v158 offset:32768
  v_mfma_f32_16x16x32_bf16 a[168:171], v[100:103], v[40:43], a[168:171]
  ds_read_b64_tr_b16 v[126:127], v158 offset:33792
  v_mfma_f32_16x16x32_bf16 a[200:203], v[40:43], v[104:107], a[200:203]
  ds_read_b128 v[64:67], v156 offset:24576
  v_mfma_f32_16x16x32_bf16 a[232:235], v[40:43], v[108:111], a[232:235]
  s_add_u32 m0, s40, 122880
  s_add_u32 s34, s36, 0
  buffer_load_dwordx4 v5, s[20:23], s34 offen lds
  v_mfma_f32_16x16x32_bf16 a[140:143], v[96:99], v[44:47], a[140:143]
  ds_read_b128 v[68:71], v156 offset:25600
  v_mfma_f32_16x16x32_bf16 a[172:175], v[100:103], v[44:47], a[172:175]
  ds_read_b128 v[72:75], v156 offset:26624
  v_mfma_f32_16x16x32_bf16 a[204:207], v[44:47], v[104:107], a[204:207]
  ds_read_b128 v[76:79], v156 offset:27648
  v_mfma_f32_16x16x32_bf16 a[236:239], v[44:47], v[108:111], a[236:239]
  s_add_u32 m0, s40, 123904
  s_add_u32 s34, s36, 32768
  buffer_load_dwordx4 v5, s[20:23], s34 offen lds
  v_mfma_f32_16x16x32_bf16 a[144:147], v[96:99], v[48:51], a[144:147]
  ds_read_b128 v[80:83], v156 offset:28672
  v_mfma_f32_16x16x32_bf16 a[176:179], v[100:103], v[48:51], a[176:179]
  ds_read_b128 v[84:87], v156 offset:29696
  v_mfma_f32_16x16x32_bf16 a[208:211], v[48:51], v[104:107], a[208:211]
  ds_read_b128 v[88:91], v156 offset:30720
  v_mfma_f32_16x16x32_bf16 a[240:243], v[48:51], v[108:111], a[240:243]
  s_add_u32 m0, s40, 131072
  s_add_u32 s34, s36, 0
  buffer_load_dwordx4 v5, s[24:27], s34 offen lds
  v_mfma_f32_16x16x32_bf16 a[148:151], v[96:99], v[52:55], a[148:151]
  ds_read_b128 v[92:95], v156 offset:31744
  v_mfma_f32_16x16x32_bf16 a[180:183], v[100:103], v[52:55], a[180:183]
  v_mfma_f32_16x16x32_bf16 a[212:215], v[52:55], v[104:107], a[212:215]
  v_mfma_f32_16x16x32_bf16 a[244:247], v[52:55], v[108:111], a[244:247]
  s_add_u32 m0, s40, 132096
  s_add_u32 s34, s36, 32768
  buffer_load_dwordx4 v5, s[24:27], s34 offen lds
  s_add_u32 s35, s35, 64
  s_add_u32 s36, s36, 262144
  v_mfma_f32_16x16x32_bf16 a[152:155], v[96:99], v[56:59], a[152:155]
  v_mfma_f32_16x16x32_bf16 a[184:187], v[100:103], v[56:59], a[184:187]
  v_mfma_f32_16x16x32_bf16 a[216:219], v[56:59], v[104:107], a[216:219]
  v_mfma_f32_16x16x32_bf16 a[248:251], v[56:59], v[108:111], a[248:251]
  v_mfma_f32_16x16x32_bf16 a[156:159], v[96:99], v[60:63], a[156:159]
  v_mfma_f32_16x16x32_bf16 a[188:191], v[100:103], v[60:63], a[188:191]
  v_mfma_f32_16x16x32_bf16 a[220:223], v[60:63], v[104:107], a[220:223]
  v_mfma_f32_16x16x32_bf16 a[252:255], v[60:63], v[108:111], a[252:255]
  s_waitcnt vmcnt(35) lgkmcnt(0)
  s_barrier
  v_mfma_f32_16x16x32_bf16 a[128:131], v[112:115], v[64:67], a[128:131]
  ds_read_b64_tr_b16 v[96:97], v160 offset:0
  v_mfma_f32_16x16x32_bf16 a[160:163], v[116:119], v[64:67], a[160:163]
  ds_read_b64_tr_b16 v[98:99], v160 offset:1024
  v_mfma_f32_16x16x32_bf16 a[192:195], v[64:67], v[120:123], a[192:195]
  ds_read_b64_tr_b16 v[100:101], v161 offset:0
  v_mfma_f32_16x16x32_bf16 a[224:227], v[64:67], v[124:127], a[224:227]
  s_add_u32 m0, s39, 0
  s_add_u32 s34, s35, 0
  buffer_load_dwordx4 v4, s[12:15], s34 offen lds
  v_mfma_f32_16x16x32_bf16 a[132:135], v[112:115], v[68:71], a[132:135]
  ds_read_b64_tr_b16 v[102:103], v161 offset:1024
  v_mfma_f32_16x16x32_bf16 a[164:167], v[116:119], v[68:71], a[164:167]
  ds_read_b64_tr_b16 v[104:105], v160 offset:8192
  v_mfma_f32_16x16x32_bf16 a[196:199], v[68:71], v[120:123], a[196:199]
  ds_read_b64_tr_b16 v[106:107], v160 offset:9216
  v_mfma_f32_16x16x32_bf16 a[228:231], v[68:71], v[124:127], a[228:231]
  s_add_u32 m0, s39, 1024
  s_add_u32 s34, s35, 16384
  buffer_load_dwordx4 v4, s[12:15], s34 offen lds
  v_mfma_f32_16x16x32_bf16 a[136:139], v[112:115], v[72:75], a[136:139]
  ds_read_b64_tr_b16 v[108:109], v161 offset:8192
  v_mfma_f32_16x16x32_bf16 a[168:171], v[116:119], v[72:75], a[168:171]
  ds_read_b64_tr_b16 v[110:111], v161 offset:9216
  v_mfma_f32_16x16x32_bf16 a[200:203], v[72:75], v[120:123], a[200:203]
  ds_read_b128 v[32:35], v159 offset:0
  v_mfma_f32_16x16x32_bf16 a[232:235], v[72:75], v[124:127], a[232:235]
  s_add_u32 m0, s40, 0
  s_add_u32 s34, s36, 0
  buffer_load_dwordx4 v5, s[20:23], s34 offen lds
  v_mfma_f32_16x16x32_bf16 a[140:143], v[112:115], v[76:79], a[140:143]
  ds_read_b128 v[36:39], v159 offset:1024
  v_mfma_f32_16x16x32_bf16 a[172:175], v[116:119], v[76:79], a[172:175]
  ds_read_b128 v[40:43], v159 offset:2048
  v_mfma_f32_16x16x32_bf16 a[204:207], v[76:79], v[120:123], a[204:207]
  ds_read_b128 v[44:47], v159 offset:3072
  v_mfma_f32_16x16x32_bf16 a[236:239], v[76:79], v[124:127], a[236:239]
  s_add_u32 m0, s40, 1024
  s_add_u32 s34, s36, 32768
  buffer_load_dwordx4 v5, s[20:23], s34 offen lds
  v_mfma_f32_16x16x32_bf16 a[144:147], v[112:115], v[80:83], a[144:147]
  ds_read_b128 v[48:51], v159 offset:4096
  v_mfma_f32_16x16x32_bf16 a[176:179], v[116:119], v[80:83], a[176:179]
  ds_read_b128 v[52:55], v159 offset:5120
  v_mfma_f32_16x16x32_bf16 a[208:211], v[80:83], v[120:123], a[208:211]
  ds_read_b128 v[56:59], v159 offset:6144
  v_mfma_f32_16x16x32_bf16 a[240:243], v[80:83], v[124:127], a[240:243]
  s_add_u32 m0, s40, 8192
  s_add_u32 s34, s36, 0
  buffer_load_dwordx4 v5, s[24:27], s34 offen lds
  v_mfma_f32_16x16x32_bf16 a[148:151], v[112:115], v[84:87], a[148:151]
  ds_read_b128 v[60:63], v159 offset:7168
  v_mfma_f32_16x16x32_bf16 a[180:183], v[116:119], v[84:87], a[180:183]
  v_mfma_f32_16x16x32_bf16 a[212:215], v[84:87], v[120:123], a[212:215]
  v_mfma_f32_16x16x32_bf16 a[244:247], v[84:87], v[124:127], a[244:247]
  s_add_u32 m0, s40, 9216
  s_add_u32 s34, s36, 32768
  buffer_load_dwordx4 v5, s[24:27], s34 offen lds
  s_add_u32 s35, s35, 64
  s_add_u32 s36, s36, 262144
  v_mfma_f32_16x16x32_bf16 a[152:155], v[112:115], v[88:91], a[152:155]
  v_mfma_f32_16x16x32_bf16 a[184:187], v[116:119], v[88:91], a[184:187]
  v_mfma_f32_16x16x32_bf16 a[216:219], v[88:91], v[120:123], a[216:219]
  v_mfma_f32_16x16x32_bf16 a[248:251], v[88:91], v[124:127], a[248:251]
  v_mfma_f32_16x16x32_bf16 a[156:159], v[112:115], v[92:95], a[156:159]
  v_mfma_f32_16x16x32_bf16 a[188:191], v[116:119], v[92:95], a[188:191]
  v_mfma_f32_16x16x32_bf16 a[220:223], v[92:95], v[120:123], a[220:223]
  v_mfma_f32_16x16x32_bf16 a[252:255], v[92:95], v[124:127], a[252:255]
  s_waitcnt vmcnt(18) lgkmcnt(0)
  s_barrier
  v_mfma_f32_16x16x32_bf16 a[128:131], v[96:99], v[32:35], a[128:131]
  ds_read_b64_tr_b16 v[112:113], v160 offset:24576
  v_mfma_f32_16x16x32_bf16 a[160:163], v[100:103], v[32:35], a[160:163]
  ds_read_b64_tr_b16 v[114:115], v160 offset:25600
  v_mfma_f32_16x16x32_bf16 a[192:195], v[32:35], v[104:107], a[192:195]
  ds_read_b64_tr_b16 v[116:117], v161 offset:24576
  v_mfma_f32_16x16x32_bf16 a[224:227], v[32:35], v[108:111], a[224:227]
  s_add_u32 m0, s39, 24576
  s_add_u32 s34, s35, 0
  buffer_load_dwordx4 v4, s[12:15], s34 offen lds
  v_mfma_f32_16x16x32_bf16 a[132:135], v[96:99], v[36:39], a[132:135]
  ds_read_b64_tr_b16 v[118:119], v161 offset:25600
  v_mfma_f32_16x16x32_bf16 a[164:167], v[100:103], v[36:39], a[164:167]
  ds_read_b64_tr_b16 v[120:121], v160 offset:32768
  v_mfma_f32_16x16x32_bf16 a[196:199], v[36:39], v[104:107], a[196:199]
  ds_read_b64_tr_b16 v[122:123], v160 offset:33792
  v_mfma_f32_16x16x32_bf16 a[228:231], v[36:39], v[108:111], a[228:231]
  s_add_u32 m0, s39, 25600
  s_add_u32 s34, s35, 16384
  buffer_load_dwordx4 v4, s[12:15], s34 offen lds
  v_mfma_f32_16x16x32_bf16 a[136:139], v[96:99], v[40:43], a[136:139]
  ds_read_b64_tr_b16 v[124:125], v161 offset:32768
  v_mfma_f32_16x16x32_bf16 a[168:171], v[100:103], v[40:43], a[168:171]
  ds_read_b64_tr_b16 v[126:127], v161 offset:33792
  v_mfma_f32_16x16x32_bf16 a[200:203], v[40:43], v[104:107], a[200:203]
  ds_read_b128 v[64:67], v159 offset:24576
  v_mfma_f32_16x16x32_bf16 a[232:235], v[40:43], v[108:111], a[232:235]
  s_add_u32 m0, s40, 24576
  s_add_u32 s34, s36, 0
  buffer_load_dwordx4 v5, s[20:23], s34 offen lds
  v_mfma_f32_16x16x32_bf16 a[140:143], v[96:99], v[44:47], a[140:143]
  ds_read_b128 v[68:71], v159 offset:25600
  v_mfma_f32_16x16x32_bf16 a[172:175], v[100:103], v[44:47], a[172:175]
  ds_read_b128 v[72:75], v159 offset:26624
  v_mfma_f32_16x16x32_bf16 a[204:207], v[44:47], v[104:107], a[204:207]
  ds_read_b128 v[76:79], v159 offset:27648
  v_mfma_f32_16x16x32_bf16 a[236:239], v[44:47], v[108:111], a[236:239]
  s_add_u32 m0, s40, 25600
  s_add_u32 s34, s36, 32768
  buffer_load_dwordx4 v5, s[20:23], s34 offen lds
  v_mfma_f32_16x16x32_bf16 a[144:147], v[96:99], v[48:51], a[144:147]
  ds_read_b128 v[80:83], v159 offset:28672
  v_mfma_f32_16x16x32_bf16 a[176:179], v[100:103], v[48:51], a[176:179]
  ds_read_b128 v[84:87], v159 offset:29696
  v_mfma_f32_16x16x32_bf16 a[208:211], v[48:51], v[104:107], a[208:211]
  ds_read_b128 v[88:91], v159 offset:30720
  v_mfma_f32_16x16x32_bf16 a[240:243], v[48:51], v[108:111], a[240:243]
  s_add_u32 m0, s40, 32768
  s_add_u32 s34, s36, 0
  buffer_load_dwordx4 v5, s[24:27], s34 offen lds
  v_mfma_f32_16x16x32_bf16 a[148:151], v[96:99], v[52:55], a[148:151]
  ds_read_b128 v[92:95], v159 offset:31744
  v_mfma_f32_16x16x32_bf16 a[180:183], v[100:103], v[52:55], a[180:183]
  v_mfma_f32_16x16x32_bf16 a[212:215], v[52:55], v[104:107], a[212:215]
  v_mfma_f32_16x16x32_bf16 a[244:247], v[52:55], v[108:111], a[244:247]
  s_add_u32 m0, s40, 33792
  s_add_u32 s34, s36, 32768
  buffer_load_dwordx4 v5, s[24:27], s34 offen lds
  s_add_u32 s35, s35, 64
  s_add_u32 s36, s36, 262144
  v_mfma_f32_16x16x32_bf16 a[152:155], v[96:99], v[56:59], a[152:155]
  v_mfma_f32_16x16x32_bf16 a[184:187], v[100:103], v[56:59], a[184:187]
  v_mfma_f32_16x16x32_bf16 a[216:219], v[56:59], v[104:107], a[216:219]
  v_mfma_f32_16x16x32_bf16 a[248:251], v[56:59], v[108:111], a[248:251]
  v_mfma_f32_16x16x32_bf16 a[156:159], v[96:99], v[60:63], a[156:159]
  v_mfma_f32_16x16x32_bf16 a[188:191], v[100:103], v[60:63], a[188:191]
  v_mfma_f32_16x16x32_bf16 a[220:223], v[60:63], v[104:107], a[220:223]
  v_mfma_f32_16x16x32_bf16 a[252:255], v[60:63], v[108:111], a[252:255]
  s_waitcnt vmcnt(18) lgkmcnt(0)
  s_barrier
  v_mfma_f32_16x16x32_bf16 a[128:131], v[112:115], v[64:67], a[128:131]
  ds_read_b64_tr_b16 v[96:97], v163 offset:0
  v_mfma_f32_16x16x32_bf16 a[160:163], v[116:119], v[64:67], a[160:163]
  ds_read_b64_tr_b16 v[98:99], v163 offset:1024
  v_mfma_f32_16x16x32_bf16 a[192:195], v[64:67], v[120:123], a[192:195]
  ds_read_b64_tr_b16 v[100:101], v164 offset:0
  v_mfma_f32_16x16x32_bf16 a[224:227], v[64:67], v[124:127], a[224:227]
  s_add_u32 m0, s39, 49152
  s_add_u32 s34, s35, 0
  buffer_load_dwordx4 v4, s[12:15], s34 offen lds
  v_mfma_f32_16x16x32_bf16 a[132:135], v[112:115], v[68:71], a[132:135]
  ds_read_b64_tr_b16 v[102:103], v164 offset:1024
  v_mfma_f32_16x16x32_bf16 a[164:167], v[116:119], v[68:71], a[164:167]
  ds_read_b64_tr_b16 v[104:105], v163 offset:8192
  v_mfma_f32_16x16x32_bf16 a[196:199], v[68:71], v[120:123], a[196:199]
  ds_read_b64_tr_b16 v[106:107], v163 offset:9216
  v_mfma_f32_16x16x32_bf16 a[228:231], v[68:71], v[124:127], a[228:231]
  s_add_u32 m0, s39, 50176
  s_add_u32 s34, s35, 16384
  buffer_load_dwordx4 v4, s[12:15], s34 offen lds
  v_mfma_f32_16x16x32_bf16 a[136:139], v[112:115], v[72:75], a[136:139]
  ds_read_b64_tr_b16 v[108:109], v164 offset:8192
  v_mfma_f32_16x16x32_bf16 a[168:171], v[116:119], v[72:75], a[168:171]
  ds_read_b64_tr_b16 v[110:111], v164 offset:9216
  v_mfma_f32_16x16x32_bf16 a[200:203], v[72:75], v[120:123], a[200:203]
  ds_read_b128 v[32:35], v162 offset:0
  v_mfma_f32_16x16x32_bf16 a[232:235], v[72:75], v[124:127], a[232:235]
  s_add_u32 m0, s40, 49152
  s_add_u32 s34, s36, 0
  buffer_load_dwordx4 v5, s[20:23], s34 offen lds
  v_mfma_f32_16x16x32_bf16 a[140:143], v[112:115], v[76:79], a[140:143]
  ds_read_b128 v[36:39], v162 offset:1024
  v_mfma_f32_16x16x32_bf16 a[172:175], v[116:119], v[76:79], a[172:175]
  ds_read_b128 v[40:43], v162 offset:2048
  v_mfma_f32_16x16x32_bf16 a[204:207], v[76:79], v[120:123], a[204:207]
  ds_read_b128 v[44:47], v162 offset:3072
  v_mfma_f32_16x16x32_bf16 a[236:239], v[76:79], v[124:127], a[236:239]
  s_add_u32 m0, s40, 50176
  s_add_u32 s34, s36, 32768
  buffer_load_dwordx4 v5, s[20:23], s34 offen lds
  v_mfma_f32_16x16x32_bf16 a[144:147], v[112:115], v[80:83], a[144:147]
  ds_read_b128 v[48:51], v162 offset:4096
  v_mfma_f32_16x16x32_bf16 a[176:179], v[116:119], v[80:83], a[176:179]
  ds_read_b128 v[52:55], v162 offset:5120
  v_mfma_f32_16x16x32_bf16 a[208:211], v[80:83], v[120:123], a[208:211]
  ds_read_b128 v[56:59], v162 offset:6144
  v_mfma_f32_16x16x32_bf16 a[240:243], v[80:83], v[124:127], a[240:243]
  s_add_u32 m0, s40, 57344
  s_add_u32 s34, s36, 0
  buffer_load_dwordx4 v5, s[24:27], s34 offen lds
  v_mfma_f32_16x16x32_bf16 a[148:151], v[112:115], v[84:87], a[148:151]
  ds_read_b128 v[60:63], v162 offset:7168
  v_mfma_f32_16x16x32_bf16 a[180:183], v[116:119], v[84:87], a[180:183]
  v_mfma_f32_16x16x32_bf16 a[212:215], v[84:87], v[120:123], a[212:215]
  v_mfma_f32_16x16x32_bf16 a[244:247], v[84:87], v[124:127], a[244:247]
  s_add_u32 m0, s40, 58368
  s_add_u32 s34, s36, 32768
  buffer_load_dwordx4 v5, s[24:27], s34 offen lds
  s_add_u32 s35, s35, 64
  s_add_u32 s36, s36, 262144
  v_mfma_f32_16x16x32_bf16 a[152:155], v[112:115], v[88:91], a[152:155]
  v_mfma_f32_16x16x32_bf16 a[184:187], v[116:119], v[88:91], a[184:187]
  v_mfma_f32_16x16x32_bf16 a[216:219], v[88:91], v[120:123], a[216:219]
  v_mfma_f32_16x16x32_bf16 a[248:251], v[88:91], v[124:127], a[248:251]
  v_mfma_f32_16x16x32_bf16 a[156:159], v[112:115], v[92:95], a[156:159]
  v_mfma_f32_16x16x32_bf16 a[188:191], v[116:119], v[92:95], a[188:191]
  v_mfma_f32_16x16x32_bf16 a[220:223], v[92:95], v[120:123], a[220:223]
  v_mfma_f32_16x16x32_bf16 a[252:255], v[92:95], v[124:127], a[252:255]
  s_waitcnt vmcnt(18) lgkmcnt(0)
  s_barrier
  v_mfma_f32_16x16x32_bf16 a[128:131], v[96:99], v[32:35], a[128:131]
  ds_read_b64_tr_b16 v[112:113], v163 offset:24576
  v_mfma_f32_16x16x32_bf16 a[160:163], v[100:103], v[32:35], a[160:163]
  ds_read_b64_tr_b16 v[114:115], v163 offset:25600
  v_mfma_f32_16x16x32_bf16 a[192:195], v[32:35], v[104:107], a[192:195]
  ds_read_b64_tr_b16 v[116:117], v164 offset:24576
  v_mfma_f32_16x16x32_bf16 a[224:227], v[32:35], v[108:111], a[224:227]
  s_add_u32 m0, s39, 73728
  s_add_u32 s34, s35, 0
  buffer_load_dwordx4 v4, s[12:15], s34 offen lds
  v_mfma_f32_16x16x32_bf16 a[132:135], v[96:99], v[36:39], a[132:135]
  ds_read_b64_tr_b16 v[118:119], v164 offset:25600
  v_mfma_f32_16x16x32_bf16 a[164:167], v[100:103], v[36:39], a[164:167]
  ds_read_b64_tr_b16 v[120:121], v163 offset:32768
  v_mfma_f32_16x16x32_bf16 a[196:199], v[36:39], v[104:107], a[196:199]
  ds_read_b64_tr_b16 v[122:123], v163 offset:33792
  v_mfma_f32_16x16x32_bf16 a[228:231], v[36:39], v[108:111], a[228:231]
  s_add_u32 m0, s39, 74752
  s_add_u32 s34, s35, 16384
  buffer_load_dwordx4 v4, s[12:15], s34 offen lds
  v_mfma_f32_16x16x32_bf16 a[136:139], v[96:99], v[40:43], a[136:139]
  ds_read_b64_tr_b16 v[124:125], v164 offset:32768
  v_mfma_f32_16x16x32_bf16 a[168:171], v[100:103], v[40:43], a[168:171]
  ds_read_b64_tr_b16 v[126:127], v164 offset:33792
  v_mfma_f32_16x16x32_bf16 a[200:203], v[40:43], v[104:107], a[200:203]
  ds_read_b128 v[64:67], v162 offset:24576
  v_mfma_f32_16x16x32_bf16 a[232:235], v[40:43], v[108:111], a[232:235]
  s_add_u32 m0, s40, 73728
  s_add_u32 s34, s36, 0
  buffer_load_dwordx4 v5, s[20:23], s34 offen lds
  v_mfma_f32_16x16x32_bf16 a[140:143], v[96:99], v[44:47], a[140:143]
  ds_read_b128 v[68:71], v162 offset:25600
  v_mfma_f32_16x16x32_bf16 a[172:175], v[100:103], v[44:47], a[172:175]
  ds_read_b128 v[72:75], v162 offset:26624
  v_mfma_f32_16x16x32_bf16 a[204:207], v[44:47], v[104:107], a[204:207]
  ds_read_b128 v[76:79], v162 offset:27648
  v_mfma_f32_16x16x32_bf16 a[236:239], v[44:47], v[108:111], a[236:239]
  s_add_u32 m0, s40, 74752
  s_add_u32 s34, s36, 32768
  buffer_load_dwordx4 v5, s[20:23], s34 offen lds
  v_mfma_f32_16x16x32_bf16 a[144:147], v[96:99], v[48:51], a[144:147]
  ds_read_b128 v[80:83], v162 offset:28672
  v_mfma_f32_16x16x32_bf16 a[176:179], v[100:103], v[48:51], a[176:179]
  ds_read_b128 v[84:87], v162 offset:29696
  v_mfma_f32_16x16x32_bf16 a[208:211], v[48:51], v[104:107], a[208:211]
  ds_read_b128 v[88:91], v162 offset:30720
  v_mfma_f32_16x16x32_bf16 a[240:243], v[48:51], v[108:111], a[240:243]
  s_add_u32 m0, s40, 81920
  s_add_u32 s34, s36, 0
  buffer_load_dwordx4 v5, s[24:27], s34 offen lds
  v_mfma_f32_16x16x32_bf16 a[148:151], v[96:99], v[52:55], a[148:151]
  ds_read_b128 v[92:95], v162 offset:31744
  v_mfma_f32_16x16x32_bf16 a[180:183], v[100:103], v[52:55], a[180:183]
  v_mfma_f32_16x16x32_bf16 a[212:215], v[52:55], v[104:107], a[212:215]
  v_mfma_f32_16x16x32_bf16 a[244:247], v[52:55], v[108:111], a[244:247]
  s_add_u32 m0, s40, 82944
  s_add_u32 s34, s36, 32768
  buffer_load_dwordx4 v5, s[24:27], s34 offen lds
  s_add_u32 s35, s35, 64
  s_add_u32 s36, s36, 262144
  v_mfma_f32_16x16x32_bf16 a[152:155], v[96:99], v[56:59], a[152:155]
  v_mfma_f32_16x16x32_bf16 a[184:187], v[100:103], v[56:59], a[184:187]
  v_mfma_f32_16x16x32_bf16 a[216:219], v[56:59], v[104:107], a[216:219]
  v_mfma_f32_16x16x32_bf16 a[248:251], v[56:59], v[108:111], a[248:251]
  v_mfma_f32_16x16x32_bf16 a[156:159], v[96:99], v[60:63], a[156:159]
  v_mfma_f32_16x16x32_bf16 a[188:191], v[100:103], v[60:63], a[188:191]
  v_mfma_f32_16x16x32_bf16 a[220:223], v[60:63], v[104:107], a[220:223]
  v_mfma_f32_16x16x32_bf16 a[252:255], v[60:63], v[108:111], a[252:255]
  s_waitcnt vmcnt(18) lgkmcnt(0)
  s_barrier
  v_mfma_f32_16x16x32_bf16 a[128:131], v[112:115], v[64:67], a[128:131]
  ds_read_b64_tr_b16 v[96:97], v157 offset:0
  v_mfma_f32_16x16x32_bf16 a[160:163], v[116:119], v[64:67], a[160:163]
  ds_read_b64_tr_b16 v[98:99], v157 offset:1024
  v_mfma_f32_16x16x32_bf16 a[192:195], v[64:67], v[120:123], a[192:195]
  ds_read_b64_tr_b16 v[100:101], v158 offset:0
  v_mfma_f32_16x16x32_bf16 a[224:227], v[64:67], v[124:127], a[224:227]
  s_add_u32 m0, s39, 98304
  s_add_u32 s34, s35, 0
  buffer_load_dwordx4 v4, s[12:15], s34 offen lds
  v_mfma_f32_16x16x32_bf16 a[132:135], v[112:115], v[68:71], a[132:135]
  ds_read_b64_tr_b16 v[102:103], v158 offset:1024
  v_mfma_f32_16x16x32_bf16 a[164:167], v[116:119], v[68:71], a[164:167]
  ds_read_b64_tr_b16 v[104:105], v157 offset:8192
  v_mfma_f32_16x16x32_bf16 a[196:199], v[68:71], v[120:123], a[196:199]
  ds_read_b64_tr_b16 v[106:107], v157 offset:9216
  v_mfma_f32_16x16x32_bf16 a[228:231], v[68:71], v[124:127], a[228:231]
  s_add_u32 m0, s39, 99328
  s_add_u32 s34, s35, 16384
  buffer_load_dwordx4 v4, s[12:15], s34 offen lds
  v_mfma_f32_16x16x32_bf16 a[136:139], v[112:115], v[72:75], a[136:139]
  ds_read_b64_tr_b16 v[108:109], v158 offset:8192
  v_mfma_f32_16x16x32_bf16 a[168:171], v[116:119], v[72:75], a[168:171]
  ds_read_b64_tr_b16 v[110:111], v158 offset:9216
  v_mfma_f32_16x16x32_bf16 a[200:203], v[72:75], v[120:123], a[200:203]
  ds_read_b128 v[32:35], v156 offset:0
  v_mfma_f32_16x16x32_bf16 a[232:235], v[72:75], v[124:127], a[232:235]
  s_add_u32 m0, s40, 98304
  s_add_u32 s34, s36, 0
  buffer_load_dwordx4 v5, s[20:23], s34 offen lds
  v_mfma_f32_16x16x32_bf16 a[140:143], v[112:115], v[76:79], a[140:143]
  ds_read_b128 v[36:39], v156 offset:1024
  v_mfma_f32_16x16x32_bf16 a[172:175], v[116:119], v[76:79], a[172:175]
  ds_read_b128 v[40:43], v156 offset:2048
  v_mfma_f32_16x16x32_bf16 a[204:207], v[76:79], v[120:123], a[204:207]
  ds_read_b128 v[44:47], v156 offset:3072
  v_mfma_f32_16x16x32_bf16 a[236:239], v[76:79], v[124:127], a[236:239]
  s_add_u32 m0, s40, 99328
  s_add_u32 s34, s36, 32768
  buffer_load_dwordx4 v5, s[20:23], s34 offen lds
  v_mfma_f32_16x16x32_bf16 a[144:147], v[112:115], v[80:83], a[144:147]
  ds_read_b128 v[48:51], v156 offset:4096
  v_mfma_f32_16x16x32_bf16 a[176:179], v[116:119], v[80:83], a[176:179]
  ds_read_b128 v[52:55], v156 offset:5120
  v_mfma_f32_16x16x32_bf16 a[208:211], v[80:83], v[120:123], a[208:211]
  ds_read_b128 v[56:59], v156 offset:6144
  v_mfma_f32_16x16x32_bf16 a[240:243], v[80:83], v[124:127], a[240:243]
  s_add_u32 m0, s40, 106496
  s_add_u32 s34, s36, 0
  buffer_load_dwordx4 v5, s[24:27], s34 offen lds
  v_mfma_f32_16x16x32_bf16 a[148:151], v[112:115], v[84:87], a[148:151]
  ds_read_b128 v[60:63], v156 offset:7168
  v_mfma_f32_16x16x32_bf16 a[180:183], v[116:119], v[84:87], a[180:183]
  v_mfma_f32_16x16x32_bf16 a[212:215], v[84:87], v[120:123], a[212:215]
  v_mfma_f32_16x16x32_bf16 a[244:247], v[84:87], v[124:127], a[244:247]
  s_add_u32 m0, s40, 107520
  s_add_u32 s34, s36, 32768
  buffer_load_dwordx4 v5, s[24:27], s34 offen lds
  s_add_u32 s35, s35, 64
  s_add_u32 s36, s36, 262144
  v_mfma_f32_16x16x32_bf16 a[152:155], v[112:115], v[88:91], a[152:155]
  v_mfma_f32_16x16x32_bf16 a[184:187], v[116:119], v[88:91], a[184:187]
  v_mfma_f32_16x16x32_bf16 a[216:219], v[88:91], v[120:123], a[216:219]
  v_mfma_f32_16x16x32_bf16 a[248:251], v[88:91], v[124:127], a[248:251]
  v_mfma_f32_16x16x32_bf16 a[156:159], v[112:115], v[92:95], a[156:159]
  v_mfma_f32_16x16x32_bf16 a[188:191], v[116:119], v[92:95], a[188:191]
  v_mfma_f32_16x16x32_bf16 a[220:223], v[92:95], v[120:123], a[220:223]
  v_mfma_f32_16x16x32_bf16 a[252:255], v[92:95], v[124:127], a[252:255]
  s_waitcnt vmcnt(18) lgkmcnt(0)
  s_barrier
  v_mfma_f32_16x16x32_bf16 a[128:131], v[96:99], v[32:35], a[128:131]
  ds_read_b64_tr_b16 v[112:113], v157 offset:24576
  v_mfma_f32_16x16x32_bf16 a[160:163], v[100:103], v[32:35], a[160:163]
  ds_read_b64_tr_b16 v[114:115], v157 offset:25600
  v_mfma_f32_16x16x32_bf16 a[192:195], v[32:35], v[104:107], a[192:195]
  ds_read_b64_tr_b16 v[116:117], v158 offset:24576
  v_mfma_f32_16x16x32_bf16 a[224:227], v[32:35], v[108:111], a[224:227]
  s_add_u32 m0, s39, 122880
  s_add_u32 s34, s35, 0
  buffer_load_dwordx4 v4, s[12:15], s34 offen lds
  v_mfma_f32_16x16x32_bf16 a[132:135], v[96:99], v[36:39], a[132:135]
  ds_read_b64_tr_b16 v[118:119], v158 offset:25600
  v_mfma_f32_16x16x32_bf16 a[164:167], v[100:103], v[36:39], a[164:167]
  ds_read_b64_tr_b16 v[120:121], v157 offset:32768
  v_mfma_f32_16x16x32_bf16 a[196:199], v[36:39], v[104:107], a[196:199]
  ds_read_b64_tr_b16 v[122:123], v157 offset:33792
  v_mfma_f32_16x16x32_bf16 a[228:231], v[36:39], v[108:111], a[228:231]
  s_add_u32 m0, s39, 123904
  s_add_u32 s34, s35, 16384
  buffer_load_dwordx4 v4, s[12:15], s34 offen lds
  v_mfma_f32_16x16x32_bf16 a[136:139], v[96:99], v[40:43], a[136:139]
  ds_read_b64_tr_b16 v[124:125], v158 offset:32768
  v_mfma_f32_16x16x32_bf16 a[168:171], v[100:103], v[40:43], a[168:171]
  ds_read_b64_tr_b16 v[126:127], v158 offset:33792
  v_mfma_f32_16x16x32_bf16 a[200:203], v[40:43], v[104:107], a[200:203]
  ds_read_b128 v[64:67], v156 offset:24576
  v_mfma_f32_16x16x32_bf16 a[232:235], v[40:43], v[108:111], a[232:235]
  s_add_u32 m0, s40, 122880
  s_add_u32 s34, s36, 0
  buffer_load_dwordx4 v5, s[20:23], s34 offen lds
  v_mfma_f32_16x16x32_bf16 a[140:143], v[96:99], v[44:47], a[140:143]
  ds_read_b128 v[68:71], v156 offset:25600
  v_mfma_f32_16x16x32_bf16 a[172:175], v[100:103], v[44:47], a[172:175]
  ds_read_b128 v[72:75], v156 offset:26624
  v_mfma_f32_16x16x32_bf16 a[204:207], v[44:47], v[104:107], a[204:207]
  ds_read_b128 v[76:79], v156 offset:27648
  v_mfma_f32_16x16x32_bf16 a[236:239], v[44:47], v[108:111], a[236:239]
  s_add_u32 m0, s40, 123904
  s_add_u32 s34, s36, 32768
  buffer_load_dwordx4 v5, s[20:23], s34 offen lds
  v_mfma_f32_16x16x32_bf16 a[144:147], v[96:99], v[48:51], a[144:147]
  ds_read_b128 v[80:83], v156 offset:28672
  v_mfma_f32_16x16x32_bf16 a[176:179], v[100:103], v[48:51], a[176:179]
  ds_read_b128 v[84:87], v156 offset:29696
  v_mfma_f32_16x16x32_bf16 a[208:211], v[48:51], v[104:107], a[208:211]
  ds_read_b128 v[88:91], v156 offset:30720
  v_mfma_f32_16x16x32_bf16 a[240:243], v[48:51], v[108:111], a[240:243]
  s_add_u32 m0, s40, 131072
  s_add_u32 s34, s36, 0
  buffer_load_dwordx4 v5, s[24:27], s34 offen lds
  v_mfma_f32_16x16x32_bf16 a[148:151], v[96:99], v[52:55], a[148:151]
  ds_read_b128 v[92:95], v156 offset:31744
  v_mfma_f32_16x16x32_bf16 a[180:183], v[100:103], v[52:55], a[180:183]
  v_mfma_f32_16x16x32_bf16 a[212:215], v[52:55], v[104:107], a[212:215]
  v_mfma_f32_16x16x32_bf16 a[244:247], v[52:55], v[108:111], a[244:247]
  s_add_u32 m0, s40, 132096
  s_add_u32 s34, s36, 32768
  buffer_load_dwordx4 v5, s[24:27], s34 offen lds
  s_add_u32 s35, s35, 64
  s_add_u32 s36, s36, 262144
  v_mfma_f32_16x16x32_bf16 a[152:155], v[96:99], v[56:59], a[152:155]
  v_mfma_f32_16x16x32_bf16 a[184:187], v[100:103], v[56:59], a[184:187]
  v_mfma_f32_16x16x32_bf16 a[216:219], v[56:59], v[104:107], a[216:219]
  v_mfma_f32_16x16x32_bf16 a[248:251], v[56:59], v[108:111], a[248:251]
  v_mfma_f32_16x16x32_bf16 a[156:159], v[96:99], v[60:63], a[156:159]
  v_mfma_f32_16x16x32_bf16 a[188:191], v[100:103], v[60:63], a[188:191]
  v_mfma_f32_16x16x32_bf16 a[220:223], v[60:63], v[104:107], a[220:223]
  v_mfma_f32_16x16x32_bf16 a[252:255], v[60:63], v[108:111], a[252:255]
  s_waitcnt vmcnt(18) lgkmcnt(0)
  s_barrier
  v_mfma_f32_16x16x32_bf16 a[128:131], v[112:115], v[64:67], a[128:131]
  ds_read_b64_tr_b16 v[96:97], v160 offset:0
  v_mfma_f32_16x16x32_bf16 a[160:163], v[116:119], v[64:67], a[160:163]
  ds_read_b64_tr_b16 v[98:99], v160 offset:1024
  v_mfma_f32_16x16x32_bf16 a[192:195], v[64:67], v[120:123], a[192:195]
  ds_read_b64_tr_b16 v[100:101], v161 offset:0
  v_mfma_f32_16x16x32_bf16 a[224:227], v[64:67], v[124:127], a[224:227]
  s_add_u32 m0, s39, 0
  s_add_u32 s34, s35, 0
  buffer_load_dwordx4 v4, s[12:15], s34 offen lds
  v_mfma_f32_16x16x32_bf16 a[132:135], v[112:115], v[68:71], a[132:135]
  ds_read_b64_tr_b16 v[102:103], v161 offset:1024
  v_mfma_f32_16x16x32_bf16 a[164:167], v[116:119], v[68:71], a[164:167]
  ds_read_b64_tr_b16 v[104:105], v160 offset:8192
  v_mfma_f32_16x16x32_bf16 a[196:199], v[68:71], v[120:123], a[196:199]
  ds_read_b64_tr_b16 v[106:107], v160 offset:9216
  v_mfma_f32_16x16x32_bf16 a[228:231], v[68:71], v[124:127], a[228:231]
  s_add_u32 m0, s39, 1024
  s_add_u32 s34, s35, 16384
  buffer_load_dwordx4 v4, s[12:15], s34 offen lds
  v_mfma_f32_16x16x32_bf16 a[136:139], v[112:115], v[72:75], a[136:139]
  ds_read_b64_tr_b16 v[108:109], v161 offset:8192
  v_mfma_f32_16x16x32_bf16 a[168:171], v[116:119], v[72:75], a[168:171]
  ds_read_b64_tr_b16 v[110:111], v161 offset:9216
  v_mfma_f32_16x16x32_bf16 a[200:203], v[72:75], v[120:123], a[200:203]
  ds_read_b128 v[32:35], v159 offset:0
  v_mfma_f32_16x16x32_bf16 a[232:235], v[72:75], v[124:127], a[232:235]
  s_add_u32 m0, s40, 0
  s_add_u32 s34, s36, 0
  buffer_load_dwordx4 v5, s[20:23], s34 offen lds
  v_mfma_f32_16x16x32_bf16 a[140:143], v[112:115], v[76:79], a[140:143]
  ds_read_b128 v[36:39], v159 offset:1024
  v_mfma_f32_16x16x32_bf16 a[172:175], v[116:119], v[76:79], a[172:175]
  ds_read_b128 v[40:43], v159 offset:2048
  v_mfma_f32_16x16x32_bf16 a[204:207], v[76:79], v[120:123], a[204:207]
  ds_read_b128 v[44:47], v159 offset:3072
  v_mfma_f32_16x16x32_bf16 a[236:239], v[76:79], v[124:127], a[236:239]
  s_add_u32 m0, s40, 1024
  s_add_u32 s34, s36, 32768
  buffer_load_dwordx4 v5, s[20:23], s34 offen lds
  v_mfma_f32_16x16x32_bf16 a[144:147], v[112:115], v[80:83], a[144:147]
  ds_read_b128 v[48:51], v159 offset:4096
  v_mfma_f32_16x16x32_bf16 a[176:179], v[116:119], v[80:83], a[176:179]
  ds_read_b128 v[52:55], v159 offset:5120
  v_mfma_f32_16x16x32_bf16 a[208:211], v[80:83], v[120:123], a[208:211]
  ds_read_b128 v[56:59], v159 offset:6144
  v_mfma_f32_16x16x32_bf16 a[240:243], v[80:83], v[124:127], a[240:243]
  s_add_u32 m0, s40, 8192
  s_add_u32 s34, s36, 0
  buffer_load_dwordx4 v5, s[24:27], s34 offen lds
  v_mfma_f32_16x16x32_bf16 a[148:151], v[112:115], v[84:87], a[148:151]
  ds_read_b128 v[60:63], v159 offset:7168
  v_mfma_f32_16x16x32_bf16 a[180:183], v[116:119], v[84:87], a[180:183]
  v_mfma_f32_16x16x32_bf16 a[212:215], v[84:87], v[120:123], a[212:215]
  v_mfma_f32_16x16x32_bf16 a[244:247], v[84:87], v[124:127], a[244:247]
  s_add_u32 m0, s40, 9216
  s_add_u32 s34, s36, 32768
  buffer_load_dwordx4 v5, s[24:27], s34 offen lds
  s_add_u32 s35, s35, 64
  s_add_u32 s36, s36, 262144
  v_mfma_f32_16x16x32_bf16 a[152:155], v[112:115], v[88:91], a[152:155]
  v_mfma_f32_16x16x32_bf16 a[184:187], v[116:119], v[88:91], a[184:187]
  v_mfma_f32_16x16x32_bf16 a[216:219], v[88:91], v[120:123], a[216:219]
  v_mfma_f32_16x16x32_bf16 a[248:251], v[88:91], v[124:127], a[248:251]
  v_mfma_f32_16x16x32_bf16 a[156:159], v[112:115], v[92:95], a[156:159]
  v_mfma_f32_16x16x32_bf16 a[188:191], v[116:119], v[92:95], a[188:191]
  v_mfma_f32_16x16x32_bf16 a[220:223], v[92:95], v[120:123], a[220:223]
  v_mfma_f32_16x16x32_bf16 a[252:255], v[92:95], v[124:127], a[252:255]
  s_waitcnt vmcnt(18) lgkmcnt(0)
  s_barrier
  v_mfma_f32_16x16x32_bf16 a[128:131], v[96:99], v[32:35], a[128:131]
  ds_read_b64_tr_b16 v[112:113], v160 offset:24576
  v_mfma_f32_16x16x32_bf16 a[160:163], v[100:103], v[32:35], a[160:163]
  ds_read_b64_tr_b16 v[114:115], v160 offset:25600
  v_mfma_f32_16x16x32_bf16 a[192:195], v[32:35], v[104:107], a[192:195]
  ds_read_b64_tr_b16 v[116:117], v161 offset:24576
  v_mfma_f32_16x16x32_bf16 a[224:227], v[32:35], v[108:111], a[224:227]
  s_add_u32 m0, s39, 24576
  s_add_u32 s34, s35, 0
  buffer_load_dwordx4 v4, s[12:15], s34 offen lds
  v_mfma_f32_16x16x32_bf16 a[132:135], v[96:99], v[36:39], a[132:135]
  ds_read_b64_tr_b16 v[118:119], v161 offset:25600
  v_mfma_f32_16x16x32_bf16 a[164:167], v[100:103], v[36:39], a[164:167]
  ds_read_b64_tr_b16 v[120:121], v160 offset:32768
  v_mfma_f32_16x16x32_bf16 a[196:199], v[36:39], v[104:107], a[196:199]
  ds_read_b64_tr_b16 v[122:123], v160 offset:33792
  v_mfma_f32_16x16x32_bf16 a[228:231], v[36:39], v[108:111], a[228:231]
  s_add_u32 m0, s39, 25600
  s_add_u32 s34, s35, 16384
  buffer_load_dwordx4 v4, s[12:15], s34 offen lds
  v_mfma_f32_16x16x32_bf16 a[136:139], v[96:99], v[40:43], a[136:139]
  ds_read_b64_tr_b16 v[124:125], v161 offset:32768
  v_mfma_f32_16x16x32_bf16 a[168:171], v[100:103], v[40:43], a[168:171]
  ds_read_b64_tr_b16 v[126:127], v161 offset:33792
  v_mfma_f32_16x16x32_bf16 a[200:203], v[40:43], v[104:107], a[200:203]
  ds_read_b128 v[64:67], v159 offset:24576
  v_mfma_f32_16x16x32_bf16 a[232:235], v[40:43], v[108:111], a[232:235]
  s_add_u32 m0, s40, 24576
  s_add_u32 s34, s36, 0
  buffer_load_dwordx4 v5, s[20:23], s34 offen lds
  v_mfma_f32_16x16x32_bf16 a[140:143], v[96:99], v[44:47], a[140:143]
  ds_read_b128 v[68:71], v159 offset:25600
  v_mfma_f32_16x16x32_bf16 a[172:175], v[100:103], v[44:47], a[172:175]
  ds_read_b128 v[72:75], v159 offset:26624
  v_mfma_f32_16x16x32_bf16 a[204:207], v[44:47], v[104:107], a[204:207]
  ds_read_b128 v[76:79], v159 offset:27648
  v_mfma_f32_16x16x32_bf16 a[236:239], v[44:47], v[108:111], a[236:239]
  s_add_u32 m0, s40, 25600
  s_add_u32 s34, s36, 32768
  buffer_load_dwordx4 v5, s[20:23], s34 offen lds
  v_mfma_f32_16x16x32_bf16 a[144:147], v[96:99], v[48:51], a[144:147]
  ds_read_b128 v[80:83], v159 offset:28672
  v_mfma_f32_16x16x32_bf16 a[176:179], v[100:103], v[48:51], a[176:179]
  ds_read_b128 v[84:87], v159 offset:29696
  v_mfma_f32_16x16x32_bf16 a[208:211], v[48:51], v[104:107], a[208:211]
  ds_read_b128 v[88:91], v159 offset:30720
  v_mfma_f32_16x16x32_bf16 a[240:243], v[48:51], v[108:111], a[240:243]
  s_add_u32 m0, s40, 32768
  s_add_u32 s34, s36, 0
  buffer_load_dwordx4 v5, s[24:27], s34 offen lds
  v_mfma_f32_16x16x32_bf16 a[148:151], v[96:99], v[52:55], a[148:151]
  ds_read_b128 v[92:95], v159 offset:31744
  v_mfma_f32_16x16x32_bf16 a[180:183], v[100:103], v[52:55], a[180:183]
  v_mfma_f32_16x16x32_bf16 a[212:215], v[52:55], v[104:107], a[212:215]
  v_mfma_f32_16x16x32_bf16 a[244:247], v[52:55], v[108:111], a[244:247]
  s_add_u32 m0, s40, 33792
  s_add_u32 s34, s36, 32768
  buffer_load_dwordx4 v5, s[24:27], s34 offen lds
  s_add_u32 s35, s35, 64
  s_add_u32 s36, s36, 262144
  v_mfma_f32_16x16x32_bf16 a[152:155], v[96:99], v[56:59], a[152:155]
  v_mfma_f32_16x16x32_bf16 a[184:187], v[100:103], v[56:59], a[184:187]
  v_mfma_f32_16x16x32_bf16 a[216:219], v[56:59], v[104:107], a[216:219]
  v_mfma_f32_16x16x32_bf16 a[248:251], v[56:59], v[108:111], a[248:251]
  v_mfma_f32_16x16x32_bf16 a[156:159], v[96:99], v[60:63], a[156:159]
  v_mfma_f32_16x16x32_bf16 a[188:191], v[100:103], v[60:63], a[188:191]
  v_mfma_f32_16x16x32_bf16 a[220:223], v[60:63], v[104:107], a[220:223]
  v_mfma_f32_16x16x32_bf16 a[252:255], v[60:63], v[108:111], a[252:255]
  s_waitcnt vmcnt(18) lgkmcnt(0)
  s_barrier
  s_mov_b32 s35, s37
  s_mov_b32 s36, s38
  v_mfma_f32_16x16x32_bf16 a[128:131], v[112:115], v[64:67], a[128:131]
  ds_read_b64_tr_b16 v[96:97], v163 offset:0
  v_mfma_f32_16x16x32_bf16 a[160:163], v[116:119], v[64:67], a[160:163]
  ds_read_b64_tr_b16 v[98:99], v163 offset:1024
  v_mfma_f32_16x16x32_bf16 a[192:195], v[64:67], v[120:123], a[192:195]
  ds_read_b64_tr_b16 v[100:101], v164 offset:0
  v_mfma_f32_16x16x32_bf16 a[224:227], v[64:67], v[124:127], a[224:227]
  s_add_u32 m0, s39, 49152
  s_add_u32 s34, s35, 0
  buffer_load_dwordx4 v4, s[12:15], s34 offen lds
  v_mfma_f32_16x16x32_bf16 a[132:135], v[112:115], v[68:71], a[132:135]
  ds_read_b64_tr_b16 v[102:103], v164 offset:1024
  v_mfma_f32_16x16x32_bf16 a[164:167], v[116:119], v[68:71], a[164:167]
  ds_read_b64_tr_b16 v[104:105], v163 offset:8192
  v_mfma_f32_16x16x32_bf16 a[196:199], v[68:71], v[120:123], a[196:199]
  ds_read_b64_tr_b16 v[106:107], v163 offset:9216
  v_mfma_f32_16x16x32_bf16 a[228:231], v[68:71], v[124:127], a[228:231]
  s_add_u32 m0, s39, 50176
  s_add_u32 s34, s35, 16384
  buffer_load_dwordx4 v4, s[12:15], s34 offen lds
  v_mfma_f32_16x16x32_bf16 a[136:139], v[112:115], v[72:75], a[136:139]
  ds_read_b64_tr_b16 v[108:109], v164 offset:8192
  v_mfma_f32_16x16x32_bf16 a[168:171], v[116:119], v[72:75], a[168:171]
  ds_read_b64_tr_b16 v[110:111], v164 offset:9216
  v_mfma_f32_16x16x32_bf16 a[200:203], v[72:75], v[120:123], a[200:203]
  ds_read_b128 v[32:35], v162 offset:0
  v_mfma_f32_16x16x32_bf16 a[232:235], v[72:75], v[124:127], a[232:235]
  s_add_u32 m0, s40, 49152
  s_add_u32 s34, s36, 0
  buffer_load_dwordx4 v5, s[20:23], s34 offen lds
  v_mfma_f32_16x16x32_bf16 a[140:143], v[112:115], v[76:79], a[140:143]
  ds_read_b128 v[36:39], v162 offset:1024
  v_mfma_f32_16x16x32_bf16 a[172:175], v[116:119], v[76:79], a[172:175]
  ds_read_b128 v[40:43], v162 offset:2048
  v_mfma_f32_16x16x32_bf16 a[204:207], v[76:79], v[120:123], a[204:207]
  ds_read_b128 v[44:47], v162 offset:3072
  v_mfma_f32_16x16x32_bf16 a[236:239], v[76:79], v[124:127], a[236:239]
  s_add_u32 m0, s40, 50176
  s_add_u32 s34, s36, 32768
  buffer_load_dwordx4 v5, s[20:23], s34 offen lds
  v_mfma_f32_16x16x32_bf16 a[144:147], v[112:115], v[80:83], a[144:147]
  ds_read_b128 v[48:51], v162 offset:4096
  v_mfma_f32_16x16x32_bf16 a[176:179], v[116:119], v[80:83], a[176:179]
  ds_read_b128 v[52:55], v162 offset:5120
  v_mfma_f32_16x16x32_bf16 a[208:211], v[80:83], v[120:123], a[208:211]
  ds_read_b128 v[56:59], v162 offset:6144
  v_mfma_f32_16x16x32_bf16 a[240:243], v[80:83], v[124:127], a[240:243]
  s_add_u32 m0, s40, 57344
  s_add_u32 s34, s36, 0
  buffer_load_dwordx4 v5, s[24:27], s34 offen lds
  v_mfma_f32_16x16x32_bf16 a[148:151], v[112:115], v[84:87], a[148:151]
  ds_read_b128 v[60:63], v162 offset:7168
  v_mfma_f32_16x16x32_bf16 a[180:183], v[116:119], v[84:87], a[180:183]
  v_mfma_f32_16x16x32_bf16 a[212:215], v[84:87], v[120:123], a[212:215]
  v_mfma_f32_16x16x32_bf16 a[244:247], v[84:87], v[124:127], a[244:247]
  s_add_u32 m0, s40, 58368
  s_add_u32 s34, s36, 32768
  buffer_load_dwordx4 v5, s[24:27], s34 offen lds
  s_add_u32 s35, s35, 64
  s_add_u32 s36, s36, 262144
  v_mfma_f32_16x16x32_bf16 a[152:155], v[112:115], v[88:91], a[152:155]
  v_mfma_f32_16x16x32_bf16 a[184:187], v[116:119], v[88:91], a[184:187]
  v_mfma_f32_16x16x32_bf16 a[216:219], v[88:91], v[120:123], a[216:219]
  v_mfma_f32_16x16x32_bf16 a[248:251], v[88:91], v[124:127], a[248:251]
  v_mfma_f32_16x16x32_bf16 a[156:159], v[112:115], v[92:95], a[156:159]
  v_mfma_f32_16x16x32_bf16 a[188:191], v[116:119], v[92:95], a[188:191]
  v_mfma_f32_16x16x32_bf16 a[220:223], v[92:95], v[120:123], a[220:223]
  v_mfma_f32_16x16x32_bf16 a[252:255], v[92:95], v[124:127], a[252:255]
  s_waitcnt vmcnt(18) lgkmcnt(0)
  s_barrier
  v_mfma_f32_16x16x32_bf16 a[128:131], v[96:99], v[32:35], a[128:131]
  ds_read_b64_tr_b16 v[112:113], v163 offset:24576
  v_mfma_f32_16x16x32_bf16 a[160:163], v[100:103], v[32:35], a[160:163]
  ds_read_b64_tr_b16 v[114:115], v163 offset:25600
  v_mfma_f32_16x16x32_bf16 a[192:195], v[32:35], v[104:107], a[192:195]
  ds_read_b64_tr_b16 v[116:117], v164 offset:24576
  v_mfma_f32_16x16x32_bf16 a[224:227], v[32:35], v[108:111], a[224:227]
  s_add_u32 m0, s39, 73728
  s_add_u32 s34, s35, 0
  buffer_load_dwordx4 v4, s[12:15], s34 offen lds
  v_mfma_f32_16x16x32_bf16 a[132:135], v[96:99], v[36:39], a[132:135]
  ds_read_b64_tr_b16 v[118:119], v164 offset:25600
  v_mfma_f32_16x16x32_bf16 a[164:167], v[100:103], v[36:39], a[164:167]
  ds_read_b64_tr_b16 v[120:121], v163 offset:32768
  v_mfma_f32_16x16x32_bf16 a[196:199], v[36:39], v[104:107], a[196:199]
  ds_read_b64_tr_b16 v[122:123], v163 offset:33792
  v_mfma_f32_16x16x32_bf16 a[228:231], v[36:39], v[108:111], a[228:231]
  s_add_u32 m0, s39, 74752
  s_add_u32 s34, s35, 16384
  buffer_load_dwordx4 v4, s[12:15], s34 offen lds
  v_mfma_f32_16x16x32_bf16 a[136:139], v[96:99], v[40:43], a[136:139]
  ds_read_b64_tr_b16 v[124:125], v164 offset:32768
  v_mfma_f32_16x16x32_bf16 a[168:171], v[100:103], v[40:43], a[168:171]
  ds_read_b64_tr_b16 v[126:127], v164 offset:33792
  v_mfma_f32_16x16x32_bf16 a[200:203], v[40:43], v[104:107], a[200:203]
  ds_read_b128 v[64:67], v162 offset:24576
  v_mfma_f32_16x16x32_bf16 a[232:235], v[40:43], v[108:111], a[232:235]
  s_add_u32 m0, s40, 73728
  s_add_u32 s34, s36, 0
  buffer_load_dwordx4 v5, s[20:23], s34 offen lds
  v_mfma_f32_16x16x32_bf16 a[140:143], v[96:99], v[44:47], a[140:143]
  ds_read_b128 v[68:71], v162 offset:25600
  v_mfma_f32_16x16x32_bf16 a[172:175], v[100:103], v[44:47], a[172:175]
  ds_read_b128 v[72:75], v162 offset:26624
  v_mfma_f32_16x16x32_bf16 a[204:207], v[44:47], v[104:107], a[204:207]
  ds_read_b128 v[76:79], v162 offset:27648
  v_mfma_f32_16x16x32_bf16 a[236:239], v[44:47], v[108:111], a[236:239]
  s_add_u32 m0, s40, 74752
  s_add_u32 s34, s36, 32768
  buffer_load_dwordx4 v5, s[20:23], s34 offen lds
  v_mfma_f32_16x16x32_bf16 a[144:147], v[96:99], v[48:51], a[144:147]
  ds_read_b128 v[80:83], v162 offset:28672
  v_mfma_f32_16x16x32_bf16 a[176:179], v[100:103], v[48:51], a[176:179]
  ds_read_b128 v[84:87], v162 offset:29696
  v_mfma_f32_16x16x32_bf16 a[208:211], v[48:51], v[104:107], a[208:211]
  ds_read_b128 v[88:91], v162 offset:30720
  v_mfma_f32_16x16x32_bf16 a[240:243], v[48:51], v[108:111], a[240:243]
  s_add_u32 m0, s40, 81920
  s_add_u32 s34, s36, 0
  buffer_load_dwordx4 v5, s[24:27], s34 offen lds
  v_mfma_f32_16x16x32_bf16 a[148:151], v[96:99], v[52:55], a[148:151]
  ds_read_b128 v[92:95], v162 offset:31744
  v_mfma_f32_16x16x32_bf16 a[180:183], v[100:103], v[52:55], a[180:183]
  v_mfma_f32_16x16x32_bf16 a[212:215], v[52:55], v[104:107], a[212:215]
  v_mfma_f32_16x16x32_bf16 a[244:247], v[52:55], v[108:111], a[244:247]
  s_add_u32 m0, s40, 82944
  s_add_u32 s34, s36, 32768
  buffer_load_dwordx4 v5, s[24:27], s34 offen lds
  s_add_u32 s35, s35, 64
  s_add_u32 s36, s36, 262144
  v_mfma_f32_16x16x32_bf16 a[152:155], v[96:99], v[56:59], a[152:155]
  v_mfma_f32_16x16x32_bf16 a[184:187], v[100:103], v[56:59], a[184:187]
  v_mfma_f32_16x16x32_bf16 a[216:219], v[56:59], v[104:107], a[216:219]
  v_mfma_f32_16x16x32_bf16 a[248:251], v[56:59], v[108:111], a[248:251]
  v_mfma_f32_16x16x32_bf16 a[156:159], v[96:99], v[60:63], a[156:159]
  v_mfma_f32_16x16x32_bf16 a[188:191], v[100:103], v[60:63], a[188:191]
  v_mfma_f32_16x16x32_bf16 a[220:223], v[60:63], v[104:107], a[220:223]
  v_mfma_f32_16x16x32_bf16 a[252:255], v[60:63], v[108:111], a[252:255]
  s_waitcnt vmcnt(18) lgkmcnt(0)
  s_barrier
  v_mfma_f32_16x16x32_bf16 a[128:131], v[112:115], v[64:67], a[128:131]
  ds_read_b64_tr_b16 v[96:97], v157 offset:0
  v_mfma_f32_16x16x32_bf16 a[160:163], v[116:119], v[64:67], a[160:163]
  ds_read_b64_tr_b16 v[98:99], v157 offset:1024
  v_mfma_f32_16x16x32_bf16 a[192:195], v[64:67], v[120:123], a[192:195]
  ds_read_b64_tr_b16 v[100:101], v158 offset:0
  v_mfma_f32_16x16x32_bf16 a[224:227], v[64:67], v[124:127], a[224:227]
  s_add_u32 m0, s39, 98304
  s_add_u32 s34, s35, 0
  buffer_load_dwordx4 v4, s[12:15], s34 offen lds
  v_mfma_f32_16x16x32_bf16 a[132:135], v[112:115], v[68:71], a[132:135]
  ds_read_b64_tr_b16 v[102:103], v158 offset:1024
  v_mfma_f32_16x16x32_bf16 a[164:167], v[116:119], v[68:71], a[164:167]
  ds_read_b64_tr_b16 v[104:105], v157 offset:8192
  v_mfma_f32_16x16x32_bf16 a[196:199], v[68:71], v[120:123], a[196:199]
  ds_read_b64_tr_b16 v[106:107], v157 offset:9216
  v_mfma_f32_16x16x32_bf16 a[228:231], v[68:71], v[124:127], a[228:231]
  s_add_u32 m0, s39, 99328
  s_add_u32 s34, s35, 16384
  buffer_load_dwordx4 v4, s[12:15], s34 offen lds
  v_mfma_f32_16x16x32_bf16 a[136:139], v[112:115], v[72:75], a[136:139]
  ds_read_b64_tr_b16 v[108:109], v158 offset:8192
  v_mfma_f32_16x16x32_bf16 a[168:171], v[116:119], v[72:75], a[168:171]
  ds_read_b64_tr_b16 v[110:111], v158 offset:9216
  v_mfma_f32_16x16x32_bf16 a[200:203], v[72:75], v[120:123], a[200:203]
  ds_read_b128 v[32:35], v156 offset:0
  v_mfma_f32_16x16x32_bf16 a[232:235], v[72:75], v[124:127], a[232:235]
  s_add_u32 m0, s40, 98304
  s_add_u32 s34, s36, 0
  buffer_load_dwordx4 v5, s[20:23], s34 offen lds
  v_mfma_f32_16x16x32_bf16 a[140:143], v[112:115], v[76:79], a[140:143]
  ds_read_b128 v[36:39], v156 offset:1024
  v_mfma_f32_16x16x32_bf16 a[172:175], v[116:119], v[76:79], a[172:175]
  ds_read_b128 v[40:43], v156 offset:2048
  v_mfma_f32_16x16x32_bf16 a[204:207], v[76:79], v[120:123], a[204:207]
  ds_read_b128 v[44:47], v156 offset:3072
  v_mfma_f32_16x16x32_bf16 a[236:239], v[76:79], v[124:127], a[236:239]
  s_add_u32 m0, s40, 99328
  s_add_u32 s34, s36, 32768
  buffer_load_dwordx4 v5, s[20:23], s34 offen lds
  v_mfma_f32_16x16x32_bf16 a[144:147], v[112:115], v[80:83], a[144:147]
  ds_read_b128 v[48:51], v156 offset:4096
  v_mfma_f32_16x16x32_bf16 a[176:179], v[116:119], v[80:83], a[176:179]
  ds_read_b128 v[52:55], v156 offset:5120
  v_mfma_f32_16x16x32_bf16 a[208:211], v[80:83], v[120:123], a[208:211]
  ds_read_b128 v[56:59], v156 offset:6144
  v_mfma_f32_16x16x32_bf16 a[240:243], v[80:83], v[124:127], a[240:243]
  s_add_u32 m0, s40, 106496
  s_add_u32 s34, s36, 0
  buffer_load_dwordx4 v5, s[24:27], s34 offen lds
  v_mfma_f32_16x16x32_bf16 a[148:151], v[112:115], v[84:87], a[148:151]
  ds_read_b128 v[60:63], v156 offset:7168
  v_mfma_f32_16x16x32_bf16 a[180:183], v[116:119], v[84:87], a[180:183]
  v_mfma_f32_16x16x32_bf16 a[212:215], v[84:87], v[120:123], a[212:215]
  v_mfma_f32_16x16x32_bf16 a[244:247], v[84:87], v[124:127], a[244:247]
  s_add_u32 m0, s40, 107520
  s_add_u32 s34, s36, 32768
  buffer_load_dwordx4 v5, s[24:27], s34 offen lds
  s_add_u32 s35, s35, 64
  s_add_u32 s36, s36, 262144
  v_mfma_f32_16x16x32_bf16 a[152:155], v[112:115], v[88:91], a[152:155]
  v_mfma_f32_16x16x32_bf16 a[184:187], v[116:119], v[88:91], a[184:187]
  v_mfma_f32_16x16x32_bf16 a[216:219], v[88:91], v[120:123], a[216:219]
  v_mfma_f32_16x16x32_bf16 a[248:251], v[88:91], v[124:127], a[248:251]
  v_mfma_f32_16x16x32_bf16 a[156:159], v[112:115], v[92:95], a[156:159]
  v_mfma_f32_16x16x32_bf16 a[188:191], v[116:119], v[92:95], a[188:191]
  v_mfma_f32_16x16x32_bf16 a[220:223], v[92:95], v[120:123], a[220:223]
  v_mfma_f32_16x16x32_bf16 a[252:255], v[92:95], v[124:127], a[252:255]
  s_waitcnt vmcnt(18) lgkmcnt(0)
  s_barrier
  v_mfma_f32_16x16x32_bf16 a[128:131], v[96:99], v[32:35], a[128:131]
  ds_read_b64_tr_b16 v[112:113], v157 offset:24576
  v_mfma_f32_16x16x32_bf16 a[160:163], v[100:103], v[32:35], a[160:163]
  ds_read_b64_tr_b16 v[114:115], v157 offset:25600
  v_mfma_f32_16x16x32_bf16 a[192:195], v[32:35], v[104:107], a[192:195]
  ds_read_b64_tr_b16 v[116:117], v158 offset:24576
  v_mfma_f32_16x16x32_bf16 a[224:227], v[32:35], v[108:111], a[224:227]
  s_add_u32 m0, s39, 122880
  s_add_u32 s34, s35, 0
  buffer_load_dwordx4 v4, s[12:15], s34 offen lds
  v_mfma_f32_16x16x32_bf16 a[132:135], v[96:99], v[36:39], a[132:135]
  ds_read_b64_tr_b16 v[118:119], v158 offset:25600
  v_mfma_f32_16x16x32_bf16 a[164:167], v[100:103], v[36:39], a[164:167]
  ds_read_b64_tr_b16 v[120:121], v157 offset:32768
  v_mfma_f32_16x16x32_bf16 a[196:199], v[36:39], v[104:107], a[196:199]
  ds_read_b64_tr_b16 v[122:123], v157 offset:33792
  v_mfma_f32_16x16x32_bf16 a[228:231], v[36:39], v[108:111], a[228:231]
  s_add_u32 m0, s39, 123904
  s_add_u32 s34, s35, 16384
  buffer_load_dwordx4 v4, s[12:15], s34 offen lds
  v_mfma_f32_16x16x32_bf16 a[136:139], v[96:99], v[40:43], a[136:139]
  ds_read_b64_tr_b16 v[124:125], v158 offset:32768
  v_mfma_f32_16x16x32_bf16 a[168:171], v[100:103], v[40:43], a[168:171]
  ds_read_b64_tr_b16 v[126:127], v158 offset:33792
  v_mfma_f32_16x16x32_bf16 a[200:203], v[40:43], v[104:107], a[200:203]
  ds_read_b128 v[64:67], v156 offset:24576
  v_mfma_f32_16x16x32_bf16 a[232:235], v[40:43], v[108:111], a[232:235]
  s_add_u32 m0, s40, 122880
  s_add_u32 s34, s36, 0
  buffer_load_dwordx4 v5, s[20:23], s34 offen lds
  v_mfma_f32_16x16x32_bf16 a[140:143], v[96:99], v[44:47], a[140:143]
  ds_read_b128 v[68:71], v156 offset:25600
  v_mfma_f32_16x16x32_bf16 a[172:175], v[100:103], v[44:47], a[172:175]
  ds_read_b128 v[72:75], v156 offset:26624
  v_mfma_f32_16x16x32_bf16 a[204:207], v[44:47], v[104:107], a[204:207]
  ds_read_b128 v[76:79], v156 offset:27648
  v_mfma_f32_16x16x32_bf16 a[236:239], v[44:47], v[108:111], a[236:239]
  s_add_u32 m0, s40, 123904
  s_add_u32 s34, s36, 32768
  buffer_load_dwordx4 v5, s[20:23], s34 offen lds
  v_mfma_f32_16x16x32_bf16 a[144:147], v[96:99], v[48:51], a[144:147]
  ds_read_b128 v[80:83], v156 offset:28672
  v_mfma_f32_16x16x32_bf16 a[176:179], v[100:103], v[48:51], a[176:179]
  ds_read_b128 v[84:87], v156 offset:29696
  v_mfma_f32_16x16x32_bf16 a[208:211], v[48:51], v[104:107], a[208:211]
  ds_read_b128 v[88:91], v156 offset:30720
  v_mfma_f32_16x16x32_bf16 a[240:243], v[48:51], v[108:111], a[240:243]
  s_add_u32 m0, s40, 131072
  s_add_u32 s34, s36, 0
  buffer_load_dwordx4 v5, s[24:27], s34 offen lds
  v_mfma_f32_16x16x32_bf16 a[148:151], v[96:99], v[52:55], a[148:151]
  ds_read_b128 v[92:95], v156 offset:31744
  v_mfma_f32_16x16x32_bf16 a[180:183], v[100:103], v[52:55], a[180:183]
  v_mfma_f32_16x16x32_bf16 a[212:215], v[52:55], v[104:107], a[212:215]
  v_mfma_f32_16x16x32_bf16 a[244:247], v[52:55], v[108:111], a[244:247]
  s_add_u32 m0, s40, 132096
  s_add_u32 s34, s36, 32768
  buffer_load_dwordx4 v5, s[24:27], s34 offen lds
  s_add_u32 s35, s35, 64
  s_add_u32 s36, s36, 262144
  v_mfma_f32_16x16x32_bf16 a[152:155], v[96:99], v[56:59], a[152:155]
  v_mfma_f32_16x16x32_bf16 a[184:187], v[100:103], v[56:59], a[184:187]
  v_mfma_f32_16x16x32_bf16 a[216:219], v[56:59], v[104:107], a[216:219]
  v_mfma_f32_16x16x32_bf16 a[248:251], v[56:59], v[108:111], a[248:251]
  v_mfma_f32_16x16x32_bf16 a[156:159], v[96:99], v[60:63], a[156:159]
  v_mfma_f32_16x16x32_bf16 a[188:191], v[100:103], v[60:63], a[188:191]
  v_mfma_f32_16x16x32_bf16 a[220:223], v[60:63], v[104:107], a[220:223]
  v_mfma_f32_16x16x32_bf16 a[252:255], v[60:63], v[108:111], a[252:255]
  s_waitcnt vmcnt(18) lgkmcnt(0)
  s_barrier
  v_mfma_f32_16x16x32_bf16 a[128:131], v[112:115], v[64:67], a[128:131]
  ds_read_b64_tr_b16 v[96:97], v160 offset:0
  v_mfma_f32_16x16x32_bf16 a[160:163], v[116:119], v[64:67], a[160:163]
  ds_read_b64_tr_b16 v[98:99], v160 offset:1024
  v_mfma_f32_16x16x32_bf16 a[192:195], v[64:67], v[120:123], a[192:195]
  ds_read_b64_tr_b16 v[100:101], v161 offset:0
  v_mfma_f32_16x16x32_bf16 a[224:227], v[64:67], v[124:127], a[224:227]
  s_add_u32 m0, s39, 0
  s_add_u32 s34, s35, 0
  buffer_load_dwordx4 v4, s[12:15], s34 offen lds
  v_mfma_f32_16x16x32_bf16 a[132:135], v[112:115], v[68:71], a[132:135]
  ds_read_b64_tr_b16 v[102:103], v161 offset:1024
  v_mfma_f32_16x16x32_bf16 a[164:167], v[116:119], v[68:71], a[164:167]
  ds_read_b64_tr_b16 v[104:105], v160 offset:8192
  v_mfma_f32_16x16x32_bf16 a[196:199], v[68:71], v[120:123], a[196:199]
  ds_read_b64_tr_b16 v[106:107], v160 offset:9216
  v_mfma_f32_16x16x32_bf16 a[228:231], v[68:71], v[124:127], a[228:231]
  s_add_u32 m0, s39, 1024
  s_add_u32 s34, s35, 16384
  buffer_load_dwordx4 v4, s[12:15], s34 offen lds
  v_mfma_f32_16x16x32_bf16 a[136:139], v[112:115], v[72:75], a[136:139]
  ds_read_b64_tr_b16 v[108:109], v161 offset:8192
  v_mfma_f32_16x16x32_bf16 a[168:171], v[116:119], v[72:75], a[168:171]
  ds_read_b64_tr_b16 v[110:111], v161 offset:9216
  v_mfma_f32_16x16x32_bf16 a[200:203], v[72:75], v[120:123], a[200:203]
  ds_read_b128 v[32:35], v159 offset:0
  v_mfma_f32_16x16x32_bf16 a[232:235], v[72:75], v[124:127], a[232:235]
  s_add_u32 m0, s40, 0
  s_add_u32 s34, s36, 0
  buffer_load_dwordx4 v5, s[20:23], s34 offen lds
  v_mfma_f32_16x16x32_bf16 a[140:143], v[112:115], v[76:79], a[140:143]
  ds_read_b128 v[36:39], v159 offset:1024
  v_mfma_f32_16x16x32_bf16 a[172:175], v[116:119], v[76:79], a[172:175]
  ds_read_b128 v[40:43], v159 offset:2048
  v_mfma_f32_16x16x32_bf16 a[204:207], v[76:79], v[120:123], a[204:207]
  ds_read_b128 v[44:47], v159 offset:3072
  v_mfma_f32_16x16x32_bf16 a[236:239], v[76:79], v[124:127], a[236:239]
  s_add_u32 m0, s40, 1024
  s_add_u32 s34, s36, 32768
  buffer_load_dwordx4 v5, s[20:23], s34 offen lds
  v_mfma_f32_16x16x32_bf16 a[144:147], v[112:115], v[80:83], a[144:147]
  ds_read_b128 v[48:51], v159 offset:4096
  v_mfma_f32_16x16x32_bf16 a[176:179], v[116:119], v[80:83], a[176:179]
  ds_read_b128 v[52:55], v159 offset:5120
  v_mfma_f32_16x16x32_bf16 a[208:211], v[80:83], v[120:123], a[208:211]
  ds_read_b128 v[56:59], v159 offset:6144
  v_mfma_f32_16x16x32_bf16 a[240:243], v[80:83], v[124:127], a[240:243]
  s_add_u32 m0, s40, 8192
  s_add_u32 s34, s36, 0
  buffer_load_dwordx4 v5, s[24:27], s34 offen lds
  v_mfma_f32_16x16x32_bf16 a[148:151], v[112:115], v[84:87], a[148:151]
  ds_read_b128 v[60:63], v159 offset:7168
  v_mfma_f32_16x16x32_bf16 a[180:183], v[116:119], v[84:87], a[180:183]
  v_mfma_f32_16x16x32_bf16 a[212:215], v[84:87], v[120:123], a[212:215]
  v_mfma_f32_16x16x32_bf16 a[244:247], v[84:87], v[124:127], a[244:247]
  s_add_u32 m0, s40, 9216
  s_add_u32 s34, s36, 32768
  buffer_load_dwordx4 v5, s[24:27], s34 offen lds
  s_add_u32 s35, s35, 64
  s_add_u32 s36, s36, 262144
  v_mfma_f32_16x16x32_bf16 a[152:155], v[112:115], v[88:91], a[152:155]
  v_mfma_f32_16x16x32_bf16 a[184:187], v[116:119], v[88:91], a[184:187]
  v_mfma_f32_16x16x32_bf16 a[216:219], v[88:91], v[120:123], a[216:219]
  v_mfma_f32_16x16x32_bf16 a[248:251], v[88:91], v[124:127], a[248:251]
  v_mfma_f32_16x16x32_bf16 a[156:159], v[112:115], v[92:95], a[156:159]
  v_mfma_f32_16x16x32_bf16 a[188:191], v[116:119], v[92:95], a[188:191]
  v_mfma_f32_16x16x32_bf16 a[220:223], v[92:95], v[120:123], a[220:223]
  v_mfma_f32_16x16x32_bf16 a[252:255], v[92:95], v[124:127], a[252:255]
  s_cmp_eq_u32 s94, -1
  s_nop 6
  s_cbranch_scc1 L_kv_two
  s_lshr_b32 s32, s93, 5
  s_lshl_b32 s32, s32, 21
  s_and_b32 s33, s93, 31
  s_lshl_b32 s33, s33, 14
  s_add_u32 s32, s32, s33
  s_lshl_b32 s33, s28, 12
  s_add_u32 s32, s32, s33
  s_add_u32 s41, s32, 16777216
  s_lshl_b32 s43, s93, 7
  s_add_u32 s43, s43, 327680
  s_cmp_eq_u32 s97, 0
  s_cselect_b32 s43, s43, 0x7f000000
  s_waitcnt vmcnt(18) lgkmcnt(0)
  s_barrier
  v_mfma_f32_16x16x32_bf16 a[0:3], v[96:99], v[32:35], 0
  ds_read_b64_tr_b16 v[112:113], v160 offset:24576
  v_accvgpr_read_b32 v128, a128
  v_accvgpr_read_b32 v129, a129
  v_mfma_f32_16x16x32_bf16 a[32:35], v[100:103], v[32:35], 0
  ds_read_b64_tr_b16 v[114:115], v160 offset:25600
  v_accvgpr_read_b32 v130, a130
  v_accvgpr_read_b32 v131, a131
  v_mfma_f32_16x16x32_bf16 a[64:67], v[32:35], v[104:107], 0
  ds_read_b64_tr_b16 v[116:117], v161 offset:24576
  v_accvgpr_read_b32 v132, a160
  v_accvgpr_read_b32 v133, a161
  v_mfma_f32_16x16x32_bf16 a[96:99], v[32:35], v[108:111], 0
  s_add_u32 m0, s39, 24576
  s_add_u32 s34, s35, 0
  buffer_load_dwordx4 v4, s[12:15], s34 offen lds
  v_accvgpr_read_b32 v134, a162
  v_accvgpr_read_b32 v135, a163
  v_mfma_f32_16x16x32_bf16 a[4:7], v[96:99], v[36:39], 0
  ds_read_b64_tr_b16 v[118:119], v161 offset:25600
  v_cvt_pk_bf16_f32 v136, v128, v129
  v_cvt_pk_bf16_f32 v137, v130, v131
  v_mfma_f32_16x16x32_bf16 a[36:39], v[100:103], v[36:39], 0
  ds_read_b64_tr_b16 v[120:121], v160 offset:32768
  v_cvt_pk_bf16_f32 v138, v132, v133
  v_cvt_pk_bf16_f32 v139, v134, v135
  v_mfma_f32_16x16x32_bf16 a[68:71], v[36:39], v[104:107], 0
  ds_read_b64_tr_b16 v[122:123], v160 offset:33792
  s_add_u32 s33, s41, 0
  buffer_store_dwordx4 v[136:139], v6, s[8:11], s33 offen offset:0 sc1
  v_accvgpr_read_b32 v140, a132
  v_mfma_f32_16x16x32_bf16 a[100:103], v[36:39], v[108:111], 0
  s_add_u32 m0, s39, 25600
  s_add_u32 s34, s35, 16384
  buffer_load_dwordx4 v4, s[12:15], s34 offen lds
  v_accvgpr_read_b32 v141, a133
  v_accvgpr_read_b32 v142, a134
  v_mfma_f32_16x16x32_bf16 a[8:11], v[96:99], v[40:43], 0
  ds_read_b64_tr_b16 v[124:125], v161 offset:32768
  v_accvgpr_read_b32 v143, a135
  v_accvgpr_read_b32 v144, a164
  v_mfma_f32_16x16x32_bf16 a[40:43], v[100:103], v[40:43], 0
  ds_read_b64_tr_b16 v[126:127], v161 offset:33792
  v_accvgpr_read_b32 v145, a165
  v_accvgpr_read_b32 v146, a166
  v_mfma_f32_16x16x32_bf16 a[72:75], v[40:43], v[104:107], 0
  ds_read_b128 v[64:67], v159 offset:24576
  v_accvgpr_read_b32 v147, a167
  v_cvt_pk_bf16_f32 v148, v140, v141
  v_mfma_f32_16x16x32_bf16 a[104:107], v[40:43], v[108:111], 0
  s_add_u32 m0, s40, 24576
  s_add_u32 s34, s36, 0
  buffer_load_dwordx4 v5, s[20:23], s34 offen lds
  v_cvt_pk_bf16_f32 v149, v142, v143
  v_cvt_pk_bf16_f32 v150, v144, v145
  v_mfma_f32_16x16x32_bf16 a[12:15], v[96:99], v[44:47], 0
  ds_read_b128 v[68:71], v159 offset:25600
  v_cvt_pk_bf16_f32 v151, v146, v147
  s_add_u32 s33, s41, 0
  buffer_store_dwordx4 v[148:151], v6, s[8:11], s33 offen offset:1024 sc1
  v_mfma_f32_16x16x32_bf16 a[44:47], v[100:103], v[44:47], 0
  ds_read_b128 v[72:75], v159 offset:26624
  v_mfma_f32_16x16x32_bf16 a[76:79], v[44:47], v[104:107], 0
  ds_read_b128 v[76:79], v159 offset:27648
  v_mfma_f32_16x16x32_bf16 a[108:111], v[44:47], v[108:111], 0
  s_add_u32 m0, s40, 25600
  s_add_u32 s34, s36, 32768
  buffer_load_dwordx4 v5, s[20:23], s34 offen lds
  v_mfma_f32_16x16x32_bf16 a[16:19], v[96:99], v[48:51], 0
  ds_read_b128 v[80:83], v159 offset:28672
  v_mfma_f32_16x16x32_bf16 a[48:51], v[100:103], v[48:51], 0
  ds_read_b128 v[84:87], v159 offset:29696
  v_mfma_f32_16x16x32_bf16 a[80:83], v[48:51], v[104:107], 0
  ds_read_b128 v[88:91], v159 offset:30720
  v_mfma_f32_16x16x32_bf16 a[112:115], v[48:51], v[108:111], 0
  s_add_u32 m0, s40, 32768
  s_add_u32 s34, s36, 0
  buffer_load_dwordx4 v5, s[24:27], s34 offen lds
  v_mfma_f32_16x16x32_bf16 a[20:23], v[96:99], v[52:55], 0
  ds_read_b128 v[92:95], v159 offset:31744
  v_mfma_f32_16x16x32_bf16 a[52:55], v[100:103], v[52:55], 0
  v_mfma_f32_16x16x32_bf16 a[84:87], v[52:55], v[104:107], 0
  v_mfma_f32_16x16x32_bf16 a[116:119], v[52:55], v[108:111], 0
  s_add_u32 m0, s40, 33792
  s_add_u32 s34, s36, 32768
  buffer_load_dwordx4 v5, s[24:27], s34 offen lds
  s_add_u32 s35, s35, 64
  s_add_u32 s36, s36, 262144
  v_mfma_f32_16x16x32_bf16 a[24:27], v[96:99], v[56:59], 0
  v_mfma_f32_16x16x32_bf16 a[56:59], v[100:103], v[56:59], 0
  v_mfma_f32_16x16x32_bf16 a[88:91], v[56:59], v[104:107], 0
  v_mfma_f32_16x16x32_bf16 a[120:123], v[56:59], v[108:111], 0
  v_mfma_f32_16x16x32_bf16 a[28:31], v[96:99], v[60:63], 0
  v_mfma_f32_16x16x32_bf16 a[60:63], v[100:103], v[60:63], 0
  v_mfma_f32_16x16x32_bf16 a[92:95], v[60:63], v[104:107], 0
  v_mfma_f32_16x16x32_bf16 a[124:127], v[60:63], v[108:111], 0
  s_waitcnt vmcnt(20) lgkmcnt(0)
  s_barrier
  v_mfma_f32_16x16x32_bf16 a[0:3], v[112:115], v[64:67], a[0:3]
  ds_read_b64_tr_b16 v[96:97], v163 offset:0
  v_accvgpr_read_b32 v128, a192
  v_accvgpr_read_b32 v129, a193
  v_mfma_f32_16x16x32_bf16 a[32:35], v[116:119], v[64:67], a[32:35]
  ds_read_b64_tr_b16 v[98:99], v163 offset:1024
  v_accvgpr_read_b32 v130, a194
  v_accvgpr_read_b32 v131, a195
  v_mfma_f32_16x16x32_bf16 a[64:67], v[64:67], v[120:123], a[64:67]
  ds_read_b64_tr_b16 v[100:101], v164 offset:0
  v_accvgpr_read_b32 v132, a196
  v_accvgpr_read_b32 v133, a197
  v_mfma_f32_16x16x32_bf16 a[96:99], v[64:67], v[124:127], a[96:99]
  s_add_u32 m0, s39, 49152
  s_add_u32 s34, s35, 0
  buffer_load_dwordx4 v4, s[12:15], s34 offen lds
  v_accvgpr_read_b32 v134, a198
  v_accvgpr_read_b32 v135, a199
  v_mfma_f32_16x16x32_bf16 a[4:7], v[112:115], v[68:71], a[4:7]
  ds_read_b64_tr_b16 v[102:103], v164 offset:1024
  v_cvt_pk_bf16_f32 v136, v128, v129
  v_cvt_pk_bf16_f32 v137, v130, v131
  v_mfma_f32_16x16x32_bf16 a[36:39], v[116:119], v[68:71], a[36:39]
  ds_read_b64_tr_b16 v[104:105], v163 offset:8192
  v_cvt_pk_bf16_f32 v138, v132, v133
  v_cvt_pk_bf16_f32 v139, v134, v135
  v_mfma_f32_16x16x32_bf16 a[68:71], v[68:71], v[120:123], a[68:71]
  ds_read_b64_tr_b16 v[106:107], v163 offset:9216
  s_add_u32 s33, s41, 0
  buffer_store_dwordx4 v[136:139], v6, s[8:11], s33 offen offset:2048 sc1
  v_accvgpr_read_b32 v140, a224
  v_mfma_f32_16x16x32_bf16 a[100:103], v[68:71], v[124:127], a[100:103]
  s_add_u32 m0, s39, 50176
  s_add_u32 s34, s35, 16384
  buffer_load_dwordx4 v4, s[12:15], s34 offen lds
  v_accvgpr_read_b32 v141, a225
  v_accvgpr_read_b32 v142, a226
  v_mfma_f32_16x16x32_bf16 a[8:11], v[112:115], v[72:75], a[8:11]
  ds_read_b64_tr_b16 v[108:109], v164 offset:8192
  v_accvgpr_read_b32 v143, a227
  v_accvgpr_read_b32 v144, a228
  v_mfma_f32_16x16x32_bf16 a[40:43], v[116:119], v[72:75], a[40:43]
  ds_read_b64_tr_b16 v[110:111], v164 offset:9216
  v_accvgpr_read_b32 v145, a229
  v_accvgpr_read_b32 v146, a230
  v_mfma_f32_16x16x32_bf16 a[72:75], v[72:75], v[120:123], a[72:75]
  ds_read_b128 v[32:35], v162 offset:0
  v_accvgpr_read_b32 v147, a231
  v_cvt_pk_bf16_f32 v148, v140, v141
  v_mfma_f32_16x16x32_bf16 a[104:107], v[72:75], v[124:127], a[104:107]
  s_add_u32 m0, s40, 49152
  s_add_u32 s34, s36, 0
  buffer_load_dwordx4 v5, s[20:23], s34 offen lds
  v_cvt_pk_bf16_f32 v149, v142, v143
  v_cvt_pk_bf16_f32 v150, v144, v145
  v_mfma_f32_16x16x32_bf16 a[12:15], v[112:115], v[76:79], a[12:15]
  ds_read_b128 v[36:39], v162 offset:1024
  v_cvt_pk_bf16_f32 v151, v146, v147
  s_add_u32 s33, s41, 0
  buffer_store_dwordx4 v[148:151], v6, s[8:11], s33 offen offset:3072 sc1
  v_mfma_f32_16x16x32_bf16 a[44:47], v[116:119], v[76:79], a[44:47]
  ds_read_b128 v[40:43], v162 offset:2048
  v_mfma_f32_16x16x32_bf16 a[76:79], v[76:79], v[120:123], a[76:79]
  ds_read_b128 v[44:47], v162 offset:3072
  v_mfma_f32_16x16x32_bf16 a[108:111], v[76:79], v[124:127], a[108:111]
  s_add_u32 m0, s40, 50176
  s_add_u32 s34, s36, 32768
  buffer_load_dwordx4 v5, s[20:23], s34 offen lds
  v_mfma_f32_16x16x32_bf16 a[16:19], v[112:115], v[80:83], a[16:19]
  ds_read_b128 v[48:51], v162 offset:4096
  v_mfma_f32_16x16x32_bf16 a[48:51], v[116:119], v[80:83], a[48:51]
  ds_read_b128 v[52:55], v162 offset:5120
  v_mfma_f32_16x16x32_bf16 a[80:83], v[80:83], v[120:123], a[80:83]
  ds_read_b128 v[56:59], v162 offset:6144
  v_mfma_f32_16x16x32_bf16 a[112:115], v[80:83], v[124:127], a[112:115]
  s_add_u32 m0, s40, 57344
  s_add_u32 s34, s36, 0
  buffer_load_dwordx4 v5, s[24:27], s34 offen lds
  v_mfma_f32_16x16x32_bf16 a[20:23], v[112:115], v[84:87], a[20:23]
  ds_read_b128 v[60:63], v162 offset:7168
  v_mfma_f32_16x16x32_bf16 a[52:55], v[116:119], v[84:87], a[52:55]
  v_mfma_f32_16x16x32_bf16 a[84:87], v[84:87], v[120:123], a[84:87]
  v_mfma_f32_16x16x32_bf16 a[116:119], v[84:87], v[124:127], a[116:119]
  s_add_u32 m0, s40, 58368
  s_add_u32 s34, s36, 32768
  buffer_load_dwordx4 v5, s[24:27], s34 offen lds
  s_add_u32 s35, s35, 64
  s_add_u32 s36, s36, 262144
  v_mfma_f32_16x16x32_bf16 a[24:27], v[112:115], v[88:91], a[24:27]
  v_mfma_f32_16x16x32_bf16 a[56:59], v[116:119], v[88:91], a[56:59]
  v_mfma_f32_16x16x32_bf16 a[88:91], v[88:91], v[120:123], a[88:91]
  v_mfma_f32_16x16x32_bf16 a[120:123], v[88:91], v[124:127], a[120:123]
  v_mfma_f32_16x16x32_bf16 a[28:31], v[112:115], v[92:95], a[28:31]
  v_mfma_f32_16x16x32_bf16 a[60:63], v[116:119], v[92:95], a[60:63]
  v_mfma_f32_16x16x32_bf16 a[92:95], v[92:95], v[120:123], a[92:95]
  v_mfma_f32_16x16x32_bf16 a[124:127], v[92:95], v[124:127], a[124:127]
  s_waitcnt vmcnt(22) lgkmcnt(0)
  s_barrier
  v_mfma_f32_16x16x32_bf16 a[0:3], v[96:99], v[32:35], a[0:3]
  ds_read_b64_tr_b16 v[112:113], v163 offset:24576
  v_accvgpr_read_b32 v128, a136
  v_accvgpr_read_b32 v129, a137
  v_mfma_f32_16x16x32_bf16 a[32:35], v[100:103], v[32:35], a[32:35]
  ds_read_b64_tr_b16 v[114:115], v163 offset:25600
  v_accvgpr_read_b32 v130, a138
  v_accvgpr_read_b32 v131, a139
  v_mfma_f32_16x16x32_bf16 a[64:67], v[32:35], v[104:107], a[64:67]
  ds_read_b64_tr_b16 v[116:117], v164 offset:24576
  v_accvgpr_read_b32 v132, a168
  v_accvgpr_read_b32 v133, a169
  v_mfma_f32_16x16x32_bf16 a[96:99], v[32:35], v[108:111], a[96:99]
  s_add_u32 m0, s39, 73728
  s_add_u32 s34, s35, 0
  buffer_load_dwordx4 v4, s[12:15], s34 offen lds
  v_accvgpr_read_b32 v134, a170
  v_accvgpr_read_b32 v135, a171
  v_mfma_f32_16x16x32_bf16 a[4:7], v[96:99], v[36:39], a[4:7]
  ds_read_b64_tr_b16 v[118:119], v164 offset:25600
  v_cvt_pk_bf16_f32 v136, v128, v129
  v_cvt_pk_bf16_f32 v137, v130, v131
  v_mfma_f32_16x16x32_bf16 a[36:39], v[100:103], v[36:39], a[36:39]
  ds_read_b64_tr_b16 v[120:121], v163 offset:32768
  v_cvt_pk_bf16_f32 v138, v132, v133
  v_cvt_pk_bf16_f32 v139, v134, v135
  v_mfma_f32_16x16x32_bf16 a[68:71], v[36:39], v[104:107], a[68:71]
  ds_read_b64_tr_b16 v[122:123], v163 offset:33792
  s_add_u32 s33, s41, 524288
  buffer_store_dwordx4 v[136:139], v6, s[8:11], s33 offen offset:0 sc1
  v_accvgpr_read_b32 v140, a140
  v_mfma_f32_16x16x32_bf16 a[100:103], v[36:39], v[108:111], a[100:103]
  s_add_u32 m0, s39, 74752
  s_add_u32 s34, s35, 16384
  buffer_load_dwordx4 v4, s[12:15], s34 offen lds
  v_accvgpr_read_b32 v141, a141
  v_accvgpr_read_b32 v142, a142
  v_mfma_f32_16x16x32_bf16 a[8:11], v[96:99], v[40:43], a[8:11]
  ds_read_b64_tr_b16 v[124:125], v164 offset:32768
  v_accvgpr_read_b32 v143, a143
  v_accvgpr_read_b32 v144, a172
  v_mfma_f32_16x16x32_bf16 a[40:43], v[100:103], v[40:43], a[40:43]
  ds_read_b64_tr_b16 v[126:127], v164 offset:33792
  v_accvgpr_read_b32 v145, a173
  v_accvgpr_read_b32 v146, a174
  v_mfma_f32_16x16x32_bf16 a[72:75], v[40:43], v[104:107], a[72:75]
  ds_read_b128 v[64:67], v162 offset:24576
  v_accvgpr_read_b32 v147, a175
  v_cvt_pk_bf16_f32 v148, v140, v141
  v_mfma_f32_16x16x32_bf16 a[104:107], v[40:43], v[108:111], a[104:107]
  s_add_u32 m0, s40, 73728
  s_add_u32 s34, s36, 0
  buffer_load_dwordx4 v5, s[20:23], s34 offen lds
  v_cvt_pk_bf16_f32 v149, v142, v143
  v_cvt_pk_bf16_f32 v150, v144, v145
  v_mfma_f32_16x16x32_bf16 a[12:15], v[96:99], v[44:47], a[12:15]
  ds_read_b128 v[68:71], v162 offset:25600
  v_cvt_pk_bf16_f32 v151, v146, v147
  s_add_u32 s33, s41, 524288
  buffer_store_dwordx4 v[148:151], v6, s[8:11], s33 offen offset:1024 sc1
  v_mfma_f32_16x16x32_bf16 a[44:47], v[100:103], v[44:47], a[44:47]
  ds_read_b128 v[72:75], v162 offset:26624
  v_mfma_f32_16x16x32_bf16 a[76:79], v[44:47], v[104:107], a[76:79]
  ds_read_b128 v[76:79], v162 offset:27648
  v_mfma_f32_16x16x32_bf16 a[108:111], v[44:47], v[108:111], a[108:111]
  s_add_u32 m0, s40, 74752
  s_add_u32 s34, s36, 32768
  buffer_load_dwordx4 v5, s[20:23], s34 offen lds
  v_mfma_f32_16x16x32_bf16 a[16:19], v[96:99], v[48:51], a[16:19]
  ds_read_b128 v[80:83], v162 offset:28672
  v_mfma_f32_16x16x32_bf16 a[48:51], v[100:103], v[48:51], a[48:51]
  ds_read_b128 v[84:87], v162 offset:29696
  v_mfma_f32_16x16x32_bf16 a[80:83], v[48:51], v[104:107], a[80:83]
  ds_read_b128 v[88:91], v162 offset:30720
  v_mfma_f32_16x16x32_bf16 a[112:115], v[48:51], v[108:111], a[112:115]
  s_add_u32 m0, s40, 81920
  s_add_u32 s34, s36, 0
  buffer_load_dwordx4 v5, s[24:27], s34 offen lds
  v_mfma_f32_16x16x32_bf16 a[20:23], v[96:99], v[52:55], a[20:23]
  ds_read_b128 v[92:95], v162 offset:31744
  v_mfma_f32_16x16x32_bf16 a[52:55], v[100:103], v[52:55], a[52:55]
  v_mfma_f32_16x16x32_bf16 a[84:87], v[52:55], v[104:107], a[84:87]
  v_mfma_f32_16x16x32_bf16 a[116:119], v[52:55], v[108:111], a[116:119]
  s_add_u32 m0, s40, 82944
  s_add_u32 s34, s36, 32768
  buffer_load_dwordx4 v5, s[24:27], s34 offen lds
  s_add_u32 s35, s35, 64
  s_add_u32 s36, s36, 262144
  v_mfma_f32_16x16x32_bf16 a[24:27], v[96:99], v[56:59], a[24:27]
  v_mfma_f32_16x16x32_bf16 a[56:59], v[100:103], v[56:59], a[56:59]
  v_mfma_f32_16x16x32_bf16 a[88:91], v[56:59], v[104:107], a[88:91]
  v_mfma_f32_16x16x32_bf16 a[120:123], v[56:59], v[108:111], a[120:123]
  v_mfma_f32_16x16x32_bf16 a[28:31], v[96:99], v[60:63], a[28:31]
  v_mfma_f32_16x16x32_bf16 a[60:63], v[100:103], v[60:63], a[60:63]
  v_mfma_f32_16x16x32_bf16 a[92:95], v[60:63], v[104:107], a[92:95]
  v_mfma_f32_16x16x32_bf16 a[124:127], v[60:63], v[108:111], a[124:127]
  s_waitcnt vmcnt(24) lgkmcnt(0)
  s_barrier
  v_mfma_f32_16x16x32_bf16 a[0:3], v[112:115], v[64:67], a[0:3]
  ds_read_b64_tr_b16 v[96:97], v157 offset:0
  v_accvgpr_read_b32 v128, a200
  v_accvgpr_read_b32 v129, a201
  v_mfma_f32_16x16x32_bf16 a[32:35], v[116:119], v[64:67], a[32:35]
  ds_read_b64_tr_b16 v[98:99], v157 offset:1024
  v_accvgpr_read_b32 v130, a202
  v_accvgpr_read_b32 v131, a203
  v_mfma_f32_16x16x32_bf16 a[64:67], v[64:67], v[120:123], a[64:67]
  ds_read_b64_tr_b16 v[100:101], v158 offset:0
  v_accvgpr_read_b32 v132, a204
  v_accvgpr_read_b32 v133, a205
  v_mfma_f32_16x16x32_bf16 a[96:99], v[64:67], v[124:127], a[96:99]
  s_add_u32 m0, s39, 98304
  s_add_u32 s34, s35, 0
  buffer_load_dwordx4 v4, s[12:15], s34 offen lds
  v_accvgpr_read_b32 v134, a206
  v_accvgpr_read_b32 v135, a207
  v_mfma_f32_16x16x32_bf16 a[4:7], v[112:115], v[68:71], a[4:7]
  ds_read_b64_tr_b16 v[102:103], v158 offset:1024
  v_cvt_pk_bf16_f32 v136, v128, v129
  v_cvt_pk_bf16_f32 v137, v130, v131
  v_mfma_f32_16x16x32_bf16 a[36:39], v[116:119], v[68:71], a[36:39]
  ds_read_b64_tr_b16 v[104:105], v157 offset:8192
  v_cvt_pk_bf16_f32 v138, v132, v133
  v_cvt_pk_bf16_f32 v139, v134, v135
  v_mfma_f32_16x16x32_bf16 a[68:71], v[68:71], v[120:123], a[68:71]
  ds_read_b64_tr_b16 v[106:107], v157 offset:9216
  s_add_u32 s33, s41, 524288
  buffer_store_dwordx4 v[136:139], v6, s[8:11], s33 offen offset:2048 sc1
  v_accvgpr_read_b32 v140, a232
  v_mfma_f32_16x16x32_bf16 a[100:103], v[68:71], v[124:127], a[100:103]
  s_add_u32 m0, s39, 99328
  s_add_u32 s34, s35, 16384
  buffer_load_dwordx4 v4, s[12:15], s34 offen lds
  v_accvgpr_read_b32 v141, a233
  v_accvgpr_read_b32 v142, a234
  v_mfma_f32_16x16x32_bf16 a[8:11], v[112:115], v[72:75], a[8:11]
  ds_read_b64_tr_b16 v[108:109], v158 offset:8192
  v_accvgpr_read_b32 v143, a235
  v_accvgpr_read_b32 v144, a236
  v_mfma_f32_16x16x32_bf16 a[40:43], v[116:119], v[72:75], a[40:43]
  ds_read_b64_tr_b16 v[110:111], v158 offset:9216
  v_accvgpr_read_b32 v145, a237
  v_accvgpr_read_b32 v146, a238
  v_mfma_f32_16x16x32_bf16 a[72:75], v[72:75], v[120:123], a[72:75]
  ds_read_b128 v[32:35], v156 offset:0
  v_accvgpr_read_b32 v147, a239
  v_cvt_pk_bf16_f32 v148, v140, v141
  v_mfma_f32_16x16x32_bf16 a[104:107], v[72:75], v[124:127], a[104:107]
  s_add_u32 m0, s40, 98304
  s_add_u32 s34, s36, 0
  buffer_load_dwordx4 v5, s[20:23], s34 offen lds
  v_cvt_pk_bf16_f32 v149, v142, v143
  v_cvt_pk_bf16_f32 v150, v144, v145
  v_mfma_f32_16x16x32_bf16 a[12:15], v[112:115], v[76:79], a[12:15]
  ds_read_b128 v[36:39], v156 offset:1024
  v_cvt_pk_bf16_f32 v151, v146, v147
  s_add_u32 s33, s41, 524288
  buffer_store_dwordx4 v[148:151], v6, s[8:11], s33 offen offset:3072 sc1
  v_mfma_f32_16x16x32_bf16 a[44:47], v[116:119], v[76:79], a[44:47]
  ds_read_b128 v[40:43], v156 offset:2048
  v_mfma_f32_16x16x32_bf16 a[76:79], v[76:79], v[120:123], a[76:79]
  ds_read_b128 v[44:47], v156 offset:3072
  v_mfma_f32_16x16x32_bf16 a[108:111], v[76:79], v[124:127], a[108:111]
  s_add_u32 m0, s40, 99328
  s_add_u32 s34, s36, 32768
  buffer_load_dwordx4 v5, s[20:23], s34 offen lds
  v_mfma_f32_16x16x32_bf16 a[16:19], v[112:115], v[80:83], a[16:19]
  ds_read_b128 v[48:51], v156 offset:4096
  v_mfma_f32_16x16x32_bf16 a[48:51], v[116:119], v[80:83], a[48:51]
  ds_read_b128 v[52:55], v156 offset:5120
  v_mfma_f32_16x16x32_bf16 a[80:83], v[80:83], v[120:123], a[80:83]
  ds_read_b128 v[56:59], v156 offset:6144
  v_mfma_f32_16x16x32_bf16 a[112:115], v[80:83], v[124:127], a[112:115]
  s_add_u32 m0, s40, 106496
  s_add_u32 s34, s36, 0
  buffer_load_dwordx4 v5, s[24:27], s34 offen lds
  v_mfma_f32_16x16x32_bf16 a[20:23], v[112:115], v[84:87], a[20:23]
  ds_read_b128 v[60:63], v156 offset:7168
  v_mfma_f32_16x16x32_bf16 a[52:55], v[116:119], v[84:87], a[52:55]
  v_mfma_f32_16x16x32_bf16 a[84:87], v[84:87], v[120:123], a[84:87]
  v_mfma_f32_16x16x32_bf16 a[116:119], v[84:87], v[124:127], a[116:119]
  s_add_u32 m0, s40, 107520
  s_add_u32 s34, s36, 32768
  buffer_load_dwordx4 v5, s[24:27], s34 offen lds
  s_add_u32 s35, s35, 64
  s_add_u32 s36, s36, 262144
  v_mfma_f32_16x16x32_bf16 a[24:27], v[112:115], v[88:91], a[24:27]
  v_mfma_f32_16x16x32_bf16 a[56:59], v[116:119], v[88:91], a[56:59]
  v_mfma_f32_16x16x32_bf16 a[88:91], v[88:91], v[120:123], a[88:91]
  v_mfma_f32_16x16x32_bf16 a[120:123], v[88:91], v[124:127], a[120:123]
  v_mfma_f32_16x16x32_bf16 a[28:31], v[112:115], v[92:95], a[28:31]
  v_mfma_f32_16x16x32_bf16 a[60:63], v[116:119], v[92:95], a[60:63]
  v_mfma_f32_16x16x32_bf16 a[92:95], v[92:95], v[120:123], a[92:95]
  v_mfma_f32_16x16x32_bf16 a[124:127], v[92:95], v[124:127], a[124:127]
  s_waitcnt vmcnt(24) lgkmcnt(0)
  s_barrier
  v_mfma_f32_16x16x32_bf16 a[0:3], v[96:99], v[32:35], a[0:3]
  ds_read_b64_tr_b16 v[112:113], v157 offset:24576
  v_accvgpr_read_b32 v128, a144
  v_accvgpr_read_b32 v129, a145
  v_mfma_f32_16x16x32_bf16 a[32:35], v[100:103], v[32:35], a[32:35]
  ds_read_b64_tr_b16 v[114:115], v157 offset:25600
  v_accvgpr_read_b32 v130, a146
  v_accvgpr_read_b32 v131, a147
  v_mfma_f32_16x16x32_bf16 a[64:67], v[32:35], v[104:107], a[64:67]
  ds_read_b64_tr_b16 v[116:117], v158 offset:24576
  v_accvgpr_read_b32 v132, a176
  v_accvgpr_read_b32 v133, a177
  v_mfma_f32_16x16x32_bf16 a[96:99], v[32:35], v[108:111], a[96:99]
  s_add_u32 m0, s39, 122880
  s_add_u32 s34, s35, 0
  buffer_load_dwordx4 v4, s[12:15], s34 offen lds
  v_accvgpr_read_b32 v134, a178
  v_accvgpr_read_b32 v135, a179
  v_mfma_f32_16x16x32_bf16 a[4:7], v[96:99], v[36:39], a[4:7]
  ds_read_b64_tr_b16 v[118:119], v158 offset:25600
  v_cvt_pk_bf16_f32 v136, v128, v129
  v_cvt_pk_bf16_f32 v137, v130, v131
  v_mfma_f32_16x16x32_bf16 a[36:39], v[100:103], v[36:39], a[36:39]
  ds_read_b64_tr_b16 v[120:121], v157 offset:32768
  v_cvt_pk_bf16_f32 v138, v132, v133
  v_cvt_pk_bf16_f32 v139, v134, v135
  v_mfma_f32_16x16x32_bf16 a[68:71], v[36:39], v[104:107], a[68:71]
  ds_read_b64_tr_b16 v[122:123], v157 offset:33792
  s_add_u32 s33, s41, 1048576
  buffer_store_dwordx4 v[136:139], v6, s[8:11], s33 offen offset:0 sc1
  v_accvgpr_read_b32 v140, a148
  v_mfma_f32_16x16x32_bf16 a[100:103], v[36:39], v[108:111], a[100:103]
  s_add_u32 m0, s39, 123904
  s_add_u32 s34, s35, 16384
  buffer_load_dwordx4 v4, s[12:15], s34 offen lds
  v_accvgpr_read_b32 v141, a149
  v_accvgpr_read_b32 v142, a150
  v_mfma_f32_16x16x32_bf16 a[8:11], v[96:99], v[40:43], a[8:11]
  ds_read_b64_tr_b16 v[124:125], v158 offset:32768
  v_accvgpr_read_b32 v143, a151
  v_accvgpr_read_b32 v144, a180
  v_mfma_f32_16x16x32_bf16 a[40:43], v[100:103], v[40:43], a[40:43]
  ds_read_b64_tr_b16 v[126:127], v158 offset:33792
  v_accvgpr_read_b32 v145, a181
  v_accvgpr_read_b32 v146, a182
  v_mfma_f32_16x16x32_bf16 a[72:75], v[40:43], v[104:107], a[72:75]
  ds_read_b128 v[64:67], v156 offset:24576
  v_accvgpr_read_b32 v147, a183
  v_cvt_pk_bf16_f32 v148, v140, v141
  v_mfma_f32_16x16x32_bf16 a[104:107], v[40:43], v[108:111], a[104:107]
  s_add_u32 m0, s40, 122880
  s_add_u32 s34, s36, 0
  buffer_load_dwordx4 v5, s[20:23], s34 offen lds
  v_cvt_pk_bf16_f32 v149, v142, v143
  v_cvt_pk_bf16_f32 v150, v144, v145
  v_mfma_f32_16x16x32_bf16 a[12:15], v[96:99], v[44:47], a[12:15]
  ds_read_b128 v[68:71], v156 offset:25600
  v_cvt_pk_bf16_f32 v151, v146, v147
  s_add_u32 s33, s41, 1048576
  buffer_store_dwordx4 v[148:151], v6, s[8:11], s33 offen offset:1024 sc1
  v_mfma_f32_16x16x32_bf16 a[44:47], v[100:103], v[44:47], a[44:47]
  ds_read_b128 v[72:75], v156 offset:26624
  v_mfma_f32_16x16x32_bf16 a[76:79], v[44:47], v[104:107], a[76:79]
  ds_read_b128 v[76:79], v156 offset:27648
  v_mfma_f32_16x16x32_bf16 a[108:111], v[44:47], v[108:111], a[108:111]
  s_add_u32 m0, s40, 123904
  s_add_u32 s34, s36, 32768
  buffer_load_dwordx4 v5, s[20:23], s34 offen lds
  v_mfma_f32_16x16x32_bf16 a[16:19], v[96:99], v[48:51], a[16:19]
  ds_read_b128 v[80:83], v156 offset:28672
  v_mfma_f32_16x16x32_bf16 a[48:51], v[100:103], v[48:51], a[48:51]
  ds_read_b128 v[84:87], v156 offset:29696
  v_mfma_f32_16x16x32_bf16 a[80:83], v[48:51], v[104:107], a[80:83]
  ds_read_b128 v[88:91], v156 offset:30720
  v_mfma_f32_16x16x32_bf16 a[112:115], v[48:51], v[108:111], a[112:115]
  s_add_u32 m0, s40, 131072
  s_add_u32 s34, s36, 0
  buffer_load_dwordx4 v5, s[24:27], s34 offen lds
  v_mfma_f32_16x16x32_bf16 a[20:23], v[96:99], v[52:55], a[20:23]
  ds_read_b128 v[92:95], v156 offset:31744
  v_mfma_f32_16x16x32_bf16 a[52:55], v[100:103], v[52:55], a[52:55]
  v_mfma_f32_16x16x32_bf16 a[84:87], v[52:55], v[104:107], a[84:87]
  v_mfma_f32_16x16x32_bf16 a[116:119], v[52:55], v[108:111], a[116:119]
  s_add_u32 m0, s40, 132096
  s_add_u32 s34, s36, 32768
  buffer_load_dwordx4 v5, s[24:27], s34 offen lds
  s_add_u32 s35, s35, 64
  s_add_u32 s36, s36, 262144
  v_mfma_f32_16x16x32_bf16 a[24:27], v[96:99], v[56:59], a[24:27]
  v_mfma_f32_16x16x32_bf16 a[56:59], v[100:103], v[56:59], a[56:59]
  v_mfma_f32_16x16x32_bf16 a[88:91], v[56:59], v[104:107], a[88:91]
  v_mfma_f32_16x16x32_bf16 a[120:123], v[56:59], v[108:111], a[120:123]
  v_mfma_f32_16x16x32_bf16 a[28:31], v[96:99], v[60:63], a[28:31]
  v_mfma_f32_16x16x32_bf16 a[60:63], v[100:103], v[60:63], a[60:63]
  v_mfma_f32_16x16x32_bf16 a[92:95], v[60:63], v[104:107], a[92:95]
  v_mfma_f32_16x16x32_bf16 a[124:127], v[60:63], v[108:111], a[124:127]
  s_waitcnt vmcnt(24) lgkmcnt(0)
  s_barrier
  v_mfma_f32_16x16x32_bf16 a[0:3], v[112:115], v[64:67], a[0:3]
  ds_read_b64_tr_b16 v[96:97], v160 offset:0
  v_accvgpr_read_b32 v128, a208
  v_accvgpr_read_b32 v129, a209
  v_mfma_f32_16x16x32_bf16 a[32:35], v[116:119], v[64:67], a[32:35]
  ds_read_b64_tr_b16 v[98:99], v160 offset:1024
  v_accvgpr_read_b32 v130, a210
  v_accvgpr_read_b32 v131, a211
  v_mfma_f32_16x16x32_bf16 a[64:67], v[64:67], v[120:123], a[64:67]
  ds_read_b64_tr_b16 v[100:101], v161 offset:0
  v_accvgpr_read_b32 v132, a212
  v_accvgpr_read_b32 v133, a213
  v_mfma_f32_16x16x32_bf16 a[96:99], v[64:67], v[124:127], a[96:99]
  s_add_u32 m0, s39, 0
  s_add_u32 s34, s35, 0
  buffer_load_dwordx4 v4, s[12:15], s34 offen lds
  v_accvgpr_read_b32 v134, a214
  v_accvgpr_read_b32 v135, a215
  v_mfma_f32_16x16x32_bf16 a[4:7], v[112:115], v[68:71], a[4:7]
  ds_read_b64_tr_b16 v[102:103], v161 offset:1024
  v_cvt_pk_bf16_f32 v136, v128, v129
  v_cvt_pk_bf16_f32 v137, v130, v131
  v_mfma_f32_16x16x32_bf16 a[36:39], v[116:119], v[68:71], a[36:39]
  ds_read_b64_tr_b16 v[104:105], v160 offset:8192
  v_cvt_pk_bf16_f32 v138, v132, v133
  v_cvt_pk_bf16_f32 v139, v134, v135
  v_mfma_f32_16x16x32_bf16 a[68:71], v[68:71], v[120:123], a[68:71]
  ds_read_b64_tr_b16 v[106:107], v160 offset:9216
  s_add_u32 s33, s41, 1048576
  buffer_store_dwordx4 v[136:139], v6, s[8:11], s33 offen offset:2048 sc1
  v_accvgpr_read_b32 v140, a240
  v_mfma_f32_16x16x32_bf16 a[100:103], v[68:71], v[124:127], a[100:103]
  s_add_u32 m0, s39, 1024
  s_add_u32 s34, s35, 16384
  buffer_load_dwordx4 v4, s[12:15], s34 offen lds
  v_accvgpr_read_b32 v141, a241
  v_accvgpr_read_b32 v142, a242
  v_mfma_f32_16x16x32_bf16 a[8:11], v[112:115], v[72:75], a[8:11]
  ds_read_b64_tr_b16 v[108:109], v161 offset:8192
  v_accvgpr_read_b32 v143, a243
  v_accvgpr_read_b32 v144, a244
  v_mfma_f32_16x16x32_bf16 a[40:43], v[116:119], v[72:75], a[40:43]
  ds_read_b64_tr_b16 v[110:111], v161 offset:9216
  v_accvgpr_read_b32 v145, a245
  v_accvgpr_read_b32 v146, a246
  v_mfma_f32_16x16x32_bf16 a[72:75], v[72:75], v[120:123], a[72:75]
  ds_read_b128 v[32:35], v159 offset:0
  v_accvgpr_read_b32 v147, a247
  v_cvt_pk_bf16_f32 v148, v140, v141
  v_mfma_f32_16x16x32_bf16 a[104:107], v[72:75], v[124:127], a[104:107]
  s_add_u32 m0, s40, 0
  s_add_u32 s34, s36, 0
  buffer_load_dwordx4 v5, s[20:23], s34 offen lds
  v_cvt_pk_bf16_f32 v149, v142, v143
  v_cvt_pk_bf16_f32 v150, v144, v145
  v_mfma_f32_16x16x32_bf16 a[12:15], v[112:115], v[76:79], a[12:15]
  ds_read_b128 v[36:39], v159 offset:1024
  v_cvt_pk_bf16_f32 v151, v146, v147
  s_add_u32 s33, s41, 1048576
  buffer_store_dwordx4 v[148:151], v6, s[8:11], s33 offen offset:3072 sc1
  v_mfma_f32_16x16x32_bf16 a[44:47], v[116:119], v[76:79], a[44:47]
  ds_read_b128 v[40:43], v159 offset:2048
  v_mfma_f32_16x16x32_bf16 a[76:79], v[76:79], v[120:123], a[76:79]
  ds_read_b128 v[44:47], v159 offset:3072
  v_mfma_f32_16x16x32_bf16 a[108:111], v[76:79], v[124:127], a[108:111]
  s_add_u32 m0, s40, 1024
  s_add_u32 s34, s36, 32768
  buffer_load_dwordx4 v5, s[20:23], s34 offen lds
  v_mfma_f32_16x16x32_bf16 a[16:19], v[112:115], v[80:83], a[16:19]
  ds_read_b128 v[48:51], v159 offset:4096
  v_mfma_f32_16x16x32_bf16 a[48:51], v[116:119], v[80:83], a[48:51]
  ds_read_b128 v[52:55], v159 offset:5120
  v_mfma_f32_16x16x32_bf16 a[80:83], v[80:83], v[120:123], a[80:83]
  ds_read_b128 v[56:59], v159 offset:6144
  v_mfma_f32_16x16x32_bf16 a[112:115], v[80:83], v[124:127], a[112:115]
  s_add_u32 m0, s40, 8192
  s_add_u32 s34, s36, 0
  buffer_load_dwordx4 v5, s[24:27], s34 offen lds
  v_mfma_f32_16x16x32_bf16 a[20:23], v[112:115], v[84:87], a[20:23]
  ds_read_b128 v[60:63], v159 offset:7168
  v_mfma_f32_16x16x32_bf16 a[52:55], v[116:119], v[84:87], a[52:55]
  v_mfma_f32_16x16x32_bf16 a[84:87], v[84:87], v[120:123], a[84:87]
  v_mfma_f32_16x16x32_bf16 a[116:119], v[84:87], v[124:127], a[116:119]
  s_add_u32 m0, s40, 9216
  s_add_u32 s34, s36, 32768
  buffer_load_dwordx4 v5, s[24:27], s34 offen lds
  s_add_u32 s35, s35, 64
  s_add_u32 s36, s36, 262144
  v_mfma_f32_16x16x32_bf16 a[24:27], v[112:115], v[88:91], a[24:27]
  v_mfma_f32_16x16x32_bf16 a[56:59], v[116:119], v[88:91], a[56:59]
  v_mfma_f32_16x16x32_bf16 a[88:91], v[88:91], v[120:123], a[88:91]
  v_mfma_f32_16x16x32_bf16 a[120:123], v[88:91], v[124:127], a[120:123]
  v_mfma_f32_16x16x32_bf16 a[28:31], v[112:115], v[92:95], a[28:31]
  v_mfma_f32_16x16x32_bf16 a[60:63], v[116:119], v[92:95], a[60:63]
  v_mfma_f32_16x16x32_bf16 a[92:95], v[92:95], v[120:123], a[92:95]
  v_mfma_f32_16x16x32_bf16 a[124:127], v[92:95], v[124:127], a[124:127]
  s_waitcnt vmcnt(24) lgkmcnt(0)
  s_barrier
  v_mfma_f32_16x16x32_bf16 a[0:3], v[96:99], v[32:35], a[0:3]
  ds_read_b64_tr_b16 v[112:113], v160 offset:24576
  v_accvgpr_read_b32 v128, a152
  v_accvgpr_read_b32 v129, a153
  v_mfma_f32_16x16x32_bf16 a[32:35], v[100:103], v[32:35], a[32:35]
  ds_read_b64_tr_b16 v[114:115], v160 offset:25600
  v_accvgpr_read_b32 v130, a154
  v_accvgpr_read_b32 v131, a155
  v_mfma_f32_16x16x32_bf16 a[64:67], v[32:35], v[104:107], a[64:67]
  ds_read_b64_tr_b16 v[116:117], v161 offset:24576
  v_accvgpr_read_b32 v132, a184
  v_accvgpr_read_b32 v133, a185
  v_mfma_f32_16x16x32_bf16 a[96:99], v[32:35], v[108:111], a[96:99]
  s_add_u32 m0, s39, 24576
  s_add_u32 s34, s35, 0
  buffer_load_dwordx4 v4, s[12:15], s34 offen lds
  v_accvgpr_read_b32 v134, a186
  v_accvgpr_read_b32 v135, a187
  v_mfma_f32_16x16x32_bf16 a[4:7], v[96:99], v[36:39], a[4:7]
  ds_read_b64_tr_b16 v[118:119], v161 offset:25600
  v_cvt_pk_bf16_f32 v136, v128, v129
  v_cvt_pk_bf16_f32 v137, v130, v131
  v_mfma_f32_16x16x32_bf16 a[36:39], v[100:103], v[36:39], a[36:39]
  ds_read_b64_tr_b16 v[120:121], v160 offset:32768
  v_cvt_pk_bf16_f32 v138, v132, v133
  v_cvt_pk_bf16_f32 v139, v134, v135
  v_mfma_f32_16x16x32_bf16 a[68:71], v[36:39], v[104:107], a[68:71]
  ds_read_b64_tr_b16 v[122:123], v160 offset:33792
  s_add_u32 s33, s41, 1572864
  buffer_store_dwordx4 v[136:139], v6, s[8:11], s33 offen offset:0 sc1
  v_accvgpr_read_b32 v140, a156
  v_mfma_f32_16x16x32_bf16 a[100:103], v[36:39], v[108:111], a[100:103]
  s_add_u32 m0, s39, 25600
  s_add_u32 s34, s35, 16384
  buffer_load_dwordx4 v4, s[12:15], s34 offen lds
  v_accvgpr_read_b32 v141, a157
  v_accvgpr_read_b32 v142, a158
  v_mfma_f32_16x16x32_bf16 a[8:11], v[96:99], v[40:43], a[8:11]
  ds_read_b64_tr_b16 v[124:125], v161 offset:32768
  v_accvgpr_read_b32 v143, a159
  v_accvgpr_read_b32 v144, a188
  v_mfma_f32_16x16x32_bf16 a[40:43], v[100:103], v[40:43], a[40:43]
  ds_read_b64_tr_b16 v[126:127], v161 offset:33792
  v_accvgpr_read_b32 v145, a189
  v_accvgpr_read_b32 v146, a190
  v_mfma_f32_16x16x32_bf16 a[72:75], v[40:43], v[104:107], a[72:75]
  ds_read_b128 v[64:67], v159 offset:24576
  v_accvgpr_read_b32 v147, a191
  v_cvt_pk_bf16_f32 v148, v140, v141
  v_mfma_f32_16x16x32_bf16 a[104:107], v[40:43], v[108:111], a[104:107]
  s_add_u32 m0, s40, 24576
  s_add_u32 s34, s36, 0
  buffer_load_dwordx4 v5, s[20:23], s34 offen lds
  v_cvt_pk_bf16_f32 v149, v142, v143
  v_cvt_pk_bf16_f32 v150, v144, v145
  v_mfma_f32_16x16x32_bf16 a[12:15], v[96:99], v[44:47], a[12:15]
  ds_read_b128 v[68:71], v159 offset:25600
  v_cvt_pk_bf16_f32 v151, v146, v147
  s_add_u32 s33, s41, 1572864
  buffer_store_dwordx4 v[148:151], v6, s[8:11], s33 offen offset:1024 sc1
  v_mfma_f32_16x16x32_bf16 a[44:47], v[100:103], v[44:47], a[44:47]
  ds_read_b128 v[72:75], v159 offset:26624
  v_mfma_f32_16x16x32_bf16 a[76:79], v[44:47], v[104:107], a[76:79]
  ds_read_b128 v[76:79], v159 offset:27648
  v_mfma_f32_16x16x32_bf16 a[108:111], v[44:47], v[108:111], a[108:111]
  s_add_u32 m0, s40, 25600
  s_add_u32 s34, s36, 32768
  buffer_load_dwordx4 v5, s[20:23], s34 offen lds
  v_mfma_f32_16x16x32_bf16 a[16:19], v[96:99], v[48:51], a[16:19]
  ds_read_b128 v[80:83], v159 offset:28672
  v_mfma_f32_16x16x32_bf16 a[48:51], v[100:103], v[48:51], a[48:51]
  ds_read_b128 v[84:87], v159 offset:29696
  v_mfma_f32_16x16x32_bf16 a[80:83], v[48:51], v[104:107], a[80:83]
  ds_read_b128 v[88:91], v159 offset:30720
  v_mfma_f32_16x16x32_bf16 a[112:115], v[48:51], v[108:111], a[112:115]
  s_add_u32 m0, s40, 32768
  s_add_u32 s34, s36, 0
  buffer_load_dwordx4 v5, s[24:27], s34 offen lds
  v_mfma_f32_16x16x32_bf16 a[20:23], v[96:99], v[52:55], a[20:23]
  ds_read_b128 v[92:95], v159 offset:31744
  v_mfma_f32_16x16x32_bf16 a[52:55], v[100:103], v[52:55], a[52:55]
  v_mfma_f32_16x16x32_bf16 a[84:87], v[52:55], v[104:107], a[84:87]
  v_mfma_f32_16x16x32_bf16 a[116:119], v[52:55], v[108:111], a[116:119]
  s_add_u32 m0, s40, 33792
  s_add_u32 s34, s36, 32768
  buffer_load_dwordx4 v5, s[24:27], s34 offen lds
  s_add_u32 s35, s35, 64
  s_add_u32 s36, s36, 262144
  v_mfma_f32_16x16x32_bf16 a[24:27], v[96:99], v[56:59], a[24:27]
  v_mfma_f32_16x16x32_bf16 a[56:59], v[100:103], v[56:59], a[56:59]
  v_mfma_f32_16x16x32_bf16 a[88:91], v[56:59], v[104:107], a[88:91]
  v_mfma_f32_16x16x32_bf16 a[120:123], v[56:59], v[108:111], a[120:123]
  v_mfma_f32_16x16x32_bf16 a[28:31], v[96:99], v[60:63], a[28:31]
  v_mfma_f32_16x16x32_bf16 a[60:63], v[100:103], v[60:63], a[60:63]
  v_mfma_f32_16x16x32_bf16 a[92:95], v[60:63], v[104:107], a[92:95]
  v_mfma_f32_16x16x32_bf16 a[124:127], v[60:63], v[108:111], a[124:127]
  s_waitcnt vmcnt(24) lgkmcnt(0)
  s_barrier
  v_mfma_f32_16x16x32_bf16 a[0:3], v[112:115], v[64:67], a[0:3]
  ds_read_b64_tr_b16 v[96:97], v163 offset:0
  v_accvgpr_read_b32 v128, a216
  v_accvgpr_read_b32 v129, a217
  v_mfma_f32_16x16x32_bf16 a[32:35], v[116:119], v[64:67], a[32:35]
  ds_read_b64_tr_b16 v[98:99], v163 offset:1024
  v_accvgpr_read_b32 v130, a218
  v_accvgpr_read_b32 v131, a219
  v_mfma_f32_16x16x32_bf16 a[64:67], v[64:67], v[120:123], a[64:67]
  ds_read_b64_tr_b16 v[100:101], v164 offset:0
  v_accvgpr_read_b32 v132, a220
  v_accvgpr_read_b32 v133, a221
  v_mfma_f32_16x16x32_bf16 a[96:99], v[64:67], v[124:127], a[96:99]
  s_add_u32 m0, s39, 49152
  s_add_u32 s34, s35, 0
  buffer_load_dwordx4 v4, s[12:15], s34 offen lds
  v_accvgpr_read_b32 v134, a222
  v_accvgpr_read_b32 v135, a223
  v_mfma_f32_16x16x32_bf16 a[4:7], v[112:115], v[68:71], a[4:7]
  ds_read_b64_tr_b16 v[102:103], v164 offset:1024
  v_cvt_pk_bf16_f32 v136, v128, v129
  v_cvt_pk_bf16_f32 v137, v130, v131
  v_mfma_f32_16x16x32_bf16 a[36:39], v[116:119], v[68:71], a[36:39]
  ds_read_b64_tr_b16 v[104:105], v163 offset:8192
  v_cvt_pk_bf16_f32 v138, v132, v133
  v_cvt_pk_bf16_f32 v139, v134, v135
  v_mfma_f32_16x16x32_bf16 a[68:71], v[68:71], v[120:123], a[68:71]
  ds_read_b64_tr_b16 v[106:107], v163 offset:9216
  s_add_u32 s33, s41, 1572864
  buffer_store_dwordx4 v[136:139], v6, s[8:11], s33 offen offset:2048 sc1
  v_accvgpr_read_b32 v140, a248
  v_mfma_f32_16x16x32_bf16 a[100:103], v[68:71], v[124:127], a[100:103]
  s_add_u32 m0, s39, 50176
  s_add_u32 s34, s35, 16384
  buffer_load_dwordx4 v4, s[12:15], s34 offen lds
  v_accvgpr_read_b32 v141, a249
  v_accvgpr_read_b32 v142, a250
  v_mfma_f32_16x16x32_bf16 a[8:11], v[112:115], v[72:75], a[8:11]
  ds_read_b64_tr_b16 v[108:109], v164 offset:8192
  v_accvgpr_read_b32 v143, a251
  v_accvgpr_read_b32 v144, a252
  v_mfma_f32_16x16x32_bf16 a[40:43], v[116:119], v[72:75], a[40:43]
  ds_read_b64_tr_b16 v[110:111], v164 offset:9216
  v_accvgpr_read_b32 v145, a253
  v_accvgpr_read_b32 v146, a254
  v_mfma_f32_16x16x32_bf16 a[72:75], v[72:75], v[120:123], a[72:75]
  ds_read_b128 v[32:35], v162 offset:0
  v_accvgpr_read_b32 v147, a255
  v_cvt_pk_bf16_f32 v148, v140, v141
  v_mfma_f32_16x16x32_bf16 a[104:107], v[72:75], v[124:127], a[104:107]
  s_add_u32 m0, s40, 49152
  s_add_u32 s34, s36, 0
  buffer_load_dwordx4 v5, s[20:23], s34 offen lds
  v_cvt_pk_bf16_f32 v149, v142, v143
  v_cvt_pk_bf16_f32 v150, v144, v145
  v_mfma_f32_16x16x32_bf16 a[12:15], v[112:115], v[76:79], a[12:15]
  ds_read_b128 v[36:39], v162 offset:1024
  v_cvt_pk_bf16_f32 v151, v146, v147
  s_add_u32 s33, s41, 1572864
  buffer_store_dwordx4 v[148:151], v6, s[8:11], s33 offen offset:3072 sc1
  v_mfma_f32_16x16x32_bf16 a[44:47], v[116:119], v[76:79], a[44:47]
  ds_read_b128 v[40:43], v162 offset:2048
  v_mfma_f32_16x16x32_bf16 a[76:79], v[76:79], v[120:123], a[76:79]
  ds_read_b128 v[44:47], v162 offset:3072
  v_mfma_f32_16x16x32_bf16 a[108:111], v[76:79], v[124:127], a[108:111]
  s_add_u32 m0, s40, 50176
  s_add_u32 s34, s36, 32768
  buffer_load_dwordx4 v5, s[20:23], s34 offen lds
  v_mfma_f32_16x16x32_bf16 a[16:19], v[112:115], v[80:83], a[16:19]
  ds_read_b128 v[48:51], v162 offset:4096
  v_mfma_f32_16x16x32_bf16 a[48:51], v[116:119], v[80:83], a[48:51]
  ds_read_b128 v[52:55], v162 offset:5120
  v_mfma_f32_16x16x32_bf16 a[80:83], v[80:83], v[120:123], a[80:83]
  ds_read_b128 v[56:59], v162 offset:6144
  v_mfma_f32_16x16x32_bf16 a[112:115], v[80:83], v[124:127], a[112:115]
  s_add_u32 m0, s40, 57344
  s_add_u32 s34, s36, 0
  buffer_load_dwordx4 v5, s[24:27], s34 offen lds
  v_mfma_f32_16x16x32_bf16 a[20:23], v[112:115], v[84:87], a[20:23]
  ds_read_b128 v[60:63], v162 offset:7168
  v_mfma_f32_16x16x32_bf16 a[52:55], v[116:119], v[84:87], a[52:55]
  v_mfma_f32_16x16x32_bf16 a[84:87], v[84:87], v[120:123], a[84:87]
  v_mfma_f32_16x16x32_bf16 a[116:119], v[84:87], v[124:127], a[116:119]
  s_add_u32 m0, s40, 58368
  s_add_u32 s34, s36, 32768
  buffer_load_dwordx4 v5, s[24:27], s34 offen lds
  s_add_u32 s35, s35, 64
  s_add_u32 s36, s36, 262144
  v_mfma_f32_16x16x32_bf16 a[24:27], v[112:115], v[88:91], a[24:27]
  v_mfma_f32_16x16x32_bf16 a[56:59], v[116:119], v[88:91], a[56:59]
  v_mfma_f32_16x16x32_bf16 a[88:91], v[88:91], v[120:123], a[88:91]
  v_mfma_f32_16x16x32_bf16 a[120:123], v[88:91], v[124:127], a[120:123]
  v_mfma_f32_16x16x32_bf16 a[28:31], v[112:115], v[92:95], a[28:31]
  v_mfma_f32_16x16x32_bf16 a[60:63], v[116:119], v[92:95], a[60:63]
  v_mfma_f32_16x16x32_bf16 a[92:95], v[92:95], v[120:123], a[92:95]
  v_mfma_f32_16x16x32_bf16 a[124:127], v[92:95], v[124:127], a[124:127]
  s_waitcnt vmcnt(24) lgkmcnt(0)
  s_barrier
  v_mfma_f32_16x16x32_bf16 a[0:3], v[96:99], v[32:35], a[0:3]
  ds_read_b64_tr_b16 v[112:113], v163 offset:24576
  v_mfma_f32_16x16x32_bf16 a[32:35], v[100:103], v[32:35], a[32:35]
  ds_read_b64_tr_b16 v[114:115], v163 offset:25600
  v_mfma_f32_16x16x32_bf16 a[64:67], v[32:35], v[104:107], a[64:67]
  ds_read_b64_tr_b16 v[116:117], v164 offset:24576
  v_mfma_f32_16x16x32_bf16 a[96:99], v[32:35], v[108:111], a[96:99]
  s_add_u32 m0, s39, 73728
  s_add_u32 s34, s35, 0
  buffer_load_dwordx4 v4, s[12:15], s34 offen lds
  v_mfma_f32_16x16x32_bf16 a[4:7], v[96:99], v[36:39], a[4:7]
  ds_read_b64_tr_b16 v[118:119], v164 offset:25600
  v_mfma_f32_16x16x32_bf16 a[36:39], v[100:103], v[36:39], a[36:39]
  ds_read_b64_tr_b16 v[120:121], v163 offset:32768
  v_mfma_f32_16x16x32_bf16 a[68:71], v[36:39], v[104:107], a[68:71]
  ds_read_b64_tr_b16 v[122:123], v163 offset:33792
  v_mfma_f32_16x16x32_bf16 a[100:103], v[36:39], v[108:111], a[100:103]
  s_add_u32 m0, s39, 74752
  s_add_u32 s34, s35, 16384
  buffer_load_dwordx4 v4, s[12:15], s34 offen lds
  v_mfma_f32_16x16x32_bf16 a[8:11], v[96:99], v[40:43], a[8:11]
  ds_read_b64_tr_b16 v[124:125], v164 offset:32768
  v_mfma_f32_16x16x32_bf16 a[40:43], v[100:103], v[40:43], a[40:43]
  ds_read_b64_tr_b16 v[126:127], v164 offset:33792
  v_mfma_f32_16x16x32_bf16 a[72:75], v[40:43], v[104:107], a[72:75]
  ds_read_b128 v[64:67], v162 offset:24576
  v_mfma_f32_16x16x32_bf16 a[104:107], v[40:43], v[108:111], a[104:107]
  s_add_u32 m0, s40, 73728
  s_add_u32 s34, s36, 0
  buffer_load_dwordx4 v5, s[20:23], s34 offen lds
  v_mfma_f32_16x16x32_bf16 a[12:15], v[96:99], v[44:47], a[12:15]
  ds_read_b128 v[68:71], v162 offset:25600
  v_mfma_f32_16x16x32_bf16 a[44:47], v[100:103], v[44:47], a[44:47]
  ds_read_b128 v[72:75], v162 offset:26624
  v_mfma_f32_16x16x32_bf16 a[76:79], v[44:47], v[104:107], a[76:79]
  ds_read_b128 v[76:79], v162 offset:27648
  v_mfma_f32_16x16x32_bf16 a[108:111], v[44:47], v[108:111], a[108:111]
  s_add_u32 m0, s40, 74752
  s_add_u32 s34, s36, 32768
  buffer_load_dwordx4 v5, s[20:23], s34 offen lds
  v_mfma_f32_16x16x32_bf16 a[16:19], v[96:99], v[48:51], a[16:19]
  ds_read_b128 v[80:83], v162 offset:28672
  v_mfma_f32_16x16x32_bf16 a[48:51], v[100:103], v[48:51], a[48:51]
  ds_read_b128 v[84:87], v162 offset:29696
  v_mfma_f32_16x16x32_bf16 a[80:83], v[48:51], v[104:107], a[80:83]
  ds_read_b128 v[88:91], v162 offset:30720
  v_mfma_f32_16x16x32_bf16 a[112:115], v[48:51], v[108:111], a[112:115]
  s_add_u32 m0, s40, 81920
  s_add_u32 s34, s36, 0
  buffer_load_dwordx4 v5, s[24:27], s34 offen lds
  v_mfma_f32_16x16x32_bf16 a[20:23], v[96:99], v[52:55], a[20:23]
  ds_read_b128 v[92:95], v162 offset:31744
  v_mfma_f32_16x16x32_bf16 a[52:55], v[100:103], v[52:55], a[52:55]
  v_mfma_f32_16x16x32_bf16 a[84:87], v[52:55], v[104:107], a[84:87]
  v_mfma_f32_16x16x32_bf16 a[116:119], v[52:55], v[108:111], a[116:119]
  s_add_u32 m0, s40, 82944
  s_add_u32 s34, s36, 32768
  buffer_load_dwordx4 v5, s[24:27], s34 offen lds
  s_add_u32 s35, s35, 64
  s_add_u32 s36, s36, 262144
  v_mfma_f32_16x16x32_bf16 a[24:27], v[96:99], v[56:59], a[24:27]
  v_mfma_f32_16x16x32_bf16 a[56:59], v[100:103], v[56:59], a[56:59]
  v_mfma_f32_16x16x32_bf16 a[88:91], v[56:59], v[104:107], a[88:91]
  v_mfma_f32_16x16x32_bf16 a[120:123], v[56:59], v[108:111], a[120:123]
  v_mfma_f32_16x16x32_bf16 a[28:31], v[96:99], v[60:63], a[28:31]
  v_mfma_f32_16x16x32_bf16 a[60:63], v[100:103], v[60:63], a[60:63]
  v_mfma_f32_16x16x32_bf16 a[92:95], v[60:63], v[104:107], a[92:95]
  v_mfma_f32_16x16x32_bf16 a[124:127], v[60:63], v[108:111], a[124:127]
  s_waitcnt vmcnt(22) lgkmcnt(0)
  s_barrier
  v_mfma_f32_16x16x32_bf16 a[0:3], v[112:115], v[64:67], a[0:3]
  ds_read_b64_tr_b16 v[96:97], v157 offset:0
  v_mfma_f32_16x16x32_bf16 a[32:35], v[116:119], v[64:67], a[32:35]
  ds_read_b64_tr_b16 v[98:99], v157 offset:1024
  v_mfma_f32_16x16x32_bf16 a[64:67], v[64:67], v[120:123], a[64:67]
  ds_read_b64_tr_b16 v[100:101], v158 offset:0
  v_mfma_f32_16x16x32_bf16 a[96:99], v[64:67], v[124:127], a[96:99]
  s_add_u32 m0, s39, 98304
  s_add_u32 s34, s35, 0
  buffer_load_dwordx4 v4, s[12:15], s34 offen lds
  v_mfma_f32_16x16x32_bf16 a[4:7], v[112:115], v[68:71], a[4:7]
  ds_read_b64_tr_b16 v[102:103], v158 offset:1024
  v_mfma_f32_16x16x32_bf16 a[36:39], v[116:119], v[68:71], a[36:39]
  ds_read_b64_tr_b16 v[104:105], v157 offset:8192
  v_mfma_f32_16x16x32_bf16 a[68:71], v[68:71], v[120:123], a[68:71]
  ds_read_b64_tr_b16 v[106:107], v157 offset:9216
  v_mfma_f32_16x16x32_bf16 a[100:103], v[68:71], v[124:127], a[100:103]
  s_add_u32 m0, s39, 99328
  s_add_u32 s34, s35, 16384
  buffer_load_dwordx4 v4, s[12:15], s34 offen lds
  v_mfma_f32_16x16x32_bf16 a[8:11], v[112:115], v[72:75], a[8:11]
  ds_read_b64_tr_b16 v[108:109], v158 offset:8192
  v_mfma_f32_16x16x32_bf16 a[40:43], v[116:119], v[72:75], a[40:43]
  ds_read_b64_tr_b16 v[110:111], v158 offset:9216
  v_mfma_f32_16x16x32_bf16 a[72:75], v[72:75], v[120:123], a[72:75]
  ds_read_b128 v[32:35], v156 offset:0
  v_mfma_f32_16x16x32_bf16 a[104:107], v[72:75], v[124:127], a[104:107]
  s_add_u32 m0, s40, 98304
  s_add_u32 s34, s36, 0
  buffer_load_dwordx4 v5, s[20:23], s34 offen lds
  v_mfma_f32_16x16x32_bf16 a[12:15], v[112:115], v[76:79], a[12:15]
  ds_read_b128 v[36:39], v156 offset:1024
  v_mfma_f32_16x16x32_bf16 a[44:47], v[116:119], v[76:79], a[44:47]
  ds_read_b128 v[40:43], v156 offset:2048
  v_mfma_f32_16x16x32_bf16 a[76:79], v[76:79], v[120:123], a[76:79]
  ds_read_b128 v[44:47], v156 offset:3072
  v_mfma_f32_16x16x32_bf16 a[108:111], v[76:79], v[124:127], a[108:111]
  s_add_u32 m0, s40, 99328
  s_add_u32 s34, s36, 32768
  buffer_load_dwordx4 v5, s[20:23], s34 offen lds
  v_mfma_f32_16x16x32_bf16 a[16:19], v[112:115], v[80:83], a[16:19]
  ds_read_b128 v[48:51], v156 offset:4096
  v_mfma_f32_16x16x32_bf16 a[48:51], v[116:119], v[80:83], a[48:51]
  ds_read_b128 v[52:55], v156 offset:5120
  v_mfma_f32_16x16x32_bf16 a[80:83], v[80:83], v[120:123], a[80:83]
  ds_read_b128 v[56:59], v156 offset:6144
  v_mfma_f32_16x16x32_bf16 a[112:115], v[80:83], v[124:127], a[112:115]
  s_add_u32 m0, s40, 106496
  s_add_u32 s34, s36, 0
  buffer_load_dwordx4 v5, s[24:27], s34 offen lds
  v_mfma_f32_16x16x32_bf16 a[20:23], v[112:115], v[84:87], a[20:23]
  ds_read_b128 v[60:63], v156 offset:7168
  v_mfma_f32_16x16x32_bf16 a[52:55], v[116:119], v[84:87], a[52:55]
  v_mfma_f32_16x16x32_bf16 a[84:87], v[84:87], v[120:123], a[84:87]
  v_mfma_f32_16x16x32_bf16 a[116:119], v[84:87], v[124:127], a[116:119]
  s_add_u32 m0, s40, 107520
  s_add_u32 s34, s36, 32768
  buffer_load_dwordx4 v5, s[24:27], s34 offen lds
  s_add_u32 s35, s35, 64
  s_add_u32 s36, s36, 262144
  v_mfma_f32_16x16x32_bf16 a[24:27], v[112:115], v[88:91], a[24:27]
  v_mfma_f32_16x16x32_bf16 a[56:59], v[116:119], v[88:91], a[56:59]
  v_mfma_f32_16x16x32_bf16 a[88:91], v[88:91], v[120:123], a[88:91]
  v_mfma_f32_16x16x32_bf16 a[120:123], v[88:91], v[124:127], a[120:123]
  v_mfma_f32_16x16x32_bf16 a[28:31], v[112:115], v[92:95], a[28:31]
  v_mfma_f32_16x16x32_bf16 a[60:63], v[116:119], v[92:95], a[60:63]
  v_mfma_f32_16x16x32_bf16 a[92:95], v[92:95], v[120:123], a[92:95]
  v_mfma_f32_16x16x32_bf16 a[124:127], v[92:95], v[124:127], a[124:127]
  s_waitcnt vmcnt(20) lgkmcnt(0)
  s_barrier
  v_mfma_f32_16x16x32_bf16 a[0:3], v[96:99], v[32:35], a[0:3]
  ds_read_b64_tr_b16 v[112:113], v157 offset:24576
  v_mfma_f32_16x16x32_bf16 a[32:35], v[100:103], v[32:35], a[32:35]
  ds_read_b64_tr_b16 v[114:115], v157 offset:25600
  v_mfma_f32_16x16x32_bf16 a[64:67], v[32:35], v[104:107], a[64:67]
  ds_read_b64_tr_b16 v[116:117], v158 offset:24576
  v_mfma_f32_16x16x32_bf16 a[96:99], v[32:35], v[108:111], a[96:99]
  s_add_u32 m0, s39, 122880
  s_add_u32 s34, s35, 0
  buffer_load_dwordx4 v4, s[12:15], s34 offen lds
  v_mfma_f32_16x16x32_bf16 a[4:7], v[96:99], v[36:39], a[4:7]
  ds_read_b64_tr_b16 v[118:119], v158 offset:25600
  v_mfma_f32_16x16x32_bf16 a[36:39], v[100:103], v[36:39], a[36:39]
  ds_read_b64_tr_b16 v[120:121], v157 offset:32768
  v_mfma_f32_16x16x32_bf16 a[68:71], v[36:39], v[104:107], a[68:71]
  ds_read_b64_tr_b16 v[122:123], v157 offset:33792
  v_mfma_f32_16x16x32_bf16 a[100:103], v[36:39], v[108:111], a[100:103]
  s_add_u32 m0, s39, 123904
  s_add_u32 s34, s35, 16384
  buffer_load_dwordx4 v4, s[12:15], s34 offen lds
  v_mfma_f32_16x16x32_bf16 a[8:11], v[96:99], v[40:43], a[8:11]
  ds_read_b64_tr_b16 v[124:125], v158 offset:32768
  v_mfma_f32_16x16x32_bf16 a[40:43], v[100:103], v[40:43], a[40:43]
  ds_read_b64_tr_b16 v[126:127], v158 offset:33792
  v_mfma_f32_16x16x32_bf16 a[72:75], v[40:43], v[104:107], a[72:75]
  ds_read_b128 v[64:67], v156 offset:24576
  v_mfma_f32_16x16x32_bf16 a[104:107], v[40:43], v[108:111], a[104:107]
  s_add_u32 m0, s40, 122880
  s_add_u32 s34, s36, 0
  buffer_load_dwordx4 v5, s[20:23], s34 offen lds
  v_mfma_f32_16x16x32_bf16 a[12:15], v[96:99], v[44:47], a[12:15]
  ds_read_b128 v[68:71], v156 offset:25600
  v_mfma_f32_16x16x32_bf16 a[44:47], v[100:103], v[44:47], a[44:47]
  ds_read_b128 v[72:75], v156 offset:26624
  v_mfma_f32_16x16x32_bf16 a[76:79], v[44:47], v[104:107], a[76:79]
  ds_read_b128 v[76:79], v156 offset:27648
  v_mfma_f32_16x16x32_bf16 a[108:111], v[44:47], v[108:111], a[108:111]
  s_add_u32 m0, s40, 123904
  s_add_u32 s34, s36, 32768
  buffer_load_dwordx4 v5, s[20:23], s34 offen lds
  v_mfma_f32_16x16x32_bf16 a[16:19], v[96:99], v[48:51], a[16:19]
  ds_read_b128 v[80:83], v156 offset:28672
  v_mfma_f32_16x16x32_bf16 a[48:51], v[100:103], v[48:51], a[48:51]
  ds_read_b128 v[84:87], v156 offset:29696
  v_mfma_f32_16x16x32_bf16 a[80:83], v[48:51], v[104:107], a[80:83]
  ds_read_b128 v[88:91], v156 offset:30720
  v_mfma_f32_16x16x32_bf16 a[112:115], v[48:51], v[108:111], a[112:115]
  s_add_u32 m0, s40, 131072
  s_add_u32 s34, s36, 0
  buffer_load_dwordx4 v5, s[24:27], s34 offen lds
  v_mfma_f32_16x16x32_bf16 a[20:23], v[96:99], v[52:55], a[20:23]
  ds_read_b128 v[92:95], v156 offset:31744
  v_mfma_f32_16x16x32_bf16 a[52:55], v[100:103], v[52:55], a[52:55]
  v_mfma_f32_16x16x32_bf16 a[84:87], v[52:55], v[104:107], a[84:87]
  v_mfma_f32_16x16x32_bf16 a[116:119], v[52:55], v[108:111], a[116:119]
  s_add_u32 m0, s40, 132096
  s_add_u32 s34, s36, 32768
  buffer_load_dwordx4 v5, s[24:27], s34 offen lds
  s_add_u32 s35, s35, 64
  s_add_u32 s36, s36, 262144
  v_mfma_f32_16x16x32_bf16 a[24:27], v[96:99], v[56:59], a[24:27]
  v_mfma_f32_16x16x32_bf16 a[56:59], v[100:103], v[56:59], a[56:59]
  v_mfma_f32_16x16x32_bf16 a[88:91], v[56:59], v[104:107], a[88:91]
  v_mfma_f32_16x16x32_bf16 a[120:123], v[56:59], v[108:111], a[120:123]
  v_mfma_f32_16x16x32_bf16 a[28:31], v[96:99], v[60:63], a[28:31]
  v_mfma_f32_16x16x32_bf16 a[60:63], v[100:103], v[60:63], a[60:63]
  v_mfma_f32_16x16x32_bf16 a[92:95], v[60:63], v[104:107], a[92:95]
  v_mfma_f32_16x16x32_bf16 a[124:127], v[60:63], v[108:111], a[124:127]
  s_waitcnt vmcnt(18) lgkmcnt(0)
  s_barrier
  s_mov_b32 s35, s37
  s_mov_b32 s36, s38
  v_mfma_f32_16x16x32_bf16 a[0:3], v[112:115], v[64:67], a[0:3]
  ds_read_b64_tr_b16 v[96:97], v160 offset:0
  v_mfma_f32_16x16x32_bf16 a[32:35], v[116:119], v[64:67], a[32:35]
  ds_read_b64_tr_b16 v[98:99], v160 offset:1024
  v_mfma_f32_16x16x32_bf16 a[64:67], v[64:67], v[120:123], a[64:67]
  ds_read_b64_tr_b16 v[100:101], v161 offset:0
  v_mfma_f32_16x16x32_bf16 a[96:99], v[64:67], v[124:127], a[96:99]
  s_add_u32 m0, s39, 0
  s_add_u32 s34, s35, 0
  buffer_load_dwordx4 v4, s[12:15], s34 offen lds
  v_mfma_f32_16x16x32_bf16 a[4:7], v[112:115], v[68:71], a[4:7]
  ds_read_b64_tr_b16 v[102:103], v161 offset:1024
  v_mfma_f32_16x16x32_bf16 a[36:39], v[116:119], v[68:71], a[36:39]
  ds_read_b64_tr_b16 v[104:105], v160 offset:8192
  v_mfma_f32_16x16x32_bf16 a[68:71], v[68:71], v[120:123], a[68:71]
  ds_read_b64_tr_b16 v[106:107], v160 offset:9216
  v_mfma_f32_16x16x32_bf16 a[100:103], v[68:71], v[124:127], a[100:103]
  s_add_u32 m0, s39, 1024
  s_add_u32 s34, s35, 16384
  buffer_load_dwordx4 v4, s[12:15], s34 offen lds
  v_mfma_f32_16x16x32_bf16 a[8:11], v[112:115], v[72:75], a[8:11]
  ds_read_b64_tr_b16 v[108:109], v161 offset:8192
  v_mfma_f32_16x16x32_bf16 a[40:43], v[116:119], v[72:75], a[40:43]
  ds_read_b64_tr_b16 v[110:111], v161 offset:9216
  v_mfma_f32_16x16x32_bf16 a[72:75], v[72:75], v[120:123], a[72:75]
  ds_read_b128 v[32:35], v159 offset:0
  v_mfma_f32_16x16x32_bf16 a[104:107], v[72:75], v[124:127], a[104:107]
  s_add_u32 m0, s40, 0
  s_add_u32 s34, s36, 0
  buffer_load_dwordx4 v5, s[20:23], s34 offen lds
  v_mfma_f32_16x16x32_bf16 a[12:15], v[112:115], v[76:79], a[12:15]
  ds_read_b128 v[36:39], v159 offset:1024
  v_mfma_f32_16x16x32_bf16 a[44:47], v[116:119], v[76:79], a[44:47]
  ds_read_b128 v[40:43], v159 offset:2048
  v_mfma_f32_16x16x32_bf16 a[76:79], v[76:79], v[120:123], a[76:79]
  ds_read_b128 v[44:47], v159 offset:3072
  v_mfma_f32_16x16x32_bf16 a[108:111], v[76:79], v[124:127], a[108:111]
  s_add_u32 m0, s40, 1024
  s_add_u32 s34, s36, 32768
  buffer_load_dwordx4 v5, s[20:23], s34 offen lds
  v_mfma_f32_16x16x32_bf16 a[16:19], v[112:115], v[80:83], a[16:19]
  ds_read_b128 v[48:51], v159 offset:4096
  v_mfma_f32_16x16x32_bf16 a[48:51], v[116:119], v[80:83], a[48:51]
  ds_read_b128 v[52:55], v159 offset:5120
  v_mfma_f32_16x16x32_bf16 a[80:83], v[80:83], v[120:123], a[80:83]
  ds_read_b128 v[56:59], v159 offset:6144
  v_mfma_f32_16x16x32_bf16 a[112:115], v[80:83], v[124:127], a[112:115]
  s_add_u32 m0, s40, 8192
  s_add_u32 s34, s36, 0
  buffer_load_dwordx4 v5, s[24:27], s34 offen lds
  v_mfma_f32_16x16x32_bf16 a[20:23], v[112:115], v[84:87], a[20:23]
  ds_read_b128 v[60:63], v159 offset:7168
  v_mfma_f32_16x16x32_bf16 a[52:55], v[116:119], v[84:87], a[52:55]
  v_mfma_f32_16x16x32_bf16 a[84:87], v[84:87], v[120:123], a[84:87]
  v_mfma_f32_16x16x32_bf16 a[116:119], v[84:87], v[124:127], a[116:119]
  s_add_u32 m0, s40, 9216
  s_add_u32 s34, s36, 32768
  buffer_load_dwordx4 v5, s[24:27], s34 offen lds
  s_add_u32 s35, s35, 64
  s_add_u32 s36, s36, 262144
  v_mfma_f32_16x16x32_bf16 a[24:27], v[112:115], v[88:91], a[24:27]
  v_mfma_f32_16x16x32_bf16 a[56:59], v[116:119], v[88:91], a[56:59]
  v_mfma_f32_16x16x32_bf16 a[88:91], v[88:91], v[120:123], a[88:91]
  v_mfma_f32_16x16x32_bf16 a[120:123], v[88:91], v[124:127], a[120:123]
  v_mfma_f32_16x16x32_bf16 a[28:31], v[112:115], v[92:95], a[28:31]
  v_mfma_f32_16x16x32_bf16 a[60:63], v[116:119], v[92:95], a[60:63]
  v_mfma_f32_16x16x32_bf16 a[92:95], v[92:95], v[120:123], a[92:95]
  v_mfma_f32_16x16x32_bf16 a[124:127], v[92:95], v[124:127], a[124:127]
  s_waitcnt vmcnt(18) lgkmcnt(0)
  s_barrier
  v_mfma_f32_16x16x32_bf16 a[0:3], v[96:99], v[32:35], a[0:3]
  ds_read_b64_tr_b16 v[112:113], v160 offset:24576
  v_mfma_f32_16x16x32_bf16 a[32:35], v[100:103], v[32:35], a[32:35]
  ds_read_b64_tr_b16 v[114:115], v160 offset:25600
  v_mfma_f32_16x16x32_bf16 a[64:67], v[32:35], v[104:107], a[64:67]
  ds_read_b64_tr_b16 v[116:117], v161 offset:24576
  v_mfma_f32_16x16x32_bf16 a[96:99], v[32:35], v[108:111], a[96:99]
  s_add_u32 m0, s39, 24576
  s_add_u32 s34, s35, 0
  buffer_load_dwordx4 v4, s[12:15], s34 offen lds
  v_mfma_f32_16x16x32_bf16 a[4:7], v[96:99], v[36:39], a[4:7]
  ds_read_b64_tr_b16 v[118:119], v161 offset:25600
  v_mfma_f32_16x16x32_bf16 a[36:39], v[100:103], v[36:39], a[36:39]
  ds_read_b64_tr_b16 v[120:121], v160 offset:32768
  v_mfma_f32_16x16x32_bf16 a[68:71], v[36:39], v[104:107], a[68:71]
  ds_read_b64_tr_b16 v[122:123], v160 offset:33792
  v_mfma_f32_16x16x32_bf16 a[100:103], v[36:39], v[108:111], a[100:103]
  s_add_u32 m0, s39, 25600
  s_add_u32 s34, s35, 16384
  buffer_load_dwordx4 v4, s[12:15], s34 offen lds
  v_mfma_f32_16x16x32_bf16 a[8:11], v[96:99], v[40:43], a[8:11]
  ds_read_b64_tr_b16 v[124:125], v161 offset:32768
  v_mfma_f32_16x16x32_bf16 a[40:43], v[100:103], v[40:43], a[40:43]
  ds_read_b64_tr_b16 v[126:127], v161 offset:33792
  v_mfma_f32_16x16x32_bf16 a[72:75], v[40:43], v[104:107], a[72:75]
  ds_read_b128 v[64:67], v159 offset:24576
  v_mfma_f32_16x16x32_bf16 a[104:107], v[40:43], v[108:111], a[104:107]
  s_add_u32 m0, s40, 24576
  s_add_u32 s34, s36, 0
  buffer_load_dwordx4 v5, s[20:23], s34 offen lds
  v_mfma_f32_16x16x32_bf16 a[12:15], v[96:99], v[44:47], a[12:15]
  ds_read_b128 v[68:71], v159 offset:25600
  v_mfma_f32_16x16x32_bf16 a[44:47], v[100:103], v[44:47], a[44:47]
  ds_read_b128 v[72:75], v159 offset:26624
  v_mfma_f32_16x16x32_bf16 a[76:79], v[44:47], v[104:107], a[76:79]
  ds_read_b128 v[76:79], v159 offset:27648
  v_mfma_f32_16x16x32_bf16 a[108:111], v[44:47], v[108:111], a[108:111]
  s_add_u32 m0, s40, 25600
  s_add_u32 s34, s36, 32768
  buffer_load_dwordx4 v5, s[20:23], s34 offen lds
  v_mfma_f32_16x16x32_bf16 a[16:19], v[96:99], v[48:51], a[16:19]
  ds_read_b128 v[80:83], v159 offset:28672
  v_mfma_f32_16x16x32_bf16 a[48:51], v[100:103], v[48:51], a[48:51]
  ds_read_b128 v[84:87], v159 offset:29696
  v_mfma_f32_16x16x32_bf16 a[80:83], v[48:51], v[104:107], a[80:83]
  ds_read_b128 v[88:91], v159 offset:30720
  v_mfma_f32_16x16x32_bf16 a[112:115], v[48:51], v[108:111], a[112:115]
  s_add_u32 m0, s40, 32768
  s_add_u32 s34, s36, 0
  buffer_load_dwordx4 v5, s[24:27], s34 offen lds
  v_mfma_f32_16x16x32_bf16 a[20:23], v[96:99], v[52:55], a[20:23]
  ds_read_b128 v[92:95], v159 offset:31744
  v_mfma_f32_16x16x32_bf16 a[52:55], v[100:103], v[52:55], a[52:55]
  v_mfma_f32_16x16x32_bf16 a[84:87], v[52:55], v[104:107], a[84:87]
  v_mfma_f32_16x16x32_bf16 a[116:119], v[52:55], v[108:111], a[116:119]
  s_add_u32 m0, s40, 33792
  s_add_u32 s34, s36, 32768
  buffer_load_dwordx4 v5, s[24:27], s34 offen lds
  s_add_u32 s35, s35, 64
  s_add_u32 s36, s36, 262144
  v_mfma_f32_16x16x32_bf16 a[24:27], v[96:99], v[56:59], a[24:27]
  v_mfma_f32_16x16x32_bf16 a[56:59], v[100:103], v[56:59], a[56:59]
  v_mfma_f32_16x16x32_bf16 a[88:91], v[56:59], v[104:107], a[88:91]
  v_mfma_f32_16x16x32_bf16 a[120:123], v[56:59], v[108:111], a[120:123]
  v_mfma_f32_16x16x32_bf16 a[28:31], v[96:99], v[60:63], a[28:31]
  v_mfma_f32_16x16x32_bf16 a[60:63], v[100:103], v[60:63], a[60:63]
  v_mfma_f32_16x16x32_bf16 a[92:95], v[60:63], v[104:107], a[92:95]
  v_mfma_f32_16x16x32_bf16 a[124:127], v[60:63], v[108:111], a[124:127]
  s_waitcnt vmcnt(18) lgkmcnt(0)
  s_barrier
  s_waitcnt vmcnt(33)
  s_barrier
  buffer_store_dword v11, v7, s[8:11], s43 offen sc1
  v_mfma_f32_16x16x32_bf16 a[0:3], v[112:115], v[64:67], a[0:3]
  ds_read_b64_tr_b16 v[96:97], v163 offset:0
  v_mfma_f32_16x16x32_bf16 a[32:35], v[116:119], v[64:67], a[32:35]
  ds_read_b64_tr_b16 v[98:99], v163 offset:1024
  v_mfma_f32_16x16x32_bf16 a[64:67], v[64:67], v[120:123], a[64:67]
  ds_read_b64_tr_b16 v[100:101], v164 offset:0
  v_mfma_f32_16x16x32_bf16 a[96:99], v[64:67], v[124:127], a[96:99]
  s_add_u32 m0, s39, 49152
  s_add_u32 s34, s35, 0
  buffer_load_dwordx4 v4, s[12:15], s34 offen lds
  v_mfma_f32_16x16x32_bf16 a[4:7], v[112:115], v[68:71], a[4:7]
  ds_read_b64_tr_b16 v[102:103], v164 offset:1024
  v_mfma_f32_16x16x32_bf16 a[36:39], v[116:119], v[68:71], a[36:39]
  ds_read_b64_tr_b16 v[104:105], v163 offset:8192
  v_mfma_f32_16x16x32_bf16 a[68:71], v[68:71], v[120:123], a[68:71]
  ds_read_b64_tr_b16 v[106:107], v163 offset:9216
  v_mfma_f32_16x16x32_bf16 a[100:103], v[68:71], v[124:127], a[100:103]
  s_add_u32 m0, s39, 50176
  s_add_u32 s34, s35, 16384
  buffer_load_dwordx4 v4, s[12:15], s34 offen lds
  v_mfma_f32_16x16x32_bf16 a[8:11], v[112:115], v[72:75], a[8:11]
  ds_read_b64_tr_b16 v[108:109], v164 offset:8192
  v_mfma_f32_16x16x32_bf16 a[40:43], v[116:119], v[72:75], a[40:43]
  ds_read_b64_tr_b16 v[110:111], v164 offset:9216
  v_mfma_f32_16x16x32_bf16 a[72:75], v[72:75], v[120:123], a[72:75]
  ds_read_b128 v[32:35], v162 offset:0
  v_mfma_f32_16x16x32_bf16 a[104:107], v[72:75], v[124:127], a[104:107]
  s_add_u32 m0, s40, 49152
  s_add_u32 s34, s36, 0
  buffer_load_dwordx4 v5, s[20:23], s34 offen lds
  v_mfma_f32_16x16x32_bf16 a[12:15], v[112:115], v[76:79], a[12:15]
  ds_read_b128 v[36:39], v162 offset:1024
  v_mfma_f32_16x16x32_bf16 a[44:47], v[116:119], v[76:79], a[44:47]
  ds_read_b128 v[40:43], v162 offset:2048
  v_mfma_f32_16x16x32_bf16 a[76:79], v[76:79], v[120:123], a[76:79]
  ds_read_b128 v[44:47], v162 offset:3072
  v_mfma_f32_16x16x32_bf16 a[108:111], v[76:79], v[124:127], a[108:111]
  s_add_u32 m0, s40, 50176
  s_add_u32 s34, s36, 32768
  buffer_load_dwordx4 v5, s[20:23], s34 offen lds
  v_mfma_f32_16x16x32_bf16 a[16:19], v[112:115], v[80:83], a[16:19]
  ds_read_b128 v[48:51], v162 offset:4096
  v_mfma_f32_16x16x32_bf16 a[48:51], v[116:119], v[80:83], a[48:51]
  ds_read_b128 v[52:55], v162 offset:5120
  v_mfma_f32_16x16x32_bf16 a[80:83], v[80:83], v[120:123], a[80:83]
  ds_read_b128 v[56:59], v162 offset:6144
  v_mfma_f32_16x16x32_bf16 a[112:115], v[80:83], v[124:127], a[112:115]
  s_add_u32 m0, s40, 57344
  s_add_u32 s34, s36, 0
  buffer_load_dwordx4 v5, s[24:27], s34 offen lds
  v_mfma_f32_16x16x32_bf16 a[20:23], v[112:115], v[84:87], a[20:23]
  ds_read_b128 v[60:63], v162 offset:7168
  v_mfma_f32_16x16x32_bf16 a[52:55], v[116:119], v[84:87], a[52:55]
  v_mfma_f32_16x16x32_bf16 a[84:87], v[84:87], v[120:123], a[84:87]
  v_mfma_f32_16x16x32_bf16 a[116:119], v[84:87], v[124:127], a[116:119]
  s_add_u32 m0, s40, 58368
  s_add_u32 s34, s36, 32768
  buffer_load_dwordx4 v5, s[24:27], s34 offen lds
  s_add_u32 s35, s35, 64
  s_add_u32 s36, s36, 262144
  v_mfma_f32_16x16x32_bf16 a[24:27], v[112:115], v[88:91], a[24:27]
  v_mfma_f32_16x16x32_bf16 a[56:59], v[116:119], v[88:91], a[56:59]
  v_mfma_f32_16x16x32_bf16 a[88:91], v[88:91], v[120:123], a[88:91]
  v_mfma_f32_16x16x32_bf16 a[120:123], v[88:91], v[124:127], a[120:123]
  v_mfma_f32_16x16x32_bf16 a[28:31], v[112:115], v[92:95], a[28:31]
  v_mfma_f32_16x16x32_bf16 a[60:63], v[116:119], v[92:95], a[60:63]
  v_mfma_f32_16x16x32_bf16 a[92:95], v[92:95], v[120:123], a[92:95]
  v_mfma_f32_16x16x32_bf16 a[124:127], v[92:95], v[124:127], a[124:127]
  s_waitcnt vmcnt(19) lgkmcnt(0)
  s_barrier
  v_mfma_f32_16x16x32_bf16 a[0:3], v[96:99], v[32:35], a[0:3]
  ds_read_b64_tr_b16 v[112:113], v163 offset:24576
  v_mfma_f32_16x16x32_bf16 a[32:35], v[100:103], v[32:35], a[32:35]
  ds_read_b64_tr_b16 v[114:115], v163 offset:25600
  v_mfma_f32_16x16x32_bf16 a[64:67], v[32:35], v[104:107], a[64:67]
  ds_read_b64_tr_b16 v[116:117], v164 offset:24576
  v_mfma_f32_16x16x32_bf16 a[96:99], v[32:35], v[108:111], a[96:99]
  s_add_u32 m0, s39, 73728
  s_add_u32 s34, s35, 0
  buffer_load_dwordx4 v4, s[12:15], s34 offen lds
  v_mfma_f32_16x16x32_bf16 a[4:7], v[96:99], v[36:39], a[4:7]
  ds_read_b64_tr_b16 v[118:119], v164 offset:25600
  v_mfma_f32_16x16x32_bf16 a[36:39], v[100:103], v[36:39], a[36:39]
  ds_read_b64_tr_b16 v[120:121], v163 offset:32768
  v_mfma_f32_16x16x32_bf16 a[68:71], v[36:39], v[104:107], a[68:71]
  ds_read_b64_tr_b16 v[122:123], v163 offset:33792
  v_mfma_f32_16x16x32_bf16 a[100:103], v[36:39], v[108:111], a[100:103]
  s_add_u32 m0, s39, 74752
  s_add_u32 s34, s35, 16384
  buffer_load_dwordx4 v4, s[12:15], s34 offen lds
  v_mfma_f32_16x16x32_bf16 a[8:11], v[96:99], v[40:43], a[8:11]
  ds_read_b64_tr_b16 v[124:125], v164 offset:32768
  v_mfma_f32_16x16x32_bf16 a[40:43], v[100:103], v[40:43], a[40:43]
  ds_read_b64_tr_b16 v[126:127], v164 offset:33792
  v_mfma_f32_16x16x32_bf16 a[72:75], v[40:43], v[104:107], a[72:75]
  ds_read_b128 v[64:67], v162 offset:24576
  v_mfma_f32_16x16x32_bf16 a[104:107], v[40:43], v[108:111], a[104:107]
  s_add_u32 m0, s40, 73728
  s_add_u32 s34, s36, 0
  buffer_load_dwordx4 v5, s[20:23], s34 offen lds
  v_mfma_f32_16x16x32_bf16 a[12:15], v[96:99], v[44:47], a[12:15]
  ds_read_b128 v[68:71], v162 offset:25600
  v_mfma_f32_16x16x32_bf16 a[44:47], v[100:103], v[44:47], a[44:47]
  ds_read_b128 v[72:75], v162 offset:26624
  v_mfma_f32_16x16x32_bf16 a[76:79], v[44:47], v[104:107], a[76:79]
  ds_read_b128 v[76:79], v162 offset:27648
  v_mfma_f32_16x16x32_bf16 a[108:111], v[44:47], v[108:111], a[108:111]
  s_add_u32 m0, s40, 74752
  s_add_u32 s34, s36, 32768
  buffer_load_dwordx4 v5, s[20:23], s34 offen lds
  v_mfma_f32_16x16x32_bf16 a[16:19], v[96:99], v[48:51], a[16:19]
  ds_read_b128 v[80:83], v162 offset:28672
  v_mfma_f32_16x16x32_bf16 a[48:51], v[100:103], v[48:51], a[48:51]
  ds_read_b128 v[84:87], v162 offset:29696
  v_mfma_f32_16x16x32_bf16 a[80:83], v[48:51], v[104:107], a[80:83]
  ds_read_b128 v[88:91], v162 offset:30720
  v_mfma_f32_16x16x32_bf16 a[112:115], v[48:51], v[108:111], a[112:115]
  s_add_u32 m0, s40, 81920
  s_add_u32 s34, s36, 0
  buffer_load_dwordx4 v5, s[24:27], s34 offen lds
  v_mfma_f32_16x16x32_bf16 a[20:23], v[96:99], v[52:55], a[20:23]
  ds_read_b128 v[92:95], v162 offset:31744
  v_mfma_f32_16x16x32_bf16 a[52:55], v[100:103], v[52:55], a[52:55]
  v_mfma_f32_16x16x32_bf16 a[84:87], v[52:55], v[104:107], a[84:87]
  v_mfma_f32_16x16x32_bf16 a[116:119], v[52:55], v[108:111], a[116:119]
  s_add_u32 m0, s40, 82944
  s_add_u32 s34, s36, 32768
  buffer_load_dwordx4 v5, s[24:27], s34 offen lds
  s_add_u32 s35, s35, 64
  s_add_u32 s36, s36, 262144
  v_mfma_f32_16x16x32_bf16 a[24:27], v[96:99], v[56:59], a[24:27]
  v_mfma_f32_16x16x32_bf16 a[56:59], v[100:103], v[56:59], a[56:59]
  v_mfma_f32_16x16x32_bf16 a[88:91], v[56:59], v[104:107], a[88:91]
  v_mfma_f32_16x16x32_bf16 a[120:123], v[56:59], v[108:111], a[120:123]
  v_mfma_f32_16x16x32_bf16 a[28:31], v[96:99], v[60:63], a[28:31]
  v_mfma_f32_16x16x32_bf16 a[60:63], v[100:103], v[60:63], a[60:63]
  v_mfma_f32_16x16x32_bf16 a[92:95], v[60:63], v[104:107], a[92:95]
  v_mfma_f32_16x16x32_bf16 a[124:127], v[60:63], v[108:111], a[124:127]
  s_waitcnt vmcnt(19) lgkmcnt(0)
  s_barrier
  v_mfma_f32_16x16x32_bf16 a[0:3], v[112:115], v[64:67], a[0:3]
  ds_read_b64_tr_b16 v[96:97], v157 offset:0
  v_mfma_f32_16x16x32_bf16 a[32:35], v[116:119], v[64:67], a[32:35]
  ds_read_b64_tr_b16 v[98:99], v157 offset:1024
  v_mfma_f32_16x16x32_bf16 a[64:67], v[64:67], v[120:123], a[64:67]
  ds_read_b64_tr_b16 v[100:101], v158 offset:0
  v_mfma_f32_16x16x32_bf16 a[96:99], v[64:67], v[124:127], a[96:99]
  s_add_u32 m0, s39, 98304
  s_add_u32 s34, s35, 0
  buffer_load_dwordx4 v4, s[12:15], s34 offen lds
  v_mfma_f32_16x16x32_bf16 a[4:7], v[112:115], v[68:71], a[4:7]
  ds_read_b64_tr_b16 v[102:103], v158 offset:1024
  v_mfma_f32_16x16x32_bf16 a[36:39], v[116:119], v[68:71], a[36:39]
  ds_read_b64_tr_b16 v[104:105], v157 offset:8192
  v_mfma_f32_16x16x32_bf16 a[68:71], v[68:71], v[120:123], a[68:71]
  ds_read_b64_tr_b16 v[106:107], v157 offset:9216
  v_mfma_f32_16x16x32_bf16 a[100:103], v[68:71], v[124:127], a[100:103]
  s_add_u32 m0, s39, 99328
  s_add_u32 s34, s35, 16384
  buffer_load_dwordx4 v4, s[12:15], s34 offen lds
  v_mfma_f32_16x16x32_bf16 a[8:11], v[112:115], v[72:75], a[8:11]
  ds_read_b64_tr_b16 v[108:109], v158 offset:8192
  v_mfma_f32_16x16x32_bf16 a[40:43], v[116:119], v[72:75], a[40:43]
  ds_read_b64_tr_b16 v[110:111], v158 offset:9216
  v_mfma_f32_16x16x32_bf16 a[72:75], v[72:75], v[120:123], a[72:75]
  ds_read_b128 v[32:35], v156 offset:0
  v_mfma_f32_16x16x32_bf16 a[104:107], v[72:75], v[124:127], a[104:107]
  s_add_u32 m0, s40, 98304
  s_add_u32 s34, s36, 0
  buffer_load_dwordx4 v5, s[20:23], s34 offen lds
  v_mfma_f32_16x16x32_bf16 a[12:15], v[112:115], v[76:79], a[12:15]
  ds_read_b128 v[36:39], v156 offset:1024
  v_mfma_f32_16x16x32_bf16 a[44:47], v[116:119], v[76:79], a[44:47]
  ds_read_b128 v[40:43], v156 offset:2048
  v_mfma_f32_16x16x32_bf16 a[76:79], v[76:79], v[120:123], a[76:79]
  ds_read_b128 v[44:47], v156 offset:3072
  v_mfma_f32_16x16x32_bf16 a[108:111], v[76:79], v[124:127], a[108:111]
  s_add_u32 m0, s40, 99328
  s_add_u32 s34, s36, 32768
  buffer_load_dwordx4 v5, s[20:23], s34 offen lds
  v_mfma_f32_16x16x32_bf16 a[16:19], v[112:115], v[80:83], a[16:19]
  ds_read_b128 v[48:51], v156 offset:4096
  v_mfma_f32_16x16x32_bf16 a[48:51], v[116:119], v[80:83], a[48:51]
  ds_read_b128 v[52:55], v156 offset:5120
  v_mfma_f32_16x16x32_bf16 a[80:83], v[80:83], v[120:123], a[80:83]
  ds_read_b128 v[56:59], v156 offset:6144
  v_mfma_f32_16x16x32_bf16 a[112:115], v[80:83], v[124:127], a[112:115]
  s_add_u32 m0, s40, 106496
  s_add_u32 s34, s36, 0
  buffer_load_dwordx4 v5, s[24:27], s34 offen lds
  v_mfma_f32_16x16x32_bf16 a[20:23], v[112:115], v[84:87], a[20:23]
  ds_read_b128 v[60:63], v156 offset:7168
  v_mfma_f32_16x16x32_bf16 a[52:55], v[116:119], v[84:87], a[52:55]
  v_mfma_f32_16x16x32_bf16 a[84:87], v[84:87], v[120:123], a[84:87]
  v_mfma_f32_16x16x32_bf16 a[116:119], v[84:87], v[124:127], a[116:119]
  s_add_u32 m0, s40, 107520
  s_add_u32 s34, s36, 32768
  buffer_load_dwordx4 v5, s[24:27], s34 offen lds
  s_add_u32 s35, s35, 64
  s_add_u32 s36, s36, 262144
  v_mfma_f32_16x16x32_bf16 a[24:27], v[112:115], v[88:91], a[24:27]
  v_mfma_f32_16x16x32_bf16 a[56:59], v[116:119], v[88:91], a[56:59]
  v_mfma_f32_16x16x32_bf16 a[88:91], v[88:91], v[120:123], a[88:91]
  v_mfma_f32_16x16x32_bf16 a[120:123], v[88:91], v[124:127], a[120:123]
  v_mfma_f32_16x16x32_bf16 a[28:31], v[112:115], v[92:95], a[28:31]
  v_mfma_f32_16x16x32_bf16 a[60:63], v[116:119], v[92:95], a[60:63]
  v_mfma_f32_16x16x32_bf16 a[92:95], v[92:95], v[120:123], a[92:95]
  v_mfma_f32_16x16x32_bf16 a[124:127], v[92:95], v[124:127], a[124:127]
  s_lshr_b32 s32, s94, 5
  s_lshl_b32 s32, s32, 21
  s_and_b32 s33, s94, 31
  s_lshl_b32 s33, s33, 14
  s_add_u32 s32, s32, s33
  s_lshl_b32 s33, s28, 12
  s_add_u32 s32, s32, s33
  s_add_u32 s41, s32, 16777216
  s_lshl_b32 s43, s94, 7
  s_add_u32 s43, s43, 327680
  s_cmp_eq_u32 s97, 0
  s_cselect_b32 s43, s43, 0x7f000000
  v_accvgpr_read_b32 v128, a0
  v_accvgpr_read_b32 v129, a1
  v_accvgpr_read_b32 v130, a2
  v_accvgpr_read_b32 v131, a3
  v_accvgpr_read_b32 v132, a32
  v_accvgpr_read_b32 v133, a33
  v_accvgpr_read_b32 v134, a34
  v_accvgpr_read_b32 v135, a35
  v_cvt_pk_bf16_f32 v136, v128, v129
  v_cvt_pk_bf16_f32 v137, v130, v131
  v_cvt_pk_bf16_f32 v138, v132, v133
  v_cvt_pk_bf16_f32 v139, v134, v135
  s_add_u32 s33, s41, 0
  buffer_store_dwordx4 v[136:139], v6, s[8:11], s33 offen offset:0 sc1
  v_accvgpr_read_b32 v140, a4
  v_accvgpr_read_b32 v141, a5
  v_accvgpr_read_b32 v142, a6
  v_accvgpr_read_b32 v143, a7
  v_accvgpr_read_b32 v144, a36
  v_accvgpr_read_b32 v145, a37
  v_accvgpr_read_b32 v146, a38
  v_accvgpr_read_b32 v147, a39
  v_cvt_pk_bf16_f32 v148, v140, v141
  v_cvt_pk_bf16_f32 v149, v142, v143
  v_cvt_pk_bf16_f32 v150, v144, v145
  v_cvt_pk_bf16_f32 v151, v146, v147
  s_add_u32 s33, s41, 0
  buffer_store_dwordx4 v[148:151], v6, s[8:11], s33 offen offset:1024 sc1
  v_accvgpr_read_b32 v128, a64
  v_accvgpr_read_b32 v129, a65
  v_accvgpr_read_b32 v130, a66
  v_accvgpr_read_b32 v131, a67
  v_accvgpr_read_b32 v132, a68
  v_accvgpr_read_b32 v133, a69
  v_accvgpr_read_b32 v134, a70
  v_accvgpr_read_b32 v135, a71
  v_cvt_pk_bf16_f32 v136, v128, v129
  v_cvt_pk_bf16_f32 v137, v130, v131
  v_cvt_pk_bf16_f32 v138, v132, v133
  v_cvt_pk_bf16_f32 v139, v134, v135
  s_add_u32 s33, s41, 0
  buffer_store_dwordx4 v[136:139], v6, s[8:11], s33 offen offset:2048 sc1
  v_accvgpr_read_b32 v140, a96
  v_accvgpr_read_b32 v141, a97
  v_accvgpr_read_b32 v142, a98
  v_accvgpr_read_b32 v143, a99
  v_accvgpr_read_b32 v144, a100
  v_accvgpr_read_b32 v145, a101
  v_accvgpr_read_b32 v146, a102
  v_accvgpr_read_b32 v147, a103
  v_cvt_pk_bf16_f32 v148, v140, v141
  v_cvt_pk_bf16_f32 v149, v142, v143
  v_cvt_pk_bf16_f32 v150, v144, v145
  v_cvt_pk_bf16_f32 v151, v146, v147
  s_add_u32 s33, s41, 0
  buffer_store_dwordx4 v[148:151], v6, s[8:11], s33 offen offset:3072 sc1
  v_accvgpr_read_b32 v128, a8
  v_accvgpr_read_b32 v129, a9
  v_accvgpr_read_b32 v130, a10
  v_accvgpr_read_b32 v131, a11
  v_accvgpr_read_b32 v132, a40
  v_accvgpr_read_b32 v133, a41
  v_accvgpr_read_b32 v134, a42
  v_accvgpr_read_b32 v135, a43
  v_cvt_pk_bf16_f32 v136, v128, v129
  v_cvt_pk_bf16_f32 v137, v130, v131
  v_cvt_pk_bf16_f32 v138, v132, v133
  v_cvt_pk_bf16_f32 v139, v134, v135
  s_add_u32 s33, s41, 524288
  buffer_store_dwordx4 v[136:139], v6, s[8:11], s33 offen offset:0 sc1
  v_accvgpr_read_b32 v140, a12
  v_accvgpr_read_b32 v141, a13
  v_accvgpr_read_b32 v142, a14
  v_accvgpr_read_b32 v143, a15
  v_accvgpr_read_b32 v144, a44
  v_accvgpr_read_b32 v145, a45
  v_accvgpr_read_b32 v146, a46
  v_accvgpr_read_b32 v147, a47
  v_cvt_pk_bf16_f32 v148, v140, v141
  v_cvt_pk_bf16_f32 v149, v142, v143
  v_cvt_pk_bf16_f32 v150, v144, v145
  v_cvt_pk_bf16_f32 v151, v146, v147
  s_add_u32 s33, s41, 524288
  buffer_store_dwordx4 v[148:151], v6, s[8:11], s33 offen offset:1024 sc1
  v_accvgpr_read_b32 v128, a72
  v_accvgpr_read_b32 v129, a73
  v_accvgpr_read_b32 v130, a74
  v_accvgpr_read_b32 v131, a75
  v_accvgpr_read_b32 v132, a76
  v_accvgpr_read_b32 v133, a77
  v_accvgpr_read_b32 v134, a78
  v_accvgpr_read_b32 v135, a79
  v_cvt_pk_bf16_f32 v136, v128, v129
  v_cvt_pk_bf16_f32 v137, v130, v131
  v_cvt_pk_bf16_f32 v138, v132, v133
  v_cvt_pk_bf16_f32 v139, v134, v135
  s_add_u32 s33, s41, 524288
  buffer_store_dwordx4 v[136:139], v6, s[8:11], s33 offen offset:2048 sc1
  v_accvgpr_read_b32 v140, a104
  v_accvgpr_read_b32 v141, a105
  v_accvgpr_read_b32 v142, a106
  v_accvgpr_read_b32 v143, a107
  v_accvgpr_read_b32 v144, a108
  v_accvgpr_read_b32 v145, a109
  v_accvgpr_read_b32 v146, a110
  v_accvgpr_read_b32 v147, a111
  v_cvt_pk_bf16_f32 v148, v140, v141
  v_cvt_pk_bf16_f32 v149, v142, v143
  v_cvt_pk_bf16_f32 v150, v144, v145
  v_cvt_pk_bf16_f32 v151, v146, v147
  s_add_u32 s33, s41, 524288
  buffer_store_dwordx4 v[148:151], v6, s[8:11], s33 offen offset:3072 sc1
  v_accvgpr_read_b32 v128, a16
  v_accvgpr_read_b32 v129, a17
  v_accvgpr_read_b32 v130, a18
  v_accvgpr_read_b32 v131, a19
  v_accvgpr_read_b32 v132, a48
  v_accvgpr_read_b32 v133, a49
  v_accvgpr_read_b32 v134, a50
  v_accvgpr_read_b32 v135, a51
  v_cvt_pk_bf16_f32 v136, v128, v129
  v_cvt_pk_bf16_f32 v137, v130, v131
  v_cvt_pk_bf16_f32 v138, v132, v133
  v_cvt_pk_bf16_f32 v139, v134, v135
  s_add_u32 s33, s41, 1048576
  buffer_store_dwordx4 v[136:139], v6, s[8:11], s33 offen offset:0 sc1
  v_accvgpr_read_b32 v140, a20
  v_accvgpr_read_b32 v141, a21
  v_accvgpr_read_b32 v142, a22
  v_accvgpr_read_b32 v143, a23
  v_accvgpr_read_b32 v144, a52
  v_accvgpr_read_b32 v145, a53
  v_accvgpr_read_b32 v146, a54
  v_accvgpr_read_b32 v147, a55
  v_cvt_pk_bf16_f32 v148, v140, v141
  v_cvt_pk_bf16_f32 v149, v142, v143
  v_cvt_pk_bf16_f32 v150, v144, v145
  v_cvt_pk_bf16_f32 v151, v146, v147
  s_add_u32 s33, s41, 1048576
  buffer_store_dwordx4 v[148:151], v6, s[8:11], s33 offen offset:1024 sc1
  v_accvgpr_read_b32 v128, a80
  v_accvgpr_read_b32 v129, a81
  v_accvgpr_read_b32 v130, a82
  v_accvgpr_read_b32 v131, a83
  v_accvgpr_read_b32 v132, a84
  v_accvgpr_read_b32 v133, a85
  v_accvgpr_read_b32 v134, a86
  v_accvgpr_read_b32 v135, a87
  v_cvt_pk_bf16_f32 v136, v128, v129
  v_cvt_pk_bf16_f32 v137, v130, v131
  v_cvt_pk_bf16_f32 v138, v132, v133
  v_cvt_pk_bf16_f32 v139, v134, v135
  s_add_u32 s33, s41, 1048576
  buffer_store_dwordx4 v[136:139], v6, s[8:11], s33 offen offset:2048 sc1
  v_accvgpr_read_b32 v140, a112
  v_accvgpr_read_b32 v141, a113
  v_accvgpr_read_b32 v142, a114
  v_accvgpr_read_b32 v143, a115
  v_accvgpr_read_b32 v144, a116
  v_accvgpr_read_b32 v145, a117
  v_accvgpr_read_b32 v146, a118
  v_accvgpr_read_b32 v147, a119
  v_cvt_pk_bf16_f32 v148, v140, v141
  v_cvt_pk_bf16_f32 v149, v142, v143
  v_cvt_pk_bf16_f32 v150, v144, v145
  v_cvt_pk_bf16_f32 v151, v146, v147
  s_add_u32 s33, s41, 1048576
  buffer_store_dwordx4 v[148:151], v6, s[8:11], s33 offen offset:3072 sc1
  v_accvgpr_read_b32 v128, a24
  v_accvgpr_read_b32 v129, a25
  v_accvgpr_read_b32 v130, a26
  v_accvgpr_read_b32 v131, a27
  v_accvgpr_read_b32 v132, a56
  v_accvgpr_read_b32 v133, a57
  v_accvgpr_read_b32 v134, a58
  v_accvgpr_read_b32 v135, a59
  v_cvt_pk_bf16_f32 v136, v128, v129
  v_cvt_pk_bf16_f32 v137, v130, v131
  v_cvt_pk_bf16_f32 v138, v132, v133
  v_cvt_pk_bf16_f32 v139, v134, v135
  s_add_u32 s33, s41, 1572864
  buffer_store_dwordx4 v[136:139], v6, s[8:11], s33 offen offset:0 sc1
  v_accvgpr_read_b32 v140, a28
  v_accvgpr_read_b32 v141, a29
  v_accvgpr_read_b32 v142, a30
  v_accvgpr_read_b32 v143, a31
  v_accvgpr_read_b32 v144, a60
  v_accvgpr_read_b32 v145, a61
  v_accvgpr_read_b32 v146, a62
  v_accvgpr_read_b32 v147, a63
  v_cvt_pk_bf16_f32 v148, v140, v141
  v_cvt_pk_bf16_f32 v149, v142, v143
  v_cvt_pk_bf16_f32 v150, v144, v145
  v_cvt_pk_bf16_f32 v151, v146, v147
  s_add_u32 s33, s41, 1572864
  buffer_store_dwordx4 v[148:151], v6, s[8:11], s33 offen offset:1024 sc1
  v_accvgpr_read_b32 v128, a88
  v_accvgpr_read_b32 v129, a89
  v_accvgpr_read_b32 v130, a90
  v_accvgpr_read_b32 v131, a91
  v_accvgpr_read_b32 v132, a92
  v_accvgpr_read_b32 v133, a93
  v_accvgpr_read_b32 v134, a94
  v_accvgpr_read_b32 v135, a95
  v_cvt_pk_bf16_f32 v136, v128, v129
  v_cvt_pk_bf16_f32 v137, v130, v131
  v_cvt_pk_bf16_f32 v138, v132, v133
  v_cvt_pk_bf16_f32 v139, v134, v135
  s_add_u32 s33, s41, 1572864
  buffer_store_dwordx4 v[136:139], v6, s[8:11], s33 offen offset:2048 sc1
  v_accvgpr_read_b32 v140, a120
  v_accvgpr_read_b32 v141, a121
  v_accvgpr_read_b32 v142, a122
  v_accvgpr_read_b32 v143, a123
  v_accvgpr_read_b32 v144, a124
  v_accvgpr_read_b32 v145, a125
  v_accvgpr_read_b32 v146, a126
  v_accvgpr_read_b32 v147, a127
  v_cvt_pk_bf16_f32 v148, v140, v141
  v_cvt_pk_bf16_f32 v149, v142, v143
  v_cvt_pk_bf16_f32 v150, v144, v145
  v_cvt_pk_bf16_f32 v151, v146, v147
  s_add_u32 s33, s41, 1572864
  buffer_store_dwordx4 v[148:151], v6, s[8:11], s33 offen offset:3072 sc1
  s_nop 1
  s_branch L_kv_fin
L_kv_two:
  s_lshr_b32 s32, s93, 5
  s_lshl_b32 s32, s32, 21
  s_and_b32 s33, s93, 31
  s_lshl_b32 s33, s33, 14
  s_add_u32 s32, s32, s33
  s_lshl_b32 s33, s28, 12
  s_add_u32 s32, s32, s33
  s_add_u32 s41, s32, 16777216
  s_lshl_b32 s43, s93, 7
  s_add_u32 s43, s43, 327680
  s_cmp_eq_u32 s97, 0
  s_cselect_b32 s43, s43, 0x7f000000
  v_accvgpr_read_b32 v128, a128
  v_accvgpr_read_b32 v129, a129
  v_accvgpr_read_b32 v130, a130
  v_accvgpr_read_b32 v131, a131
  v_accvgpr_read_b32 v132, a160
  v_accvgpr_read_b32 v133, a161
  v_accvgpr_read_b32 v134, a162
  v_accvgpr_read_b32 v135, a163
  v_cvt_pk_bf16_f32 v136, v128, v129
  v_cvt_pk_bf16_f32 v137, v130, v131
  v_cvt_pk_bf16_f32 v138, v132, v133
  v_cvt_pk_bf16_f32 v139, v134, v135
  s_add_u32 s33, s41, 0
  buffer_store_dwordx4 v[136:139], v6, s[8:11], s33 offen offset:0 sc1
  v_accvgpr_read_b32 v140, a132
  v_accvgpr_read_b32 v141, a133
  v_accvgpr_read_b32 v142, a134
  v_accvgpr_read_b32 v143, a135
  v_accvgpr_read_b32 v144, a164
  v_accvgpr_read_b32 v145, a165
  v_accvgpr_read_b32 v146, a166
  v_accvgpr_read_b32 v147, a167
  v_cvt_pk_bf16_f32 v148, v140, v141
  v_cvt_pk_bf16_f32 v149, v142, v143
  v_cvt_pk_bf16_f32 v150, v144, v145
  v_cvt_pk_bf16_f32 v151, v146, v147
  s_add_u32 s33, s41, 0
  buffer_store_dwordx4 v[148:151], v6, s[8:11], s33 offen offset:1024 sc1
  v_accvgpr_read_b32 v128, a192
  v_accvgpr_read_b32 v129, a193
  v_accvgpr_read_b32 v130, a194
  v_accvgpr_read_b32 v131, a195
  v_accvgpr_read_b32 v132, a196
  v_accvgpr_read_b32 v133, a197
  v_accvgpr_read_b32 v134, a198
  v_accvgpr_read_b32 v135, a199
  v_cvt_pk_bf16_f32 v136, v128, v129
  v_cvt_pk_bf16_f32 v137, v130, v131
  v_cvt_pk_bf16_f32 v138, v132, v133
  v_cvt_pk_bf16_f32 v139, v134, v135
  s_add_u32 s33, s41, 0
  buffer_store_dwordx4 v[136:139], v6, s[8:11], s33 offen offset:2048 sc1
  v_accvgpr_read_b32 v140, a224
  v_accvgpr_read_b32 v141, a225
  v_accvgpr_read_b32 v142, a226
  v_accvgpr_read_b32 v143, a227
  v_accvgpr_read_b32 v144, a228
  v_accvgpr_read_b32 v145, a229
  v_accvgpr_read_b32 v146, a230
  v_accvgpr_read_b32 v147, a231
  v_cvt_pk_bf16_f32 v148, v140, v141
  v_cvt_pk_bf16_f32 v149, v142, v143
  v_cvt_pk_bf16_f32 v150, v144, v145
  v_cvt_pk_bf16_f32 v151, v146, v147
  s_add_u32 s33, s41, 0
  buffer_store_dwordx4 v[148:151], v6, s[8:11], s33 offen offset:3072 sc1
  v_accvgpr_read_b32 v128, a136
  v_accvgpr_read_b32 v129, a137
  v_accvgpr_read_b32 v130, a138
  v_accvgpr_read_b32 v131, a139
  v_accvgpr_read_b32 v132, a168
  v_accvgpr_read_b32 v133, a169
  v_accvgpr_read_b32 v134, a170
  v_accvgpr_read_b32 v135, a171
  v_cvt_pk_bf16_f32 v136, v128, v129
  v_cvt_pk_bf16_f32 v137, v130, v131
  v_cvt_pk_bf16_f32 v138, v132, v133
  v_cvt_pk_bf16_f32 v139, v134, v135
  s_add_u32 s33, s41, 524288
  buffer_store_dwordx4 v[136:139], v6, s[8:11], s33 offen offset:0 sc1
  v_accvgpr_read_b32 v140, a140
  v_accvgpr_read_b32 v141, a141
  v_accvgpr_read_b32 v142, a142
  v_accvgpr_read_b32 v143, a143
  v_accvgpr_read_b32 v144, a172
  v_accvgpr_read_b32 v145, a173
  v_accvgpr_read_b32 v146, a174
  v_accvgpr_read_b32 v147, a175
  v_cvt_pk_bf16_f32 v148, v140, v141
  v_cvt_pk_bf16_f32 v149, v142, v143
  v_cvt_pk_bf16_f32 v150, v144, v145
  v_cvt_pk_bf16_f32 v151, v146, v147
  s_add_u32 s33, s41, 524288
  buffer_store_dwordx4 v[148:151], v6, s[8:11], s33 offen offset:1024 sc1
  v_accvgpr_read_b32 v128, a200
  v_accvgpr_read_b32 v129, a201
  v_accvgpr_read_b32 v130, a202
  v_accvgpr_read_b32 v131, a203
  v_accvgpr_read_b32 v132, a204
  v_accvgpr_read_b32 v133, a205
  v_accvgpr_read_b32 v134, a206
  v_accvgpr_read_b32 v135, a207
  v_cvt_pk_bf16_f32 v136, v128, v129
  v_cvt_pk_bf16_f32 v137, v130, v131
  v_cvt_pk_bf16_f32 v138, v132, v133
  v_cvt_pk_bf16_f32 v139, v134, v135
  s_add_u32 s33, s41, 524288
  buffer_store_dwordx4 v[136:139], v6, s[8:11], s33 offen offset:2048 sc1
  v_accvgpr_read_b32 v140, a232
  v_accvgpr_read_b32 v141, a233
  v_accvgpr_read_b32 v142, a234
  v_accvgpr_read_b32 v143, a235
  v_accvgpr_read_b32 v144, a236
  v_accvgpr_read_b32 v145, a237
  v_accvgpr_read_b32 v146, a238
  v_accvgpr_read_b32 v147, a239
  v_cvt_pk_bf16_f32 v148, v140, v141
  v_cvt_pk_bf16_f32 v149, v142, v143
  v_cvt_pk_bf16_f32 v150, v144, v145
  v_cvt_pk_bf16_f32 v151, v146, v147
  s_add_u32 s33, s41, 524288
  buffer_store_dwordx4 v[148:151], v6, s[8:11], s33 offen offset:3072 sc1
  v_accvgpr_read_b32 v128, a144
  v_accvgpr_read_b32 v129, a145
  v_accvgpr_read_b32 v130, a146
  v_accvgpr_read_b32 v131, a147
  v_accvgpr_read_b32 v132, a176
  v_accvgpr_read_b32 v133, a177
  v_accvgpr_read_b32 v134, a178
  v_accvgpr_read_b32 v135, a179
  v_cvt_pk_bf16_f32 v136, v128, v129
  v_cvt_pk_bf16_f32 v137, v130, v131
  v_cvt_pk_bf16_f32 v138, v132, v133
  v_cvt_pk_bf16_f32 v139, v134, v135
  s_add_u32 s33, s41, 1048576
  buffer_store_dwordx4 v[136:139], v6, s[8:11], s33 offen offset:0 sc1
  v_accvgpr_read_b32 v140, a148
  v_accvgpr_read_b32 v141, a149
  v_accvgpr_read_b32 v142, a150
  v_accvgpr_read_b32 v143, a151
  v_accvgpr_read_b32 v144, a180
  v_accvgpr_read_b32 v145, a181
  v_accvgpr_read_b32 v146, a182
  v_accvgpr_read_b32 v147, a183
  v_cvt_pk_bf16_f32 v148, v140, v141
  v_cvt_pk_bf16_f32 v149, v142, v143
  v_cvt_pk_bf16_f32 v150, v144, v145
  v_cvt_pk_bf16_f32 v151, v146, v147
  s_add_u32 s33, s41, 1048576
  buffer_store_dwordx4 v[148:151], v6, s[8:11], s33 offen offset:1024 sc1
  v_accvgpr_read_b32 v128, a208
  v_accvgpr_read_b32 v129, a209
  v_accvgpr_read_b32 v130, a210
  v_accvgpr_read_b32 v131, a211
  v_accvgpr_read_b32 v132, a212
  v_accvgpr_read_b32 v133, a213
  v_accvgpr_read_b32 v134, a214
  v_accvgpr_read_b32 v135, a215
  v_cvt_pk_bf16_f32 v136, v128, v129
  v_cvt_pk_bf16_f32 v137, v130, v131
  v_cvt_pk_bf16_f32 v138, v132, v133
  v_cvt_pk_bf16_f32 v139, v134, v135
  s_add_u32 s33, s41, 1048576
  buffer_store_dwordx4 v[136:139], v6, s[8:11], s33 offen offset:2048 sc1
  v_accvgpr_read_b32 v140, a240
  v_accvgpr_read_b32 v141, a241
  v_accvgpr_read_b32 v142, a242
  v_accvgpr_read_b32 v143, a243
  v_accvgpr_read_b32 v144, a244
  v_accvgpr_read_b32 v145, a245
  v_accvgpr_read_b32 v146, a246
  v_accvgpr_read_b32 v147, a247
  v_cvt_pk_bf16_f32 v148, v140, v141
  v_cvt_pk_bf16_f32 v149, v142, v143
  v_cvt_pk_bf16_f32 v150, v144, v145
  v_cvt_pk_bf16_f32 v151, v146, v147
  s_add_u32 s33, s41, 1048576
  buffer_store_dwordx4 v[148:151], v6, s[8:11], s33 offen offset:3072 sc1
  v_accvgpr_read_b32 v128, a152
  v_accvgpr_read_b32 v129, a153
  v_accvgpr_read_b32 v130, a154
  v_accvgpr_read_b32 v131, a155
  v_accvgpr_read_b32 v132, a184
  v_accvgpr_read_b32 v133, a185
  v_accvgpr_read_b32 v134, a186
  v_accvgpr_read_b32 v135, a187
  v_cvt_pk_bf16_f32 v136, v128, v129
  v_cvt_pk_bf16_f32 v137, v130, v131
  v_cvt_pk_bf16_f32 v138, v132, v133
  v_cvt_pk_bf16_f32 v139, v134, v135
  s_add_u32 s33, s41, 1572864
  buffer_store_dwordx4 v[136:139], v6, s[8:11], s33 offen offset:0 sc1
  v_accvgpr_read_b32 v140, a156
  v_accvgpr_read_b32 v141, a157
  v_accvgpr_read_b32 v142, a158
  v_accvgpr_read_b32 v143, a159
  v_accvgpr_read_b32 v144, a188
  v_accvgpr_read_b32 v145, a189
  v_accvgpr_read_b32 v146, a190
  v_accvgpr_read_b32 v147, a191
  v_cvt_pk_bf16_f32 v148, v140, v141
  v_cvt_pk_bf16_f32 v149, v142, v143
  v_cvt_pk_bf16_f32 v150, v144, v145
  v_cvt_pk_bf16_f32 v151, v146, v147
  s_add_u32 s33, s41, 1572864
  buffer_store_dwordx4 v[148:151], v6, s[8:11], s33 offen offset:1024 sc1
  v_accvgpr_read_b32 v128, a216
  v_accvgpr_read_b32 v129, a217
  v_accvgpr_read_b32 v130, a218
  v_accvgpr_read_b32 v131, a219
  v_accvgpr_read_b32 v132, a220
  v_accvgpr_read_b32 v133, a221
  v_accvgpr_read_b32 v134, a222
  v_accvgpr_read_b32 v135, a223
  v_cvt_pk_bf16_f32 v136, v128, v129
  v_cvt_pk_bf16_f32 v137, v130, v131
  v_cvt_pk_bf16_f32 v138, v132, v133
  v_cvt_pk_bf16_f32 v139, v134, v135
  s_add_u32 s33, s41, 1572864
  buffer_store_dwordx4 v[136:139], v6, s[8:11], s33 offen offset:2048 sc1
  v_accvgpr_read_b32 v140, a248
  v_accvgpr_read_b32 v141, a249
  v_accvgpr_read_b32 v142, a250
  v_accvgpr_read_b32 v143, a251
  v_accvgpr_read_b32 v144, a252
  v_accvgpr_read_b32 v145, a253
  v_accvgpr_read_b32 v146, a254
  v_accvgpr_read_b32 v147, a255
  v_cvt_pk_bf16_f32 v148, v140, v141
  v_cvt_pk_bf16_f32 v149, v142, v143
  v_cvt_pk_bf16_f32 v150, v144, v145
  v_cvt_pk_bf16_f32 v151, v146, v147
  s_add_u32 s33, s41, 1572864
  buffer_store_dwordx4 v[148:151], v6, s[8:11], s33 offen offset:3072 sc1
  s_nop 1
L_kv_fin:
  s_waitcnt vmcnt(0) lgkmcnt(0)
  s_barrier
  buffer_store_dword v11, v7, s[8:11], s43 offen sc1
  s_mov_b32 s95, 0
  s_lshl_b32 s3, s95, 5
  s_add_u32 s3, s3, s91
  s_mul_i32 s4, s3, 52429
  s_lshr_b32 s4, s4, 18
  s_lshr_b32 s5, s3, 2
  s_cmp_eq_u32 s89, 5
  s_cselect_b32 s4, s4, s5
  s_mul_i32 s5, s4, s89
  s_sub_u32 s5, s3, s5
  s_add_u32 s5, s5, s88
  s_lshl_b32 s92, s4, 5
  s_add_u32 s92, s92, s5
  s_cmp_lt_u32 s4, 16
  s_cselect_b32 s92, s92, -1
  s_mov_b32 s95, 1
  s_lshl_b32 s3, s95, 5
  s_add_u32 s3, s3, s91
  s_mul_i32 s4, s3, 52429
  s_lshr_b32 s4, s4, 18
  s_lshr_b32 s5, s3, 2
  s_cmp_eq_u32 s89, 5
  s_cselect_b32 s4, s4, s5
  s_mul_i32 s5, s4, s89
  s_sub_u32 s5, s3, s5
  s_add_u32 s5, s5, s88
  s_lshl_b32 s93, s4, 5
  s_add_u32 s93, s93, s5
  s_cmp_lt_u32 s4, 16
  s_cselect_b32 s93, s93, -1
  s_mov_b32 s95, 2
  s_lshl_b32 s3, s95, 5
  s_add_u32 s3, s3, s91
  s_mul_i32 s4, s3, 52429
  s_lshr_b32 s4, s4, 18
  s_lshr_b32 s5, s3, 2
  s_cmp_eq_u32 s89, 5
  s_cselect_b32 s4, s4, s5
  s_mul_i32 s5, s4, s89
  s_sub_u32 s5, s3, s5
  s_add_u32 s5, s5, s88
  s_lshl_b32 s94, s4, 5
  s_add_u32 s94, s94, s5
  s_cmp_lt_u32 s4, 16
  s_cselect_b32 s94, s94, -1
  s_barrier
  v_add_u32 v156, 0, v1
  v_add_u32 v157, 0, v2
  v_add_u32 v158, 0, v3
  v_add_u32 v159, 49152, v1
  v_add_u32 v160, 49152, v2
  v_add_u32 v161, 49152, v3
  v_add_u32 v162, 98304, v1
  v_add_u32 v163, 98304, v2
  v_add_u32 v164, 98304, v3
  s_lshr_b32 s32, s92, 5
  s_lshl_b32 s35, s32, 17
  s_lshl_b32 s32, s28, 15
  s_add_u32 s35, s35, s32
  s_and_b32 s32, s92, 31
  s_lshl_b32 s36, s32, 8
  s_lshl_b32 s32, s28, 16
  s_add_u32 s36, s36, s32
  s_add_u32 m0, s39, 0
  s_add_u32 s34, s35, 0
  buffer_load_dwordx4 v4, s[12:15], s34 offen lds
  s_add_u32 m0, s39, 1024
  s_add_u32 s34, s35, 16384
  buffer_load_dwordx4 v4, s[12:15], s34 offen lds
  s_add_u32 m0, s40, 0
  s_add_u32 s34, s36, 0
  buffer_load_dwordx4 v5, s[16:19], s34 offen lds
  s_add_u32 m0, s40, 1024
  s_add_u32 s34, s36, 32768
  buffer_load_dwordx4 v5, s[16:19], s34 offen lds
  s_add_u32 s35, s35, 64
  s_add_u32 s36, s36, 262144
  s_add_u32 m0, s39, 24576
  s_add_u32 s34, s35, 0
  buffer_load_dwordx4 v4, s[12:15], s34 offen lds
  s_add_u32 m0, s39, 25600
  s_add_u32 s34, s35, 16384
  buffer_load_dwordx4 v4, s[12:15], s34 offen lds
  s_add_u32 m0, s40, 24576
  s_add_u32 s34, s36, 0
  buffer_load_dwordx4 v5, s[16:19], s34 offen lds
  s_add_u32 m0, s40, 25600
  s_add_u32 s34, s36, 32768
  buffer_load_dwordx4 v5, s[16:19], s34 offen lds
  s_add_u32 s35, s35, 64
  s_add_u32 s36, s36, 262144
  s_add_u32 m0, s39, 49152
  s_add_u32 s34, s35, 0
  buffer_load_dwordx4 v4, s[12:15], s34 offen lds
  s_add_u32 m0, s39, 50176
  s_add_u32 s34, s35, 16384
  buffer_load_dwordx4 v4, s[12:15], s34 offen lds
  s_add_u32 m0, s40, 49152
  s_add_u32 s34, s36, 0
  buffer_load_dwordx4 v5, s[16:19], s34 offen lds
  s_add_u32 m0, s40, 50176
  s_add_u32 s34, s36, 32768
  buffer_load_dwordx4 v5, s[16:19], s34 offen lds
  s_add_u32 s35, s35, 64
  s_add_u32 s36, s36, 262144
  s_add_u32 m0, s39, 73728
  s_add_u32 s34, s35, 0
  buffer_load_dwordx4 v4, s[12:15], s34 offen lds
  s_add_u32 m0, s39, 74752
  s_add_u32 s34, s35, 16384
  buffer_load_dwordx4 v4, s[12:15], s34 offen lds
  s_add_u32 m0, s40, 73728
  s_add_u32 s34, s36, 0
  buffer_load_dwordx4 v5, s[16:19], s34 offen lds
  s_add_u32 m0, s40, 74752
  s_add_u32 s34, s36, 32768
  buffer_load_dwordx4 v5, s[16:19], s34 offen lds
  s_add_u32 s35, s35, 64
  s_add_u32 s36, s36, 262144
  s_add_u32 m0, s39, 98304
  s_add_u32 s34, s35, 0
  buffer_load_dwordx4 v4, s[12:15], s34 offen lds
  s_add_u32 m0, s39, 99328
  s_add_u32 s34, s35, 16384
  buffer_load_dwordx4 v4, s[12:15], s34 offen lds
  s_add_u32 m0, s40, 98304
  s_add_u32 s34, s36, 0
  buffer_load_dwordx4 v5, s[16:19], s34 offen lds
  s_add_u32 m0, s40, 99328
  s_add_u32 s34, s36, 32768
  buffer_load_dwordx4 v5, s[16:19], s34 offen lds
  s_add_u32 s35, s35, 64
  s_add_u32 s36, s36, 262144
  s_waitcnt vmcnt(16)
  s_barrier
  ds_read_b64_tr_b16 v[96:97], v157 offset:0
  ds_read_b64_tr_b16 v[98:99], v157 offset:1024
  ds_read_b64_tr_b16 v[100:101], v158 offset:0
  ds_read_b64_tr_b16 v[102:103], v158 offset:1024
  ds_read_b128 v[32:35], v156 offset:0
  ds_read_b128 v[36:39], v156 offset:1024
  ds_read_b128 v[40:43], v156 offset:2048
  ds_read_b128 v[44:47], v156 offset:3072
  ds_read_b128 v[48:51], v156 offset:4096
  ds_read_b128 v[52:55], v156 offset:5120
  ds_read_b128 v[56:59], v156 offset:6144
  ds_read_b128 v[60:63], v156 offset:7168
  s_lshr_b32 s32, s93, 5
  s_lshl_b32 s37, s32, 17
  s_lshl_b32 s32, s28, 15
  s_add_u32 s37, s37, s32
  s_and_b32 s32, s93, 31
  s_lshl_b32 s38, s32, 8
  s_lshl_b32 s32, s28, 16
  s_add_u32 s38, s38, s32
  s_waitcnt vmcnt(12) lgkmcnt(0)
  s_barrier
  v_mfma_f32_16x16x32_bf16 a[0:3], v[96:99], v[32:35], 0
  ds_read_b64_tr_b16 v[112:113], v157 offset:24576
  v_mfma_f32_16x16x32_bf16 a[32:35], v[100:103], v[32:35], 0
  ds_read_b64_tr_b16 v[114:115], v157 offset:25600
  v_mfma_f32_16x16x32_bf16 a[4:7], v[96:99], v[36:39], 0
  s_add_u32 m0, s39, 122880
  s_add_u32 s34, s35, 0
  buffer_load_dwordx4 v4, s[12:15], s34 offen lds
  v_mfma_f32_16x16x32_bf16 a[36:39], v[100:103], v[36:39], 0
  ds_read_b64_tr_b16 v[116:117], v158 offset:24576
  v_mfma_f32_16x16x32_bf16 a[8:11], v[96:99], v[40:43], 0
  ds_read_b64_tr_b16 v[118:119], v158 offset:25600
  v_mfma_f32_16x16x32_bf16 a[40:43], v[100:103], v[40:43], 0
  s_add_u32 m0, s39, 123904
  s_add_u32 s34, s35, 16384
  buffer_load_dwordx4 v4, s[12:15], s34 offen lds
  v_mfma_f32_16x16x32_bf16 a[12:15], v[96:99], v[44:47], 0
  ds_read_b128 v[64:67], v156 offset:24576
  v_mfma_f32_16x16x32_bf16 a[44:47], v[100:103], v[44:47], 0
  ds_read_b128 v[68:71], v156 offset:25600
  v_mfma_f32_16x16x32_bf16 a[16:19], v[96:99], v[48:51], 0
  s_add_u32 m0, s40, 122880
  s_add_u32 s34, s36, 0
  buffer_load_dwordx4 v5, s[16:19], s34 offen lds
  v_mfma_f32_16x16x32_bf16 a[48:51], v[100:103], v[48:51], 0
  ds_read_b128 v[72:75], v156 offset:26624
  v_mfma_f32_16x16x32_bf16 a[20:23], v[96:99], v[52:55], 0
  ds_read_b128 v[76:79], v156 offset:27648
  v_mfma_f32_16x16x32_bf16 a[52:55], v[100:103], v[52:55], 0
  s_add_u32 m0, s40, 123904
  s_add_u32 s34, s36, 32768
  buffer_load_dwordx4 v5, s[16:19], s34 offen lds
  s_add_u32 s35, s35, 64
  s_add_u32 s36, s36, 262144
  v_mfma_f32_16x16x32_bf16 a[24:27], v[96:99], v[56:59], 0
  ds_read_b128 v[80:83], v156 offset:28672
  v_mfma_f32_16x16x32_bf16 a[56:59], v[100:103], v[56:59], 0
  ds_read_b128 v[84:87], v156 offset:29696
  v_mfma_f32_16x16x32_bf16 a[28:31], v[96:99], v[60:63], 0
  ds_read_b128 v[88:91], v156 offset:30720
  v_mfma_f32_16x16x32_bf16 a[60:63], v[100:103], v[60:63], 0
  ds_read_b128 v[92:95], v156 offset:31744
  s_waitcnt vmcnt(12) lgkmcnt(0)
  s_barrier
  v_mfma_f32_16x16x32_bf16 a[0:3], v[112:115], v[64:67], a[0:3]
  ds_read_b64_tr_b16 v[96:97], v160 offset:0
  v_mfma_f32_16x16x32_bf16 a[32:35], v[116:119], v[64:67], a[32:35]
  ds_read_b64_tr_b16 v[98:99], v160 offset:1024
  v_mfma_f32_16x16x32_bf16 a[4:7], v[112:115], v[68:71], a[4:7]
  s_add_u32 m0, s39, 0
  s_add_u32 s34, s35, 0
  buffer_load_dwordx4 v4, s[12:15], s34 offen lds
  v_mfma_f32_16x16x32_bf16 a[36:39], v[116:119], v[68:71], a[36:39]
  ds_read_b64_tr_b16 v[100:101], v161 offset:0
  v_mfma_f32_16x16x32_bf16 a[8:11], v[112:115], v[72:75], a[8:11]
  ds_read_b64_tr_b16 v[102:103], v161 offset:1024
  v_mfma_f32_16x16x32_bf16 a[40:43], v[116:119], v[72:75], a[40:43]
  s_add_u32 m0, s39, 1024
  s_add_u32 s34, s35, 16384
  buffer_load_dwordx4 v4, s[12:15], s34 offen lds
  v_mfma_f32_16x16x32_bf16 a[12:15], v[112:115], v[76:79], a[12:15]
  ds_read_b128 v[32:35], v159 offset:0
  v_mfma_f32_16x16x32_bf16 a[44:47], v[116:119], v[76:79], a[44:47]
  ds_read_b128 v[36:39], v159 offset:1024
  v_mfma_f32_16x16x32_bf16 a[16:19], v[112:115], v[80:83], a[16:19]
  s_add_u32 m0, s40, 0
  s_add_u32 s34, s36, 0
  buffer_load_dwordx4 v5, s[16:19], s34 offen lds
  v_mfma_f32_16x16x32_bf16 a[48:51], v[116:119], v[80:83], a[48:51]
  ds_read_b128 v[40:43], v159 offset:2048
  v_mfma_f32_16x16x32_bf16 a[20:23], v[112:115], v[84:87], a[20:23]
  ds_read_b128 v[44:47], v159 offset:3072
  v_mfma_f32_16x16x32_bf16 a[52:55], v[116:119], v[84:87], a[52:55]
  s_add_u32 m0, s40, 1024
  s_add_u32 s34, s36, 32768
  buffer_load_dwordx4 v5, s[16:19], s34 offen lds
  s_add_u32 s35, s35, 64
  s_add_u32 s36, s36, 262144
  v_mfma_f32_16x16x32_bf16 a[24:27], v[112:115], v[88:91], a[24:27]
  ds_read_b128 v[48:51], v159 offset:4096
  v_mfma_f32_16x16x32_bf16 a[56:59], v[116:119], v[88:91], a[56:59]
  ds_read_b128 v[52:55], v159 offset:5120
  v_mfma_f32_16x16x32_bf16 a[28:31], v[112:115], v[92:95], a[28:31]
  ds_read_b128 v[56:59], v159 offset:6144
  v_mfma_f32_16x16x32_bf16 a[60:63], v[116:119], v[92:95], a[60:63]
  ds_read_b128 v[60:63], v159 offset:7168
  s_waitcnt vmcnt(12) lgkmcnt(0)
  s_barrier
  v_mfma_f32_16x16x32_bf16 a[0:3], v[96:99], v[32:35], a[0:3]
  ds_read_b64_tr_b16 v[112:113], v160 offset:24576
  v_mfma_f32_16x16x32_bf16 a[32:35], v[100:103], v[32:35], a[32:35]
  ds_read_b64_tr_b16 v[114:115], v160 offset:25600
  v_mfma_f32_16x16x32_bf16 a[4:7], v[96:99], v[36:39], a[4:7]
  s_add_u32 m0, s39, 24576
  s_add_u32 s34, s35, 0
  buffer_load_dwordx4 v4, s[12:15], s34 offen lds
  v_mfma_f32_16x16x32_bf16 a[36:39], v[100:103], v[36:39], a[36:39]
  ds_read_b64_tr_b16 v[116:117], v161 offset:24576
  v_mfma_f32_16x16x32_bf16 a[8:11], v[96:99], v[40:43], a[8:11]
  ds_read_b64_tr_b16 v[118:119], v161 offset:25600
  v_mfma_f32_16x16x32_bf16 a[40:43], v[100:103], v[40:43], a[40:43]
  s_add_u32 m0, s39, 25600
  s_add_u32 s34, s35, 16384
  buffer_load_dwordx4 v4, s[12:15], s34 offen lds
  v_mfma_f32_16x16x32_bf16 a[12:15], v[96:99], v[44:47], a[12:15]
  ds_read_b128 v[64:67], v159 offset:24576
  v_mfma_f32_16x16x32_bf16 a[44:47], v[100:103], v[44:47], a[44:47]
  ds_read_b128 v[68:71], v159 offset:25600
  v_mfma_f32_16x16x32_bf16 a[16:19], v[96:99], v[48:51], a[16:19]
  s_add_u32 m0, s40, 24576
  s_add_u32 s34, s36, 0
  buffer_load_dwordx4 v5, s[16:19], s34 offen lds
  v_mfma_f32_16x16x32_bf16 a[48:51], v[100:103], v[48:51], a[48:51]
  ds_read_b128 v[72:75], v159 offset:26624
  v_mfma_f32_16x16x32_bf16 a[20:23], v[96:99], v[52:55], a[20:23]
  ds_read_b128 v[76:79], v159 offset:27648
  v_mfma_f32_16x16x32_bf16 a[52:55], v[100:103], v[52:55], a[52:55]
  s_add_u32 m0, s40, 25600
  s_add_u32 s34, s36, 32768
  buffer_load_dwordx4 v5, s[16:19], s34 offen lds
  s_add_u32 s35, s35, 64
  s_add_u32 s36, s36, 262144
  v_mfma_f32_16x16x32_bf16 a[24:27], v[96:99], v[56:59], a[24:27]
  ds_read_b128 v[80:83], v159 offset:28672
  v_mfma_f32_16x16x32_bf16 a[56:59], v[100:103], v[56:59], a[56:59]
  ds_read_b128 v[84:87], v159 offset:29696
  v_mfma_f32_16x16x32_bf16 a[28:31], v[96:99], v[60:63], a[28:31]
  ds_read_b128 v[88:91], v159 offset:30720
  v_mfma_f32_16x16x32_bf16 a[60:63], v[100:103], v[60:63], a[60:63]
  ds_read_b128 v[92:95], v159 offset:31744
  s_waitcnt vmcnt(12) lgkmcnt(0)
  s_barrier
  v_mfma_f32_16x16x32_bf16 a[0:3], v[112:115], v[64:67], a[0:3]
  ds_read_b64_tr_b16 v[96:97], v163 offset:0
  v_mfma_f32_16x16x32_bf16 a[32:35], v[116:119], v[64:67], a[32:35]
  ds_read_b64_tr_b16 v[98:99], v163 offset:1024
  v_mfma_f32_16x16x32_bf16 a[4:7], v[112:115], v[68:71], a[4:7]
  s_add_u32 m0, s39, 49152
  s_add_u32 s34, s35, 0
  buffer_load_dwordx4 v4, s[12:15], s34 offen lds
  v_mfma_f32_16x16x32_bf16 a[36:39], v[116:119], v[68:71], a[36:39]
  ds_read_b64_tr_b16 v[100:101], v164 offset:0
  v_mfma_f32_16x16x32_bf16 a[8:11], v[112:115], v[72:75], a[8:11]
  ds_read_b64_tr_b16 v[102:103], v164 offset:1024
  v_mfma_f32_16x16x32_bf16 a[40:43], v[116:119], v[72:75], a[40:43]
  s_add_u32 m0, s39, 50176
  s_add_u32 s34, s35, 16384
  buffer_load_dwordx4 v4, s[12:15], s34 offen lds
  v_mfma_f32_16x16x32_bf16 a[12:15], v[112:115], v[76:79], a[12:15]
  ds_read_b128 v[32:35], v162 offset:0
  v_mfma_f32_16x16x32_bf16 a[44:47], v[116:119], v[76:79], a[44:47]
  ds_read_b128 v[36:39], v162 offset:1024
  v_mfma_f32_16x16x32_bf16 a[16:19], v[112:115], v[80:83], a[16:19]
  s_add_u32 m0, s40, 49152
  s_add_u32 s34, s36, 0
  buffer_load_dwordx4 v5, s[16:19], s34 offen lds
  v_mfma_f32_16x16x32_bf16 a[48:51], v[116:119], v[80:83], a[48:51]
  ds_read_b128 v[40:43], v162 offset:2048
  v_mfma_f32_16x16x32_bf16 a[20:23], v[112:115], v[84:87], a[20:23]
  ds_read_b128 v[44:47], v162 offset:3072
  v_mfma_f32_16x16x32_bf16 a[52:55], v[116:119], v[84:87], a[52:55]
  s_add_u32 m0, s40, 50176
  s_add_u32 s34, s36, 32768
  buffer_load_dwordx4 v5, s[16:19], s34 offen lds
  s_add_u32 s35, s35, 64
  s_add_u32 s36, s36, 262144
  v_mfma_f32_16x16x32_bf16 a[24:27], v[112:115], v[88:91], a[24:27]
  ds_read_b128 v[48:51], v162 offset:4096
  v_mfma_f32_16x16x32_bf16 a[56:59], v[116:119], v[88:91], a[56:59]
  ds_read_b128 v[52:55], v162 offset:5120
  v_mfma_f32_16x16x32_bf16 a[28:31], v[112:115], v[92:95], a[28:31]
  ds_read_b128 v[56:59], v162 offset:6144
  v_mfma_f32_16x16x32_bf16 a[60:63], v[116:119], v[92:95], a[60:63]
  ds_read_b128 v[60:63], v162 offset:7168
  s_waitcnt vmcnt(12) lgkmcnt(0)
  s_barrier
  v_mfma_f32_16x16x32_bf16 a[0:3], v[96:99], v[32:35], a[0:3]
  ds_read_b64_tr_b16 v[112:113], v163 offset:24576
  v_mfma_f32_16x16x32_bf16 a[32:35], v[100:103], v[32:35], a[32:35]
  ds_read_b64_tr_b16 v[114:115], v163 offset:25600
  v_mfma_f32_16x16x32_bf16 a[4:7], v[96:99], v[36:39], a[4:7]
  s_add_u32 m0, s39, 73728
  s_add_u32 s34, s35, 0
  buffer_load_dwordx4 v4, s[12:15], s34 offen lds
  v_mfma_f32_16x16x32_bf16 a[36:39], v[100:103], v[36:39], a[36:39]
  ds_read_b64_tr_b16 v[116:117], v164 offset:24576
  v_mfma_f32_16x16x32_bf16 a[8:11], v[96:99], v[40:43], a[8:11]
  ds_read_b64_tr_b16 v[118:119], v164 offset:25600
  v_mfma_f32_16x16x32_bf16 a[40:43], v[100:103], v[40:43], a[40:43]
  s_add_u32 m0, s39, 74752
  s_add_u32 s34, s35, 16384
  buffer_load_dwordx4 v4, s[12:15], s34 offen lds
  v_mfma_f32_16x16x32_bf16 a[12:15], v[96:99], v[44:47], a[12:15]
  ds_read_b128 v[64:67], v162 offset:24576
  v_mfma_f32_16x16x32_bf16 a[44:47], v[100:103], v[44:47], a[44:47]
  ds_read_b128 v[68:71], v162 offset:25600
  v_mfma_f32_16x16x32_bf16 a[16:19], v[96:99], v[48:51], a[16:19]
  s_add_u32 m0, s40, 73728
  s_add_u32 s34, s36, 0
  buffer_load_dwordx4 v5, s[16:19], s34 offen lds
  v_mfma_f32_16x16x32_bf16 a[48:51], v[100:103], v[48:51], a[48:51]
  ds_read_b128 v[72:75], v162 offset:26624
  v_mfma_f32_16x16x32_bf16 a[20:23], v[96:99], v[52:55], a[20:23]
  ds_read_b128 v[76:79], v162 offset:27648
  v_mfma_f32_16x16x32_bf16 a[52:55], v[100:103], v[52:55], a[52:55]
  s_add_u32 m0, s40, 74752
  s_add_u32 s34, s36, 32768
  buffer_load_dwordx4 v5, s[16:19], s34 offen lds
  s_add_u32 s35, s35, 64
  s_add_u32 s36, s36, 262144
  v_mfma_f32_16x16x32_bf16 a[24:27], v[96:99], v[56:59], a[24:27]
  ds_read_b128 v[80:83], v162 offset:28672
  v_mfma_f32_16x16x32_bf16 a[56:59], v[100:103], v[56:59], a[56:59]
  ds_read_b128 v[84:87], v162 offset:29696
  v_mfma_f32_16x16x32_bf16 a[28:31], v[96:99], v[60:63], a[28:31]
  ds_read_b128 v[88:91], v162 offset:30720
  v_mfma_f32_16x16x32_bf16 a[60:63], v[100:103], v[60:63], a[60:63]
  ds_read_b128 v[92:95], v162 offset:31744
  s_waitcnt vmcnt(12) lgkmcnt(0)
  s_barrier
  v_mfma_f32_16x16x32_bf16 a[0:3], v[112:115], v[64:67], a[0:3]
  ds_read_b64_tr_b16 v[96:97], v157 offset:0
  v_mfma_f32_16x16x32_bf16 a[32:35], v[116:119], v[64:67], a[32:35]
  ds_read_b64_tr_b16 v[98:99], v157 offset:1024
  v_mfma_f32_16x16x32_bf16 a[4:7], v[112:115], v[68:71], a[4:7]
  s_add_u32 m0, s39, 98304
  s_add_u32 s34, s35, 0
  buffer_load_dwordx4 v4, s[12:15], s34 offen lds
  v_mfma_f32_16x16x32_bf16 a[36:39], v[116:119], v[68:71], a[36:39]
  ds_read_b64_tr_b16 v[100:101], v158 offset:0
  v_mfma_f32_16x16x32_bf16 a[8:11], v[112:115], v[72:75], a[8:11]
  ds_read_b64_tr_b16 v[102:103], v158 offset:1024
  v_mfma_f32_16x16x32_bf16 a[40:43], v[116:119], v[72:75], a[40:43]
  s_add_u32 m0, s39, 99328
  s_add_u32 s34, s35, 16384
  buffer_load_dwordx4 v4, s[12:15], s34 offen lds
  v_mfma_f32_16x16x32_bf16 a[12:15], v[112:115], v[76:79], a[12:15]
  ds_read_b128 v[32:35], v156 offset:0
  v_mfma_f32_16x16x32_bf16 a[44:47], v[116:119], v[76:79], a[44:47]
  ds_read_b128 v[36:39], v156 offset:1024
  v_mfma_f32_16x16x32_bf16 a[16:19], v[112:115], v[80:83], a[16:19]
  s_add_u32 m0, s40, 98304
  s_add_u32 s34, s36, 0
  buffer_load_dwordx4 v5, s[16:19], s34 offen lds
  v_mfma_f32_16x16x32_bf16 a[48:51], v[116:119], v[80:83], a[48:51]
  ds_read_b128 v[40:43], v156 offset:2048
  v_mfma_f32_16x16x32_bf16 a[20:23], v[112:115], v[84:87], a[20:23]
  ds_read_b128 v[44:47], v156 offset:3072
  v_mfma_f32_16x16x32_bf16 a[52:55], v[116:119], v[84:87], a[52:55]
  s_add_u32 m0, s40, 99328
  s_add_u32 s34, s36, 32768
  buffer_load_dwordx4 v5, s[16:19], s34 offen lds
  s_add_u32 s35, s35, 64
  s_add_u32 s36, s36, 262144
  v_mfma_f32_16x16x32_bf16 a[24:27], v[112:115], v[88:91], a[24:27]
  ds_read_b128 v[48:51], v156 offset:4096
  v_mfma_f32_16x16x32_bf16 a[56:59], v[116:119], v[88:91], a[56:59]
  ds_read_b128 v[52:55], v156 offset:5120
  v_mfma_f32_16x16x32_bf16 a[28:31], v[112:115], v[92:95], a[28:31]
  ds_read_b128 v[56:59], v156 offset:6144
  v_mfma_f32_16x16x32_bf16 a[60:63], v[116:119], v[92:95], a[60:63]
  ds_read_b128 v[60:63], v156 offset:7168
  s_waitcnt vmcnt(12) lgkmcnt(0)
  s_barrier
  v_mfma_f32_16x16x32_bf16 a[0:3], v[96:99], v[32:35], a[0:3]
  ds_read_b64_tr_b16 v[112:113], v157 offset:24576
  v_mfma_f32_16x16x32_bf16 a[32:35], v[100:103], v[32:35], a[32:35]
  ds_read_b64_tr_b16 v[114:115], v157 offset:25600
  v_mfma_f32_16x16x32_bf16 a[4:7], v[96:99], v[36:39], a[4:7]
  s_add_u32 m0, s39, 122880
  s_add_u32 s34, s35, 0
  buffer_load_dwordx4 v4, s[12:15], s34 offen lds
  v_mfma_f32_16x16x32_bf16 a[36:39], v[100:103], v[36:39], a[36:39]
  ds_read_b64_tr_b16 v[116:117], v158 offset:24576
  v_mfma_f32_16x16x32_bf16 a[8:11], v[96:99], v[40:43], a[8:11]
  ds_read_b64_tr_b16 v[118:119], v158 offset:25600
  v_mfma_f32_16x16x32_bf16 a[40:43], v[100:103], v[40:43], a[40:43]
  s_add_u32 m0, s39, 123904
  s_add_u32 s34, s35, 16384
  buffer_load_dwordx4 v4, s[12:15], s34 offen lds
  v_mfma_f32_16x16x32_bf16 a[12:15], v[96:99], v[44:47], a[12:15]
  ds_read_b128 v[64:67], v156 offset:24576
  v_mfma_f32_16x16x32_bf16 a[44:47], v[100:103], v[44:47], a[44:47]
  ds_read_b128 v[68:71], v156 offset:25600
  v_mfma_f32_16x16x32_bf16 a[16:19], v[96:99], v[48:51], a[16:19]
  s_add_u32 m0, s40, 122880
  s_add_u32 s34, s36, 0
  buffer_load_dwordx4 v5, s[16:19], s34 offen lds
  v_mfma_f32_16x16x32_bf16 a[48:51], v[100:103], v[48:51], a[48:51]
  ds_read_b128 v[72:75], v156 offset:26624
  v_mfma_f32_16x16x32_bf16 a[20:23], v[96:99], v[52:55], a[20:23]
  ds_read_b128 v[76:79], v156 offset:27648
  v_mfma_f32_16x16x32_bf16 a[52:55], v[100:103], v[52:55], a[52:55]
  s_add_u32 m0, s40, 123904
  s_add_u32 s34, s36, 32768
  buffer_load_dwordx4 v5, s[16:19], s34 offen lds
  s_add_u32 s35, s35, 64
  s_add_u32 s36, s36, 262144
  v_mfma_f32_16x16x32_bf16 a[24:27], v[96:99], v[56:59], a[24:27]
  ds_read_b128 v[80:83], v156 offset:28672
  v_mfma_f32_16x16x32_bf16 a[56:59], v[100:103], v[56:59], a[56:59]
  ds_read_b128 v[84:87], v156 offset:29696
  v_mfma_f32_16x16x32_bf16 a[28:31], v[96:99], v[60:63], a[28:31]
  ds_read_b128 v[88:91], v156 offset:30720
  v_mfma_f32_16x16x32_bf16 a[60:63], v[100:103], v[60:63], a[60:63]
  ds_read_b128 v[92:95], v156 offset:31744
  s_waitcnt vmcnt(12) lgkmcnt(0)
  s_barrier
  v_mfma_f32_16x16x32_bf16 a[0:3], v[112:115], v[64:67], a[0:3]
  ds_read_b64_tr_b16 v[96:97], v160 offset:0
  v_mfma_f32_16x16x32_bf16 a[32:35], v[116:119], v[64:67], a[32:35]
  ds_read_b64_tr_b16 v[98:99], v160 offset:1024
  v_mfma_f32_16x16x32_bf16 a[4:7], v[112:115], v[68:71], a[4:7]
  s_add_u32 m0, s39, 0
  s_add_u32 s34, s35, 0
  buffer_load_dwordx4 v4, s[12:15], s34 offen lds
  v_mfma_f32_16x16x32_bf16 a[36:39], v[116:119], v[68:71], a[36:39]
  ds_read_b64_tr_b16 v[100:101], v161 offset:0
  v_mfma_f32_16x16x32_bf16 a[8:11], v[112:115], v[72:75], a[8:11]
  ds_read_b64_tr_b16 v[102:103], v161 offset:1024
  v_mfma_f32_16x16x32_bf16 a[40:43], v[116:119], v[72:75], a[40:43]
  s_add_u32 m0, s39, 1024
  s_add_u32 s34, s35, 16384
  buffer_load_dwordx4 v4, s[12:15], s34 offen lds
  v_mfma_f32_16x16x32_bf16 a[12:15], v[112:115], v[76:79], a[12:15]
  ds_read_b128 v[32:35], v159 offset:0
  v_mfma_f32_16x16x32_bf16 a[44:47], v[116:119], v[76:79], a[44:47]
  ds_read_b128 v[36:39], v159 offset:1024
  v_mfma_f32_16x16x32_bf16 a[16:19], v[112:115], v[80:83], a[16:19]
  s_add_u32 m0, s40, 0
  s_add_u32 s34, s36, 0
  buffer_load_dwordx4 v5, s[16:19], s34 offen lds
  v_mfma_f32_16x16x32_bf16 a[48:51], v[116:119], v[80:83], a[48:51]
  ds_read_b128 v[40:43], v159 offset:2048
  v_mfma_f32_16x16x32_bf16 a[20:23], v[112:115], v[84:87], a[20:23]
  ds_read_b128 v[44:47], v159 offset:3072
  v_mfma_f32_16x16x32_bf16 a[52:55], v[116:119], v[84:87], a[52:55]
  s_add_u32 m0, s40, 1024
  s_add_u32 s34, s36, 32768
  buffer_load_dwordx4 v5, s[16:19], s34 offen lds
  s_add_u32 s35, s35, 64
  s_add_u32 s36, s36, 262144
  v_mfma_f32_16x16x32_bf16 a[24:27], v[112:115], v[88:91], a[24:27]
  ds_read_b128 v[48:51], v159 offset:4096
  v_mfma_f32_16x16x32_bf16 a[56:59], v[116:119], v[88:91], a[56:59]
  ds_read_b128 v[52:55], v159 offset:5120
  v_mfma_f32_16x16x32_bf16 a[28:31], v[112:115], v[92:95], a[28:31]
  ds_read_b128 v[56:59], v159 offset:6144
  v_mfma_f32_16x16x32_bf16 a[60:63], v[116:119], v[92:95], a[60:63]
  ds_read_b128 v[60:63], v159 offset:7168
  s_waitcnt vmcnt(12) lgkmcnt(0)
  s_barrier
  v_mfma_f32_16x16x32_bf16 a[0:3], v[96:99], v[32:35], a[0:3]
  ds_read_b64_tr_b16 v[112:113], v160 offset:24576
  v_mfma_f32_16x16x32_bf16 a[32:35], v[100:103], v[32:35], a[32:35]
  ds_read_b64_tr_b16 v[114:115], v160 offset:25600
  v_mfma_f32_16x16x32_bf16 a[4:7], v[96:99], v[36:39], a[4:7]
  s_add_u32 m0, s39, 24576
  s_add_u32 s34, s35, 0
  buffer_load_dwordx4 v4, s[12:15], s34 offen lds
  v_mfma_f32_16x16x32_bf16 a[36:39], v[100:103], v[36:39], a[36:39]
  ds_read_b64_tr_b16 v[116:117], v161 offset:24576
  v_mfma_f32_16x16x32_bf16 a[8:11], v[96:99], v[40:43], a[8:11]
  ds_read_b64_tr_b16 v[118:119], v161 offset:25600
  v_mfma_f32_16x16x32_bf16 a[40:43], v[100:103], v[40:43], a[40:43]
  s_add_u32 m0, s39, 25600
  s_add_u32 s34, s35, 16384
  buffer_load_dwordx4 v4, s[12:15], s34 offen lds
  v_mfma_f32_16x16x32_bf16 a[12:15], v[96:99], v[44:47], a[12:15]
  ds_read_b128 v[64:67], v159 offset:24576
  v_mfma_f32_16x16x32_bf16 a[44:47], v[100:103], v[44:47], a[44:47]
  ds_read_b128 v[68:71], v159 offset:25600
  v_mfma_f32_16x16x32_bf16 a[16:19], v[96:99], v[48:51], a[16:19]
  s_add_u32 m0, s40, 24576
  s_add_u32 s34, s36, 0
  buffer_load_dwordx4 v5, s[16:19], s34 offen lds
  v_mfma_f32_16x16x32_bf16 a[48:51], v[100:103], v[48:51], a[48:51]
  ds_read_b128 v[72:75], v159 offset:26624
  v_mfma_f32_16x16x32_bf16 a[20:23], v[96:99], v[52:55], a[20:23]
  ds_read_b128 v[76:79], v159 offset:27648
  v_mfma_f32_16x16x32_bf16 a[52:55], v[100:103], v[52:55], a[52:55]
  s_add_u32 m0, s40, 25600
  s_add_u32 s34, s36, 32768
  buffer_load_dwordx4 v5, s[16:19], s34 offen lds
  s_add_u32 s35, s35, 64
  s_add_u32 s36, s36, 262144
  v_mfma_f32_16x16x32_bf16 a[24:27], v[96:99], v[56:59], a[24:27]
  ds_read_b128 v[80:83], v159 offset:28672
  v_mfma_f32_16x16x32_bf16 a[56:59], v[100:103], v[56:59], a[56:59]
  ds_read_b128 v[84:87], v159 offset:29696
  v_mfma_f32_16x16x32_bf16 a[28:31], v[96:99], v[60:63], a[28:31]
  ds_read_b128 v[88:91], v159 offset:30720
  v_mfma_f32_16x16x32_bf16 a[60:63], v[100:103], v[60:63], a[60:63]
  ds_read_b128 v[92:95], v159 offset:31744
  s_waitcnt vmcnt(12) lgkmcnt(0)
  s_barrier
  v_mfma_f32_16x16x32_bf16 a[0:3], v[112:115], v[64:67], a[0:3]
  ds_read_b64_tr_b16 v[96:97], v163 offset:0
  v_mfma_f32_16x16x32_bf16 a[32:35], v[116:119], v[64:67], a[32:35]
  ds_read_b64_tr_b16 v[98:99], v163 offset:1024
  v_mfma_f32_16x16x32_bf16 a[4:7], v[112:115], v[68:71], a[4:7]
  s_add_u32 m0, s39, 49152
  s_add_u32 s34, s35, 0
  buffer_load_dwordx4 v4, s[12:15], s34 offen lds
  v_mfma_f32_16x16x32_bf16 a[36:39], v[116:119], v[68:71], a[36:39]
  ds_read_b64_tr_b16 v[100:101], v164 offset:0
  v_mfma_f32_16x16x32_bf16 a[8:11], v[112:115], v[72:75], a[8:11]
  ds_read_b64_tr_b16 v[102:103], v164 offset:1024
  v_mfma_f32_16x16x32_bf16 a[40:43], v[116:119], v[72:75], a[40:43]
  s_add_u32 m0, s39, 50176
  s_add_u32 s34, s35, 16384
  buffer_load_dwordx4 v4, s[12:15], s34 offen lds
  v_mfma_f32_16x16x32_bf16 a[12:15], v[112:115], v[76:79], a[12:15]
  ds_read_b128 v[32:35], v162 offset:0
  v_mfma_f32_16x16x32_bf16 a[44:47], v[116:119], v[76:79], a[44:47]
  ds_read_b128 v[36:39], v162 offset:1024
  v_mfma_f32_16x16x32_bf16 a[16:19], v[112:115], v[80:83], a[16:19]
  s_add_u32 m0, s40, 49152
  s_add_u32 s34, s36, 0
  buffer_load_dwordx4 v5, s[16:19], s34 offen lds
  v_mfma_f32_16x16x32_bf16 a[48:51], v[116:119], v[80:83], a[48:51]
  ds_read_b128 v[40:43], v162 offset:2048
  v_mfma_f32_16x16x32_bf16 a[20:23], v[112:115], v[84:87], a[20:23]
  ds_read_b128 v[44:47], v162 offset:3072
  v_mfma_f32_16x16x32_bf16 a[52:55], v[116:119], v[84:87], a[52:55]
  s_add_u32 m0, s40, 50176
  s_add_u32 s34, s36, 32768
  buffer_load_dwordx4 v5, s[16:19], s34 offen lds
  s_add_u32 s35, s35, 64
  s_add_u32 s36, s36, 262144
  v_mfma_f32_16x16x32_bf16 a[24:27], v[112:115], v[88:91], a[24:27]
  ds_read_b128 v[48:51], v162 offset:4096
  v_mfma_f32_16x16x32_bf16 a[56:59], v[116:119], v[88:91], a[56:59]
  ds_read_b128 v[52:55], v162 offset:5120
  v_mfma_f32_16x16x32_bf16 a[28:31], v[112:115], v[92:95], a[28:31]
  ds_read_b128 v[56:59], v162 offset:6144
  v_mfma_f32_16x16x32_bf16 a[60:63], v[116:119], v[92:95], a[60:63]
  ds_read_b128 v[60:63], v162 offset:7168
  s_waitcnt vmcnt(12) lgkmcnt(0)
  s_barrier
  v_mfma_f32_16x16x32_bf16 a[0:3], v[96:99], v[32:35], a[0:3]
  ds_read_b64_tr_b16 v[112:113], v163 offset:24576
  v_mfma_f32_16x16x32_bf16 a[32:35], v[100:103], v[32:35], a[32:35]
  ds_read_b64_tr_b16 v[114:115], v163 offset:25600
  v_mfma_f32_16x16x32_bf16 a[4:7], v[96:99], v[36:39], a[4:7]
  s_add_u32 m0, s39, 73728
  s_add_u32 s34, s35, 0
  buffer_load_dwordx4 v4, s[12:15], s34 offen lds
  v_mfma_f32_16x16x32_bf16 a[36:39], v[100:103], v[36:39], a[36:39]
  ds_read_b64_tr_b16 v[116:117], v164 offset:24576
  v_mfma_f32_16x16x32_bf16 a[8:11], v[96:99], v[40:43], a[8:11]
  ds_read_b64_tr_b16 v[118:119], v164 offset:25600
  v_mfma_f32_16x16x32_bf16 a[40:43], v[100:103], v[40:43], a[40:43]
  s_add_u32 m0, s39, 74752
  s_add_u32 s34, s35, 16384
  buffer_load_dwordx4 v4, s[12:15], s34 offen lds
  v_mfma_f32_16x16x32_bf16 a[12:15], v[96:99], v[44:47], a[12:15]
  ds_read_b128 v[64:67], v162 offset:24576
  v_mfma_f32_16x16x32_bf16 a[44:47], v[100:103], v[44:47], a[44:47]
  ds_read_b128 v[68:71], v162 offset:25600
  v_mfma_f32_16x16x32_bf16 a[16:19], v[96:99], v[48:51], a[16:19]
  s_add_u32 m0, s40, 73728
  s_add_u32 s34, s36, 0
  buffer_load_dwordx4 v5, s[16:19], s34 offen lds
  v_mfma_f32_16x16x32_bf16 a[48:51], v[100:103], v[48:51], a[48:51]
  ds_read_b128 v[72:75], v162 offset:26624
  v_mfma_f32_16x16x32_bf16 a[20:23], v[96:99], v[52:55], a[20:23]
  ds_read_b128 v[76:79], v162 offset:27648
  v_mfma_f32_16x16x32_bf16 a[52:55], v[100:103], v[52:55], a[52:55]
  s_add_u32 m0, s40, 74752
  s_add_u32 s34, s36, 32768
  buffer_load_dwordx4 v5, s[16:19], s34 offen lds
  s_add_u32 s35, s35, 64
  s_add_u32 s36, s36, 262144
  v_mfma_f32_16x16x32_bf16 a[24:27], v[96:99], v[56:59], a[24:27]
  ds_read_b128 v[80:83], v162 offset:28672
  v_mfma_f32_16x16x32_bf16 a[56:59], v[100:103], v[56:59], a[56:59]
  ds_read_b128 v[84:87], v162 offset:29696
  v_mfma_f32_16x16x32_bf16 a[28:31], v[96:99], v[60:63], a[28:31]
  ds_read_b128 v[88:91], v162 offset:30720
  v_mfma_f32_16x16x32_bf16 a[60:63], v[100:103], v[60:63], a[60:63]
  ds_read_b128 v[92:95], v162 offset:31744
  s_waitcnt vmcnt(12) lgkmcnt(0)
  s_barrier
  s_mov_b32 s35, s37
  s_mov_b32 s36, s38
  v_mfma_f32_16x16x32_bf16 a[0:3], v[112:115], v[64:67], a[0:3]
  ds_read_b64_tr_b16 v[96:97], v157 offset:0
  v_mfma_f32_16x16x32_bf16 a[32:35], v[116:119], v[64:67], a[32:35]
  ds_read_b64_tr_b16 v[98:99], v157 offset:1024
  v_mfma_f32_16x16x32_bf16 a[4:7], v[112:115], v[68:71], a[4:7]
  s_add_u32 m0, s39, 98304
  s_add_u32 s34, s35, 0
  buffer_load_dwordx4 v4, s[12:15], s34 offen lds
  v_mfma_f32_16x16x32_bf16 a[36:39], v[116:119], v[68:71], a[36:39]
  ds_read_b64_tr_b16 v[100:101], v158 offset:0
  v_mfma_f32_16x16x32_bf16 a[8:11], v[112:115], v[72:75], a[8:11]
  ds_read_b64_tr_b16 v[102:103], v158 offset:1024
  v_mfma_f32_16x16x32_bf16 a[40:43], v[116:119], v[72:75], a[40:43]
  s_add_u32 m0, s39, 99328
  s_add_u32 s34, s35, 16384
  buffer_load_dwordx4 v4, s[12:15], s34 offen lds
  v_mfma_f32_16x16x32_bf16 a[12:15], v[112:115], v[76:79], a[12:15]
  ds_read_b128 v[32:35], v156 offset:0
  v_mfma_f32_16x16x32_bf16 a[44:47], v[116:119], v[76:79], a[44:47]
  ds_read_b128 v[36:39], v156 offset:1024
  v_mfma_f32_16x16x32_bf16 a[16:19], v[112:115], v[80:83], a[16:19]
  s_add_u32 m0, s40, 98304
  s_add_u32 s34, s36, 0
  buffer_load_dwordx4 v5, s[16:19], s34 offen lds
  v_mfma_f32_16x16x32_bf16 a[48:51], v[116:119], v[80:83], a[48:51]
  ds_read_b128 v[40:43], v156 offset:2048
  v_mfma_f32_16x16x32_bf16 a[20:23], v[112:115], v[84:87], a[20:23]
  ds_read_b128 v[44:47], v156 offset:3072
  v_mfma_f32_16x16x32_bf16 a[52:55], v[116:119], v[84:87], a[52:55]
  s_add_u32 m0, s40, 99328
  s_add_u32 s34, s36, 32768
  buffer_load_dwordx4 v5, s[16:19], s34 offen lds
  s_add_u32 s35, s35, 64
  s_add_u32 s36, s36, 262144
  v_mfma_f32_16x16x32_bf16 a[24:27], v[112:115], v[88:91], a[24:27]
  ds_read_b128 v[48:51], v156 offset:4096
  v_mfma_f32_16x16x32_bf16 a[56:59], v[116:119], v[88:91], a[56:59]
  ds_read_b128 v[52:55], v156 offset:5120
  v_mfma_f32_16x16x32_bf16 a[28:31], v[112:115], v[92:95], a[28:31]
  ds_read_b128 v[56:59], v156 offset:6144
  v_mfma_f32_16x16x32_bf16 a[60:63], v[116:119], v[92:95], a[60:63]
  ds_read_b128 v[60:63], v156 offset:7168
  s_waitcnt vmcnt(12) lgkmcnt(0)
  s_barrier
  v_mfma_f32_16x16x32_bf16 a[0:3], v[96:99], v[32:35], a[0:3]
  ds_read_b64_tr_b16 v[112:113], v157 offset:24576
  v_mfma_f32_16x16x32_bf16 a[32:35], v[100:103], v[32:35], a[32:35]
  ds_read_b64_tr_b16 v[114:115], v157 offset:25600
  v_mfma_f32_16x16x32_bf16 a[4:7], v[96:99], v[36:39], a[4:7]
  s_add_u32 m0, s39, 122880
  s_add_u32 s34, s35, 0
  buffer_load_dwordx4 v4, s[12:15], s34 offen lds
  v_mfma_f32_16x16x32_bf16 a[36:39], v[100:103], v[36:39], a[36:39]
  ds_read_b64_tr_b16 v[116:117], v158 offset:24576
  v_mfma_f32_16x16x32_bf16 a[8:11], v[96:99], v[40:43], a[8:11]
  ds_read_b64_tr_b16 v[118:119], v158 offset:25600
  v_mfma_f32_16x16x32_bf16 a[40:43], v[100:103], v[40:43], a[40:43]
  s_add_u32 m0, s39, 123904
  s_add_u32 s34, s35, 16384
  buffer_load_dwordx4 v4, s[12:15], s34 offen lds
  v_mfma_f32_16x16x32_bf16 a[12:15], v[96:99], v[44:47], a[12:15]
  ds_read_b128 v[64:67], v156 offset:24576
  v_mfma_f32_16x16x32_bf16 a[44:47], v[100:103], v[44:47], a[44:47]
  ds_read_b128 v[68:71], v156 offset:25600
  v_mfma_f32_16x16x32_bf16 a[16:19], v[96:99], v[48:51], a[16:19]
  s_add_u32 m0, s40, 122880
  s_add_u32 s34, s36, 0
  buffer_load_dwordx4 v5, s[16:19], s34 offen lds
  v_mfma_f32_16x16x32_bf16 a[48:51], v[100:103], v[48:51], a[48:51]
  ds_read_b128 v[72:75], v156 offset:26624
  v_mfma_f32_16x16x32_bf16 a[20:23], v[96:99], v[52:55], a[20:23]
  ds_read_b128 v[76:79], v156 offset:27648
  v_mfma_f32_16x16x32_bf16 a[52:55], v[100:103], v[52:55], a[52:55]
  s_add_u32 m0, s40, 123904
  s_add_u32 s34, s36, 32768
  buffer_load_dwordx4 v5, s[16:19], s34 offen lds
  s_add_u32 s35, s35, 64
  s_add_u32 s36, s36, 262144
  v_mfma_f32_16x16x32_bf16 a[24:27], v[96:99], v[56:59], a[24:27]
  ds_read_b128 v[80:83], v156 offset:28672
  v_mfma_f32_16x16x32_bf16 a[56:59], v[100:103], v[56:59], a[56:59]
  ds_read_b128 v[84:87], v156 offset:29696
  v_mfma_f32_16x16x32_bf16 a[28:31], v[96:99], v[60:63], a[28:31]
  ds_read_b128 v[88:91], v156 offset:30720
  v_mfma_f32_16x16x32_bf16 a[60:63], v[100:103], v[60:63], a[60:63]
  ds_read_b128 v[92:95], v156 offset:31744
  s_waitcnt vmcnt(12) lgkmcnt(0)
  s_barrier
  v_mfma_f32_16x16x32_bf16 a[0:3], v[112:115], v[64:67], a[0:3]
  ds_read_b64_tr_b16 v[96:97], v160 offset:0
  v_mfma_f32_16x16x32_bf16 a[32:35], v[116:119], v[64:67], a[32:35]
  ds_read_b64_tr_b16 v[98:99], v160 offset:1024
  v_mfma_f32_16x16x32_bf16 a[4:7], v[112:115], v[68:71], a[4:7]
  s_add_u32 m0, s39, 0
  s_add_u32 s34, s35, 0
  buffer_load_dwordx4 v4, s[12:15], s34 offen lds
  v_mfma_f32_16x16x32_bf16 a[36:39], v[116:119], v[68:71], a[36:39]
  ds_read_b64_tr_b16 v[100:101], v161 offset:0
  v_mfma_f32_16x16x32_bf16 a[8:11], v[112:115], v[72:75], a[8:11]
  ds_read_b64_tr_b16 v[102:103], v161 offset:1024
  v_mfma_f32_16x16x32_bf16 a[40:43], v[116:119], v[72:75], a[40:43]
  s_add_u32 m0, s39, 1024
  s_add_u32 s34, s35, 16384
  buffer_load_dwordx4 v4, s[12:15], s34 offen lds
  v_mfma_f32_16x16x32_bf16 a[12:15], v[112:115], v[76:79], a[12:15]
  ds_read_b128 v[32:35], v159 offset:0
  v_mfma_f32_16x16x32_bf16 a[44:47], v[116:119], v[76:79], a[44:47]
  ds_read_b128 v[36:39], v159 offset:1024
  v_mfma_f32_16x16x32_bf16 a[16:19], v[112:115], v[80:83], a[16:19]
  s_add_u32 m0, s40, 0
  s_add_u32 s34, s36, 0
  buffer_load_dwordx4 v5, s[16:19], s34 offen lds
  v_mfma_f32_16x16x32_bf16 a[48:51], v[116:119], v[80:83], a[48:51]
  ds_read_b128 v[40:43], v159 offset:2048
  v_mfma_f32_16x16x32_bf16 a[20:23], v[112:115], v[84:87], a[20:23]
  ds_read_b128 v[44:47], v159 offset:3072
  v_mfma_f32_16x16x32_bf16 a[52:55], v[116:119], v[84:87], a[52:55]
  s_add_u32 m0, s40, 1024
  s_add_u32 s34, s36, 32768
  buffer_load_dwordx4 v5, s[16:19], s34 offen lds
  s_add_u32 s35, s35, 64
  s_add_u32 s36, s36, 262144
  v_mfma_f32_16x16x32_bf16 a[24:27], v[112:115], v[88:91], a[24:27]
  ds_read_b128 v[48:51], v159 offset:4096
  v_mfma_f32_16x16x32_bf16 a[56:59], v[116:119], v[88:91], a[56:59]
  ds_read_b128 v[52:55], v159 offset:5120
  v_mfma_f32_16x16x32_bf16 a[28:31], v[112:115], v[92:95], a[28:31]
  ds_read_b128 v[56:59], v159 offset:6144
  v_mfma_f32_16x16x32_bf16 a[60:63], v[116:119], v[92:95], a[60:63]
  ds_read_b128 v[60:63], v159 offset:7168
  s_waitcnt vmcnt(12) lgkmcnt(0)
  s_barrier
  v_mfma_f32_16x16x32_bf16 a[0:3], v[96:99], v[32:35], a[0:3]
  ds_read_b64_tr_b16 v[112:113], v160 offset:24576
  v_mfma_f32_16x16x32_bf16 a[32:35], v[100:103], v[32:35], a[32:35]
  ds_read_b64_tr_b16 v[114:115], v160 offset:25600
  v_mfma_f32_16x16x32_bf16 a[4:7], v[96:99], v[36:39], a[4:7]
  s_add_u32 m0, s39, 24576
  s_add_u32 s34, s35, 0
  buffer_load_dwordx4 v4, s[12:15], s34 offen lds
  v_mfma_f32_16x16x32_bf16 a[36:39], v[100:103], v[36:39], a[36:39]
  ds_read_b64_tr_b16 v[116:117], v161 offset:24576
  v_mfma_f32_16x16x32_bf16 a[8:11], v[96:99], v[40:43], a[8:11]
  ds_read_b64_tr_b16 v[118:119], v161 offset:25600
  v_mfma_f32_16x16x32_bf16 a[40:43], v[100:103], v[40:43], a[40:43]
  s_add_u32 m0, s39, 25600
  s_add_u32 s34, s35, 16384
  buffer_load_dwordx4 v4, s[12:15], s34 offen lds
  v_mfma_f32_16x16x32_bf16 a[12:15], v[96:99], v[44:47], a[12:15]
  ds_read_b128 v[64:67], v159 offset:24576
  v_mfma_f32_16x16x32_bf16 a[44:47], v[100:103], v[44:47], a[44:47]
  ds_read_b128 v[68:71], v159 offset:25600
  v_mfma_f32_16x16x32_bf16 a[16:19], v[96:99], v[48:51], a[16:19]
  s_add_u32 m0, s40, 24576
  s_add_u32 s34, s36, 0
  buffer_load_dwordx4 v5, s[16:19], s34 offen lds
  v_mfma_f32_16x16x32_bf16 a[48:51], v[100:103], v[48:51], a[48:51]
  ds_read_b128 v[72:75], v159 offset:26624
  v_mfma_f32_16x16x32_bf16 a[20:23], v[96:99], v[52:55], a[20:23]
  ds_read_b128 v[76:79], v159 offset:27648
  v_mfma_f32_16x16x32_bf16 a[52:55], v[100:103], v[52:55], a[52:55]
  s_add_u32 m0, s40, 25600
  s_add_u32 s34, s36, 32768
  buffer_load_dwordx4 v5, s[16:19], s34 offen lds
  s_add_u32 s35, s35, 64
  s_add_u32 s36, s36, 262144
  v_mfma_f32_16x16x32_bf16 a[24:27], v[96:99], v[56:59], a[24:27]
  ds_read_b128 v[80:83], v159 offset:28672
  v_mfma_f32_16x16x32_bf16 a[56:59], v[100:103], v[56:59], a[56:59]
  ds_read_b128 v[84:87], v159 offset:29696
  v_mfma_f32_16x16x32_bf16 a[28:31], v[96:99], v[60:63], a[28:31]
  ds_read_b128 v[88:91], v159 offset:30720
  v_mfma_f32_16x16x32_bf16 a[60:63], v[100:103], v[60:63], a[60:63]
  ds_read_b128 v[92:95], v159 offset:31744
  s_waitcnt vmcnt(12) lgkmcnt(0)
  s_barrier
  v_mfma_f32_16x16x32_bf16 a[0:3], v[112:115], v[64:67], a[0:3]
  ds_read_b64_tr_b16 v[96:97], v163 offset:0
  v_mfma_f32_16x16x32_bf16 a[32:35], v[116:119], v[64:67], a[32:35]
  ds_read_b64_tr_b16 v[98:99], v163 offset:1024
  v_mfma_f32_16x16x32_bf16 a[4:7], v[112:115], v[68:71], a[4:7]
  s_add_u32 m0, s39, 49152
  s_add_u32 s34, s35, 0
  buffer_load_dwordx4 v4, s[12:15], s34 offen lds
  v_mfma_f32_16x16x32_bf16 a[36:39], v[116:119], v[68:71], a[36:39]
  ds_read_b64_tr_b16 v[100:101], v164 offset:0
  v_mfma_f32_16x16x32_bf16 a[8:11], v[112:115], v[72:75], a[8:11]
  ds_read_b64_tr_b16 v[102:103], v164 offset:1024
  v_mfma_f32_16x16x32_bf16 a[40:43], v[116:119], v[72:75], a[40:43]
  s_add_u32 m0, s39, 50176
  s_add_u32 s34, s35, 16384
  buffer_load_dwordx4 v4, s[12:15], s34 offen lds
  v_mfma_f32_16x16x32_bf16 a[12:15], v[112:115], v[76:79], a[12:15]
  ds_read_b128 v[32:35], v162 offset:0
  v_mfma_f32_16x16x32_bf16 a[44:47], v[116:119], v[76:79], a[44:47]
  ds_read_b128 v[36:39], v162 offset:1024
  v_mfma_f32_16x16x32_bf16 a[16:19], v[112:115], v[80:83], a[16:19]
  s_add_u32 m0, s40, 49152
  s_add_u32 s34, s36, 0
  buffer_load_dwordx4 v5, s[16:19], s34 offen lds
  v_mfma_f32_16x16x32_bf16 a[48:51], v[116:119], v[80:83], a[48:51]
  ds_read_b128 v[40:43], v162 offset:2048
  v_mfma_f32_16x16x32_bf16 a[20:23], v[112:115], v[84:87], a[20:23]
  ds_read_b128 v[44:47], v162 offset:3072
  v_mfma_f32_16x16x32_bf16 a[52:55], v[116:119], v[84:87], a[52:55]
  s_add_u32 m0, s40, 50176
  s_add_u32 s34, s36, 32768
  buffer_load_dwordx4 v5, s[16:19], s34 offen lds
  s_add_u32 s35, s35, 64
  s_add_u32 s36, s36, 262144
  v_mfma_f32_16x16x32_bf16 a[24:27], v[112:115], v[88:91], a[24:27]
  ds_read_b128 v[48:51], v162 offset:4096
  v_mfma_f32_16x16x32_bf16 a[56:59], v[116:119], v[88:91], a[56:59]
  ds_read_b128 v[52:55], v162 offset:5120
  v_mfma_f32_16x16x32_bf16 a[28:31], v[112:115], v[92:95], a[28:31]
  ds_read_b128 v[56:59], v162 offset:6144
  v_mfma_f32_16x16x32_bf16 a[60:63], v[116:119], v[92:95], a[60:63]
  ds_read_b128 v[60:63], v162 offset:7168
  s_cmp_eq_u32 s94, -1
  s_cselect_b32 s87, s93, s94
  s_lshr_b32 s32, s87, 5
  s_lshl_b32 s37, s32, 17
  s_lshl_b32 s32, s28, 15
  s_add_u32 s37, s37, s32
  s_and_b32 s32, s87, 31
  s_lshl_b32 s38, s32, 8
  s_lshl_b32 s32, s28, 16
  s_add_u32 s38, s38, s32
  s_lshr_b32 s32, s92, 5
  s_lshl_b32 s32, s32, 21
  s_and_b32 s33, s92, 31
  s_lshl_b32 s33, s33, 14
  s_add_u32 s32, s32, s33
  s_lshl_b32 s33, s28, 12
  s_add_u32 s32, s32, s33
  s_lshr_b32 s32, s32, 1
  s_add_u32 s41, s32, 50331648
  s_lshl_b32 s43, s92, 7
  s_add_u32 s43, s43, 393216
  s_cmp_eq_u32 s97, 0
  s_cselect_b32 s43, s43, 0x7f000000
  s_waitcnt vmcnt(12) lgkmcnt(0)
  s_barrier
  v_mfma_f32_16x16x32_bf16 a[128:131], v[96:99], v[32:35], 0
  ds_read_b64_tr_b16 v[112:113], v163 offset:24576
  v_accvgpr_read_b32 v128, a0
  v_accvgpr_read_b32 v129, a1
  v_accvgpr_read_b32 v130, a2
  v_mfma_f32_16x16x32_bf16 a[160:163], v[100:103], v[32:35], 0
  ds_read_b64_tr_b16 v[114:115], v163 offset:25600
  v_accvgpr_read_b32 v131, a3
  v_accvgpr_read_b32 v132, a32
  v_accvgpr_read_b32 v133, a33
  v_mfma_f32_16x16x32_bf16 a[132:135], v[96:99], v[36:39], 0
  s_add_u32 m0, s39, 73728
  s_add_u32 s34, s35, 0
  buffer_load_dwordx4 v4, s[12:15], s34 offen lds
  v_accvgpr_read_b32 v134, a34
  v_accvgpr_read_b32 v135, a35
  v_cvt_pk_bf16_f32 v136, v128, v129
  v_mfma_f32_16x16x32_bf16 a[164:167], v[100:103], v[36:39], 0
  ds_read_b64_tr_b16 v[116:117], v164 offset:24576
  v_cvt_pk_bf16_f32 v137, v130, v131
  v_cvt_pk_bf16_f32 v138, v132, v133
  v_cvt_pk_bf16_f32 v139, v134, v135
  v_mfma_f32_16x16x32_bf16 a[136:139], v[96:99], v[40:43], 0
  ds_read_b64_tr_b16 v[118:119], v164 offset:25600
  s_add_u32 s33, s41, 0
  buffer_store_dwordx4 v[136:139], v6, s[8:11], s33 offen offset:0 sc1
  v_mfma_f32_16x16x32_bf16 a[168:171], v[100:103], v[40:43], 0
  s_add_u32 m0, s39, 74752
  s_add_u32 s34, s35, 16384
  buffer_load_dwordx4 v4, s[12:15], s34 offen lds
  v_mfma_f32_16x16x32_bf16 a[140:143], v[96:99], v[44:47], 0
  ds_read_b128 v[64:67], v162 offset:24576
  v_mfma_f32_16x16x32_bf16 a[172:175], v[100:103], v[44:47], 0
  ds_read_b128 v[68:71], v162 offset:25600
  v_mfma_f32_16x16x32_bf16 a[144:147], v[96:99], v[48:51], 0
  s_add_u32 m0, s40, 73728
  s_add_u32 s34, s36, 0
  buffer_load_dwordx4 v5, s[16:19], s34 offen lds
  v_mfma_f32_16x16x32_bf16 a[176:179], v[100:103], v[48:51], 0
  ds_read_b128 v[72:75], v162 offset:26624
  v_mfma_f32_16x16x32_bf16 a[148:151], v[96:99], v[52:55], 0
  ds_read_b128 v[76:79], v162 offset:27648
  v_mfma_f32_16x16x32_bf16 a[180:183], v[100:103], v[52:55], 0
  s_add_u32 m0, s40, 74752
  s_add_u32 s34, s36, 32768
  buffer_load_dwordx4 v5, s[16:19], s34 offen lds
  s_add_u32 s35, s35, 64
  s_add_u32 s36, s36, 262144
  v_mfma_f32_16x16x32_bf16 a[152:155], v[96:99], v[56:59], 0
  ds_read_b128 v[80:83], v162 offset:28672
  v_mfma_f32_16x16x32_bf16 a[184:187], v[100:103], v[56:59], 0
  ds_read_b128 v[84:87], v162 offset:29696
  v_mfma_f32_16x16x32_bf16 a[156:159], v[96:99], v[60:63], 0
  ds_read_b128 v[88:91], v162 offset:30720
  v_mfma_f32_16x16x32_bf16 a[188:191], v[100:103], v[60:63], 0
  ds_read_b128 v[92:95], v162 offset:31744
  s_waitcnt vmcnt(13) lgkmcnt(0)
  s_barrier
  v_mfma_f32_16x16x32_bf16 a[128:131], v[112:115], v[64:67], a[128:131]
  ds_read_b64_tr_b16 v[96:97], v157 offset:0
  v_accvgpr_read_b32 v140, a4
  v_accvgpr_read_b32 v141, a5
  v_accvgpr_read_b32 v142, a6
  v_mfma_f32_16x16x32_bf16 a[160:163], v[116:119], v[64:67], a[160:163]
  ds_read_b64_tr_b16 v[98:99], v157 offset:1024
  v_accvgpr_read_b32 v143, a7
  v_accvgpr_read_b32 v144, a36
  v_accvgpr_read_b32 v145, a37
  v_mfma_f32_16x16x32_bf16 a[132:135], v[112:115], v[68:71], a[132:135]
  s_add_u32 m0, s39, 98304
  s_add_u32 s34, s35, 0
  buffer_load_dwordx4 v4, s[12:15], s34 offen lds
  v_accvgpr_read_b32 v146, a38
  v_accvgpr_read_b32 v147, a39
  v_cvt_pk_bf16_f32 v148, v140, v141
  v_mfma_f32_16x16x32_bf16 a[164:167], v[116:119], v[68:71], a[164:167]
  ds_read_b64_tr_b16 v[100:101], v158 offset:0
  v_cvt_pk_bf16_f32 v149, v142, v143
  v_cvt_pk_bf16_f32 v150, v144, v145
  v_cvt_pk_bf16_f32 v151, v146, v147
  v_mfma_f32_16x16x32_bf16 a[136:139], v[112:115], v[72:75], a[136:139]
  ds_read_b64_tr_b16 v[102:103], v158 offset:1024
  s_add_u32 s33, s41, 0
  buffer_store_dwordx4 v[148:151], v6, s[8:11], s33 offen offset:1024 sc1
  v_mfma_f32_16x16x32_bf16 a[168:171], v[116:119], v[72:75], a[168:171]
  s_add_u32 m0, s39, 99328
  s_add_u32 s34, s35, 16384
  buffer_load_dwordx4 v4, s[12:15], s34 offen lds
  v_mfma_f32_16x16x32_bf16 a[140:143], v[112:115], v[76:79], a[140:143]
  ds_read_b128 v[32:35], v156 offset:0
  v_mfma_f32_16x16x32_bf16 a[172:175], v[116:119], v[76:79], a[172:175]
  ds_read_b128 v[36:39], v156 offset:1024
  v_mfma_f32_16x16x32_bf16 a[144:147], v[112:115], v[80:83], a[144:147]
  s_add_u32 m0, s40, 98304
  s_add_u32 s34, s36, 0
  buffer_load_dwordx4 v5, s[16:19], s34 offen lds
  v_mfma_f32_16x16x32_bf16 a[176:179], v[116:119], v[80:83], a[176:179]
  ds_read_b128 v[40:43], v156 offset:2048
  v_mfma_f32_16x16x32_bf16 a[148:151], v[112:115], v[84:87], a[148:151]
  ds_read_b128 v[44:47], v156 offset:3072
  v_mfma_f32_16x16x32_bf16 a[180:183], v[116:119], v[84:87], a[180:183]
  s_add_u32 m0, s40, 99328
  s_add_u32 s34, s36, 32768
  buffer_load_dwordx4 v5, s[16:19], s34 offen lds
  s_add_u32 s35, s35, 64
  s_add_u32 s36, s36, 262144
  v_mfma_f32_16x16x32_bf16 a[152:155], v[112:115], v[88:91], a[152:155]
  ds_read_b128 v[48:51], v156 offset:4096
  v_mfma_f32_16x16x32_bf16 a[184:187], v[116:119], v[88:91], a[184:187]
  ds_read_b128 v[52:55], v156 offset:5120
  v_mfma_f32_16x16x32_bf16 a[156:159], v[112:115], v[92:95], a[156:159]
  ds_read_b128 v[56:59], v156 offset:6144
  v_mfma_f32_16x16x32_bf16 a[188:191], v[116:119], v[92:95], a[188:191]
  ds_read_b128 v[60:63], v156 offset:7168
  s_waitcnt vmcnt(14) lgkmcnt(0)
  s_barrier
  v_mfma_f32_16x16x32_bf16 a[128:131], v[96:99], v[32:35], a[128:131]
  ds_read_b64_tr_b16 v[112:113], v157 offset:24576
  v_accvgpr_read_b32 v128, a8
  v_accvgpr_read_b32 v129, a9
  v_accvgpr_read_b32 v130, a10
  v_mfma_f32_16x16x32_bf16 a[160:163], v[100:103], v[32:35], a[160:163]
  ds_read_b64_tr_b16 v[114:115], v157 offset:25600
  v_accvgpr_read_b32 v131, a11
  v_accvgpr_read_b32 v132, a40
  v_accvgpr_read_b32 v133, a41
  v_mfma_f32_16x16x32_bf16 a[132:135], v[96:99], v[36:39], a[132:135]
  s_add_u32 m0, s39, 122880
  s_add_u32 s34, s35, 0
  buffer_load_dwordx4 v4, s[12:15], s34 offen lds
  v_accvgpr_read_b32 v134, a42
  v_accvgpr_read_b32 v135, a43
  v_cvt_pk_bf16_f32 v136, v128, v129
  v_mfma_f32_16x16x32_bf16 a[164:167], v[100:103], v[36:39], a[164:167]
  ds_read_b64_tr_b16 v[116:117], v158 offset:24576
  v_cvt_pk_bf16_f32 v137, v130, v131
  v_cvt_pk_bf16_f32 v138, v132, v133
  v_cvt_pk_bf16_f32 v139, v134, v135
  v_mfma_f32_16x16x32_bf16 a[136:139], v[96:99], v[40:43], a[136:139]
  ds_read_b64_tr_b16 v[118:119], v158 offset:25600
  s_add_u32 s33, s41, 262144
  buffer_store_dwordx4 v[136:139], v6, s[8:11], s33 offen offset:0 sc1
  v_mfma_f32_16x16x32_bf16 a[168:171], v[100:103], v[40:43], a[168:171]
  s_add_u32 m0, s39, 123904
  s_add_u32 s34, s35, 16384
  buffer_load_dwordx4 v4, s[12:15], s34 offen lds
  v_mfma_f32_16x16x32_bf16 a[140:143], v[96:99], v[44:47], a[140:143]
  ds_read_b128 v[64:67], v156 offset:24576
  v_mfma_f32_16x16x32_bf16 a[172:175], v[100:103], v[44:47], a[172:175]
  ds_read_b128 v[68:71], v156 offset:25600
  v_mfma_f32_16x16x32_bf16 a[144:147], v[96:99], v[48:51], a[144:147]
  s_add_u32 m0, s40, 122880
  s_add_u32 s34, s36, 0
  buffer_load_dwordx4 v5, s[16:19], s34 offen lds
  v_mfma_f32_16x16x32_bf16 a[176:179], v[100:103], v[48:51], a[176:179]
  ds_read_b128 v[72:75], v156 offset:26624
  v_mfma_f32_16x16x32_bf16 a[148:151], v[96:99], v[52:55], a[148:151]
  ds_read_b128 v[76:79], v156 offset:27648
  v_mfma_f32_16x16x32_bf16 a[180:183], v[100:103], v[52:55], a[180:183]
  s_add_u32 m0, s40, 123904
  s_add_u32 s34, s36, 32768
  buffer_load_dwordx4 v5, s[16:19], s34 offen lds
  s_add_u32 s35, s35, 64
  s_add_u32 s36, s36, 262144
  v_mfma_f32_16x16x32_bf16 a[152:155], v[96:99], v[56:59], a[152:155]
  ds_read_b128 v[80:83], v156 offset:28672
  v_mfma_f32_16x16x32_bf16 a[184:187], v[100:103], v[56:59], a[184:187]
  ds_read_b128 v[84:87], v156 offset:29696
  v_mfma_f32_16x16x32_bf16 a[156:159], v[96:99], v[60:63], a[156:159]
  ds_read_b128 v[88:91], v156 offset:30720
  v_mfma_f32_16x16x32_bf16 a[188:191], v[100:103], v[60:63], a[188:191]
  ds_read_b128 v[92:95], v156 offset:31744
  s_waitcnt vmcnt(15) lgkmcnt(0)
  s_barrier
  v_mfma_f32_16x16x32_bf16 a[128:131], v[112:115], v[64:67], a[128:131]
  ds_read_b64_tr_b16 v[96:97], v160 offset:0
  v_accvgpr_read_b32 v140, a12
  v_accvgpr_read_b32 v141, a13
  v_accvgpr_read_b32 v142, a14
  v_mfma_f32_16x16x32_bf16 a[160:163], v[116:119], v[64:67], a[160:163]
  ds_read_b64_tr_b16 v[98:99], v160 offset:1024
  v_accvgpr_read_b32 v143, a15
  v_accvgpr_read_b32 v144, a44
  v_accvgpr_read_b32 v145, a45
  v_mfma_f32_16x16x32_bf16 a[132:135], v[112:115], v[68:71], a[132:135]
  s_add_u32 m0, s39, 0
  s_add_u32 s34, s35, 0
  buffer_load_dwordx4 v4, s[12:15], s34 offen lds
  v_accvgpr_read_b32 v146, a46
  v_accvgpr_read_b32 v147, a47
  v_cvt_pk_bf16_f32 v148, v140, v141
  v_mfma_f32_16x16x32_bf16 a[164:167], v[116:119], v[68:71], a[164:167]
  ds_read_b64_tr_b16 v[100:101], v161 offset:0
  v_cvt_pk_bf16_f32 v149, v142, v143
  v_cvt_pk_bf16_f32 v150, v144, v145
  v_cvt_pk_bf16_f32 v151, v146, v147
  v_mfma_f32_16x16x32_bf16 a[136:139], v[112:115], v[72:75], a[136:139]
  ds_read_b64_tr_b16 v[102:103], v161 offset:1024
  s_add_u32 s33, s41, 262144
  buffer_store_dwordx4 v[148:151], v6, s[8:11], s33 offen offset:1024 sc1
  v_mfma_f32_16x16x32_bf16 a[168:171], v[116:119], v[72:75], a[168:171]
  s_add_u32 m0, s39, 1024
  s_add_u32 s34, s35, 16384
  buffer_load_dwordx4 v4, s[12:15], s34 offen lds
  v_mfma_f32_16x16x32_bf16 a[140:143], v[112:115], v[76:79], a[140:143]
  ds_read_b128 v[32:35], v159 offset:0
  v_mfma_f32_16x16x32_bf16 a[172:175], v[116:119], v[76:79], a[172:175]
  ds_read_b128 v[36:39], v159 offset:1024
  v_mfma_f32_16x16x32_bf16 a[144:147], v[112:115], v[80:83], a[144:147]
  s_add_u32 m0, s40, 0
  s_add_u32 s34, s36, 0
  buffer_load_dwordx4 v5, s[16:19], s34 offen lds
  v_mfma_f32_16x16x32_bf16 a[176:179], v[116:119], v[80:83], a[176:179]
  ds_read_b128 v[40:43], v159 offset:2048
  v_mfma_f32_16x16x32_bf16 a[148:151], v[112:115], v[84:87], a[148:151]
  ds_read_b128 v[44:47], v159 offset:3072
  v_mfma_f32_16x16x32_bf16 a[180:183], v[116:119], v[84:87], a[180:183]
  s_add_u32 m0, s40, 1024
  s_add_u32 s34, s36, 32768
  buffer_load_dwordx4 v5, s[16:19], s34 offen lds
  s_add_u32 s35, s35, 64
  s_add_u32 s36, s36, 262144
  v_mfma_f32_16x16x32_bf16 a[152:155], v[112:115], v[88:91], a[152:155]
  ds_read_b128 v[48:51], v159 offset:4096
  v_mfma_f32_16x16x32_bf16 a[184:187], v[116:119], v[88:91], a[184:187]
  ds_read_b128 v[52:55], v159 offset:5120
  v_mfma_f32_16x16x32_bf16 a[156:159], v[112:115], v[92:95], a[156:159]
  ds_read_b128 v[56:59], v159 offset:6144
  v_mfma_f32_16x16x32_bf16 a[188:191], v[116:119], v[92:95], a[188:191]
  ds_read_b128 v[60:63], v159 offset:7168
  s_waitcnt vmcnt(15) lgkmcnt(0)
  s_barrier
  v_mfma_f32_16x16x32_bf16 a[128:131], v[96:99], v[32:35], a[128:131]
  ds_read_b64_tr_b16 v[112:113], v160 offset:24576
  v_accvgpr_read_b32 v128, a16
  v_accvgpr_read_b32 v129, a17
  v_accvgpr_read_b32 v130, a18
  v_mfma_f32_16x16x32_bf16 a[160:163], v[100:103], v[32:35], a[160:163]
  ds_read_b64_tr_b16 v[114:115], v160 offset:25600
  v_accvgpr_read_b32 v131, a19
  v_accvgpr_read_b32 v132, a48
  v_accvgpr_read_b32 v133, a49
  v_mfma_f32_16x16x32_bf16 a[132:135], v[96:99], v[36:39], a[132:135]
  s_add_u32 m0, s39, 24576
  s_add_u32 s34, s35, 0
  buffer_load_dwordx4 v4, s[12:15], s34 offen lds
  v_accvgpr_read_b32 v134, a50
  v_accvgpr_read_b32 v135, a51
  v_cvt_pk_bf16_f32 v136, v128, v129
  v_mfma_f32_16x16x32_bf16 a[164:167], v[100:103], v[36:39], a[164:167]
  ds_read_b64_tr_b16 v[116:117], v161 offset:24576
  v_cvt_pk_bf16_f32 v137, v130, v131
  v_cvt_pk_bf16_f32 v138, v132, v133
  v_cvt_pk_bf16_f32 v139, v134, v135
  v_mfma_f32_16x16x32_bf16 a[136:139], v[96:99], v[40:43], a[136:139]
  ds_read_b64_tr_b16 v[118:119], v161 offset:25600
  s_add_u32 s33, s41, 524288
  buffer_store_dwordx4 v[136:139], v6, s[8:11], s33 offen offset:0 sc1
  v_mfma_f32_16x16x32_bf16 a[168:171], v[100:103], v[40:43], a[168:171]
  s_add_u32 m0, s39, 25600
  s_add_u32 s34, s35, 16384
  buffer_load_dwordx4 v4, s[12:15], s34 offen lds
  v_mfma_f32_16x16x32_bf16 a[140:143], v[96:99], v[44:47], a[140:143]
  ds_read_b128 v[64:67], v159 offset:24576
  v_mfma_f32_16x16x32_bf16 a[172:175], v[100:103], v[44:47], a[172:175]
  ds_read_b128 v[68:71], v159 offset:25600
  v_mfma_f32_16x16x32_bf16 a[144:147], v[96:99], v[48:51], a[144:147]
  s_add_u32 m0, s40, 24576
  s_add_u32 s34, s36, 0
  buffer_load_dwordx4 v5, s[16:19], s34 offen lds
  v_mfma_f32_16x16x32_bf16 a[176:179], v[100:103], v[48:51], a[176:179]
  ds_read_b128 v[72:75], v159 offset:26624
  v_mfma_f32_16x16x32_bf16 a[148:151], v[96:99], v[52:55], a[148:151]
  ds_read_b128 v[76:79], v159 offset:27648
  v_mfma_f32_16x16x32_bf16 a[180:183], v[100:103], v[52:55], a[180:183]
  s_add_u32 m0, s40, 25600
  s_add_u32 s34, s36, 32768
  buffer_load_dwordx4 v5, s[16:19], s34 offen lds
  s_add_u32 s35, s35, 64
  s_add_u32 s36, s36, 262144
  v_mfma_f32_16x16x32_bf16 a[152:155], v[96:99], v[56:59], a[152:155]
  ds_read_b128 v[80:83], v159 offset:28672
  v_mfma_f32_16x16x32_bf16 a[184:187], v[100:103], v[56:59], a[184:187]
  ds_read_b128 v[84:87], v159 offset:29696
  v_mfma_f32_16x16x32_bf16 a[156:159], v[96:99], v[60:63], a[156:159]
  ds_read_b128 v[88:91], v159 offset:30720
  v_mfma_f32_16x16x32_bf16 a[188:191], v[100:103], v[60:63], a[188:191]
  ds_read_b128 v[92:95], v159 offset:31744
  s_waitcnt vmcnt(15) lgkmcnt(0)
  s_barrier
  v_mfma_f32_16x16x32_bf16 a[128:131], v[112:115], v[64:67], a[128:131]
  ds_read_b64_tr_b16 v[96:97], v163 offset:0
  v_accvgpr_read_b32 v140, a20
  v_accvgpr_read_b32 v141, a21
  v_accvgpr_read_b32 v142, a22
  v_mfma_f32_16x16x32_bf16 a[160:163], v[116:119], v[64:67], a[160:163]
  ds_read_b64_tr_b16 v[98:99], v163 offset:1024
  v_accvgpr_read_b32 v143, a23
  v_accvgpr_read_b32 v144, a52
  v_accvgpr_read_b32 v145, a53
  v_mfma_f32_16x16x32_bf16 a[132:135], v[112:115], v[68:71], a[132:135]
  s_add_u32 m0, s39, 49152
  s_add_u32 s34, s35, 0
  buffer_load_dwordx4 v4, s[12:15], s34 offen lds
  v_accvgpr_read_b32 v146, a54
  v_accvgpr_read_b32 v147, a55
  v_cvt_pk_bf16_f32 v148, v140, v141
  v_mfma_f32_16x16x32_bf16 a[164:167], v[116:119], v[68:71], a[164:167]
  ds_read_b64_tr_b16 v[100:101], v164 offset:0
  v_cvt_pk_bf16_f32 v149, v142, v143
  v_cvt_pk_bf16_f32 v150, v144, v145
  v_cvt_pk_bf16_f32 v151, v146, v147
  v_mfma_f32_16x16x32_bf16 a[136:139], v[112:115], v[72:75], a[136:139]
  ds_read_b64_tr_b16 v[102:103], v164 offset:1024
  s_add_u32 s33, s41, 524288
  buffer_store_dwordx4 v[148:151], v6, s[8:11], s33 offen offset:1024 sc1
  v_mfma_f32_16x16x32_bf16 a[168:171], v[116:119], v[72:75], a[168:171]
  s_add_u32 m0, s39, 50176
  s_add_u32 s34, s35, 16384
  buffer_load_dwordx4 v4, s[12:15], s34 offen lds
  v_mfma_f32_16x16x32_bf16 a[140:143], v[112:115], v[76:79], a[140:143]
  ds_read_b128 v[32:35], v162 offset:0
  v_mfma_f32_16x16x32_bf16 a[172:175], v[116:119], v[76:79], a[172:175]
  ds_read_b128 v[36:39], v162 offset:1024
  v_mfma_f32_16x16x32_bf16 a[144:147], v[112:115], v[80:83], a[144:147]
  s_add_u32 m0, s40, 49152
  s_add_u32 s34, s36, 0
  buffer_load_dwordx4 v5, s[16:19], s34 offen lds
  v_mfma_f32_16x16x32_bf16 a[176:179], v[116:119], v[80:83], a[176:179]
  ds_read_b128 v[40:43], v162 offset:2048
  v_mfma_f32_16x16x32_bf16 a[148:151], v[112:115], v[84:87], a[148:151]
  ds_read_b128 v[44:47], v162 offset:3072
  v_mfma_f32_16x16x32_bf16 a[180:183], v[116:119], v[84:87], a[180:183]
  s_add_u32 m0, s40, 50176
  s_add_u32 s34, s36, 32768
  buffer_load_dwordx4 v5, s[16:19], s34 offen lds
  s_add_u32 s35, s35, 64
  s_add_u32 s36, s36, 262144
  v_mfma_f32_16x16x32_bf16 a[152:155], v[112:115], v[88:91], a[152:155]
  ds_read_b128 v[48:51], v162 offset:4096
  v_mfma_f32_16x16x32_bf16 a[184:187], v[116:119], v[88:91], a[184:187]
  ds_read_b128 v[52:55], v162 offset:5120
  v_mfma_f32_16x16x32_bf16 a[156:159], v[112:115], v[92:95], a[156:159]
  ds_read_b128 v[56:59], v162 offset:6144
  v_mfma_f32_16x16x32_bf16 a[188:191], v[116:119], v[92:95], a[188:191]
  ds_read_b128 v[60:63], v162 offset:7168
  s_waitcnt vmcnt(15) lgkmcnt(0)
  s_barrier
  v_mfma_f32_16x16x32_bf16 a[128:131], v[96:99], v[32:35], a[128:131]
  ds_read_b64_tr_b16 v[112:113], v163 offset:24576
  v_accvgpr_read_b32 v128, a24
  v_accvgpr_read_b32 v129, a25
  v_accvgpr_read_b32 v130, a26
  v_mfma_f32_16x16x32_bf16 a[160:163], v[100:103], v[32:35], a[160:163]
  ds_read_b64_tr_b16 v[114:115], v163 offset:25600
  v_accvgpr_read_b32 v131, a27
  v_accvgpr_read_b32 v132, a56
  v_accvgpr_read_b32 v133, a57
  v_mfma_f32_16x16x32_bf16 a[132:135], v[96:99], v[36:39], a[132:135]
  s_add_u32 m0, s39, 73728
  s_add_u32 s34, s35, 0
  buffer_load_dwordx4 v4, s[12:15], s34 offen lds
  v_accvgpr_read_b32 v134, a58
  v_accvgpr_read_b32 v135, a59
  v_cvt_pk_bf16_f32 v136, v128, v129
  v_mfma_f32_16x16x32_bf16 a[164:167], v[100:103], v[36:39], a[164:167]
  ds_read_b64_tr_b16 v[116:117], v164 offset:24576
  v_cvt_pk_bf16_f32 v137, v130, v131
  v_cvt_pk_bf16_f32 v138, v132, v133
  v_cvt_pk_bf16_f32 v139, v134, v135
  v_mfma_f32_16x16x32_bf16 a[136:139], v[96:99], v[40:43], a[136:139]
  ds_read_b64_tr_b16 v[118:119], v164 offset:25600
  s_add_u32 s33, s41, 786432
  buffer_store_dwordx4 v[136:139], v6, s[8:11], s33 offen offset:0 sc1
  v_mfma_f32_16x16x32_bf16 a[168:171], v[100:103], v[40:43], a[168:171]
  s_add_u32 m0, s39, 74752
  s_add_u32 s34, s35, 16384
  buffer_load_dwordx4 v4, s[12:15], s34 offen lds
  v_mfma_f32_16x16x32_bf16 a[140:143], v[96:99], v[44:47], a[140:143]
  ds_read_b128 v[64:67], v162 offset:24576
  v_mfma_f32_16x16x32_bf16 a[172:175], v[100:103], v[44:47], a[172:175]
  ds_read_b128 v[68:71], v162 offset:25600
  v_mfma_f32_16x16x32_bf16 a[144:147], v[96:99], v[48:51], a[144:147]
  s_add_u32 m0, s40, 73728
  s_add_u32 s34, s36, 0
  buffer_load_dwordx4 v5, s[16:19], s34 offen lds
  v_mfma_f32_16x16x32_bf16 a[176:179], v[100:103], v[48:51], a[176:179]
  ds_read_b128 v[72:75], v162 offset:26624
  v_mfma_f32_16x16x32_bf16 a[148:151], v[96:99], v[52:55], a[148:151]
  ds_read_b128 v[76:79], v162 offset:27648
  v_mfma_f32_16x16x32_bf16 a[180:183], v[100:103], v[52:55], a[180:183]
  s_add_u32 m0, s40, 74752
  s_add_u32 s34, s36, 32768
  buffer_load_dwordx4 v5, s[16:19], s34 offen lds
  s_add_u32 s35, s35, 64
  s_add_u32 s36, s36, 262144
  v_mfma_f32_16x16x32_bf16 a[152:155], v[96:99], v[56:59], a[152:155]
  ds_read_b128 v[80:83], v162 offset:28672
  v_mfma_f32_16x16x32_bf16 a[184:187], v[100:103], v[56:59], a[184:187]
  ds_read_b128 v[84:87], v162 offset:29696
  v_mfma_f32_16x16x32_bf16 a[156:159], v[96:99], v[60:63], a[156:159]
  ds_read_b128 v[88:91], v162 offset:30720
  v_mfma_f32_16x16x32_bf16 a[188:191], v[100:103], v[60:63], a[188:191]
  ds_read_b128 v[92:95], v162 offset:31744
  s_waitcnt vmcnt(15) lgkmcnt(0)
  s_barrier
  v_mfma_f32_16x16x32_bf16 a[128:131], v[112:115], v[64:67], a[128:131]
  ds_read_b64_tr_b16 v[96:97], v157 offset:0
  v_accvgpr_read_b32 v140, a28
  v_accvgpr_read_b32 v141, a29
  v_accvgpr_read_b32 v142, a30
  v_mfma_f32_16x16x32_bf16 a[160:163], v[116:119], v[64:67], a[160:163]
  ds_read_b64_tr_b16 v[98:99], v157 offset:1024
  v_accvgpr_read_b32 v143, a31
  v_accvgpr_read_b32 v144, a60
  v_accvgpr_read_b32 v145, a61
  v_mfma_f32_16x16x32_bf16 a[132:135], v[112:115], v[68:71], a[132:135]
  s_add_u32 m0, s39, 98304
  s_add_u32 s34, s35, 0
  buffer_load_dwordx4 v4, s[12:15], s34 offen lds
  v_accvgpr_read_b32 v146, a62
  v_accvgpr_read_b32 v147, a63
  v_cvt_pk_bf16_f32 v148, v140, v141
  v_mfma_f32_16x16x32_bf16 a[164:167], v[116:119], v[68:71], a[164:167]
  ds_read_b64_tr_b16 v[100:101], v158 offset:0
  v_cvt_pk_bf16_f32 v149, v142, v143
  v_cvt_pk_bf16_f32 v150, v144, v145
  v_cvt_pk_bf16_f32 v151, v146, v147
  v_mfma_f32_16x16x32_bf16 a[136:139], v[112:115], v[72:75], a[136:139]
  ds_read_b64_tr_b16 v[102:103], v158 offset:1024
  s_add_u32 s33, s41, 786432
  buffer_store_dwordx4 v[148:151], v6, s[8:11], s33 offen offset:1024 sc1
  v_mfma_f32_16x16x32_bf16 a[168:171], v[116:119], v[72:75], a[168:171]
  s_add_u32 m0, s39, 99328
  s_add_u32 s34, s35, 16384
  buffer_load_dwordx4 v4, s[12:15], s34 offen lds
  v_mfma_f32_16x16x32_bf16 a[140:143], v[112:115], v[76:79], a[140:143]
  ds_read_b128 v[32:35], v156 offset:0
  v_mfma_f32_16x16x32_bf16 a[172:175], v[116:119], v[76:79], a[172:175]
  ds_read_b128 v[36:39], v156 offset:1024
  v_mfma_f32_16x16x32_bf16 a[144:147], v[112:115], v[80:83], a[144:147]
  s_add_u32 m0, s40, 98304
  s_add_u32 s34, s36, 0
  buffer_load_dwordx4 v5, s[16:19], s34 offen lds
  v_mfma_f32_16x16x32_bf16 a[176:179], v[116:119], v[80:83], a[176:179]
  ds_read_b128 v[40:43], v156 offset:2048
  v_mfma_f32_16x16x32_bf16 a[148:151], v[112:115], v[84:87], a[148:151]
  ds_read_b128 v[44:47], v156 offset:3072
  v_mfma_f32_16x16x32_bf16 a[180:183], v[116:119], v[84:87], a[180:183]
  s_add_u32 m0, s40, 99328
  s_add_u32 s34, s36, 32768
  buffer_load_dwordx4 v5, s[16:19], s34 offen lds
  s_add_u32 s35, s35, 64
  s_add_u32 s36, s36, 262144
  v_mfma_f32_16x16x32_bf16 a[152:155], v[112:115], v[88:91], a[152:155]
  ds_read_b128 v[48:51], v156 offset:4096
  v_mfma_f32_16x16x32_bf16 a[184:187], v[116:119], v[88:91], a[184:187]
  ds_read_b128 v[52:55], v156 offset:5120
  v_mfma_f32_16x16x32_bf16 a[156:159], v[112:115], v[92:95], a[156:159]
  ds_read_b128 v[56:59], v156 offset:6144
  v_mfma_f32_16x16x32_bf16 a[188:191], v[116:119], v[92:95], a[188:191]
  ds_read_b128 v[60:63], v156 offset:7168
  s_waitcnt vmcnt(15) lgkmcnt(0)
  s_barrier
  v_mfma_f32_16x16x32_bf16 a[128:131], v[96:99], v[32:35], a[128:131]
  ds_read_b64_tr_b16 v[112:113], v157 offset:24576
  v_mfma_f32_16x16x32_bf16 a[160:163], v[100:103], v[32:35], a[160:163]
  ds_read_b64_tr_b16 v[114:115], v157 offset:25600
  v_mfma_f32_16x16x32_bf16 a[132:135], v[96:99], v[36:39], a[132:135]
  s_add_u32 m0, s39, 122880
  s_add_u32 s34, s35, 0
  buffer_load_dwordx4 v4, s[12:15], s34 offen lds
  v_mfma_f32_16x16x32_bf16 a[164:167], v[100:103], v[36:39], a[164:167]
  ds_read_b64_tr_b16 v[116:117], v158 offset:24576
  v_mfma_f32_16x16x32_bf16 a[136:139], v[96:99], v[40:43], a[136:139]
  ds_read_b64_tr_b16 v[118:119], v158 offset:25600
  v_mfma_f32_16x16x32_bf16 a[168:171], v[100:103], v[40:43], a[168:171]
  s_add_u32 m0, s39, 123904
  s_add_u32 s34, s35, 16384
  buffer_load_dwordx4 v4, s[12:15], s34 offen lds
  v_mfma_f32_16x16x32_bf16 a[140:143], v[96:99], v[44:47], a[140:143]
  ds_read_b128 v[64:67], v156 offset:24576
  v_mfma_f32_16x16x32_bf16 a[172:175], v[100:103], v[44:47], a[172:175]
  ds_read_b128 v[68:71], v156 offset:25600
  v_mfma_f32_16x16x32_bf16 a[144:147], v[96:99], v[48:51], a[144:147]
  s_add_u32 m0, s40, 122880
  s_add_u32 s34, s36, 0
  buffer_load_dwordx4 v5, s[16:19], s34 offen lds
  v_mfma_f32_16x16x32_bf16 a[176:179], v[100:103], v[48:51], a[176:179]
  ds_read_b128 v[72:75], v156 offset:26624
  v_mfma_f32_16x16x32_bf16 a[148:151], v[96:99], v[52:55], a[148:151]
  ds_read_b128 v[76:79], v156 offset:27648
  v_mfma_f32_16x16x32_bf16 a[180:183], v[100:103], v[52:55], a[180:183]
  s_add_u32 m0, s40, 123904
  s_add_u32 s34, s36, 32768
  buffer_load_dwordx4 v5, s[16:19], s34 offen lds
  s_add_u32 s35, s35, 64
  s_add_u32 s36, s36, 262144
  v_mfma_f32_16x16x32_bf16 a[152:155], v[96:99], v[56:59], a[152:155]
  ds_read_b128 v[80:83], v156 offset:28672
  v_mfma_f32_16x16x32_bf16 a[184:187], v[100:103], v[56:59], a[184:187]
  ds_read_b128 v[84:87], v156 offset:29696
  v_mfma_f32_16x16x32_bf16 a[156:159], v[96:99], v[60:63], a[156:159]
  ds_read_b128 v[88:91], v156 offset:30720
  v_mfma_f32_16x16x32_bf16 a[188:191], v[100:103], v[60:63], a[188:191]
  ds_read_b128 v[92:95], v156 offset:31744
  s_waitcnt vmcnt(14) lgkmcnt(0)
  s_barrier
  v_mfma_f32_16x16x32_bf16 a[128:131], v[112:115], v[64:67], a[128:131]
  ds_read_b64_tr_b16 v[96:97], v160 offset:0
  v_mfma_f32_16x16x32_bf16 a[160:163], v[116:119], v[64:67], a[160:163]
  ds_read_b64_tr_b16 v[98:99], v160 offset:1024
  v_mfma_f32_16x16x32_bf16 a[132:135], v[112:115], v[68:71], a[132:135]
  s_add_u32 m0, s39, 0
  s_add_u32 s34, s35, 0
  buffer_load_dwordx4 v4, s[12:15], s34 offen lds
  v_mfma_f32_16x16x32_bf16 a[164:167], v[116:119], v[68:71], a[164:167]
  ds_read_b64_tr_b16 v[100:101], v161 offset:0
  v_mfma_f32_16x16x32_bf16 a[136:139], v[112:115], v[72:75], a[136:139]
  ds_read_b64_tr_b16 v[102:103], v161 offset:1024
  v_mfma_f32_16x16x32_bf16 a[168:171], v[116:119], v[72:75], a[168:171]
  s_add_u32 m0, s39, 1024
  s_add_u32 s34, s35, 16384
  buffer_load_dwordx4 v4, s[12:15], s34 offen lds
  v_mfma_f32_16x16x32_bf16 a[140:143], v[112:115], v[76:79], a[140:143]
  ds_read_b128 v[32:35], v159 offset:0
  v_mfma_f32_16x16x32_bf16 a[172:175], v[116:119], v[76:79], a[172:175]
  ds_read_b128 v[36:39], v159 offset:1024
  v_mfma_f32_16x16x32_bf16 a[144:147], v[112:115], v[80:83], a[144:147]
  s_add_u32 m0, s40, 0
  s_add_u32 s34, s36, 0
  buffer_load_dwordx4 v5, s[16:19], s34 offen lds
  v_mfma_f32_16x16x32_bf16 a[176:179], v[116:119], v[80:83], a[176:179]
  ds_read_b128 v[40:43], v159 offset:2048
  v_mfma_f32_16x16x32_bf16 a[148:151], v[112:115], v[84:87], a[148:151]
  ds_read_b128 v[44:47], v159 offset:3072
  v_mfma_f32_16x16x32_bf16 a[180:183], v[116:119], v[84:87], a[180:183]
  s_add_u32 m0, s40, 1024
  s_add_u32 s34, s36, 32768
  buffer_load_dwordx4 v5, s[16:19], s34 offen lds
  s_add_u32 s35, s35, 64
  s_add_u32 s36, s36, 262144
  v_mfma_f32_16x16x32_bf16 a[152:155], v[112:115], v[88:91], a[152:155]
  ds_read_b128 v[48:51], v159 offset:4096
  v_mfma_f32_16x16x32_bf16 a[184:187], v[116:119], v[88:91], a[184:187]
  ds_read_b128 v[52:55], v159 offset:5120
  v_mfma_f32_16x16x32_bf16 a[156:159], v[112:115], v[92:95], a[156:159]
  ds_read_b128 v[56:59], v159 offset:6144
  v_mfma_f32_16x16x32_bf16 a[188:191], v[116:119], v[92:95], a[188:191]
  ds_read_b128 v[60:63], v159 offset:7168
  s_waitcnt vmcnt(13) lgkmcnt(0)
  s_barrier
  v_mfma_f32_16x16x32_bf16 a[128:131], v[96:99], v[32:35], a[128:131]
  ds_read_b64_tr_b16 v[112:113], v160 offset:24576
  v_mfma_f32_16x16x32_bf16 a[160:163], v[100:103], v[32:35], a[160:163]
  ds_read_b64_tr_b16 v[114:115], v160 offset:25600
  v_mfma_f32_16x16x32_bf16 a[132:135], v[96:99], v[36:39], a[132:135]
  s_add_u32 m0, s39, 24576
  s_add_u32 s34, s35, 0
  buffer_load_dwordx4 v4, s[12:15], s34 offen lds
  v_mfma_f32_16x16x32_bf16 a[164:167], v[100:103], v[36:39], a[164:167]
  ds_read_b64_tr_b16 v[116:117], v161 offset:24576
  v_mfma_f32_16x16x32_bf16 a[136:139], v[96:99], v[40:43], a[136:139]
  ds_read_b64_tr_b16 v[118:119], v161 offset:25600
  v_mfma_f32_16x16x32_bf16 a[168:171], v[100:103], v[40:43], a[168:171]
  s_add_u32 m0, s39, 25600
  s_add_u32 s34, s35, 16384
  buffer_load_dwordx4 v4, s[12:15], s34 offen lds
  v_mfma_f32_16x16x32_bf16 a[140:143], v[96:99], v[44:47], a[140:143]
  ds_read_b128 v[64:67], v159 offset:24576
  v_mfma_f32_16x16x32_bf16 a[172:175], v[100:103], v[44:47], a[172:175]
  ds_read_b128 v[68:71], v159 offset:25600
  v_mfma_f32_16x16x32_bf16 a[144:147], v[96:99], v[48:51], a[144:147]
  s_add_u32 m0, s40, 24576
  s_add_u32 s34, s36, 0
  buffer_load_dwordx4 v5, s[16:19], s34 offen lds
  v_mfma_f32_16x16x32_bf16 a[176:179], v[100:103], v[48:51], a[176:179]
  ds_read_b128 v[72:75], v159 offset:26624
  v_mfma_f32_16x16x32_bf16 a[148:151], v[96:99], v[52:55], a[148:151]
  ds_read_b128 v[76:79], v159 offset:27648
  v_mfma_f32_16x16x32_bf16 a[180:183], v[100:103], v[52:55], a[180:183]
  s_add_u32 m0, s40, 25600
  s_add_u32 s34, s36, 32768
  buffer_load_dwordx4 v5, s[16:19], s34 offen lds
  s_add_u32 s35, s35, 64
  s_add_u32 s36, s36, 262144
  v_mfma_f32_16x16x32_bf16 a[152:155], v[96:99], v[56:59], a[152:155]
  ds_read_b128 v[80:83], v159 offset:28672
  v_mfma_f32_16x16x32_bf16 a[184:187], v[100:103], v[56:59], a[184:187]
  ds_read_b128 v[84:87], v159 offset:29696
  v_mfma_f32_16x16x32_bf16 a[156:159], v[96:99], v[60:63], a[156:159]
  ds_read_b128 v[88:91], v159 offset:30720
  v_mfma_f32_16x16x32_bf16 a[188:191], v[100:103], v[60:63], a[188:191]
  ds_read_b128 v[92:95], v159 offset:31744
  s_waitcnt vmcnt(12) lgkmcnt(0)
  s_barrier
  s_mov_b32 s35, s37
  s_mov_b32 s36, s38
  v_mfma_f32_16x16x32_bf16 a[128:131], v[112:115], v[64:67], a[128:131]
  ds_read_b64_tr_b16 v[96:97], v163 offset:0
  v_mfma_f32_16x16x32_bf16 a[160:163], v[116:119], v[64:67], a[160:163]
  ds_read_b64_tr_b16 v[98:99], v163 offset:1024
  v_mfma_f32_16x16x32_bf16 a[132:135], v[112:115], v[68:71], a[132:135]
  s_add_u32 m0, s39, 49152
  s_add_u32 s34, s35, 0
  buffer_load_dwordx4 v4, s[12:15], s34 offen lds
  v_mfma_f32_16x16x32_bf16 a[164:167], v[116:119], v[68:71], a[164:167]
  ds_read_b64_tr_b16 v[100:101], v164 offset:0
  v_mfma_f32_16x16x32_bf16 a[136:139], v[112:115], v[72:75], a[136:139]
  ds_read_b64_tr_b16 v[102:103], v164 offset:1024
  v_mfma_f32_16x16x32_bf16 a[168:171], v[116:119], v[72:75], a[168:171]
  s_add_u32 m0, s39, 50176
  s_add_u32 s34, s35, 16384
  buffer_load_dwordx4 v4, s[12:15], s34 offen lds
  v_mfma_f32_16x16x32_bf16 a[140:143], v[112:115], v[76:79], a[140:143]
  ds_read_b128 v[32:35], v162 offset:0
  v_mfma_f32_16x16x32_bf16 a[172:175], v[116:119], v[76:79], a[172:175]
  ds_read_b128 v[36:39], v162 offset:1024
  v_mfma_f32_16x16x32_bf16 a[144:147], v[112:115], v[80:83], a[144:147]
  s_add_u32 m0, s40, 49152
  s_add_u32 s34, s36, 0
  buffer_load_dwordx4 v5, s[16:19], s34 offen lds
  v_mfma_f32_16x16x32_bf16 a[176:179], v[116:119], v[80:83], a[176:179]
  ds_read_b128 v[40:43], v162 offset:2048
  v_mfma_f32_16x16x32_bf16 a[148:151], v[112:115], v[84:87], a[148:151]
  ds_read_b128 v[44:47], v162 offset:3072
  v_mfma_f32_16x16x32_bf16 a[180:183], v[116:119], v[84:87], a[180:183]
  s_add_u32 m0, s40, 50176
  s_add_u32 s34, s36, 32768
  buffer_load_dwordx4 v5, s[16:19], s34 offen lds
  s_add_u32 s35, s35, 64
  s_add_u32 s36, s36, 262144
  v_mfma_f32_16x16x32_bf16 a[152:155], v[112:115], v[88:91], a[152:155]
  ds_read_b128 v[48:51], v162 offset:4096
  v_mfma_f32_16x16x32_bf16 a[184:187], v[116:119], v[88:91], a[184:187]
  ds_read_b128 v[52:55], v162 offset:5120
  v_mfma_f32_16x16x32_bf16 a[156:159], v[112:115], v[92:95], a[156:159]
  ds_read_b128 v[56:59], v162 offset:6144
  v_mfma_f32_16x16x32_bf16 a[188:191], v[116:119], v[92:95], a[188:191]
  ds_read_b128 v[60:63], v162 offset:7168
  s_waitcnt vmcnt(12) lgkmcnt(0)
  s_barrier
  v_mfma_f32_16x16x32_bf16 a[128:131], v[96:99], v[32:35], a[128:131]
  ds_read_b64_tr_b16 v[112:113], v163 offset:24576
  v_mfma_f32_16x16x32_bf16 a[160:163], v[100:103], v[32:35], a[160:163]
  ds_read_b64_tr_b16 v[114:115], v163 offset:25600
  v_mfma_f32_16x16x32_bf16 a[132:135], v[96:99], v[36:39], a[132:135]
  s_add_u32 m0, s39, 73728
  s_add_u32 s34, s35, 0
  buffer_load_dwordx4 v4, s[12:15], s34 offen lds
  v_mfma_f32_16x16x32_bf16 a[164:167], v[100:103], v[36:39], a[164:167]
  ds_read_b64_tr_b16 v[116:117], v164 offset:24576
  v_mfma_f32_16x16x32_bf16 a[136:139], v[96:99], v[40:43], a[136:139]
  ds_read_b64_tr_b16 v[118:119], v164 offset:25600
  v_mfma_f32_16x16x32_bf16 a[168:171], v[100:103], v[40:43], a[168:171]
  s_add_u32 m0, s39, 74752
  s_add_u32 s34, s35, 16384
  buffer_load_dwordx4 v4, s[12:15], s34 offen lds
  v_mfma_f32_16x16x32_bf16 a[140:143], v[96:99], v[44:47], a[140:143]
  ds_read_b128 v[64:67], v162 offset:24576
  v_mfma_f32_16x16x32_bf16 a[172:175], v[100:103], v[44:47], a[172:175]
  ds_read_b128 v[68:71], v162 offset:25600
  v_mfma_f32_16x16x32_bf16 a[144:147], v[96:99], v[48:51], a[144:147]
  s_add_u32 m0, s40, 73728
  s_add_u32 s34, s36, 0
  buffer_load_dwordx4 v5, s[16:19], s34 offen lds
  v_mfma_f32_16x16x32_bf16 a[176:179], v[100:103], v[48:51], a[176:179]
  ds_read_b128 v[72:75], v162 offset:26624
  v_mfma_f32_16x16x32_bf16 a[148:151], v[96:99], v[52:55], a[148:151]
  ds_read_b128 v[76:79], v162 offset:27648
  v_mfma_f32_16x16x32_bf16 a[180:183], v[100:103], v[52:55], a[180:183]
  s_add_u32 m0, s40, 74752
  s_add_u32 s34, s36, 32768
  buffer_load_dwordx4 v5, s[16:19], s34 offen lds
  s_add_u32 s35, s35, 64
  s_add_u32 s36, s36, 262144
  v_mfma_f32_16x16x32_bf16 a[152:155], v[96:99], v[56:59], a[152:155]
  ds_read_b128 v[80:83], v162 offset:28672
  v_mfma_f32_16x16x32_bf16 a[184:187], v[100:103], v[56:59], a[184:187]
  ds_read_b128 v[84:87], v162 offset:29696
  v_mfma_f32_16x16x32_bf16 a[156:159], v[96:99], v[60:63], a[156:159]
  ds_read_b128 v[88:91], v162 offset:30720
  v_mfma_f32_16x16x32_bf16 a[188:191], v[100:103], v[60:63], a[188:191]
  ds_read_b128 v[92:95], v162 offset:31744
  s_waitcnt vmcnt(12) lgkmcnt(0)
  s_barrier
  s_waitcnt vmcnt(23)
  s_barrier
  buffer_store_dword v11, v7, s[8:11], s43 offen sc1
  v_mfma_f32_16x16x32_bf16 a[128:131], v[112:115], v[64:67], a[128:131]
  ds_read_b64_tr_b16 v[96:97], v157 offset:0
  v_mfma_f32_16x16x32_bf16 a[160:163], v[116:119], v[64:67], a[160:163]
  ds_read_b64_tr_b16 v[98:99], v157 offset:1024
  v_mfma_f32_16x16x32_bf16 a[132:135], v[112:115], v[68:71], a[132:135]
  s_add_u32 m0, s39, 98304
  s_add_u32 s34, s35, 0
  buffer_load_dwordx4 v4, s[12:15], s34 offen lds
  v_mfma_f32_16x16x32_bf16 a[164:167], v[116:119], v[68:71], a[164:167]
  ds_read_b64_tr_b16 v[100:101], v158 offset:0
  v_mfma_f32_16x16x32_bf16 a[136:139], v[112:115], v[72:75], a[136:139]
  ds_read_b64_tr_b16 v[102:103], v158 offset:1024
  v_mfma_f32_16x16x32_bf16 a[168:171], v[116:119], v[72:75], a[168:171]
  s_add_u32 m0, s39, 99328
  s_add_u32 s34, s35, 16384
  buffer_load_dwordx4 v4, s[12:15], s34 offen lds
  v_mfma_f32_16x16x32_bf16 a[140:143], v[112:115], v[76:79], a[140:143]
  ds_read_b128 v[32:35], v156 offset:0
  v_mfma_f32_16x16x32_bf16 a[172:175], v[116:119], v[76:79], a[172:175]
  ds_read_b128 v[36:39], v156 offset:1024
  v_mfma_f32_16x16x32_bf16 a[144:147], v[112:115], v[80:83], a[144:147]
  s_add_u32 m0, s40, 98304
  s_add_u32 s34, s36, 0
  buffer_load_dwordx4 v5, s[16:19], s34 offen lds
  v_mfma_f32_16x16x32_bf16 a[176:179], v[116:119], v[80:83], a[176:179]
  ds_read_b128 v[40:43], v156 offset:2048
  v_mfma_f32_16x16x32_bf16 a[148:151], v[112:115], v[84:87], a[148:151]
  ds_read_b128 v[44:47], v156 offset:3072
  v_mfma_f32_16x16x32_bf16 a[180:183], v[116:119], v[84:87], a[180:183]
  s_add_u32 m0, s40, 99328
  s_add_u32 s34, s36, 32768
  buffer_load_dwordx4 v5, s[16:19], s34 offen lds
  s_add_u32 s35, s35, 64
  s_add_u32 s36, s36, 262144
  v_mfma_f32_16x16x32_bf16 a[152:155], v[112:115], v[88:91], a[152:155]
  ds_read_b128 v[48:51], v156 offset:4096
  v_mfma_f32_16x16x32_bf16 a[184:187], v[116:119], v[88:91], a[184:187]
  ds_read_b128 v[52:55], v156 offset:5120
  v_mfma_f32_16x16x32_bf16 a[156:159], v[112:115], v[92:95], a[156:159]
  ds_read_b128 v[56:59], v156 offset:6144
  v_mfma_f32_16x16x32_bf16 a[188:191], v[116:119], v[92:95], a[188:191]
  ds_read_b128 v[60:63], v156 offset:7168
  s_waitcnt vmcnt(13) lgkmcnt(0)
  s_barrier
  v_mfma_f32_16x16x32_bf16 a[128:131], v[96:99], v[32:35], a[128:131]
  ds_read_b64_tr_b16 v[112:113], v157 offset:24576
  v_mfma_f32_16x16x32_bf16 a[160:163], v[100:103], v[32:35], a[160:163]
  ds_read_b64_tr_b16 v[114:115], v157 offset:25600
  v_mfma_f32_16x16x32_bf16 a[132:135], v[96:99], v[36:39], a[132:135]
  s_add_u32 m0, s39, 122880
  s_add_u32 s34, s35, 0
  buffer_load_dwordx4 v4, s[12:15], s34 offen lds
  v_mfma_f32_16x16x32_bf16 a[164:167], v[100:103], v[36:39], a[164:167]
  ds_read_b64_tr_b16 v[116:117], v158 offset:24576
  v_mfma_f32_16x16x32_bf16 a[136:139], v[96:99], v[40:43], a[136:139]
  ds_read_b64_tr_b16 v[118:119], v158 offset:25600
  v_mfma_f32_16x16x32_bf16 a[168:171], v[100:103], v[40:43], a[168:171]
  s_add_u32 m0, s39, 123904
  s_add_u32 s34, s35, 16384
  buffer_load_dwordx4 v4, s[12:15], s34 offen lds
  v_mfma_f32_16x16x32_bf16 a[140:143], v[96:99], v[44:47], a[140:143]
  ds_read_b128 v[64:67], v156 offset:24576
  v_mfma_f32_16x16x32_bf16 a[172:175], v[100:103], v[44:47], a[172:175]
  ds_read_b128 v[68:71], v156 offset:25600
  v_mfma_f32_16x16x32_bf16 a[144:147], v[96:99], v[48:51], a[144:147]
  s_add_u32 m0, s40, 122880
  s_add_u32 s34, s36, 0
  buffer_load_dwordx4 v5, s[16:19], s34 offen lds
  v_mfma_f32_16x16x32_bf16 a[176:179], v[100:103], v[48:51], a[176:179]
  ds_read_b128 v[72:75], v156 offset:26624
  v_mfma_f32_16x16x32_bf16 a[148:151], v[96:99], v[52:55], a[148:151]
  ds_read_b128 v[76:79], v156 offset:27648
  v_mfma_f32_16x16x32_bf16 a[180:183], v[100:103], v[52:55], a[180:183]
  s_add_u32 m0, s40, 123904
  s_add_u32 s34, s36, 32768
  buffer_load_dwordx4 v5, s[16:19], s34 offen lds
  s_add_u32 s35, s35, 64
  s_add_u32 s36, s36, 262144
  v_mfma_f32_16x16x32_bf16 a[152:155], v[96:99], v[56:59], a[152:155]
  ds_read_b128 v[80:83], v156 offset:28672
  v_mfma_f32_16x16x32_bf16 a[184:187], v[100:103], v[56:59], a[184:187]
  ds_read_b128 v[84:87], v156 offset:29696
  v_mfma_f32_16x16x32_bf16 a[156:159], v[96:99], v[60:63], a[156:159]
  ds_read_b128 v[88:91], v156 offset:30720
  v_mfma_f32_16x16x32_bf16 a[188:191], v[100:103], v[60:63], a[188:191]
  ds_read_b128 v[92:95], v156 offset:31744
  s_waitcnt vmcnt(13) lgkmcnt(0)
  s_barrier
  v_mfma_f32_16x16x32_bf16 a[128:131], v[112:115], v[64:67], a[128:131]
  ds_read_b64_tr_b16 v[96:97], v160 offset:0
  v_mfma_f32_16x16x32_bf16 a[160:163], v[116:119], v[64:67], a[160:163]
  ds_read_b64_tr_b16 v[98:99], v160 offset:1024
  v_mfma_f32_16x16x32_bf16 a[132:135], v[112:115], v[68:71], a[132:135]
  s_add_u32 m0, s39, 0
  s_add_u32 s34, s35, 0
  buffer_load_dwordx4 v4, s[12:15], s34 offen lds
  v_mfma_f32_16x16x32_bf16 a[164:167], v[116:119], v[68:71], a[164:167]
  ds_read_b64_tr_b16 v[100:101], v161 offset:0
  v_mfma_f32_16x16x32_bf16 a[136:139], v[112:115], v[72:75], a[136:139]
  ds_read_b64_tr_b16 v[102:103], v161 offset:1024
  v_mfma_f32_16x16x32_bf16 a[168:171], v[116:119], v[72:75], a[168:171]
  s_add_u32 m0, s39, 1024
  s_add_u32 s34, s35, 16384
  buffer_load_dwordx4 v4, s[12:15], s34 offen lds
  v_mfma_f32_16x16x32_bf16 a[140:143], v[112:115], v[76:79], a[140:143]
  ds_read_b128 v[32:35], v159 offset:0
  v_mfma_f32_16x16x32_bf16 a[172:175], v[116:119], v[76:79], a[172:175]
  ds_read_b128 v[36:39], v159 offset:1024
  v_mfma_f32_16x16x32_bf16 a[144:147], v[112:115], v[80:83], a[144:147]
  s_add_u32 m0, s40, 0
  s_add_u32 s34, s36, 0
  buffer_load_dwordx4 v5, s[16:19], s34 offen lds
  v_mfma_f32_16x16x32_bf16 a[176:179], v[116:119], v[80:83], a[176:179]
  ds_read_b128 v[40:43], v159 offset:2048
  v_mfma_f32_16x16x32_bf16 a[148:151], v[112:115], v[84:87], a[148:151]
  ds_read_b128 v[44:47], v159 offset:3072
  v_mfma_f32_16x16x32_bf16 a[180:183], v[116:119], v[84:87], a[180:183]
  s_add_u32 m0, s40, 1024
  s_add_u32 s34, s36, 32768
  buffer_load_dwordx4 v5, s[16:19], s34 offen lds
  s_add_u32 s35, s35, 64
  s_add_u32 s36, s36, 262144
  v_mfma_f32_16x16x32_bf16 a[152:155], v[112:115], v[88:91], a[152:155]
  ds_read_b128 v[48:51], v159 offset:4096
  v_mfma_f32_16x16x32_bf16 a[184:187], v[116:119], v[88:91], a[184:187]
  ds_read_b128 v[52:55], v159 offset:5120
  v_mfma_f32_16x16x32_bf16 a[156:159], v[112:115], v[92:95], a[156:159]
  ds_read_b128 v[56:59], v159 offset:6144
  v_mfma_f32_16x16x32_bf16 a[188:191], v[116:119], v[92:95], a[188:191]
  ds_read_b128 v[60:63], v159 offset:7168
  s_cmp_eq_u32 s94, -1
  s_nop 5
  s_cbranch_scc1 L_q_two
  s_lshr_b32 s32, s93, 5
  s_lshl_b32 s32, s32, 21
  s_and_b32 s33, s93, 31
  s_lshl_b32 s33, s33, 14
  s_add_u32 s32, s32, s33
  s_lshl_b32 s33, s28, 12
  s_add_u32 s32, s32, s33
  s_lshr_b32 s32, s32, 1
  s_add_u32 s41, s32, 50331648
  s_lshl_b32 s43, s93, 7
  s_add_u32 s43, s43, 393216
  s_cmp_eq_u32 s97, 0
  s_cselect_b32 s43, s43, 0x7f000000
  s_waitcnt vmcnt(13) lgkmcnt(0)
  s_barrier
  v_mfma_f32_16x16x32_bf16 a[0:3], v[96:99], v[32:35], 0
  ds_read_b64_tr_b16 v[112:113], v160 offset:24576
  v_accvgpr_read_b32 v128, a128
  v_accvgpr_read_b32 v129, a129
  v_accvgpr_read_b32 v130, a130
  v_mfma_f32_16x16x32_bf16 a[32:35], v[100:103], v[32:35], 0
  ds_read_b64_tr_b16 v[114:115], v160 offset:25600
  v_accvgpr_read_b32 v131, a131
  v_accvgpr_read_b32 v132, a160
  v_accvgpr_read_b32 v133, a161
  v_mfma_f32_16x16x32_bf16 a[4:7], v[96:99], v[36:39], 0
  s_add_u32 m0, s39, 24576
  s_add_u32 s34, s35, 0
  buffer_load_dwordx4 v4, s[12:15], s34 offen lds
  v_accvgpr_read_b32 v134, a162
  v_accvgpr_read_b32 v135, a163
  v_cvt_pk_bf16_f32 v136, v128, v129
  v_mfma_f32_16x16x32_bf16 a[36:39], v[100:103], v[36:39], 0
  ds_read_b64_tr_b16 v[116:117], v161 offset:24576
  v_cvt_pk_bf16_f32 v137, v130, v131
  v_cvt_pk_bf16_f32 v138, v132, v133
  v_cvt_pk_bf16_f32 v139, v134, v135
  v_mfma_f32_16x16x32_bf16 a[8:11], v[96:99], v[40:43], 0
  ds_read_b64_tr_b16 v[118:119], v161 offset:25600
  s_add_u32 s33, s41, 0
  buffer_store_dwordx4 v[136:139], v6, s[8:11], s33 offen offset:0 sc1
  v_mfma_f32_16x16x32_bf16 a[40:43], v[100:103], v[40:43], 0
  s_add_u32 m0, s39, 25600
  s_add_u32 s34, s35, 16384
  buffer_load_dwordx4 v4, s[12:15], s34 offen lds
  v_mfma_f32_16x16x32_bf16 a[12:15], v[96:99], v[44:47], 0
  ds_read_b128 v[64:67], v159 offset:24576
  v_mfma_f32_16x16x32_bf16 a[44:47], v[100:103], v[44:47], 0
  ds_read_b128 v[68:71], v159 offset:25600
  v_mfma_f32_16x16x32_bf16 a[16:19], v[96:99], v[48:51], 0
  s_add_u32 m0, s40, 24576
  s_add_u32 s34, s36, 0
  buffer_load_dwordx4 v5, s[16:19], s34 offen lds
  v_mfma_f32_16x16x32_bf16 a[48:51], v[100:103], v[48:51], 0
  ds_read_b128 v[72:75], v159 offset:26624
  v_mfma_f32_16x16x32_bf16 a[20:23], v[96:99], v[52:55], 0
  ds_read_b128 v[76:79], v159 offset:27648
  v_mfma_f32_16x16x32_bf16 a[52:55], v[100:103], v[52:55], 0
  s_add_u32 m0, s40, 25600
  s_add_u32 s34, s36, 32768
  buffer_load_dwordx4 v5, s[16:19], s34 offen lds
  s_add_u32 s35, s35, 64
  s_add_u32 s36, s36, 262144
  v_mfma_f32_16x16x32_bf16 a[24:27], v[96:99], v[56:59], 0
  ds_read_b128 v[80:83], v159 offset:28672
  v_mfma_f32_16x16x32_bf16 a[56:59], v[100:103], v[56:59], 0
  ds_read_b128 v[84:87], v159 offset:29696
  v_mfma_f32_16x16x32_bf16 a[28:31], v[96:99], v[60:63], 0
  ds_read_b128 v[88:91], v159 offset:30720
  v_mfma_f32_16x16x32_bf16 a[60:63], v[100:103], v[60:63], 0
  ds_read_b128 v[92:95], v159 offset:31744
  s_waitcnt vmcnt(13) lgkmcnt(0)
  s_barrier
  v_mfma_f32_16x16x32_bf16 a[0:3], v[112:115], v[64:67], a[0:3]
  ds_read_b64_tr_b16 v[96:97], v163 offset:0
  v_accvgpr_read_b32 v140, a132
  v_accvgpr_read_b32 v141, a133
  v_accvgpr_read_b32 v142, a134
  v_mfma_f32_16x16x32_bf16 a[32:35], v[116:119], v[64:67], a[32:35]
  ds_read_b64_tr_b16 v[98:99], v163 offset:1024
  v_accvgpr_read_b32 v143, a135
  v_accvgpr_read_b32 v144, a164
  v_accvgpr_read_b32 v145, a165
  v_mfma_f32_16x16x32_bf16 a[4:7], v[112:115], v[68:71], a[4:7]
  s_add_u32 m0, s39, 49152
  s_add_u32 s34, s35, 0
  buffer_load_dwordx4 v4, s[12:15], s34 offen lds
  v_accvgpr_read_b32 v146, a166
  v_accvgpr_read_b32 v147, a167
  v_cvt_pk_bf16_f32 v148, v140, v141
  v_mfma_f32_16x16x32_bf16 a[36:39], v[116:119], v[68:71], a[36:39]
  ds_read_b64_tr_b16 v[100:101], v164 offset:0
  v_cvt_pk_bf16_f32 v149, v142, v143
  v_cvt_pk_bf16_f32 v150, v144, v145
  v_cvt_pk_bf16_f32 v151, v146, v147
  v_mfma_f32_16x16x32_bf16 a[8:11], v[112:115], v[72:75], a[8:11]
  ds_read_b64_tr_b16 v[102:103], v164 offset:1024
  s_add_u32 s33, s41, 0
  buffer_store_dwordx4 v[148:151], v6, s[8:11], s33 offen offset:1024 sc1
  v_mfma_f32_16x16x32_bf16 a[40:43], v[116:119], v[72:75], a[40:43]
  s_add_u32 m0, s39, 50176
  s_add_u32 s34, s35, 16384
  buffer_load_dwordx4 v4, s[12:15], s34 offen lds
  v_mfma_f32_16x16x32_bf16 a[12:15], v[112:115], v[76:79], a[12:15]
  ds_read_b128 v[32:35], v162 offset:0
  v_mfma_f32_16x16x32_bf16 a[44:47], v[116:119], v[76:79], a[44:47]
  ds_read_b128 v[36:39], v162 offset:1024
  v_mfma_f32_16x16x32_bf16 a[16:19], v[112:115], v[80:83], a[16:19]
  s_add_u32 m0, s40, 49152
  s_add_u32 s34, s36, 0
  buffer_load_dwordx4 v5, s[16:19], s34 offen lds
  v_mfma_f32_16x16x32_bf16 a[48:51], v[116:119], v[80:83], a[48:51]
  ds_read_b128 v[40:43], v162 offset:2048
  v_mfma_f32_16x16x32_bf16 a[20:23], v[112:115], v[84:87], a[20:23]
  ds_read_b128 v[44:47], v162 offset:3072
  v_mfma_f32_16x16x32_bf16 a[52:55], v[116:119], v[84:87], a[52:55]
  s_add_u32 m0, s40, 50176
  s_add_u32 s34, s36, 32768
  buffer_load_dwordx4 v5, s[16:19], s34 offen lds
  s_add_u32 s35, s35, 64
  s_add_u32 s36, s36, 262144
  v_mfma_f32_16x16x32_bf16 a[24:27], v[112:115], v[88:91], a[24:27]
  ds_read_b128 v[48:51], v162 offset:4096
  v_mfma_f32_16x16x32_bf16 a[56:59], v[116:119], v[88:91], a[56:59]
  ds_read_b128 v[52:55], v162 offset:5120
  v_mfma_f32_16x16x32_bf16 a[28:31], v[112:115], v[92:95], a[28:31]
  ds_read_b128 v[56:59], v162 offset:6144
  v_mfma_f32_16x16x32_bf16 a[60:63], v[116:119], v[92:95], a[60:63]
  ds_read_b128 v[60:63], v162 offset:7168
  s_waitcnt vmcnt(14) lgkmcnt(0)
  s_barrier
  v_mfma_f32_16x16x32_bf16 a[0:3], v[96:99], v[32:35], a[0:3]
  ds_read_b64_tr_b16 v[112:113], v163 offset:24576
  v_accvgpr_read_b32 v128, a136
  v_accvgpr_read_b32 v129, a137
  v_accvgpr_read_b32 v130, a138
  v_mfma_f32_16x16x32_bf16 a[32:35], v[100:103], v[32:35], a[32:35]
  ds_read_b64_tr_b16 v[114:115], v163 offset:25600
  v_accvgpr_read_b32 v131, a139
  v_accvgpr_read_b32 v132, a168
  v_accvgpr_read_b32 v133, a169
  v_mfma_f32_16x16x32_bf16 a[4:7], v[96:99], v[36:39], a[4:7]
  s_add_u32 m0, s39, 73728
  s_add_u32 s34, s35, 0
  buffer_load_dwordx4 v4, s[12:15], s34 offen lds
  v_accvgpr_read_b32 v134, a170
  v_accvgpr_read_b32 v135, a171
  v_cvt_pk_bf16_f32 v136, v128, v129
  v_mfma_f32_16x16x32_bf16 a[36:39], v[100:103], v[36:39], a[36:39]
  ds_read_b64_tr_b16 v[116:117], v164 offset:24576
  v_cvt_pk_bf16_f32 v137, v130, v131
  v_cvt_pk_bf16_f32 v138, v132, v133
  v_cvt_pk_bf16_f32 v139, v134, v135
  v_mfma_f32_16x16x32_bf16 a[8:11], v[96:99], v[40:43], a[8:11]
  ds_read_b64_tr_b16 v[118:119], v164 offset:25600
  s_add_u32 s33, s41, 262144
  buffer_store_dwordx4 v[136:139], v6, s[8:11], s33 offen offset:0 sc1
  v_mfma_f32_16x16x32_bf16 a[40:43], v[100:103], v[40:43], a[40:43]
  s_add_u32 m0, s39, 74752
  s_add_u32 s34, s35, 16384
  buffer_load_dwordx4 v4, s[12:15], s34 offen lds
  v_mfma_f32_16x16x32_bf16 a[12:15], v[96:99], v[44:47], a[12:15]
  ds_read_b128 v[64:67], v162 offset:24576
  v_mfma_f32_16x16x32_bf16 a[44:47], v[100:103], v[44:47], a[44:47]
  ds_read_b128 v[68:71], v162 offset:25600
  v_mfma_f32_16x16x32_bf16 a[16:19], v[96:99], v[48:51], a[16:19]
  s_add_u32 m0, s40, 73728
  s_add_u32 s34, s36, 0
  buffer_load_dwordx4 v5, s[16:19], s34 offen lds
  v_mfma_f32_16x16x32_bf16 a[48:51], v[100:103], v[48:51], a[48:51]
  ds_read_b128 v[72:75], v162 offset:26624
  v_mfma_f32_16x16x32_bf16 a[20:23], v[96:99], v[52:55], a[20:23]
  ds_read_b128 v[76:79], v162 offset:27648
  v_mfma_f32_16x16x32_bf16 a[52:55], v[100:103], v[52:55], a[52:55]
  s_add_u32 m0, s40, 74752
  s_add_u32 s34, s36, 32768
  buffer_load_dwordx4 v5, s[16:19], s34 offen lds
  s_add_u32 s35, s35, 64
  s_add_u32 s36, s36, 262144
  v_mfma_f32_16x16x32_bf16 a[24:27], v[96:99], v[56:59], a[24:27]
  ds_read_b128 v[80:83], v162 offset:28672
  v_mfma_f32_16x16x32_bf16 a[56:59], v[100:103], v[56:59], a[56:59]
  ds_read_b128 v[84:87], v162 offset:29696
  v_mfma_f32_16x16x32_bf16 a[28:31], v[96:99], v[60:63], a[28:31]
  ds_read_b128 v[88:91], v162 offset:30720
  v_mfma_f32_16x16x32_bf16 a[60:63], v[100:103], v[60:63], a[60:63]
  ds_read_b128 v[92:95], v162 offset:31744
  s_waitcnt vmcnt(15) lgkmcnt(0)
  s_barrier
  v_mfma_f32_16x16x32_bf16 a[0:3], v[112:115], v[64:67], a[0:3]
  ds_read_b64_tr_b16 v[96:97], v157 offset:0
  v_accvgpr_read_b32 v140, a140
  v_accvgpr_read_b32 v141, a141
  v_accvgpr_read_b32 v142, a142
  v_mfma_f32_16x16x32_bf16 a[32:35], v[116:119], v[64:67], a[32:35]
  ds_read_b64_tr_b16 v[98:99], v157 offset:1024
  v_accvgpr_read_b32 v143, a143
  v_accvgpr_read_b32 v144, a172
  v_accvgpr_read_b32 v145, a173
  v_mfma_f32_16x16x32_bf16 a[4:7], v[112:115], v[68:71], a[4:7]
  s_add_u32 m0, s39, 98304
  s_add_u32 s34, s35, 0
  buffer_load_dwordx4 v4, s[12:15], s34 offen lds
  v_accvgpr_read_b32 v146, a174
  v_accvgpr_read_b32 v147, a175
  v_cvt_pk_bf16_f32 v148, v140, v141
  v_mfma_f32_16x16x32_bf16 a[36:39], v[116:119], v[68:71], a[36:39]
  ds_read_b64_tr_b16 v[100:101], v158 offset:0
  v_cvt_pk_bf16_f32 v149, v142, v143
  v_cvt_pk_bf16_f32 v150, v144, v145
  v_cvt_pk_bf16_f32 v151, v146, v147
  v_mfma_f32_16x16x32_bf16 a[8:11], v[112:115], v[72:75], a[8:11]
  ds_read_b64_tr_b16 v[102:103], v158 offset:1024
  s_add_u32 s33, s41, 262144
  buffer_store_dwordx4 v[148:151], v6, s[8:11], s33 offen offset:1024 sc1
  v_mfma_f32_16x16x32_bf16 a[40:43], v[116:119], v[72:75], a[40:43]
  s_add_u32 m0, s39, 99328
  s_add_u32 s34, s35, 16384
  buffer_load_dwordx4 v4, s[12:15], s34 offen lds
  v_mfma_f32_16x16x32_bf16 a[12:15], v[112:115], v[76:79], a[12:15]
  ds_read_b128 v[32:35], v156 offset:0
  v_mfma_f32_16x16x32_bf16 a[44:47], v[116:119], v[76:79], a[44:47]
  ds_read_b128 v[36:39], v156 offset:1024
  v_mfma_f32_16x16x32_bf16 a[16:19], v[112:115], v[80:83], a[16:19]
  s_add_u32 m0, s40, 98304
  s_add_u32 s34, s36, 0
  buffer_load_dwordx4 v5, s[16:19], s34 offen lds
  v_mfma_f32_16x16x32_bf16 a[48:51], v[116:119], v[80:83], a[48:51]
  ds_read_b128 v[40:43], v156 offset:2048
  v_mfma_f32_16x16x32_bf16 a[20:23], v[112:115], v[84:87], a[20:23]
  ds_read_b128 v[44:47], v156 offset:3072
  v_mfma_f32_16x16x32_bf16 a[52:55], v[116:119], v[84:87], a[52:55]
  s_add_u32 m0, s40, 99328
  s_add_u32 s34, s36, 32768
  buffer_load_dwordx4 v5, s[16:19], s34 offen lds
  s_add_u32 s35, s35, 64
  s_add_u32 s36, s36, 262144
  v_mfma_f32_16x16x32_bf16 a[24:27], v[112:115], v[88:91], a[24:27]
  ds_read_b128 v[48:51], v156 offset:4096
  v_mfma_f32_16x16x32_bf16 a[56:59], v[116:119], v[88:91], a[56:59]
  ds_read_b128 v[52:55], v156 offset:5120
  v_mfma_f32_16x16x32_bf16 a[28:31], v[112:115], v[92:95], a[28:31]
  ds_read_b128 v[56:59], v156 offset:6144
  v_mfma_f32_16x16x32_bf16 a[60:63], v[116:119], v[92:95], a[60:63]
  ds_read_b128 v[60:63], v156 offset:7168
  s_waitcnt vmcnt(15) lgkmcnt(0)
  s_barrier
  v_mfma_f32_16x16x32_bf16 a[0:3], v[96:99], v[32:35], a[0:3]
  ds_read_b64_tr_b16 v[112:113], v157 offset:24576
  v_accvgpr_read_b32 v128, a144
  v_accvgpr_read_b32 v129, a145
  v_accvgpr_read_b32 v130, a146
  v_mfma_f32_16x16x32_bf16 a[32:35], v[100:103], v[32:35], a[32:35]
  ds_read_b64_tr_b16 v[114:115], v157 offset:25600
  v_accvgpr_read_b32 v131, a147
  v_accvgpr_read_b32 v132, a176
  v_accvgpr_read_b32 v133, a177
  v_mfma_f32_16x16x32_bf16 a[4:7], v[96:99], v[36:39], a[4:7]
  s_add_u32 m0, s39, 122880
  s_add_u32 s34, s35, 0
  buffer_load_dwordx4 v4, s[12:15], s34 offen lds
  v_accvgpr_read_b32 v134, a178
  v_accvgpr_read_b32 v135, a179
  v_cvt_pk_bf16_f32 v136, v128, v129
  v_mfma_f32_16x16x32_bf16 a[36:39], v[100:103], v[36:39], a[36:39]
  ds_read_b64_tr_b16 v[116:117], v158 offset:24576
  v_cvt_pk_bf16_f32 v137, v130, v131
  v_cvt_pk_bf16_f32 v138, v132, v133
  v_cvt_pk_bf16_f32 v139, v134, v135
  v_mfma_f32_16x16x32_bf16 a[8:11], v[96:99], v[40:43], a[8:11]
  ds_read_b64_tr_b16 v[118:119], v158 offset:25600
  s_add_u32 s33, s41, 524288
  buffer_store_dwordx4 v[136:139], v6, s[8:11], s33 offen offset:0 sc1
  v_mfma_f32_16x16x32_bf16 a[40:43], v[100:103], v[40:43], a[40:43]
  s_add_u32 m0, s39, 123904
  s_add_u32 s34, s35, 16384
  buffer_load_dwordx4 v4, s[12:15], s34 offen lds
  v_mfma_f32_16x16x32_bf16 a[12:15], v[96:99], v[44:47], a[12:15]
  ds_read_b128 v[64:67], v156 offset:24576
  v_mfma_f32_16x16x32_bf16 a[44:47], v[100:103], v[44:47], a[44:47]
  ds_read_b128 v[68:71], v156 offset:25600
  v_mfma_f32_16x16x32_bf16 a[16:19], v[96:99], v[48:51], a[16:19]
  s_add_u32 m0, s40, 122880
  s_add_u32 s34, s36, 0
  buffer_load_dwordx4 v5, s[16:19], s34 offen lds
  v_mfma_f32_16x16x32_bf16 a[48:51], v[100:103], v[48:51], a[48:51]
  ds_read_b128 v[72:75], v156 offset:26624
  v_mfma_f32_16x16x32_bf16 a[20:23], v[96:99], v[52:55], a[20:23]
  ds_read_b128 v[76:79], v156 offset:27648
  v_mfma_f32_16x16x32_bf16 a[52:55], v[100:103], v[52:55], a[52:55]
  s_add_u32 m0, s40, 123904
  s_add_u32 s34, s36, 32768
  buffer_load_dwordx4 v5, s[16:19], s34 offen lds
  s_add_u32 s35, s35, 64
  s_add_u32 s36, s36, 262144
  v_mfma_f32_16x16x32_bf16 a[24:27], v[96:99], v[56:59], a[24:27]
  ds_read_b128 v[80:83], v156 offset:28672
  v_mfma_f32_16x16x32_bf16 a[56:59], v[100:103], v[56:59], a[56:59]
  ds_read_b128 v[84:87], v156 offset:29696
  v_mfma_f32_16x16x32_bf16 a[28:31], v[96:99], v[60:63], a[28:31]
  ds_read_b128 v[88:91], v156 offset:30720
  v_mfma_f32_16x16x32_bf16 a[60:63], v[100:103], v[60:63], a[60:63]
  ds_read_b128 v[92:95], v156 offset:31744
  s_waitcnt vmcnt(15) lgkmcnt(0)
  s_barrier
  v_mfma_f32_16x16x32_bf16 a[0:3], v[112:115], v[64:67], a[0:3]
  ds_read_b64_tr_b16 v[96:97], v160 offset:0
  v_accvgpr_read_b32 v140, a148
  v_accvgpr_read_b32 v141, a149
  v_accvgpr_read_b32 v142, a150
  v_mfma_f32_16x16x32_bf16 a[32:35], v[116:119], v[64:67], a[32:35]
  ds_read_b64_tr_b16 v[98:99], v160 offset:1024
  v_accvgpr_read_b32 v143, a151
  v_accvgpr_read_b32 v144, a180
  v_accvgpr_read_b32 v145, a181
  v_mfma_f32_16x16x32_bf16 a[4:7], v[112:115], v[68:71], a[4:7]
  s_add_u32 m0, s39, 0
  s_add_u32 s34, s35, 0
  buffer_load_dwordx4 v4, s[12:15], s34 offen lds
  v_accvgpr_read_b32 v146, a182
  v_accvgpr_read_b32 v147, a183
  v_cvt_pk_bf16_f32 v148, v140, v141
  v_mfma_f32_16x16x32_bf16 a[36:39], v[116:119], v[68:71], a[36:39]
  ds_read_b64_tr_b16 v[100:101], v161 offset:0
  v_cvt_pk_bf16_f32 v149, v142, v143
  v_cvt_pk_bf16_f32 v150, v144, v145
  v_cvt_pk_bf16_f32 v151, v146, v147
  v_mfma_f32_16x16x32_bf16 a[8:11], v[112:115], v[72:75], a[8:11]
  ds_read_b64_tr_b16 v[102:103], v161 offset:1024
  s_add_u32 s33, s41, 524288
  buffer_store_dwordx4 v[148:151], v6, s[8:11], s33 offen offset:1024 sc1
  v_mfma_f32_16x16x32_bf16 a[40:43], v[116:119], v[72:75], a[40:43]
  s_add_u32 m0, s39, 1024
  s_add_u32 s34, s35, 16384
  buffer_load_dwordx4 v4, s[12:15], s34 offen lds
  v_mfma_f32_16x16x32_bf16 a[12:15], v[112:115], v[76:79], a[12:15]
  ds_read_b128 v[32:35], v159 offset:0
  v_mfma_f32_16x16x32_bf16 a[44:47], v[116:119], v[76:79], a[44:47]
  ds_read_b128 v[36:39], v159 offset:1024
  v_mfma_f32_16x16x32_bf16 a[16:19], v[112:115], v[80:83], a[16:19]
  s_add_u32 m0, s40, 0
  s_add_u32 s34, s36, 0
  buffer_load_dwordx4 v5, s[16:19], s34 offen lds
  v_mfma_f32_16x16x32_bf16 a[48:51], v[116:119], v[80:83], a[48:51]
  ds_read_b128 v[40:43], v159 offset:2048
  v_mfma_f32_16x16x32_bf16 a[20:23], v[112:115], v[84:87], a[20:23]
  ds_read_b128 v[44:47], v159 offset:3072
  v_mfma_f32_16x16x32_bf16 a[52:55], v[116:119], v[84:87], a[52:55]
  s_add_u32 m0, s40, 1024
  s_add_u32 s34, s36, 32768
  buffer_load_dwordx4 v5, s[16:19], s34 offen lds
  s_add_u32 s35, s35, 64
  s_add_u32 s36, s36, 262144
  v_mfma_f32_16x16x32_bf16 a[24:27], v[112:115], v[88:91], a[24:27]
  ds_read_b128 v[48:51], v159 offset:4096
  v_mfma_f32_16x16x32_bf16 a[56:59], v[116:119], v[88:91], a[56:59]
  ds_read_b128 v[52:55], v159 offset:5120
  v_mfma_f32_16x16x32_bf16 a[28:31], v[112:115], v[92:95], a[28:31]
  ds_read_b128 v[56:59], v159 offset:6144
  v_mfma_f32_16x16x32_bf16 a[60:63], v[116:119], v[92:95], a[60:63]
  ds_read_b128 v[60:63], v159 offset:7168
  s_waitcnt vmcnt(15) lgkmcnt(0)
  s_barrier
  v_mfma_f32_16x16x32_bf16 a[0:3], v[96:99], v[32:35], a[0:3]
  ds_read_b64_tr_b16 v[112:113], v160 offset:24576
  v_accvgpr_read_b32 v128, a152
  v_accvgpr_read_b32 v129, a153
  v_accvgpr_read_b32 v130, a154
  v_mfma_f32_16x16x32_bf16 a[32:35], v[100:103], v[32:35], a[32:35]
  ds_read_b64_tr_b16 v[114:115], v160 offset:25600
  v_accvgpr_read_b32 v131, a155
  v_accvgpr_read_b32 v132, a184
  v_accvgpr_read_b32 v133, a185
  v_mfma_f32_16x16x32_bf16 a[4:7], v[96:99], v[36:39], a[4:7]
  s_add_u32 m0, s39, 24576
  s_add_u32 s34, s35, 0
  buffer_load_dwordx4 v4, s[12:15], s34 offen lds
  v_accvgpr_read_b32 v134, a186
  v_accvgpr_read_b32 v135, a187
  v_cvt_pk_bf16_f32 v136, v128, v129
  v_mfma_f32_16x16x32_bf16 a[36:39], v[100:103], v[36:39], a[36:39]
  ds_read_b64_tr_b16 v[116:117], v161 offset:24576
  v_cvt_pk_bf16_f32 v137, v130, v131
  v_cvt_pk_bf16_f32 v138, v132, v133
  v_cvt_pk_bf16_f32 v139, v134, v135
  v_mfma_f32_16x16x32_bf16 a[8:11], v[96:99], v[40:43], a[8:11]
  ds_read_b64_tr_b16 v[118:119], v161 offset:25600
  s_add_u32 s33, s41, 786432
  buffer_store_dwordx4 v[136:139], v6, s[8:11], s33 offen offset:0 sc1
  v_mfma_f32_16x16x32_bf16 a[40:43], v[100:103], v[40:43], a[40:43]
  s_add_u32 m0, s39, 25600
  s_add_u32 s34, s35, 16384
  buffer_load_dwordx4 v4, s[12:15], s34 offen lds
  v_mfma_f32_16x16x32_bf16 a[12:15], v[96:99], v[44:47], a[12:15]
  ds_read_b128 v[64:67], v159 offset:24576
  v_mfma_f32_16x16x32_bf16 a[44:47], v[100:103], v[44:47], a[44:47]
  ds_read_b128 v[68:71], v159 offset:25600
  v_mfma_f32_16x16x32_bf16 a[16:19], v[96:99], v[48:51], a[16:19]
  s_add_u32 m0, s40, 24576
  s_add_u32 s34, s36, 0
  buffer_load_dwordx4 v5, s[16:19], s34 offen lds
  v_mfma_f32_16x16x32_bf16 a[48:51], v[100:103], v[48:51], a[48:51]
  ds_read_b128 v[72:75], v159 offset:26624
  v_mfma_f32_16x16x32_bf16 a[20:23], v[96:99], v[52:55], a[20:23]
  ds_read_b128 v[76:79], v159 offset:27648
  v_mfma_f32_16x16x32_bf16 a[52:55], v[100:103], v[52:55], a[52:55]
  s_add_u32 m0, s40, 25600
  s_add_u32 s34, s36, 32768
  buffer_load_dwordx4 v5, s[16:19], s34 offen lds
  s_add_u32 s35, s35, 64
  s_add_u32 s36, s36, 262144
  v_mfma_f32_16x16x32_bf16 a[24:27], v[96:99], v[56:59], a[24:27]
  ds_read_b128 v[80:83], v159 offset:28672
  v_mfma_f32_16x16x32_bf16 a[56:59], v[100:103], v[56:59], a[56:59]
  ds_read_b128 v[84:87], v159 offset:29696
  v_mfma_f32_16x16x32_bf16 a[28:31], v[96:99], v[60:63], a[28:31]
  ds_read_b128 v[88:91], v159 offset:30720
  v_mfma_f32_16x16x32_bf16 a[60:63], v[100:103], v[60:63], a[60:63]
  ds_read_b128 v[92:95], v159 offset:31744
  s_waitcnt vmcnt(15) lgkmcnt(0)
  s_barrier
  v_mfma_f32_16x16x32_bf16 a[0:3], v[112:115], v[64:67], a[0:3]
  ds_read_b64_tr_b16 v[96:97], v163 offset:0
  v_accvgpr_read_b32 v140, a156
  v_accvgpr_read_b32 v141, a157
  v_accvgpr_read_b32 v142, a158
  v_mfma_f32_16x16x32_bf16 a[32:35], v[116:119], v[64:67], a[32:35]
  ds_read_b64_tr_b16 v[98:99], v163 offset:1024
  v_accvgpr_read_b32 v143, a159
  v_accvgpr_read_b32 v144, a188
  v_accvgpr_read_b32 v145, a189
  v_mfma_f32_16x16x32_bf16 a[4:7], v[112:115], v[68:71], a[4:7]
  s_add_u32 m0, s39, 49152
  s_add_u32 s34, s35, 0
  buffer_load_dwordx4 v4, s[12:15], s34 offen lds
  v_accvgpr_read_b32 v146, a190
  v_accvgpr_read_b32 v147, a191
  v_cvt_pk_bf16_f32 v148, v140, v141
  v_mfma_f32_16x16x32_bf16 a[36:39], v[116:119], v[68:71], a[36:39]
  ds_read_b64_tr_b16 v[100:101], v164 offset:0
  v_cvt_pk_bf16_f32 v149, v142, v143
  v_cvt_pk_bf16_f32 v150, v144, v145
  v_cvt_pk_bf16_f32 v151, v146, v147
  v_mfma_f32_16x16x32_bf16 a[8:11], v[112:115], v[72:75], a[8:11]
  ds_read_b64_tr_b16 v[102:103], v164 offset:1024
  s_add_u32 s33, s41, 786432
  buffer_store_dwordx4 v[148:151], v6, s[8:11], s33 offen offset:1024 sc1
  v_mfma_f32_16x16x32_bf16 a[40:43], v[116:119], v[72:75], a[40:43]
  s_add_u32 m0, s39, 50176
  s_add_u32 s34, s35, 16384
  buffer_load_dwordx4 v4, s[12:15], s34 offen lds
  v_mfma_f32_16x16x32_bf16 a[12:15], v[112:115], v[76:79], a[12:15]
  ds_read_b128 v[32:35], v162 offset:0
  v_mfma_f32_16x16x32_bf16 a[44:47], v[116:119], v[76:79], a[44:47]
  ds_read_b128 v[36:39], v162 offset:1024
  v_mfma_f32_16x16x32_bf16 a[16:19], v[112:115], v[80:83], a[16:19]
  s_add_u32 m0, s40, 49152
  s_add_u32 s34, s36, 0
  buffer_load_dwordx4 v5, s[16:19], s34 offen lds
  v_mfma_f32_16x16x32_bf16 a[48:51], v[116:119], v[80:83], a[48:51]
  ds_read_b128 v[40:43], v162 offset:2048
  v_mfma_f32_16x16x32_bf16 a[20:23], v[112:115], v[84:87], a[20:23]
  ds_read_b128 v[44:47], v162 offset:3072
  v_mfma_f32_16x16x32_bf16 a[52:55], v[116:119], v[84:87], a[52:55]
  s_add_u32 m0, s40, 50176
  s_add_u32 s34, s36, 32768
  buffer_load_dwordx4 v5, s[16:19], s34 offen lds
  s_add_u32 s35, s35, 64
  s_add_u32 s36, s36, 262144
  v_mfma_f32_16x16x32_bf16 a[24:27], v[112:115], v[88:91], a[24:27]
  ds_read_b128 v[48:51], v162 offset:4096
  v_mfma_f32_16x16x32_bf16 a[56:59], v[116:119], v[88:91], a[56:59]
  ds_read_b128 v[52:55], v162 offset:5120
  v_mfma_f32_16x16x32_bf16 a[28:31], v[112:115], v[92:95], a[28:31]
  ds_read_b128 v[56:59], v162 offset:6144
  v_mfma_f32_16x16x32_bf16 a[60:63], v[116:119], v[92:95], a[60:63]
  ds_read_b128 v[60:63], v162 offset:7168
  s_waitcnt vmcnt(15) lgkmcnt(0)
  s_barrier
  v_mfma_f32_16x16x32_bf16 a[0:3], v[96:99], v[32:35], a[0:3]
  ds_read_b64_tr_b16 v[112:113], v163 offset:24576
  v_mfma_f32_16x16x32_bf16 a[32:35], v[100:103], v[32:35], a[32:35]
  ds_read_b64_tr_b16 v[114:115], v163 offset:25600
  v_mfma_f32_16x16x32_bf16 a[4:7], v[96:99], v[36:39], a[4:7]
  s_add_u32 m0, s39, 73728
  s_add_u32 s34, s35, 0
  buffer_load_dwordx4 v4, s[12:15], s34 offen lds
  v_mfma_f32_16x16x32_bf16 a[36:39], v[100:103], v[36:39], a[36:39]
  ds_read_b64_tr_b16 v[116:117], v164 offset:24576
  v_mfma_f32_16x16x32_bf16 a[8:11], v[96:99], v[40:43], a[8:11]
  ds_read_b64_tr_b16 v[118:119], v164 offset:25600
  v_mfma_f32_16x16x32_bf16 a[40:43], v[100:103], v[40:43], a[40:43]
  s_add_u32 m0, s39, 74752
  s_add_u32 s34, s35, 16384
  buffer_load_dwordx4 v4, s[12:15], s34 offen lds
  v_mfma_f32_16x16x32_bf16 a[12:15], v[96:99], v[44:47], a[12:15]
  ds_read_b128 v[64:67], v162 offset:24576
  v_mfma_f32_16x16x32_bf16 a[44:47], v[100:103], v[44:47], a[44:47]
  ds_read_b128 v[68:71], v162 offset:25600
  v_mfma_f32_16x16x32_bf16 a[16:19], v[96:99], v[48:51], a[16:19]
  s_add_u32 m0, s40, 73728
  s_add_u32 s34, s36, 0
  buffer_load_dwordx4 v5, s[16:19], s34 offen lds
  v_mfma_f32_16x16x32_bf16 a[48:51], v[100:103], v[48:51], a[48:51]
  ds_read_b128 v[72:75], v162 offset:26624
  v_mfma_f32_16x16x32_bf16 a[20:23], v[96:99], v[52:55], a[20:23]
  ds_read_b128 v[76:79], v162 offset:27648
  v_mfma_f32_16x16x32_bf16 a[52:55], v[100:103], v[52:55], a[52:55]
  s_add_u32 m0, s40, 74752
  s_add_u32 s34, s36, 32768
  buffer_load_dwordx4 v5, s[16:19], s34 offen lds
  s_add_u32 s35, s35, 64
  s_add_u32 s36, s36, 262144
  v_mfma_f32_16x16x32_bf16 a[24:27], v[96:99], v[56:59], a[24:27]
  ds_read_b128 v[80:83], v162 offset:28672
  v_mfma_f32_16x16x32_bf16 a[56:59], v[100:103], v[56:59], a[56:59]
  ds_read_b128 v[84:87], v162 offset:29696
  v_mfma_f32_16x16x32_bf16 a[28:31], v[96:99], v[60:63], a[28:31]
  ds_read_b128 v[88:91], v162 offset:30720
  v_mfma_f32_16x16x32_bf16 a[60:63], v[100:103], v[60:63], a[60:63]
  ds_read_b128 v[92:95], v162 offset:31744
  s_waitcnt vmcnt(14) lgkmcnt(0)
  s_barrier
  v_mfma_f32_16x16x32_bf16 a[0:3], v[112:115], v[64:67], a[0:3]
  ds_read_b64_tr_b16 v[96:97], v157 offset:0
  v_mfma_f32_16x16x32_bf16 a[32:35], v[116:119], v[64:67], a[32:35]
  ds_read_b64_tr_b16 v[98:99], v157 offset:1024
  v_mfma_f32_16x16x32_bf16 a[4:7], v[112:115], v[68:71], a[4:7]
  s_add_u32 m0, s39, 98304
  s_add_u32 s34, s35, 0
  buffer_load_dwordx4 v4, s[12:15], s34 offen lds
  v_mfma_f32_16x16x32_bf16 a[36:39], v[116:119], v[68:71], a[36:39]
  ds_read_b64_tr_b16 v[100:101], v158 offset:0
  v_mfma_f32_16x16x32_bf16 a[8:11], v[112:115], v[72:75], a[8:11]
  ds_read_b64_tr_b16 v[102:103], v158 offset:1024
  v_mfma_f32_16x16x32_bf16 a[40:43], v[116:119], v[72:75], a[40:43]
  s_add_u32 m0, s39, 99328
  s_add_u32 s34, s35, 16384
  buffer_load_dwordx4 v4, s[12:15], s34 offen lds
  v_mfma_f32_16x16x32_bf16 a[12:15], v[112:115], v[76:79], a[12:15]
  ds_read_b128 v[32:35], v156 offset:0
  v_mfma_f32_16x16x32_bf16 a[44:47], v[116:119], v[76:79], a[44:47]
  ds_read_b128 v[36:39], v156 offset:1024
  v_mfma_f32_16x16x32_bf16 a[16:19], v[112:115], v[80:83], a[16:19]
  s_add_u32 m0, s40, 98304
  s_add_u32 s34, s36, 0
  buffer_load_dwordx4 v5, s[16:19], s34 offen lds
  v_mfma_f32_16x16x32_bf16 a[48:51], v[116:119], v[80:83], a[48:51]
  ds_read_b128 v[40:43], v156 offset:2048
  v_mfma_f32_16x16x32_bf16 a[20:23], v[112:115], v[84:87], a[20:23]
  ds_read_b128 v[44:47], v156 offset:3072
  v_mfma_f32_16x16x32_bf16 a[52:55], v[116:119], v[84:87], a[52:55]
  s_add_u32 m0, s40, 99328
  s_add_u32 s34, s36, 32768
  buffer_load_dwordx4 v5, s[16:19], s34 offen lds
  s_add_u32 s35, s35, 64
  s_add_u32 s36, s36, 262144
  v_mfma_f32_16x16x32_bf16 a[24:27], v[112:115], v[88:91], a[24:27]
  ds_read_b128 v[48:51], v156 offset:4096
  v_mfma_f32_16x16x32_bf16 a[56:59], v[116:119], v[88:91], a[56:59]
  ds_read_b128 v[52:55], v156 offset:5120
  v_mfma_f32_16x16x32_bf16 a[28:31], v[112:115], v[92:95], a[28:31]
  ds_read_b128 v[56:59], v156 offset:6144
  v_mfma_f32_16x16x32_bf16 a[60:63], v[116:119], v[92:95], a[60:63]
  ds_read_b128 v[60:63], v156 offset:7168
  s_waitcnt vmcnt(13) lgkmcnt(0)
  s_barrier
  v_mfma_f32_16x16x32_bf16 a[0:3], v[96:99], v[32:35], a[0:3]
  ds_read_b64_tr_b16 v[112:113], v157 offset:24576
  v_mfma_f32_16x16x32_bf16 a[32:35], v[100:103], v[32:35], a[32:35]
  ds_read_b64_tr_b16 v[114:115], v157 offset:25600
  v_mfma_f32_16x16x32_bf16 a[4:7], v[96:99], v[36:39], a[4:7]
  s_add_u32 m0, s39, 122880
  s_add_u32 s34, s35, 0
  buffer_load_dwordx4 v4, s[12:15], s34 offen lds
  v_mfma_f32_16x16x32_bf16 a[36:39], v[100:103], v[36:39], a[36:39]
  ds_read_b64_tr_b16 v[116:117], v158 offset:24576
  v_mfma_f32_16x16x32_bf16 a[8:11], v[96:99], v[40:43], a[8:11]
  ds_read_b64_tr_b16 v[118:119], v158 offset:25600
  v_mfma_f32_16x16x32_bf16 a[40:43], v[100:103], v[40:43], a[40:43]
  s_add_u32 m0, s39, 123904
  s_add_u32 s34, s35, 16384
  buffer_load_dwordx4 v4, s[12:15], s34 offen lds
  v_mfma_f32_16x16x32_bf16 a[12:15], v[96:99], v[44:47], a[12:15]
  ds_read_b128 v[64:67], v156 offset:24576
  v_mfma_f32_16x16x32_bf16 a[44:47], v[100:103], v[44:47], a[44:47]
  ds_read_b128 v[68:71], v156 offset:25600
  v_mfma_f32_16x16x32_bf16 a[16:19], v[96:99], v[48:51], a[16:19]
  s_add_u32 m0, s40, 122880
  s_add_u32 s34, s36, 0
  buffer_load_dwordx4 v5, s[16:19], s34 offen lds
  v_mfma_f32_16x16x32_bf16 a[48:51], v[100:103], v[48:51], a[48:51]
  ds_read_b128 v[72:75], v156 offset:26624
  v_mfma_f32_16x16x32_bf16 a[20:23], v[96:99], v[52:55], a[20:23]
  ds_read_b128 v[76:79], v156 offset:27648
  v_mfma_f32_16x16x32_bf16 a[52:55], v[100:103], v[52:55], a[52:55]
  s_add_u32 m0, s40, 123904
  s_add_u32 s34, s36, 32768
  buffer_load_dwordx4 v5, s[16:19], s34 offen lds
  s_add_u32 s35, s35, 64
  s_add_u32 s36, s36, 262144
  v_mfma_f32_16x16x32_bf16 a[24:27], v[96:99], v[56:59], a[24:27]
  ds_read_b128 v[80:83], v156 offset:28672
  v_mfma_f32_16x16x32_bf16 a[56:59], v[100:103], v[56:59], a[56:59]
  ds_read_b128 v[84:87], v156 offset:29696
  v_mfma_f32_16x16x32_bf16 a[28:31], v[96:99], v[60:63], a[28:31]
  ds_read_b128 v[88:91], v156 offset:30720
  v_mfma_f32_16x16x32_bf16 a[60:63], v[100:103], v[60:63], a[60:63]
  ds_read_b128 v[92:95], v156 offset:31744
  s_waitcnt vmcnt(12) lgkmcnt(0)
  s_barrier
  s_mov_b32 s35, s37
  s_mov_b32 s36, s38
  v_mfma_f32_16x16x32_bf16 a[0:3], v[112:115], v[64:67], a[0:3]
  ds_read_b64_tr_b16 v[96:97], v160 offset:0
  v_mfma_f32_16x16x32_bf16 a[32:35], v[116:119], v[64:67], a[32:35]
  ds_read_b64_tr_b16 v[98:99], v160 offset:1024
  v_mfma_f32_16x16x32_bf16 a[4:7], v[112:115], v[68:71], a[4:7]
  s_add_u32 m0, s39, 0
  s_add_u32 s34, s35, 0
  buffer_load_dwordx4 v4, s[12:15], s34 offen lds
  v_mfma_f32_16x16x32_bf16 a[36:39], v[116:119], v[68:71], a[36:39]
  ds_read_b64_tr_b16 v[100:101], v161 offset:0
  v_mfma_f32_16x16x32_bf16 a[8:11], v[112:115], v[72:75], a[8:11]
  ds_read_b64_tr_b16 v[102:103], v161 offset:1024
  v_mfma_f32_16x16x32_bf16 a[40:43], v[116:119], v[72:75], a[40:43]
  s_add_u32 m0, s39, 1024
  s_add_u32 s34, s35, 16384
  buffer_load_dwordx4 v4, s[12:15], s34 offen lds
  v_mfma_f32_16x16x32_bf16 a[12:15], v[112:115], v[76:79], a[12:15]
  ds_read_b128 v[32:35], v159 offset:0
  v_mfma_f32_16x16x32_bf16 a[44:47], v[116:119], v[76:79], a[44:47]
  ds_read_b128 v[36:39], v159 offset:1024
  v_mfma_f32_16x16x32_bf16 a[16:19], v[112:115], v[80:83], a[16:19]
  s_add_u32 m0, s40, 0
  s_add_u32 s34, s36, 0
  buffer_load_dwordx4 v5, s[16:19], s34 offen lds
  v_mfma_f32_16x16x32_bf16 a[48:51], v[116:119], v[80:83], a[48:51]
  ds_read_b128 v[40:43], v159 offset:2048
  v_mfma_f32_16x16x32_bf16 a[20:23], v[112:115], v[84:87], a[20:23]
  ds_read_b128 v[44:47], v159 offset:3072
  v_mfma_f32_16x16x32_bf16 a[52:55], v[116:119], v[84:87], a[52:55]
  s_add_u32 m0, s40, 1024
  s_add_u32 s34, s36, 32768
  buffer_load_dwordx4 v5, s[16:19], s34 offen lds
  s_add_u32 s35, s35, 64
  s_add_u32 s36, s36, 262144
  v_mfma_f32_16x16x32_bf16 a[24:27], v[112:115], v[88:91], a[24:27]
  ds_read_b128 v[48:51], v159 offset:4096
  v_mfma_f32_16x16x32_bf16 a[56:59], v[116:119], v[88:91], a[56:59]
  ds_read_b128 v[52:55], v159 offset:5120
  v_mfma_f32_16x16x32_bf16 a[28:31], v[112:115], v[92:95], a[28:31]
  ds_read_b128 v[56:59], v159 offset:6144
  v_mfma_f32_16x16x32_bf16 a[60:63], v[116:119], v[92:95], a[60:63]
  ds_read_b128 v[60:63], v159 offset:7168
  s_waitcnt vmcnt(12) lgkmcnt(0)
  s_barrier
  v_mfma_f32_16x16x32_bf16 a[0:3], v[96:99], v[32:35], a[0:3]
  ds_read_b64_tr_b16 v[112:113], v160 offset:24576
  v_mfma_f32_16x16x32_bf16 a[32:35], v[100:103], v[32:35], a[32:35]
  ds_read_b64_tr_b16 v[114:115], v160 offset:25600
  v_mfma_f32_16x16x32_bf16 a[4:7], v[96:99], v[36:39], a[4:7]
  s_add_u32 m0, s39, 24576
  s_add_u32 s34, s35, 0
  buffer_load_dwordx4 v4, s[12:15], s34 offen lds
  v_mfma_f32_16x16x32_bf16 a[36:39], v[100:103], v[36:39], a[36:39]
  ds_read_b64_tr_b16 v[116:117], v161 offset:24576
  v_mfma_f32_16x16x32_bf16 a[8:11], v[96:99], v[40:43], a[8:11]
  ds_read_b64_tr_b16 v[118:119], v161 offset:25600
  v_mfma_f32_16x16x32_bf16 a[40:43], v[100:103], v[40:43], a[40:43]
  s_add_u32 m0, s39, 25600
  s_add_u32 s34, s35, 16384
  buffer_load_dwordx4 v4, s[12:15], s34 offen lds
  v_mfma_f32_16x16x32_bf16 a[12:15], v[96:99], v[44:47], a[12:15]
  ds_read_b128 v[64:67], v159 offset:24576
  v_mfma_f32_16x16x32_bf16 a[44:47], v[100:103], v[44:47], a[44:47]
  ds_read_b128 v[68:71], v159 offset:25600
  v_mfma_f32_16x16x32_bf16 a[16:19], v[96:99], v[48:51], a[16:19]
  s_add_u32 m0, s40, 24576
  s_add_u32 s34, s36, 0
  buffer_load_dwordx4 v5, s[16:19], s34 offen lds
  v_mfma_f32_16x16x32_bf16 a[48:51], v[100:103], v[48:51], a[48:51]
  ds_read_b128 v[72:75], v159 offset:26624
  v_mfma_f32_16x16x32_bf16 a[20:23], v[96:99], v[52:55], a[20:23]
  ds_read_b128 v[76:79], v159 offset:27648
  v_mfma_f32_16x16x32_bf16 a[52:55], v[100:103], v[52:55], a[52:55]
  s_add_u32 m0, s40, 25600
  s_add_u32 s34, s36, 32768
  buffer_load_dwordx4 v5, s[16:19], s34 offen lds
  s_add_u32 s35, s35, 64
  s_add_u32 s36, s36, 262144
  v_mfma_f32_16x16x32_bf16 a[24:27], v[96:99], v[56:59], a[24:27]
  ds_read_b128 v[80:83], v159 offset:28672
  v_mfma_f32_16x16x32_bf16 a[56:59], v[100:103], v[56:59], a[56:59]
  ds_read_b128 v[84:87], v159 offset:29696
  v_mfma_f32_16x16x32_bf16 a[28:31], v[96:99], v[60:63], a[28:31]
  ds_read_b128 v[88:91], v159 offset:30720
  v_mfma_f32_16x16x32_bf16 a[60:63], v[100:103], v[60:63], a[60:63]
  ds_read_b128 v[92:95], v159 offset:31744
  s_waitcnt vmcnt(12) lgkmcnt(0)
  s_barrier
  s_waitcnt vmcnt(23)
  s_barrier
  buffer_store_dword v11, v7, s[8:11], s43 offen sc1
  v_mfma_f32_16x16x32_bf16 a[0:3], v[112:115], v[64:67], a[0:3]
  ds_read_b64_tr_b16 v[96:97], v163 offset:0
  v_mfma_f32_16x16x32_bf16 a[32:35], v[116:119], v[64:67], a[32:35]
  ds_read_b64_tr_b16 v[98:99], v163 offset:1024
  v_mfma_f32_16x16x32_bf16 a[4:7], v[112:115], v[68:71], a[4:7]
  s_add_u32 m0, s39, 49152
  s_add_u32 s34, s35, 0
  buffer_load_dwordx4 v4, s[12:15], s34 offen lds
  v_mfma_f32_16x16x32_bf16 a[36:39], v[116:119], v[68:71], a[36:39]
  ds_read_b64_tr_b16 v[100:101], v164 offset:0
  v_mfma_f32_16x16x32_bf16 a[8:11], v[112:115], v[72:75], a[8:11]
  ds_read_b64_tr_b16 v[102:103], v164 offset:1024
  v_mfma_f32_16x16x32_bf16 a[40:43], v[116:119], v[72:75], a[40:43]
  s_add_u32 m0, s39, 50176
  s_add_u32 s34, s35, 16384
  buffer_load_dwordx4 v4, s[12:15], s34 offen lds
  v_mfma_f32_16x16x32_bf16 a[12:15], v[112:115], v[76:79], a[12:15]
  ds_read_b128 v[32:35], v162 offset:0
  v_mfma_f32_16x16x32_bf16 a[44:47], v[116:119], v[76:79], a[44:47]
  ds_read_b128 v[36:39], v162 offset:1024
  v_mfma_f32_16x16x32_bf16 a[16:19], v[112:115], v[80:83], a[16:19]
  s_add_u32 m0, s40, 49152
  s_add_u32 s34, s36, 0
  buffer_load_dwordx4 v5, s[16:19], s34 offen lds
  v_mfma_f32_16x16x32_bf16 a[48:51], v[116:119], v[80:83], a[48:51]
  ds_read_b128 v[40:43], v162 offset:2048
  v_mfma_f32_16x16x32_bf16 a[20:23], v[112:115], v[84:87], a[20:23]
  ds_read_b128 v[44:47], v162 offset:3072
  v_mfma_f32_16x16x32_bf16 a[52:55], v[116:119], v[84:87], a[52:55]
  s_add_u32 m0, s40, 50176
  s_add_u32 s34, s36, 32768
  buffer_load_dwordx4 v5, s[16:19], s34 offen lds
  s_add_u32 s35, s35, 64
  s_add_u32 s36, s36, 262144
  v_mfma_f32_16x16x32_bf16 a[24:27], v[112:115], v[88:91], a[24:27]
  ds_read_b128 v[48:51], v162 offset:4096
  v_mfma_f32_16x16x32_bf16 a[56:59], v[116:119], v[88:91], a[56:59]
  ds_read_b128 v[52:55], v162 offset:5120
  v_mfma_f32_16x16x32_bf16 a[28:31], v[112:115], v[92:95], a[28:31]
  ds_read_b128 v[56:59], v162 offset:6144
  v_mfma_f32_16x16x32_bf16 a[60:63], v[116:119], v[92:95], a[60:63]
  ds_read_b128 v[60:63], v162 offset:7168
  s_waitcnt vmcnt(13) lgkmcnt(0)
  s_barrier
  v_mfma_f32_16x16x32_bf16 a[0:3], v[96:99], v[32:35], a[0:3]
  ds_read_b64_tr_b16 v[112:113], v163 offset:24576
  v_mfma_f32_16x16x32_bf16 a[32:35], v[100:103], v[32:35], a[32:35]
  ds_read_b64_tr_b16 v[114:115], v163 offset:25600
  v_mfma_f32_16x16x32_bf16 a[4:7], v[96:99], v[36:39], a[4:7]
  s_add_u32 m0, s39, 73728
  s_add_u32 s34, s35, 0
  buffer_load_dwordx4 v4, s[12:15], s34 offen lds
  v_mfma_f32_16x16x32_bf16 a[36:39], v[100:103], v[36:39], a[36:39]
  ds_read_b64_tr_b16 v[116:117], v164 offset:24576
  v_mfma_f32_16x16x32_bf16 a[8:11], v[96:99], v[40:43], a[8:11]
  ds_read_b64_tr_b16 v[118:119], v164 offset:25600
  v_mfma_f32_16x16x32_bf16 a[40:43], v[100:103], v[40:43], a[40:43]
  s_add_u32 m0, s39, 74752
  s_add_u32 s34, s35, 16384
  buffer_load_dwordx4 v4, s[12:15], s34 offen lds
  v_mfma_f32_16x16x32_bf16 a[12:15], v[96:99], v[44:47], a[12:15]
  ds_read_b128 v[64:67], v162 offset:24576
  v_mfma_f32_16x16x32_bf16 a[44:47], v[100:103], v[44:47], a[44:47]
  ds_read_b128 v[68:71], v162 offset:25600
  v_mfma_f32_16x16x32_bf16 a[16:19], v[96:99], v[48:51], a[16:19]
  s_add_u32 m0, s40, 73728
  s_add_u32 s34, s36, 0
  buffer_load_dwordx4 v5, s[16:19], s34 offen lds
  v_mfma_f32_16x16x32_bf16 a[48:51], v[100:103], v[48:51], a[48:51]
  ds_read_b128 v[72:75], v162 offset:26624
  v_mfma_f32_16x16x32_bf16 a[20:23], v[96:99], v[52:55], a[20:23]
  ds_read_b128 v[76:79], v162 offset:27648
  v_mfma_f32_16x16x32_bf16 a[52:55], v[100:103], v[52:55], a[52:55]
  s_add_u32 m0, s40, 74752
  s_add_u32 s34, s36, 32768
  buffer_load_dwordx4 v5, s[16:19], s34 offen lds
  s_add_u32 s35, s35, 64
  s_add_u32 s36, s36, 262144
  v_mfma_f32_16x16x32_bf16 a[24:27], v[96:99], v[56:59], a[24:27]
  ds_read_b128 v[80:83], v162 offset:28672
  v_mfma_f32_16x16x32_bf16 a[56:59], v[100:103], v[56:59], a[56:59]
  ds_read_b128 v[84:87], v162 offset:29696
  v_mfma_f32_16x16x32_bf16 a[28:31], v[96:99], v[60:63], a[28:31]
  ds_read_b128 v[88:91], v162 offset:30720
  v_mfma_f32_16x16x32_bf16 a[60:63], v[100:103], v[60:63], a[60:63]
  ds_read_b128 v[92:95], v162 offset:31744
  s_waitcnt vmcnt(13) lgkmcnt(0)
  s_barrier
  v_mfma_f32_16x16x32_bf16 a[0:3], v[112:115], v[64:67], a[0:3]
  ds_read_b64_tr_b16 v[96:97], v157 offset:0
  v_mfma_f32_16x16x32_bf16 a[32:35], v[116:119], v[64:67], a[32:35]
  ds_read_b64_tr_b16 v[98:99], v157 offset:1024
  v_mfma_f32_16x16x32_bf16 a[4:7], v[112:115], v[68:71], a[4:7]
  s_add_u32 m0, s39, 98304
  s_add_u32 s34, s35, 0
  buffer_load_dwordx4 v4, s[12:15], s34 offen lds
  v_mfma_f32_16x16x32_bf16 a[36:39], v[116:119], v[68:71], a[36:39]
  ds_read_b64_tr_b16 v[100:101], v158 offset:0
  v_mfma_f32_16x16x32_bf16 a[8:11], v[112:115], v[72:75], a[8:11]
  ds_read_b64_tr_b16 v[102:103], v158 offset:1024
  v_mfma_f32_16x16x32_bf16 a[40:43], v[116:119], v[72:75], a[40:43]
  s_add_u32 m0, s39, 99328
  s_add_u32 s34, s35, 16384
  buffer_load_dwordx4 v4, s[12:15], s34 offen lds
  v_mfma_f32_16x16x32_bf16 a[12:15], v[112:115], v[76:79], a[12:15]
  ds_read_b128 v[32:35], v156 offset:0
  v_mfma_f32_16x16x32_bf16 a[44:47], v[116:119], v[76:79], a[44:47]
  ds_read_b128 v[36:39], v156 offset:1024
  v_mfma_f32_16x16x32_bf16 a[16:19], v[112:115], v[80:83], a[16:19]
  s_add_u32 m0, s40, 98304
  s_add_u32 s34, s36, 0
  buffer_load_dwordx4 v5, s[16:19], s34 offen lds
  v_mfma_f32_16x16x32_bf16 a[48:51], v[116:119], v[80:83], a[48:51]
  ds_read_b128 v[40:43], v156 offset:2048
  v_mfma_f32_16x16x32_bf16 a[20:23], v[112:115], v[84:87], a[20:23]
  ds_read_b128 v[44:47], v156 offset:3072
  v_mfma_f32_16x16x32_bf16 a[52:55], v[116:119], v[84:87], a[52:55]
  s_add_u32 m0, s40, 99328
  s_add_u32 s34, s36, 32768
  buffer_load_dwordx4 v5, s[16:19], s34 offen lds
  s_add_u32 s35, s35, 64
  s_add_u32 s36, s36, 262144
  v_mfma_f32_16x16x32_bf16 a[24:27], v[112:115], v[88:91], a[24:27]
  ds_read_b128 v[48:51], v156 offset:4096
  v_mfma_f32_16x16x32_bf16 a[56:59], v[116:119], v[88:91], a[56:59]
  ds_read_b128 v[52:55], v156 offset:5120
  v_mfma_f32_16x16x32_bf16 a[28:31], v[112:115], v[92:95], a[28:31]
  ds_read_b128 v[56:59], v156 offset:6144
  v_mfma_f32_16x16x32_bf16 a[60:63], v[116:119], v[92:95], a[60:63]
  ds_read_b128 v[60:63], v156 offset:7168
  s_lshr_b32 s32, s94, 5
  s_lshl_b32 s32, s32, 21
  s_and_b32 s33, s94, 31
  s_lshl_b32 s33, s33, 14
  s_add_u32 s32, s32, s33
  s_lshl_b32 s33, s28, 12
  s_add_u32 s32, s32, s33
  s_lshr_b32 s32, s32, 1
  s_add_u32 s41, s32, 50331648
  s_lshl_b32 s43, s94, 7
  s_add_u32 s43, s43, 393216
  s_cmp_eq_u32 s97, 0
  s_cselect_b32 s43, s43, 0x7f000000
  v_accvgpr_read_b32 v128, a0
  v_accvgpr_read_b32 v129, a1
  v_accvgpr_read_b32 v130, a2
  v_accvgpr_read_b32 v131, a3
  v_accvgpr_read_b32 v132, a32
  v_accvgpr_read_b32 v133, a33
  v_accvgpr_read_b32 v134, a34
  v_accvgpr_read_b32 v135, a35
  v_cvt_pk_bf16_f32 v136, v128, v129
  v_cvt_pk_bf16_f32 v137, v130, v131
  v_cvt_pk_bf16_f32 v138, v132, v133
  v_cvt_pk_bf16_f32 v139, v134, v135
  s_add_u32 s33, s41, 0
  buffer_store_dwordx4 v[136:139], v6, s[8:11], s33 offen offset:0 sc1
  v_accvgpr_read_b32 v140, a4
  v_accvgpr_read_b32 v141, a5
  v_accvgpr_read_b32 v142, a6
  v_accvgpr_read_b32 v143, a7
  v_accvgpr_read_b32 v144, a36
  v_accvgpr_read_b32 v145, a37
  v_accvgpr_read_b32 v146, a38
  v_accvgpr_read_b32 v147, a39
  v_cvt_pk_bf16_f32 v148, v140, v141
  v_cvt_pk_bf16_f32 v149, v142, v143
  v_cvt_pk_bf16_f32 v150, v144, v145
  v_cvt_pk_bf16_f32 v151, v146, v147
  s_add_u32 s33, s41, 0
  buffer_store_dwordx4 v[148:151], v6, s[8:11], s33 offen offset:1024 sc1
  v_accvgpr_read_b32 v128, a8
  v_accvgpr_read_b32 v129, a9
  v_accvgpr_read_b32 v130, a10
  v_accvgpr_read_b32 v131, a11
  v_accvgpr_read_b32 v132, a40
  v_accvgpr_read_b32 v133, a41
  v_accvgpr_read_b32 v134, a42
  v_accvgpr_read_b32 v135, a43
  v_cvt_pk_bf16_f32 v136, v128, v129
  v_cvt_pk_bf16_f32 v137, v130, v131
  v_cvt_pk_bf16_f32 v138, v132, v133
  v_cvt_pk_bf16_f32 v139, v134, v135
  s_add_u32 s33, s41, 262144
  buffer_store_dwordx4 v[136:139], v6, s[8:11], s33 offen offset:0 sc1
  v_accvgpr_read_b32 v140, a12
  v_accvgpr_read_b32 v141, a13
  v_accvgpr_read_b32 v142, a14
  v_accvgpr_read_b32 v143, a15
  v_accvgpr_read_b32 v144, a44
  v_accvgpr_read_b32 v145, a45
  v_accvgpr_read_b32 v146, a46
  v_accvgpr_read_b32 v147, a47
  v_cvt_pk_bf16_f32 v148, v140, v141
  v_cvt_pk_bf16_f32 v149, v142, v143
  v_cvt_pk_bf16_f32 v150, v144, v145
  v_cvt_pk_bf16_f32 v151, v146, v147
  s_add_u32 s33, s41, 262144
  buffer_store_dwordx4 v[148:151], v6, s[8:11], s33 offen offset:1024 sc1
  v_accvgpr_read_b32 v128, a16
  v_accvgpr_read_b32 v129, a17
  v_accvgpr_read_b32 v130, a18
  v_accvgpr_read_b32 v131, a19
  v_accvgpr_read_b32 v132, a48
  v_accvgpr_read_b32 v133, a49
  v_accvgpr_read_b32 v134, a50
  v_accvgpr_read_b32 v135, a51
  v_cvt_pk_bf16_f32 v136, v128, v129
  v_cvt_pk_bf16_f32 v137, v130, v131
  v_cvt_pk_bf16_f32 v138, v132, v133
  v_cvt_pk_bf16_f32 v139, v134, v135
  s_add_u32 s33, s41, 524288
  buffer_store_dwordx4 v[136:139], v6, s[8:11], s33 offen offset:0 sc1
  v_accvgpr_read_b32 v140, a20
  v_accvgpr_read_b32 v141, a21
  v_accvgpr_read_b32 v142, a22
  v_accvgpr_read_b32 v143, a23
  v_accvgpr_read_b32 v144, a52
  v_accvgpr_read_b32 v145, a53
  v_accvgpr_read_b32 v146, a54
  v_accvgpr_read_b32 v147, a55
  v_cvt_pk_bf16_f32 v148, v140, v141
  v_cvt_pk_bf16_f32 v149, v142, v143
  v_cvt_pk_bf16_f32 v150, v144, v145
  v_cvt_pk_bf16_f32 v151, v146, v147
  s_add_u32 s33, s41, 524288
  buffer_store_dwordx4 v[148:151], v6, s[8:11], s33 offen offset:1024 sc1
  v_accvgpr_read_b32 v128, a24
  v_accvgpr_read_b32 v129, a25
  v_accvgpr_read_b32 v130, a26
  v_accvgpr_read_b32 v131, a27
  v_accvgpr_read_b32 v132, a56
  v_accvgpr_read_b32 v133, a57
  v_accvgpr_read_b32 v134, a58
  v_accvgpr_read_b32 v135, a59
  v_cvt_pk_bf16_f32 v136, v128, v129
  v_cvt_pk_bf16_f32 v137, v130, v131
  v_cvt_pk_bf16_f32 v138, v132, v133
  v_cvt_pk_bf16_f32 v139, v134, v135
  s_add_u32 s33, s41, 786432
  buffer_store_dwordx4 v[136:139], v6, s[8:11], s33 offen offset:0 sc1
  v_accvgpr_read_b32 v140, a28
  v_accvgpr_read_b32 v141, a29
  v_accvgpr_read_b32 v142, a30
  v_accvgpr_read_b32 v143, a31
  v_accvgpr_read_b32 v144, a60
  v_accvgpr_read_b32 v145, a61
  v_accvgpr_read_b32 v146, a62
  v_accvgpr_read_b32 v147, a63
  v_cvt_pk_bf16_f32 v148, v140, v141
  v_cvt_pk_bf16_f32 v149, v142, v143
  v_cvt_pk_bf16_f32 v150, v144, v145
  v_cvt_pk_bf16_f32 v151, v146, v147
  s_add_u32 s33, s41, 786432
  buffer_store_dwordx4 v[148:151], v6, s[8:11], s33 offen offset:1024 sc1
  s_nop 1
  s_branch L_q_fin
L_q_two:
  s_lshr_b32 s32, s93, 5
  s_lshl_b32 s32, s32, 21
  s_and_b32 s33, s93, 31
  s_lshl_b32 s33, s33, 14
  s_add_u32 s32, s32, s33
  s_lshl_b32 s33, s28, 12
  s_add_u32 s32, s32, s33
  s_lshr_b32 s32, s32, 1
  s_add_u32 s41, s32, 50331648
  s_lshl_b32 s43, s93, 7
  s_add_u32 s43, s43, 393216
  s_cmp_eq_u32 s97, 0
  s_cselect_b32 s43, s43, 0x7f000000
  v_accvgpr_read_b32 v128, a128
  v_accvgpr_read_b32 v129, a129
  v_accvgpr_read_b32 v130, a130
  v_accvgpr_read_b32 v131, a131
  v_accvgpr_read_b32 v132, a160
  v_accvgpr_read_b32 v133, a161
  v_accvgpr_read_b32 v134, a162
  v_accvgpr_read_b32 v135, a163
  v_cvt_pk_bf16_f32 v136, v128, v129
  v_cvt_pk_bf16_f32 v137, v130, v131
  v_cvt_pk_bf16_f32 v138, v132, v133
  v_cvt_pk_bf16_f32 v139, v134, v135
  s_add_u32 s33, s41, 0
  buffer_store_dwordx4 v[136:139], v6, s[8:11], s33 offen offset:0 sc1
  v_accvgpr_read_b32 v140, a132
  v_accvgpr_read_b32 v141, a133
  v_accvgpr_read_b32 v142, a134
  v_accvgpr_read_b32 v143, a135
  v_accvgpr_read_b32 v144, a164
  v_accvgpr_read_b32 v145, a165
  v_accvgpr_read_b32 v146, a166
  v_accvgpr_read_b32 v147, a167
  v_cvt_pk_bf16_f32 v148, v140, v141
  v_cvt_pk_bf16_f32 v149, v142, v143
  v_cvt_pk_bf16_f32 v150, v144, v145
  v_cvt_pk_bf16_f32 v151, v146, v147
  s_add_u32 s33, s41, 0
  buffer_store_dwordx4 v[148:151], v6, s[8:11], s33 offen offset:1024 sc1
  v_accvgpr_read_b32 v128, a136
  v_accvgpr_read_b32 v129, a137
  v_accvgpr_read_b32 v130, a138
  v_accvgpr_read_b32 v131, a139
  v_accvgpr_read_b32 v132, a168
  v_accvgpr_read_b32 v133, a169
  v_accvgpr_read_b32 v134, a170
  v_accvgpr_read_b32 v135, a171
  v_cvt_pk_bf16_f32 v136, v128, v129
  v_cvt_pk_bf16_f32 v137, v130, v131
  v_cvt_pk_bf16_f32 v138, v132, v133
  v_cvt_pk_bf16_f32 v139, v134, v135
  s_add_u32 s33, s41, 262144
  buffer_store_dwordx4 v[136:139], v6, s[8:11], s33 offen offset:0 sc1
  v_accvgpr_read_b32 v140, a140
  v_accvgpr_read_b32 v141, a141
  v_accvgpr_read_b32 v142, a142
  v_accvgpr_read_b32 v143, a143
  v_accvgpr_read_b32 v144, a172
  v_accvgpr_read_b32 v145, a173
  v_accvgpr_read_b32 v146, a174
  v_accvgpr_read_b32 v147, a175
  v_cvt_pk_bf16_f32 v148, v140, v141
  v_cvt_pk_bf16_f32 v149, v142, v143
  v_cvt_pk_bf16_f32 v150, v144, v145
  v_cvt_pk_bf16_f32 v151, v146, v147
  s_add_u32 s33, s41, 262144
  buffer_store_dwordx4 v[148:151], v6, s[8:11], s33 offen offset:1024 sc1
  v_accvgpr_read_b32 v128, a144
  v_accvgpr_read_b32 v129, a145
  v_accvgpr_read_b32 v130, a146
  v_accvgpr_read_b32 v131, a147
  v_accvgpr_read_b32 v132, a176
  v_accvgpr_read_b32 v133, a177
  v_accvgpr_read_b32 v134, a178
  v_accvgpr_read_b32 v135, a179
  v_cvt_pk_bf16_f32 v136, v128, v129
  v_cvt_pk_bf16_f32 v137, v130, v131
  v_cvt_pk_bf16_f32 v138, v132, v133
  v_cvt_pk_bf16_f32 v139, v134, v135
  s_add_u32 s33, s41, 524288
  buffer_store_dwordx4 v[136:139], v6, s[8:11], s33 offen offset:0 sc1
  v_accvgpr_read_b32 v140, a148
  v_accvgpr_read_b32 v141, a149
  v_accvgpr_read_b32 v142, a150
  v_accvgpr_read_b32 v143, a151
  v_accvgpr_read_b32 v144, a180
  v_accvgpr_read_b32 v145, a181
  v_accvgpr_read_b32 v146, a182
  v_accvgpr_read_b32 v147, a183
  v_cvt_pk_bf16_f32 v148, v140, v141
  v_cvt_pk_bf16_f32 v149, v142, v143
  v_cvt_pk_bf16_f32 v150, v144, v145
  v_cvt_pk_bf16_f32 v151, v146, v147
  s_add_u32 s33, s41, 524288
  buffer_store_dwordx4 v[148:151], v6, s[8:11], s33 offen offset:1024 sc1
  v_accvgpr_read_b32 v128, a152
  v_accvgpr_read_b32 v129, a153
  v_accvgpr_read_b32 v130, a154
  v_accvgpr_read_b32 v131, a155
  v_accvgpr_read_b32 v132, a184
  v_accvgpr_read_b32 v133, a185
  v_accvgpr_read_b32 v134, a186
  v_accvgpr_read_b32 v135, a187
  v_cvt_pk_bf16_f32 v136, v128, v129
  v_cvt_pk_bf16_f32 v137, v130, v131
  v_cvt_pk_bf16_f32 v138, v132, v133
  v_cvt_pk_bf16_f32 v139, v134, v135
  s_add_u32 s33, s41, 786432
  buffer_store_dwordx4 v[136:139], v6, s[8:11], s33 offen offset:0 sc1
  v_accvgpr_read_b32 v140, a156
  v_accvgpr_read_b32 v141, a157
  v_accvgpr_read_b32 v142, a158
  v_accvgpr_read_b32 v143, a159
  v_accvgpr_read_b32 v144, a188
  v_accvgpr_read_b32 v145, a189
  v_accvgpr_read_b32 v146, a190
  v_accvgpr_read_b32 v147, a191
  v_cvt_pk_bf16_f32 v148, v140, v141
  v_cvt_pk_bf16_f32 v149, v142, v143
  v_cvt_pk_bf16_f32 v150, v144, v145
  v_cvt_pk_bf16_f32 v151, v146, v147
  s_add_u32 s33, s41, 786432
  buffer_store_dwordx4 v[148:151], v6, s[8:11], s33 offen offset:1024 sc1
  s_nop 1
L_q_fin:
  s_waitcnt vmcnt(0) lgkmcnt(0)
  s_barrier
  buffer_store_dword v11, v7, s[8:11], s43 offen sc1
  s_waitcnt vmcnt(0)
  s_cmp_lt_u32 s91, 8
  s_cbranch_scc1 L_w4role
  s_cmp_eq_u32 s90, 0
  s_cbranch_scc1 L_x0
  s_cmp_lt_u32 s91, 13
  s_cbranch_scc1 L_w2a
  s_mul_i32 s94, s90, 19
  s_add_u32 s94, s94, s91
  s_sub_u32 s94, s94, 18
  s_branch L_w3go
L_w2a:
  s_mul_i32 s94, s90, 5
  s_add_u32 s94, s94, s91
  s_sub_u32 s94, s94, 13
  s_branch L_w2role
L_x0:
  s_cmp_lt_u32 s91, 16
  s_cbranch_scc1 L_w4role
  s_cmp_lt_u32 s91, 18
  s_cbranch_scc0 L_x0w3
  s_add_u32 s94, s91, 14
  s_branch L_w2role
L_x0w3:
  s_sub_u32 s94, s91, 18
L_w3go:
  v_mov_b32 v9, 16
  s_nop 1
L_wiw3:
  global_load_dword v10, v9, s[6:7] sc1
  s_waitcnt vmcnt(0)
  v_cmp_gt_u32 vcc, 256, v10
  s_nop 4
  s_cbranch_vccz L_widw3
  s_sleep 8
  s_branch L_wiw3
L_widw3:
  v_lshlrev_b32 v8, 4, v0
  v_and_b32 v20, 15, v0
  v_lshrrev_b32 v21, 4, v0
  v_lshrrev_b32 v22, 2, v20
  v_lshlrev_b32 v22, 1, v22
  v_and_b32 v23, 1, v20
  v_add_u32 v22, v22, v23
  v_lshlrev_b32 v22, 6, v22
  v_lshlrev_b32 v23, 4, v21
  v_add_u32 v9, v22, v23
  s_mov_b32 s39, 0x3e0293ee
  v_mov_b32 v10, 0x3f803f80
  v_mov_b32 v11, 0x3f803f80
  v_mov_b32 v12, 0x3f803f80
  v_mov_b32 v13, 0x3f803f80
  v_lshlrev_b32 v22, 2, v21
  v_add_u32 v23, 0, v22
  v_cmp_le_u32 s[40:41], v23, v20
  v_add_u32 v23, 1, v22
  v_cmp_le_u32 s[42:43], v23, v20
  v_add_u32 v23, 2, v22
  v_cmp_le_u32 s[44:45], v23, v20
  v_add_u32 v23, 3, v22
  v_cmp_le_u32 s[46:47], v23, v20
  s_lshl_b32 s94, s94, 2
  s_add_u32 s94, s94, s97
  s_and_b32 s30, s94, 31
  s_lshr_b32 s92, s94, 5
  s_and_b32 s92, s92, 1
  s_lshr_b32 s29, s94, 6
  v_mov_b32 v14, 0x7fff0000
  v_cmp_eq_u32 vcc, 0, v0
  s_nop 1
  v_cndmask_b32 v14, v14, 0, vcc
  v_mov_b32 v15, 0
  s_nop 1
L_w3l:
  s_lshl_b32 s32, s29, 19
  s_lshl_b32 s33, s30, 14
  s_add_u32 s32, s32, s33
  s_add_u32 s35, s32, 16777216
  s_lshr_b32 s32, s32, 1
  s_add_u32 s36, s32, 50331648
  s_lshr_b32 s33, s32, 1
  s_add_u32 s38, s33, 5505024
  s_lshr_b32 s33, s33, 1
  s_add_u32 s37, s33, 1310720
  s_lshr_b32 s3, s29, 2
  s_lshl_b32 s3, s3, 5
  s_add_u32 s3, s3, s30
  s_lshl_b32 s3, s3, 7
  s_add_u32 s3, s3, 327680
L_pfw3a:
  buffer_load_dword v240, v15, s[8:11], s3 offen sc1
  s_waitcnt vmcnt(0)
  v_cmp_eq_u32 vcc, 0, v240
  s_nop 4
  s_cbranch_vccz L_pfdw3a
  s_sleep 2
  s_branch L_pfw3a
L_pfdw3a:
  s_add_u32 s3, s3, 65536
L_pfw3q:
  buffer_load_dword v240, v15, s[8:11], s3 offen sc1
  s_waitcnt vmcnt(0)
  v_cmp_eq_u32 vcc, 0, v240
  s_nop 4
  s_cbranch_vccz L_pfdw3q
  s_sleep 2
  s_branch L_pfw3q
L_pfdw3q:
  s_lshl_b32 s3, s29, 5
  s_add_u32 s3, s3, s30
  s_lshl_b32 s93, s3, 7
  s_add_u32 s91, s93, 458752
  s_cmp_lg_u32 s92, 0
  s_cbranch_scc1 L_w3q1
  s_add_u32 s32, s36, 0
  s_add_u32 s33, s35, 0
  buffer_load_dwordx4 v[16:19], v8, s[8:11], s32 offen offset:0 sc1
  buffer_load_dwordx4 v[48:51], v8, s[8:11], s33 offen offset:0 sc1
  buffer_load_dwordx4 v[80:83], v8, s[8:11], s33 offen offset:2048 sc1
  buffer_load_dwordx4 v[84:87], v8, s[8:11], s33 offen offset:3072 sc1
  s_add_u32 s32, s36, 2048
  s_add_u32 s33, s35, 4096
  buffer_load_dwordx4 v[24:27], v8, s[8:11], s32 offen offset:0 sc1
  buffer_load_dwordx4 v[56:59], v8, s[8:11], s33 offen offset:0 sc1
  buffer_load_dwordx4 v[88:91], v8, s[8:11], s33 offen offset:2048 sc1
  buffer_load_dwordx4 v[92:95], v8, s[8:11], s33 offen offset:3072 sc1
  s_add_u32 s32, s36, 4096
  s_add_u32 s33, s35, 8192
  buffer_load_dwordx4 v[32:35], v8, s[8:11], s32 offen offset:0 sc1
  buffer_load_dwordx4 v[64:67], v8, s[8:11], s33 offen offset:0 sc1
  buffer_load_dwordx4 v[96:99], v8, s[8:11], s33 offen offset:2048 sc1
  buffer_load_dwordx4 v[100:103], v8, s[8:11], s33 offen offset:3072 sc1
  s_add_u32 s32, s36, 6144
  s_add_u32 s33, s35, 12288
  buffer_load_dwordx4 v[40:43], v8, s[8:11], s32 offen offset:0 sc1
  buffer_load_dwordx4 v[72:75], v8, s[8:11], s33 offen offset:0 sc1
  buffer_load_dwordx4 v[104:107], v8, s[8:11], s33 offen offset:2048 sc1
  buffer_load_dwordx4 v[108:111], v8, s[8:11], s33 offen offset:3072 sc1
  s_waitcnt vmcnt(0)
  v_mfma_f32_16x16x32_bf16 v[148:151], v[48:51], v[16:19], 0
  v_mfma_f32_16x16x32_bf16 v[148:151], v[56:59], v[24:27], v[148:151]
  v_mfma_f32_16x16x32_bf16 v[148:151], v[64:67], v[32:35], v[148:151]
  v_mfma_f32_16x16x32_bf16 v[148:151], v[72:75], v[40:43], v[148:151]
  s_nop 7
L_pfw3b0:
  buffer_load_dword v240, v15, s[8:11], s91 offen sc1
  s_waitcnt vmcnt(0)
  v_cmp_eq_u32 vcc, 0, v240
  s_nop 4
  s_cbranch_vccz L_pfdw3b0
  s_sleep 2
  s_branch L_pfw3b0
L_pfdw3b0:
  buffer_load_dwordx4 v[112:115], v9, s[8:11], s37 offen offset:0 sc1
  buffer_load_dwordx4 v[116:119], v9, s[8:11], s37 offen offset:512 sc1
  buffer_load_dwordx4 v[120:123], v9, s[8:11], s37 offen offset:1024 sc1
  buffer_load_dwordx4 v[124:127], v9, s[8:11], s37 offen offset:1536 sc1
  buffer_load_dwordx4 v[128:131], v8, s[8:11], s38 offen offset:0 sc1
  buffer_load_dwordx4 v[132:135], v8, s[8:11], s38 offen offset:1024 sc1
  buffer_load_dwordx4 v[136:139], v8, s[8:11], s38 offen offset:2048 sc1
  buffer_load_dwordx4 v[140:143], v8, s[8:11], s38 offen offset:3072 sc1
  s_waitcnt vmcnt(0)
  v_mfma_f32_16x16x32_bf16 v[144:147], v[112:115], v[16:19], 0
  v_mfma_f32_16x16x32_bf16 v[144:147], v[116:119], v[24:27], v[144:147]
  v_mfma_f32_16x16x32_bf16 v[144:147], v[120:123], v[32:35], v[144:147]
  v_mfma_f32_16x16x32_bf16 v[144:147], v[124:127], v[40:43], v[144:147]
  v_mov_b32 v215, 0xff800000
  v_cndmask_b32 v148, v215, v148, s[40:41]
  v_cndmask_b32 v149, v215, v149, s[42:43]
  v_cndmask_b32 v150, v215, v150, s[44:45]
  v_cndmask_b32 v151, v215, v151, s[46:47]
  s_nop 2
  v_max3_f32 v200, v144, v145, v148
  v_max3_f32 v200, v200, v149, v150
  v_max_f32 v200, v200, v151
  v_mov_b32 v201, v200
  s_nop 1
  v_permlane16_swap_b32 v200, v201
  v_max_f32 v200, v200, v201
  v_mov_b32 v201, v200
  s_nop 1
  v_permlane32_swap_b32 v200, v201
  v_max_f32 v200, v200, v201
  v_mul_f32 v200, s39, v200
  v_fma_f32 v144, v144, s39, -v200
  v_fma_f32 v145, v145, s39, -v200
  v_fma_f32 v148, v148, s39, -v200
  v_fma_f32 v149, v149, s39, -v200
  v_fma_f32 v150, v150, s39, -v200
  v_fma_f32 v151, v151, s39, -v200
  v_exp_f32 v144, v144
  v_exp_f32 v145, v145
  v_exp_f32 v148, v148
  v_exp_f32 v149, v149
  v_exp_f32 v150, v150
  v_exp_f32 v151, v151
  v_cvt_pk_bf16_f32 v216, v148, v149
  v_cvt_pk_bf16_f32 v217, v150, v151
  v_mov_b32 v218, 0
  v_mov_b32 v219, 0
  v_cvt_pk_bf16_f32 v220, v144, v145
  v_mov_b32 v221, v220
  v_mov_b32 v222, v220
  v_mov_b32 v223, 0
  v_mfma_f32_16x16x32_bf16 v[204:207], v[10:13], v[216:219], 0
  v_mfma_f32_16x16x32_bf16 v[168:171], v[80:83], v[216:219], 0
  v_mfma_f32_16x16x32_bf16 v[172:175], v[84:87], v[216:219], 0
  v_mfma_f32_16x16x32_bf16 v[176:179], v[88:91], v[216:219], 0
  v_mfma_f32_16x16x32_bf16 v[180:183], v[92:95], v[216:219], 0
  v_mfma_f32_16x16x32_bf16 v[184:187], v[96:99], v[216:219], 0
  v_mfma_f32_16x16x32_bf16 v[188:191], v[100:103], v[216:219], 0
  v_mfma_f32_16x16x32_bf16 v[192:195], v[104:107], v[216:219], 0
  v_mfma_f32_16x16x32_bf16 v[196:199], v[108:111], v[216:219], 0
  v_mfma_f32_16x16x16_bf16 v[204:207], v[10:11], v[222:223], v[204:207]
  v_mfma_f32_16x16x16_bf16 v[168:171], v[128:129], v[220:221], v[168:171]
  v_mfma_f32_16x16x16_bf16 v[172:175], v[130:131], v[220:221], v[172:175]
  v_mfma_f32_16x16x16_bf16 v[176:179], v[132:133], v[220:221], v[176:179]
  v_mfma_f32_16x16x16_bf16 v[180:183], v[134:135], v[220:221], v[180:183]
  v_mfma_f32_16x16x16_bf16 v[184:187], v[136:137], v[220:221], v[184:187]
  v_mfma_f32_16x16x16_bf16 v[188:191], v[138:139], v[220:221], v[188:191]
  v_mfma_f32_16x16x16_bf16 v[192:195], v[140:141], v[220:221], v[192:195]
  v_mfma_f32_16x16x16_bf16 v[196:199], v[142:143], v[220:221], v[196:199]
  v_rcp_f32 v202, v204
  s_nop 0
  v_mul_f32 v168, v168, v202
  v_mul_f32 v169, v169, v202
  v_mul_f32 v170, v170, v202
  v_mul_f32 v171, v171, v202
  v_mul_f32 v172, v172, v202
  v_mul_f32 v173, v173, v202
  v_mul_f32 v174, v174, v202
  v_mul_f32 v175, v175, v202
  v_cvt_pk_bf16_f32 v224, v168, v169
  v_cvt_pk_bf16_f32 v225, v170, v171
  v_cvt_pk_bf16_f32 v226, v172, v173
  v_cvt_pk_bf16_f32 v227, v174, v175
  s_add_u32 s32, s36, 16777216
  buffer_store_dwordx4 v[224:227], v8, s[8:11], s32 offen offset:0 sc1
  v_mul_f32 v176, v176, v202
  v_mul_f32 v177, v177, v202
  v_mul_f32 v178, v178, v202
  v_mul_f32 v179, v179, v202
  v_mul_f32 v180, v180, v202
  v_mul_f32 v181, v181, v202
  v_mul_f32 v182, v182, v202
  v_mul_f32 v183, v183, v202
  v_cvt_pk_bf16_f32 v228, v176, v177
  v_cvt_pk_bf16_f32 v229, v178, v179
  v_cvt_pk_bf16_f32 v230, v180, v181
  v_cvt_pk_bf16_f32 v231, v182, v183
  s_add_u32 s32, s36, 16779264
  buffer_store_dwordx4 v[228:231], v8, s[8:11], s32 offen offset:0 sc1
  v_mul_f32 v184, v184, v202
  v_mul_f32 v185, v185, v202
  v_mul_f32 v186, v186, v202
  v_mul_f32 v187, v187, v202
  v_mul_f32 v188, v188, v202
  v_mul_f32 v189, v189, v202
  v_mul_f32 v190, v190, v202
  v_mul_f32 v191, v191, v202
  v_cvt_pk_bf16_f32 v232, v184, v185
  v_cvt_pk_bf16_f32 v233, v186, v187
  v_cvt_pk_bf16_f32 v234, v188, v189
  v_cvt_pk_bf16_f32 v235, v190, v191
  s_add_u32 s32, s36, 16781312
  buffer_store_dwordx4 v[232:235], v8, s[8:11], s32 offen offset:0 sc1
  v_mul_f32 v192, v192, v202
  v_mul_f32 v193, v193, v202
  v_mul_f32 v194, v194, v202
  v_mul_f32 v195, v195, v202
  v_mul_f32 v196, v196, v202
  v_mul_f32 v197, v197, v202
  v_mul_f32 v198, v198, v202
  v_mul_f32 v199, v199, v202
  v_cvt_pk_bf16_f32 v236, v192, v193
  v_cvt_pk_bf16_f32 v237, v194, v195
  v_cvt_pk_bf16_f32 v238, v196, v197
  v_cvt_pk_bf16_f32 v239, v198, v199
  s_add_u32 s32, s36, 16783360
  buffer_store_dwordx4 v[236:239], v8, s[8:11], s32 offen offset:0 sc1
  s_nop 1
  s_branch L_w3qe
L_w3q1:
  s_add_u32 s32, s36, 0
  s_add_u32 s33, s35, 0
  buffer_load_dwordx4 v[20:23], v8, s[8:11], s32 offen offset:1024 sc1
  buffer_load_dwordx4 v[48:51], v8, s[8:11], s33 offen offset:0 sc1
  buffer_load_dwordx4 v[52:55], v8, s[8:11], s33 offen offset:1024 sc1
  buffer_load_dwordx4 v[80:83], v8, s[8:11], s33 offen offset:2048 sc1
  buffer_load_dwordx4 v[84:87], v8, s[8:11], s33 offen offset:3072 sc1
  s_add_u32 s32, s36, 2048
  s_add_u32 s33, s35, 4096
  buffer_load_dwordx4 v[28:31], v8, s[8:11], s32 offen offset:1024 sc1
  buffer_load_dwordx4 v[56:59], v8, s[8:11], s33 offen offset:0 sc1
  buffer_load_dwordx4 v[60:63], v8, s[8:11], s33 offen offset:1024 sc1
  buffer_load_dwordx4 v[88:91], v8, s[8:11], s33 offen offset:2048 sc1
  buffer_load_dwordx4 v[92:95], v8, s[8:11], s33 offen offset:3072 sc1
  s_add_u32 s32, s36, 4096
  s_add_u32 s33, s35, 8192
  buffer_load_dwordx4 v[36:39], v8, s[8:11], s32 offen offset:1024 sc1
  buffer_load_dwordx4 v[64:67], v8, s[8:11], s33 offen offset:0 sc1
  buffer_load_dwordx4 v[68:71], v8, s[8:11], s33 offen offset:1024 sc1
  buffer_load_dwordx4 v[96:99], v8, s[8:11], s33 offen offset:2048 sc1
  buffer_load_dwordx4 v[100:103], v8, s[8:11], s33 offen offset:3072 sc1
  s_add_u32 s32, s36, 6144
  s_add_u32 s33, s35, 12288
  buffer_load_dwordx4 v[44:47], v8, s[8:11], s32 offen offset:1024 sc1
  buffer_load_dwordx4 v[72:75], v8, s[8:11], s33 offen offset:0 sc1
  buffer_load_dwordx4 v[76:79], v8, s[8:11], s33 offen offset:1024 sc1
  buffer_load_dwordx4 v[104:107], v8, s[8:11], s33 offen offset:2048 sc1
  buffer_load_dwordx4 v[108:111], v8, s[8:11], s33 offen offset:3072 sc1
  s_waitcnt vmcnt(0)
  v_mfma_f32_16x16x32_bf16 v[156:159], v[48:51], v[20:23], 0
  v_mfma_f32_16x16x32_bf16 v[160:163], v[52:55], v[20:23], 0
  v_mfma_f32_16x16x32_bf16 v[156:159], v[56:59], v[28:31], v[156:159]
  v_mfma_f32_16x16x32_bf16 v[160:163], v[60:63], v[28:31], v[160:163]
  v_mfma_f32_16x16x32_bf16 v[156:159], v[64:67], v[36:39], v[156:159]
  v_mfma_f32_16x16x32_bf16 v[160:163], v[68:71], v[36:39], v[160:163]
  v_mfma_f32_16x16x32_bf16 v[156:159], v[72:75], v[44:47], v[156:159]
  v_mfma_f32_16x16x32_bf16 v[160:163], v[76:79], v[44:47], v[160:163]
  s_nop 7
L_pfw3b1:
  buffer_load_dword v240, v15, s[8:11], s91 offen sc1
  s_waitcnt vmcnt(0)
  v_cmp_eq_u32 vcc, 0, v240
  s_nop 4
  s_cbranch_vccz L_pfdw3b1
  s_sleep 2
  s_branch L_pfw3b1
L_pfdw3b1:
  buffer_load_dwordx4 v[112:115], v9, s[8:11], s37 offen offset:0 sc1
  buffer_load_dwordx4 v[116:119], v9, s[8:11], s37 offen offset:512 sc1
  buffer_load_dwordx4 v[120:123], v9, s[8:11], s37 offen offset:1024 sc1
  buffer_load_dwordx4 v[124:127], v9, s[8:11], s37 offen offset:1536 sc1
  buffer_load_dwordx4 v[128:131], v8, s[8:11], s38 offen offset:0 sc1
  buffer_load_dwordx4 v[132:135], v8, s[8:11], s38 offen offset:1024 sc1
  buffer_load_dwordx4 v[136:139], v8, s[8:11], s38 offen offset:2048 sc1
  buffer_load_dwordx4 v[140:143], v8, s[8:11], s38 offen offset:3072 sc1
  s_waitcnt vmcnt(0)
  v_mfma_f32_16x16x32_bf16 v[152:155], v[112:115], v[20:23], 0
  v_mfma_f32_16x16x32_bf16 v[152:155], v[116:119], v[28:31], v[152:155]
  v_mfma_f32_16x16x32_bf16 v[152:155], v[120:123], v[36:39], v[152:155]
  v_mfma_f32_16x16x32_bf16 v[152:155], v[124:127], v[44:47], v[152:155]
  v_mov_b32 v215, 0xff800000
  v_cndmask_b32 v160, v215, v160, s[40:41]
  v_cndmask_b32 v161, v215, v161, s[42:43]
  v_cndmask_b32 v162, v215, v162, s[44:45]
  v_cndmask_b32 v163, v215, v163, s[46:47]
  s_nop 2
  v_max3_f32 v200, v152, v153, v156
  v_max3_f32 v200, v200, v157, v158
  v_max_f32 v200, v200, v159
  v_max3_f32 v200, v200, v160, v161
  v_max3_f32 v200, v200, v162, v163
  v_mov_b32 v201, v200
  s_nop 1
  v_permlane16_swap_b32 v200, v201
  v_max_f32 v200, v200, v201
  v_mov_b32 v201, v200
  s_nop 1
  v_permlane32_swap_b32 v200, v201
  v_max_f32 v200, v200, v201
  v_mul_f32 v200, s39, v200
  v_fma_f32 v152, v152, s39, -v200
  v_fma_f32 v153, v153, s39, -v200
  v_fma_f32 v156, v156, s39, -v200
  v_fma_f32 v157, v157, s39, -v200
  v_fma_f32 v158, v158, s39, -v200
  v_fma_f32 v159, v159, s39, -v200
  v_fma_f32 v160, v160, s39, -v200
  v_fma_f32 v161, v161, s39, -v200
  v_fma_f32 v162, v162, s39, -v200
  v_fma_f32 v163, v163, s39, -v200
  v_exp_f32 v152, v152
  v_exp_f32 v153, v153
  v_exp_f32 v156, v156
  v_exp_f32 v157, v157
  v_exp_f32 v158, v158
  v_exp_f32 v159, v159
  v_exp_f32 v160, v160
  v_exp_f32 v161, v161
  v_exp_f32 v162, v162
  v_exp_f32 v163, v163
  v_cvt_pk_bf16_f32 v216, v156, v157
  v_cvt_pk_bf16_f32 v217, v158, v159
  v_cvt_pk_bf16_f32 v218, v160, v161
  v_cvt_pk_bf16_f32 v219, v162, v163
  v_cvt_pk_bf16_f32 v220, v152, v153
  v_mov_b32 v221, v220
  v_mov_b32 v222, v220
  v_mov_b32 v223, 0
  v_mfma_f32_16x16x32_bf16 v[204:207], v[10:13], v[216:219], 0
  v_mfma_f32_16x16x32_bf16 v[168:171], v[80:83], v[216:219], 0
  v_mfma_f32_16x16x32_bf16 v[172:175], v[84:87], v[216:219], 0
  v_mfma_f32_16x16x32_bf16 v[176:179], v[88:91], v[216:219], 0
  v_mfma_f32_16x16x32_bf16 v[180:183], v[92:95], v[216:219], 0
  v_mfma_f32_16x16x32_bf16 v[184:187], v[96:99], v[216:219], 0
  v_mfma_f32_16x16x32_bf16 v[188:191], v[100:103], v[216:219], 0
  v_mfma_f32_16x16x32_bf16 v[192:195], v[104:107], v[216:219], 0
  v_mfma_f32_16x16x32_bf16 v[196:199], v[108:111], v[216:219], 0
  v_mfma_f32_16x16x16_bf16 v[204:207], v[10:11], v[222:223], v[204:207]
  v_mfma_f32_16x16x16_bf16 v[168:171], v[128:129], v[220:221], v[168:171]
  v_mfma_f32_16x16x16_bf16 v[172:175], v[130:131], v[220:221], v[172:175]
  v_mfma_f32_16x16x16_bf16 v[176:179], v[132:133], v[220:221], v[176:179]
  v_mfma_f32_16x16x16_bf16 v[180:183], v[134:135], v[220:221], v[180:183]
  v_mfma_f32_16x16x16_bf16 v[184:187], v[136:137], v[220:221], v[184:187]
  v_mfma_f32_16x16x16_bf16 v[188:191], v[138:139], v[220:221], v[188:191]
  v_mfma_f32_16x16x16_bf16 v[192:195], v[140:141], v[220:221], v[192:195]
  v_mfma_f32_16x16x16_bf16 v[196:199], v[142:143], v[220:221], v[196:199]
  v_rcp_f32 v202, v204
  s_nop 0
  v_mul_f32 v168, v168, v202
  v_mul_f32 v169, v169, v202
  v_mul_f32 v170, v170, v202
  v_mul_f32 v171, v171, v202
  v_mul_f32 v172, v172, v202
  v_mul_f32 v173, v173, v202
  v_mul_f32 v174, v174, v202
  v_mul_f32 v175, v175, v202
  v_cvt_pk_bf16_f32 v224, v168, v169
  v_cvt_pk_bf16_f32 v225, v170, v171
  v_cvt_pk_bf16_f32 v226, v172, v173
  v_cvt_pk_bf16_f32 v227, v174, v175
  s_add_u32 s32, s36, 16777216
  buffer_store_dwordx4 v[224:227], v8, s[8:11], s32 offen offset:1024 sc1
  v_mul_f32 v176, v176, v202
  v_mul_f32 v177, v177, v202
  v_mul_f32 v178, v178, v202
  v_mul_f32 v179, v179, v202
  v_mul_f32 v180, v180, v202
  v_mul_f32 v181, v181, v202
  v_mul_f32 v182, v182, v202
  v_mul_f32 v183, v183, v202
  v_cvt_pk_bf16_f32 v228, v176, v177
  v_cvt_pk_bf16_f32 v229, v178, v179
  v_cvt_pk_bf16_f32 v230, v180, v181
  v_cvt_pk_bf16_f32 v231, v182, v183
  s_add_u32 s32, s36, 16779264
  buffer_store_dwordx4 v[228:231], v8, s[8:11], s32 offen offset:1024 sc1
  v_mul_f32 v184, v184, v202
  v_mul_f32 v185, v185, v202
  v_mul_f32 v186, v186, v202
  v_mul_f32 v187, v187, v202
  v_mul_f32 v188, v188, v202
  v_mul_f32 v189, v189, v202
  v_mul_f32 v190, v190, v202
  v_mul_f32 v191, v191, v202
  v_cvt_pk_bf16_f32 v232, v184, v185
  v_cvt_pk_bf16_f32 v233, v186, v187
  v_cvt_pk_bf16_f32 v234, v188, v189
  v_cvt_pk_bf16_f32 v235, v190, v191
  s_add_u32 s32, s36, 16781312
  buffer_store_dwordx4 v[232:235], v8, s[8:11], s32 offen offset:1024 sc1
  v_mul_f32 v192, v192, v202
  v_mul_f32 v193, v193, v202
  v_mul_f32 v194, v194, v202
  v_mul_f32 v195, v195, v202
  v_mul_f32 v196, v196, v202
  v_mul_f32 v197, v197, v202
  v_mul_f32 v198, v198, v202
  v_mul_f32 v199, v199, v202
  v_cvt_pk_bf16_f32 v236, v192, v193
  v_cvt_pk_bf16_f32 v237, v194, v195
  v_cvt_pk_bf16_f32 v238, v196, v197
  v_cvt_pk_bf16_f32 v239, v198, v199
  s_add_u32 s32, s36, 16783360
  buffer_store_dwordx4 v[236:239], v8, s[8:11], s32 offen offset:1024 sc1
  s_nop 1
L_w3qe:
  s_waitcnt vmcnt(0)
  s_lshl_b32 s93, s93, 1
  s_lshl_b32 s3, s92, 7
  s_add_u32 s93, s93, s3
  s_add_u32 s93, s93, 720896
  v_mov_b32 v240, 1
  buffer_store_dword v240, v14, s[8:11], s93 offen sc1
  s_add_u32 s29, s29, 8
  s_cmp_lt_u32 s29, 64
  s_cbranch_scc1 L_w3l
  s_branch L_endF
L_w2role:
  s_mov_b32 s29, s94
  s_lshl_b32 s3, s97, 6
  v_add_u32 v1, s3, v0
  s_load_dwordx2 s[8:9], s[0:1], 8
  s_mov_b32 s10, 2097152
  s_mov_b32 s11, 0x20000
  s_load_dwordx2 s[12:13], s[0:1], 16
  s_mov_b32 s14, 2097152
  s_mov_b32 s15, 0x20000
  s_load_dwordx2 s[16:17], s[0:1], 0
  s_mov_b32 s18, 2097152
  s_mov_b32 s19, 0x20000
  s_load_dwordx2 s[20:21], s[0:1], 32
  s_mov_b32 s22, 2097152
  s_mov_b32 s23, 0x20000
  s_load_dwordx2 s[24:25], s[0:1], 104
  s_mov_b32 s26, 4194304
  s_mov_b32 s27, 0x20000
  s_load_dwordx2 s[52:53], s[0:1], 24
  s_mov_b32 s54, 4096
  s_mov_b32 s55, 0x20000
  s_barrier
  v_mov_b32 v4, 0
  v_mov_b32 v5, 0
  v_mov_b32 v6, 0
  v_mov_b32 v7, 0
  v_lshrrev_b32 v8, 4, v1
  v_mul_u32_u24 v8, 5184, v8
  v_and_b32 v9, 15, v1
  v_lshlrev_b32 v9, 6, v9
  v_add_u32 v8, v8, v9
  ds_write_b128 v8, v[4:7] offset:0
  ds_write_b128 v8, v[4:7] offset:16
  ds_write_b128 v8, v[4:7] offset:32
  ds_write_b128 v8, v[4:7] offset:48
  v_lshrrev_b32 v8, 2, v1
  v_mul_u32_u24 v8, 4160, v8
  v_and_b32 v9, 3, v1
  v_lshlrev_b32 v9, 4, v9
  v_add_u32 v8, v8, v9
  v_add_u32 v8, 82944, v8
  v_cmp_gt_u32 vcc, 32, v1
  s_and_saveexec_b64 s[56:57], vcc
  ds_write_b128 v8, v[4:7]
  s_mov_b64 exec, s[56:57]
  s_waitcnt lgkmcnt(0)
  v_and_b32 v10, 1, v1
  v_lshlrev_b32 v11, 6, v10
  s_lshl_b32 s32, s29, 7
  buffer_load_dwordx4 v[48:51], v11, s[52:55], s32 offen offset:0
  buffer_load_dwordx4 v[52:55], v11, s[52:55], s32 offen offset:16
  buffer_load_dwordx4 v[56:59], v11, s[52:55], s32 offen offset:32
  buffer_load_dwordx4 v[60:63], v11, s[52:55], s32 offen offset:48
  s_waitcnt vmcnt(0)
  v_lshlrev_b32 v16, 16, v48
  v_and_b32 v24, 0xffff0000, v48
  v_lshlrev_b32 v32, 16, v49
  v_and_b32 v40, 0xffff0000, v49
  v_lshlrev_b32 v17, 16, v50
  v_and_b32 v25, 0xffff0000, v50
  v_lshlrev_b32 v33, 16, v51
  v_and_b32 v41, 0xffff0000, v51
  v_lshlrev_b32 v18, 16, v52
  v_and_b32 v26, 0xffff0000, v52
  v_lshlrev_b32 v34, 16, v53
  v_and_b32 v42, 0xffff0000, v53
  v_lshlrev_b32 v19, 16, v54
  v_and_b32 v27, 0xffff0000, v54
  v_lshlrev_b32 v35, 16, v55
  v_and_b32 v43, 0xffff0000, v55
  v_lshlrev_b32 v20, 16, v56
  v_and_b32 v28, 0xffff0000, v56
  v_lshlrev_b32 v36, 16, v57
  v_and_b32 v44, 0xffff0000, v57
  v_lshlrev_b32 v21, 16, v58
  v_and_b32 v29, 0xffff0000, v58
  v_lshlrev_b32 v37, 16, v59
  v_and_b32 v45, 0xffff0000, v59
  v_lshlrev_b32 v22, 16, v60
  v_and_b32 v30, 0xffff0000, v60
  v_lshlrev_b32 v38, 16, v61
  v_and_b32 v46, 0xffff0000, v61
  v_lshlrev_b32 v23, 16, v62
  v_and_b32 v31, 0xffff0000, v62
  v_lshlrev_b32 v39, 16, v63
  v_and_b32 v47, 0xffff0000, v63
  s_load_dwordx2 s[52:53], s[0:1], 40
  s_mov_b32 s54, 1024
  s_mov_b32 s55, 0x20000
  s_waitcnt lgkmcnt(0)
  v_lshlrev_b32 v11, 1, v0
  s_lshl_b32 s32, s29, 5
  buffer_load_ushort v12, v11, s[52:55], s32 offen
  s_waitcnt vmcnt(0)
  v_lshlrev_b32 v12, 16, v12
  s_nop 1
  v_readlane_b32 s36, v12, 0
  v_readlane_b32 s37, v12, 1
  v_readlane_b32 s38, v12, 2
  v_readlane_b32 s39, v12, 3
  v_readlane_b32 s40, v12, 4
  v_readlane_b32 s41, v12, 5
  v_readlane_b32 s42, v12, 6
  v_readlane_b32 s43, v12, 7
  v_readlane_b32 s44, v12, 8
  v_readlane_b32 s45, v12, 9
  v_readlane_b32 s46, v12, 10
  v_readlane_b32 s47, v12, 11
  v_readlane_b32 s48, v12, 12
  v_readlane_b32 s49, v12, 13
  v_readlane_b32 s50, v12, 14
  v_readlane_b32 s51, v12, 15
  v_lshrrev_b32 v11, 1, v1
  v_lshlrev_b32 v12, 11, v11
  v_lshlrev_b32 v13, 4, v10
  v_add_u32 v12, v12, v13
  s_lshl_b32 s32, s29, 5
  v_add_u32 v12, s32, v12
  v_subrev_u32 v12, 3072, v12
  v_bfe_u32 v13, v1, 1, 4
  v_lshlrev_b32 v13, 1, v13
  v_sub_u32 v13, 30, v13
  v_lshrrev_b32 v14, 5, v1
  v_add_u32 v14, 16, v14
  v_lshlrev_b32 v14, 5, v14
  v_add_u32 v13, v13, v14
  v_lshlrev_b32 v13, 1, v13
  v_mul_u32_u24 v14, 41472, v10
  v_add_u32 v13, v13, v14
  v_add_u32 v144, 0, v12
  v_add_u32 v145, 1024, v12
  v_add_u32 v146, 2048, v12
  v_add_u32 v147, 3072, v12
  v_add_u32 v148, 4096, v12
  buffer_load_dwordx4 v[48:51], v144, s[8:11], 0 offen
  buffer_load_dwordx4 v[52:55], v145, s[8:11], 0 offen
  buffer_load_dwordx4 v[56:59], v146, s[8:11], 0 offen
  buffer_load_dwordx4 v[60:63], v147, s[8:11], 0 offen
  buffer_load_dwordx4 v[64:67], v148, s[8:11], 0 offen
  buffer_load_dwordx4 v[68:71], v147, s[12:15], 0 offen
  buffer_load_dwordx4 v[72:75], v148, s[12:15], 0 offen
  s_waitcnt vmcnt(0)
  v_lshlrev_b32 v80, 16, v48
  v_and_b32 v81, 0xffff0000, v48
  v_lshlrev_b32 v82, 16, v49
  v_and_b32 v83, 0xffff0000, v49
  v_lshlrev_b32 v84, 16, v50
  v_and_b32 v85, 0xffff0000, v50
  v_lshlrev_b32 v86, 16, v51
  v_and_b32 v87, 0xffff0000, v51
  v_lshlrev_b32 v88, 16, v52
  v_and_b32 v89, 0xffff0000, v52
  v_lshlrev_b32 v90, 16, v53
  v_and_b32 v91, 0xffff0000, v53
  v_lshlrev_b32 v92, 16, v54
  v_and_b32 v93, 0xffff0000, v54
  v_lshlrev_b32 v94, 16, v55
  v_and_b32 v95, 0xffff0000, v55
  v_lshlrev_b32 v96, 16, v56
  v_and_b32 v97, 0xffff0000, v56
  v_lshlrev_b32 v98, 16, v57
  v_and_b32 v99, 0xffff0000, v57
  v_lshlrev_b32 v100, 16, v58
  v_and_b32 v101, 0xffff0000, v58
  v_lshlrev_b32 v102, 16, v59
  v_and_b32 v103, 0xffff0000, v59
  v_lshlrev_b32 v104, 16, v60
  v_and_b32 v105, 0xffff0000, v60
  v_lshlrev_b32 v106, 16, v61
  v_and_b32 v107, 0xffff0000, v61
  v_lshlrev_b32 v108, 16, v62
  v_and_b32 v109, 0xffff0000, v62
  v_lshlrev_b32 v110, 16, v63
  v_and_b32 v111, 0xffff0000, v63
  v_lshlrev_b32 v112, 16, v64
  v_and_b32 v113, 0xffff0000, v64
  v_lshlrev_b32 v114, 16, v65
  v_and_b32 v115, 0xffff0000, v65
  v_lshlrev_b32 v116, 16, v66
  v_and_b32 v117, 0xffff0000, v66
  v_lshlrev_b32 v118, 16, v67
  v_and_b32 v119, 0xffff0000, v67
  v_lshlrev_b32 v120, 16, v68
  v_and_b32 v121, 0xffff0000, v68
  v_lshlrev_b32 v122, 16, v69
  v_and_b32 v123, 0xffff0000, v69
  v_lshlrev_b32 v124, 16, v70
  v_and_b32 v125, 0xffff0000, v70
  v_lshlrev_b32 v126, 16, v71
  v_and_b32 v127, 0xffff0000, v71
  v_lshlrev_b32 v128, 16, v72
  v_and_b32 v129, 0xffff0000, v72
  v_lshlrev_b32 v130, 16, v73
  v_and_b32 v131, 0xffff0000, v73
  v_lshlrev_b32 v132, 16, v74
  v_and_b32 v133, 0xffff0000, v74
  v_lshlrev_b32 v134, 16, v75
  v_and_b32 v135, 0xffff0000, v75
  v_mul_f32 v136, v80, v40
  v_mul_f32 v137, v88, v40
  v_cvt_pk_bf16_f32 v138, v136, v137
  v_lshlrev_b32 v136, 16, v138
  v_and_b32 v137, 0xffff0000, v138
  v_mul_f32 v150, v88, v32
  v_mul_f32 v151, v96, v32
  v_cvt_pk_bf16_f32 v138, v150, v151
  v_lshlrev_b32 v150, 16, v138
  v_and_b32 v151, 0xffff0000, v138
  v_add_f32 v136, v136, v150
  v_add_f32 v137, v137, v151
  v_cvt_pk_bf16_f32 v138, v136, v137
  v_lshlrev_b32 v136, 16, v138
  v_and_b32 v137, 0xffff0000, v138
  v_mul_f32 v150, v96, v24
  v_mul_f32 v151, v104, v24
  v_cvt_pk_bf16_f32 v138, v150, v151
  v_lshlrev_b32 v150, 16, v138
  v_and_b32 v151, 0xffff0000, v138
  v_add_f32 v136, v136, v150
  v_add_f32 v137, v137, v151
  v_cvt_pk_bf16_f32 v138, v136, v137
  v_lshlrev_b32 v136, 16, v138
  v_and_b32 v137, 0xffff0000, v138
  v_mul_f32 v150, v104, v16
  v_mul_f32 v151, v112, v16
  v_cvt_pk_bf16_f32 v138, v150, v151
  v_lshlrev_b32 v150, 16, v138
  v_and_b32 v151, 0xffff0000, v138
  v_add_f32 v136, v136, v150
  v_add_f32 v137, v137, v151
  v_cvt_pk_bf16_f32 v138, v136, v137
  v_lshlrev_b32 v136, 16, v138
  v_and_b32 v137, 0xffff0000, v138
  v_mul_f32 v136, v136, v120
  v_mul_f32 v137, v137, v128
  v_cvt_pk_bf16_f32 v139, v137, v136
  ds_write_b32 v13, v139 offset:0
  v_mul_f32 v136, v81, v41
  v_mul_f32 v137, v89, v41
  v_cvt_pk_bf16_f32 v138, v136, v137
  v_lshlrev_b32 v136, 16, v138
  v_and_b32 v137, 0xffff0000, v138
  v_mul_f32 v150, v89, v33
  v_mul_f32 v151, v97, v33
  v_cvt_pk_bf16_f32 v138, v150, v151
  v_lshlrev_b32 v150, 16, v138
  v_and_b32 v151, 0xffff0000, v138
  v_add_f32 v136, v136, v150
  v_add_f32 v137, v137, v151
  v_cvt_pk_bf16_f32 v138, v136, v137
  v_lshlrev_b32 v136, 16, v138
  v_and_b32 v137, 0xffff0000, v138
  v_mul_f32 v150, v97, v25
  v_mul_f32 v151, v105, v25
  v_cvt_pk_bf16_f32 v138, v150, v151
  v_lshlrev_b32 v150, 16, v138
  v_and_b32 v151, 0xffff0000, v138
  v_add_f32 v136, v136, v150
  v_add_f32 v137, v137, v151
  v_cvt_pk_bf16_f32 v138, v136, v137
  v_lshlrev_b32 v136, 16, v138
  v_and_b32 v137, 0xffff0000, v138
  v_mul_f32 v150, v105, v17
  v_mul_f32 v151, v113, v17
  v_cvt_pk_bf16_f32 v138, v150, v151
  v_lshlrev_b32 v150, 16, v138
  v_and_b32 v151, 0xffff0000, v138
  v_add_f32 v136, v136, v150
  v_add_f32 v137, v137, v151
  v_cvt_pk_bf16_f32 v138, v136, v137
  v_lshlrev_b32 v136, 16, v138
  v_and_b32 v137, 0xffff0000, v138
  v_mul_f32 v136, v136, v121
  v_mul_f32 v137, v137, v129
  v_cvt_pk_bf16_f32 v140, v137, v136
  ds_write_b32 v13, v140 offset:5184
  v_mul_f32 v136, v82, v42
  v_mul_f32 v137, v90, v42
  v_cvt_pk_bf16_f32 v138, v136, v137
  v_lshlrev_b32 v136, 16, v138
  v_and_b32 v137, 0xffff0000, v138
  v_mul_f32 v150, v90, v34
  v_mul_f32 v151, v98, v34
  v_cvt_pk_bf16_f32 v138, v150, v151
  v_lshlrev_b32 v150, 16, v138
  v_and_b32 v151, 0xffff0000, v138
  v_add_f32 v136, v136, v150
  v_add_f32 v137, v137, v151
  v_cvt_pk_bf16_f32 v138, v136, v137
  v_lshlrev_b32 v136, 16, v138
  v_and_b32 v137, 0xffff0000, v138
  v_mul_f32 v150, v98, v26
  v_mul_f32 v151, v106, v26
  v_cvt_pk_bf16_f32 v138, v150, v151
  v_lshlrev_b32 v150, 16, v138
  v_and_b32 v151, 0xffff0000, v138
  v_add_f32 v136, v136, v150
  v_add_f32 v137, v137, v151
  v_cvt_pk_bf16_f32 v138, v136, v137
  v_lshlrev_b32 v136, 16, v138
  v_and_b32 v137, 0xffff0000, v138
  v_mul_f32 v150, v106, v18
  v_mul_f32 v151, v114, v18
  v_cvt_pk_bf16_f32 v138, v150, v151
  v_lshlrev_b32 v150, 16, v138
  v_and_b32 v151, 0xffff0000, v138
  v_add_f32 v136, v136, v150
  v_add_f32 v137, v137, v151
  v_cvt_pk_bf16_f32 v138, v136, v137
  v_lshlrev_b32 v136, 16, v138
  v_and_b32 v137, 0xffff0000, v138
  v_mul_f32 v136, v136, v122
  v_mul_f32 v137, v137, v130
  v_cvt_pk_bf16_f32 v141, v137, v136
  ds_write_b32 v13, v141 offset:10368
  v_mul_f32 v136, v83, v43
  v_mul_f32 v137, v91, v43
  v_cvt_pk_bf16_f32 v138, v136, v137
  v_lshlrev_b32 v136, 16, v138
  v_and_b32 v137, 0xffff0000, v138
  v_mul_f32 v150, v91, v35
  v_mul_f32 v151, v99, v35
  v_cvt_pk_bf16_f32 v138, v150, v151
  v_lshlrev_b32 v150, 16, v138
  v_and_b32 v151, 0xffff0000, v138
  v_add_f32 v136, v136, v150
  v_add_f32 v137, v137, v151
  v_cvt_pk_bf16_f32 v138, v136, v137
  v_lshlrev_b32 v136, 16, v138
  v_and_b32 v137, 0xffff0000, v138
  v_mul_f32 v150, v99, v27
  v_mul_f32 v151, v107, v27
  v_cvt_pk_bf16_f32 v138, v150, v151
  v_lshlrev_b32 v150, 16, v138
  v_and_b32 v151, 0xffff0000, v138
  v_add_f32 v136, v136, v150
  v_add_f32 v137, v137, v151
  v_cvt_pk_bf16_f32 v138, v136, v137
  v_lshlrev_b32 v136, 16, v138
  v_and_b32 v137, 0xffff0000, v138
  v_mul_f32 v150, v107, v19
  v_mul_f32 v151, v115, v19
  v_cvt_pk_bf16_f32 v138, v150, v151
  v_lshlrev_b32 v150, 16, v138
  v_and_b32 v151, 0xffff0000, v138
  v_add_f32 v136, v136, v150
  v_add_f32 v137, v137, v151
  v_cvt_pk_bf16_f32 v138, v136, v137
  v_lshlrev_b32 v136, 16, v138
  v_and_b32 v137, 0xffff0000, v138
  v_mul_f32 v136, v136, v123
  v_mul_f32 v137, v137, v131
  v_cvt_pk_bf16_f32 v142, v137, v136
  ds_write_b32 v13, v142 offset:15552
  v_mul_f32 v136, v84, v44
  v_mul_f32 v137, v92, v44
  v_cvt_pk_bf16_f32 v138, v136, v137
  v_lshlrev_b32 v136, 16, v138
  v_and_b32 v137, 0xffff0000, v138
  v_mul_f32 v150, v92, v36
  v_mul_f32 v151, v100, v36
  v_cvt_pk_bf16_f32 v138, v150, v151
  v_lshlrev_b32 v150, 16, v138
  v_and_b32 v151, 0xffff0000, v138
  v_add_f32 v136, v136, v150
  v_add_f32 v137, v137, v151
  v_cvt_pk_bf16_f32 v138, v136, v137
  v_lshlrev_b32 v136, 16, v138
  v_and_b32 v137, 0xffff0000, v138
  v_mul_f32 v150, v100, v28
  v_mul_f32 v151, v108, v28
  v_cvt_pk_bf16_f32 v138, v150, v151
  v_lshlrev_b32 v150, 16, v138
  v_and_b32 v151, 0xffff0000, v138
  v_add_f32 v136, v136, v150
  v_add_f32 v137, v137, v151
  v_cvt_pk_bf16_f32 v138, v136, v137
  v_lshlrev_b32 v136, 16, v138
  v_and_b32 v137, 0xffff0000, v138
  v_mul_f32 v150, v108, v20
  v_mul_f32 v151, v116, v20
  v_cvt_pk_bf16_f32 v138, v150, v151
  v_lshlrev_b32 v150, 16, v138
  v_and_b32 v151, 0xffff0000, v138
  v_add_f32 v136, v136, v150
  v_add_f32 v137, v137, v151
  v_cvt_pk_bf16_f32 v138, v136, v137
  v_lshlrev_b32 v136, 16, v138
  v_and_b32 v137, 0xffff0000, v138
  v_mul_f32 v136, v136, v124
  v_mul_f32 v137, v137, v132
  v_cvt_pk_bf16_f32 v139, v137, v136
  ds_write_b32 v13, v139 offset:20736
  v_mul_f32 v136, v85, v45
  v_mul_f32 v137, v93, v45
  v_cvt_pk_bf16_f32 v138, v136, v137
  v_lshlrev_b32 v136, 16, v138
  v_and_b32 v137, 0xffff0000, v138
  v_mul_f32 v150, v93, v37
  v_mul_f32 v151, v101, v37
  v_cvt_pk_bf16_f32 v138, v150, v151
  v_lshlrev_b32 v150, 16, v138
  v_and_b32 v151, 0xffff0000, v138
  v_add_f32 v136, v136, v150
  v_add_f32 v137, v137, v151
  v_cvt_pk_bf16_f32 v138, v136, v137
  v_lshlrev_b32 v136, 16, v138
  v_and_b32 v137, 0xffff0000, v138
  v_mul_f32 v150, v101, v29
  v_mul_f32 v151, v109, v29
  v_cvt_pk_bf16_f32 v138, v150, v151
  v_lshlrev_b32 v150, 16, v138
  v_and_b32 v151, 0xffff0000, v138
  v_add_f32 v136, v136, v150
  v_add_f32 v137, v137, v151
  v_cvt_pk_bf16_f32 v138, v136, v137
  v_lshlrev_b32 v136, 16, v138
  v_and_b32 v137, 0xffff0000, v138
  v_mul_f32 v150, v109, v21
  v_mul_f32 v151, v117, v21
  v_cvt_pk_bf16_f32 v138, v150, v151
  v_lshlrev_b32 v150, 16, v138
  v_and_b32 v151, 0xffff0000, v138
  v_add_f32 v136, v136, v150
  v_add_f32 v137, v137, v151
  v_cvt_pk_bf16_f32 v138, v136, v137
  v_lshlrev_b32 v136, 16, v138
  v_and_b32 v137, 0xffff0000, v138
  v_mul_f32 v136, v136, v125
  v_mul_f32 v137, v137, v133
  v_cvt_pk_bf16_f32 v140, v137, v136
  ds_write_b32 v13, v140 offset:25920
  v_mul_f32 v136, v86, v46
  v_mul_f32 v137, v94, v46
  v_cvt_pk_bf16_f32 v138, v136, v137
  v_lshlrev_b32 v136, 16, v138
  v_and_b32 v137, 0xffff0000, v138
  v_mul_f32 v150, v94, v38
  v_mul_f32 v151, v102, v38
  v_cvt_pk_bf16_f32 v138, v150, v151
  v_lshlrev_b32 v150, 16, v138
  v_and_b32 v151, 0xffff0000, v138
  v_add_f32 v136, v136, v150
  v_add_f32 v137, v137, v151
  v_cvt_pk_bf16_f32 v138, v136, v137
  v_lshlrev_b32 v136, 16, v138
  v_and_b32 v137, 0xffff0000, v138
  v_mul_f32 v150, v102, v30
  v_mul_f32 v151, v110, v30
  v_cvt_pk_bf16_f32 v138, v150, v151
  v_lshlrev_b32 v150, 16, v138
  v_and_b32 v151, 0xffff0000, v138
  v_add_f32 v136, v136, v150
  v_add_f32 v137, v137, v151
  v_cvt_pk_bf16_f32 v138, v136, v137
  v_lshlrev_b32 v136, 16, v138
  v_and_b32 v137, 0xffff0000, v138
  v_mul_f32 v150, v110, v22
  v_mul_f32 v151, v118, v22
  v_cvt_pk_bf16_f32 v138, v150, v151
  v_lshlrev_b32 v150, 16, v138
  v_and_b32 v151, 0xffff0000, v138
  v_add_f32 v136, v136, v150
  v_add_f32 v137, v137, v151
  v_cvt_pk_bf16_f32 v138, v136, v137
  v_lshlrev_b32 v136, 16, v138
  v_and_b32 v137, 0xffff0000, v138
  v_mul_f32 v136, v136, v126
  v_mul_f32 v137, v137, v134
  v_cvt_pk_bf16_f32 v141, v137, v136
  ds_write_b32 v13, v141 offset:31104
  v_mul_f32 v136, v87, v47
  v_mul_f32 v137, v95, v47
  v_cvt_pk_bf16_f32 v138, v136, v137
  v_lshlrev_b32 v136, 16, v138
  v_and_b32 v137, 0xffff0000, v138
  v_mul_f32 v150, v95, v39
  v_mul_f32 v151, v103, v39
  v_cvt_pk_bf16_f32 v138, v150, v151
  v_lshlrev_b32 v150, 16, v138
  v_and_b32 v151, 0xffff0000, v138
  v_add_f32 v136, v136, v150
  v_add_f32 v137, v137, v151
  v_cvt_pk_bf16_f32 v138, v136, v137
  v_lshlrev_b32 v136, 16, v138
  v_and_b32 v137, 0xffff0000, v138
  v_mul_f32 v150, v103, v31
  v_mul_f32 v151, v111, v31
  v_cvt_pk_bf16_f32 v138, v150, v151
  v_lshlrev_b32 v150, 16, v138
  v_and_b32 v151, 0xffff0000, v138
  v_add_f32 v136, v136, v150
  v_add_f32 v137, v137, v151
  v_cvt_pk_bf16_f32 v138, v136, v137
  v_lshlrev_b32 v136, 16, v138
  v_and_b32 v137, 0xffff0000, v138
  v_mul_f32 v150, v111, v23
  v_mul_f32 v151, v119, v23
  v_cvt_pk_bf16_f32 v138, v150, v151
  v_lshlrev_b32 v150, 16, v138
  v_and_b32 v151, 0xffff0000, v138
  v_add_f32 v136, v136, v150
  v_add_f32 v137, v137, v151
  v_cvt_pk_bf16_f32 v138, v136, v137
  v_lshlrev_b32 v136, 16, v138
  v_and_b32 v137, 0xffff0000, v138
  v_mul_f32 v136, v136, v127
  v_mul_f32 v137, v137, v135
  v_cvt_pk_bf16_f32 v142, v137, v136
  ds_write_b32 v13, v142 offset:36288
  v_add_u32 v12, 262144, v12
  v_add_u32 v144, 0, v12
  v_add_u32 v145, 1024, v12
  v_add_u32 v146, 2048, v12
  v_add_u32 v147, 3072, v12
  v_add_u32 v148, 4096, v12
  buffer_load_dwordx4 v[48:51], v144, s[8:11], 0 offen
  buffer_load_dwordx4 v[52:55], v145, s[8:11], 0 offen
  buffer_load_dwordx4 v[56:59], v146, s[8:11], 0 offen
  buffer_load_dwordx4 v[60:63], v147, s[8:11], 0 offen
  buffer_load_dwordx4 v[64:67], v148, s[8:11], 0 offen
  buffer_load_dwordx4 v[68:71], v147, s[12:15], 0 offen
  buffer_load_dwordx4 v[72:75], v148, s[12:15], 0 offen
  s_waitcnt vmcnt(0)
  v_lshlrev_b32 v80, 16, v48
  v_and_b32 v81, 0xffff0000, v48
  v_lshlrev_b32 v82, 16, v49
  v_and_b32 v83, 0xffff0000, v49
  v_lshlrev_b32 v84, 16, v50
  v_and_b32 v85, 0xffff0000, v50
  v_lshlrev_b32 v86, 16, v51
  v_and_b32 v87, 0xffff0000, v51
  v_lshlrev_b32 v88, 16, v52
  v_and_b32 v89, 0xffff0000, v52
  v_lshlrev_b32 v90, 16, v53
  v_and_b32 v91, 0xffff0000, v53
  v_lshlrev_b32 v92, 16, v54
  v_and_b32 v93, 0xffff0000, v54
  v_lshlrev_b32 v94, 16, v55
  v_and_b32 v95, 0xffff0000, v55
  v_lshlrev_b32 v96, 16, v56
  v_and_b32 v97, 0xffff0000, v56
  v_lshlrev_b32 v98, 16, v57
  v_and_b32 v99, 0xffff0000, v57
  v_lshlrev_b32 v100, 16, v58
  v_and_b32 v101, 0xffff0000, v58
  v_lshlrev_b32 v102, 16, v59
  v_and_b32 v103, 0xffff0000, v59
  v_lshlrev_b32 v104, 16, v60
  v_and_b32 v105, 0xffff0000, v60
  v_lshlrev_b32 v106, 16, v61
  v_and_b32 v107, 0xffff0000, v61
  v_lshlrev_b32 v108, 16, v62
  v_and_b32 v109, 0xffff0000, v62
  v_lshlrev_b32 v110, 16, v63
  v_and_b32 v111, 0xffff0000, v63
  v_lshlrev_b32 v112, 16, v64
  v_and_b32 v113, 0xffff0000, v64
  v_lshlrev_b32 v114, 16, v65
  v_and_b32 v115, 0xffff0000, v65
  v_lshlrev_b32 v116, 16, v66
  v_and_b32 v117, 0xffff0000, v66
  v_lshlrev_b32 v118, 16, v67
  v_and_b32 v119, 0xffff0000, v67
  v_lshlrev_b32 v120, 16, v68
  v_and_b32 v121, 0xffff0000, v68
  v_lshlrev_b32 v122, 16, v69
  v_and_b32 v123, 0xffff0000, v69
  v_lshlrev_b32 v124, 16, v70
  v_and_b32 v125, 0xffff0000, v70
  v_lshlrev_b32 v126, 16, v71
  v_and_b32 v127, 0xffff0000, v71
  v_lshlrev_b32 v128, 16, v72
  v_and_b32 v129, 0xffff0000, v72
  v_lshlrev_b32 v130, 16, v73
  v_and_b32 v131, 0xffff0000, v73
  v_lshlrev_b32 v132, 16, v74
  v_and_b32 v133, 0xffff0000, v74
  v_lshlrev_b32 v134, 16, v75
  v_and_b32 v135, 0xffff0000, v75
  v_mul_f32 v136, v80, v40
  v_mul_f32 v137, v88, v40
  v_cvt_pk_bf16_f32 v138, v136, v137
  v_lshlrev_b32 v136, 16, v138
  v_and_b32 v137, 0xffff0000, v138
  v_mul_f32 v150, v88, v32
  v_mul_f32 v151, v96, v32
  v_cvt_pk_bf16_f32 v138, v150, v151
  v_lshlrev_b32 v150, 16, v138
  v_and_b32 v151, 0xffff0000, v138
  v_add_f32 v136, v136, v150
  v_add_f32 v137, v137, v151
  v_cvt_pk_bf16_f32 v138, v136, v137
  v_lshlrev_b32 v136, 16, v138
  v_and_b32 v137, 0xffff0000, v138
  v_mul_f32 v150, v96, v24
  v_mul_f32 v151, v104, v24
  v_cvt_pk_bf16_f32 v138, v150, v151
  v_lshlrev_b32 v150, 16, v138
  v_and_b32 v151, 0xffff0000, v138
  v_add_f32 v136, v136, v150
  v_add_f32 v137, v137, v151
  v_cvt_pk_bf16_f32 v138, v136, v137
  v_lshlrev_b32 v136, 16, v138
  v_and_b32 v137, 0xffff0000, v138
  v_mul_f32 v150, v104, v16
  v_mul_f32 v151, v112, v16
  v_cvt_pk_bf16_f32 v138, v150, v151
  v_lshlrev_b32 v150, 16, v138
  v_and_b32 v151, 0xffff0000, v138
  v_add_f32 v136, v136, v150
  v_add_f32 v137, v137, v151
  v_cvt_pk_bf16_f32 v138, v136, v137
  v_lshlrev_b32 v136, 16, v138
  v_and_b32 v137, 0xffff0000, v138
  v_mul_f32 v136, v136, v120
  v_mul_f32 v137, v137, v128
  v_cvt_pk_bf16_f32 v139, v137, v136
  ds_write_b32 v13, v139 offset:512
  v_mul_f32 v136, v81, v41
  v_mul_f32 v137, v89, v41
  v_cvt_pk_bf16_f32 v138, v136, v137
  v_lshlrev_b32 v136, 16, v138
  v_and_b32 v137, 0xffff0000, v138
  v_mul_f32 v150, v89, v33
  v_mul_f32 v151, v97, v33
  v_cvt_pk_bf16_f32 v138, v150, v151
  v_lshlrev_b32 v150, 16, v138
  v_and_b32 v151, 0xffff0000, v138
  v_add_f32 v136, v136, v150
  v_add_f32 v137, v137, v151
  v_cvt_pk_bf16_f32 v138, v136, v137
  v_lshlrev_b32 v136, 16, v138
  v_and_b32 v137, 0xffff0000, v138
  v_mul_f32 v150, v97, v25
  v_mul_f32 v151, v105, v25
  v_cvt_pk_bf16_f32 v138, v150, v151
  v_lshlrev_b32 v150, 16, v138
  v_and_b32 v151, 0xffff0000, v138
  v_add_f32 v136, v136, v150
  v_add_f32 v137, v137, v151
  v_cvt_pk_bf16_f32 v138, v136, v137
  v_lshlrev_b32 v136, 16, v138
  v_and_b32 v137, 0xffff0000, v138
  v_mul_f32 v150, v105, v17
  v_mul_f32 v151, v113, v17
  v_cvt_pk_bf16_f32 v138, v150, v151
  v_lshlrev_b32 v150, 16, v138
  v_and_b32 v151, 0xffff0000, v138
  v_add_f32 v136, v136, v150
  v_add_f32 v137, v137, v151
  v_cvt_pk_bf16_f32 v138, v136, v137
  v_lshlrev_b32 v136, 16, v138
  v_and_b32 v137, 0xffff0000, v138
  v_mul_f32 v136, v136, v121
  v_mul_f32 v137, v137, v129
  v_cvt_pk_bf16_f32 v140, v137, v136
  ds_write_b32 v13, v140 offset:5696
  v_mul_f32 v136, v82, v42
  v_mul_f32 v137, v90, v42
  v_cvt_pk_bf16_f32 v138, v136, v137
  v_lshlrev_b32 v136, 16, v138
  v_and_b32 v137, 0xffff0000, v138
  v_mul_f32 v150, v90, v34
  v_mul_f32 v151, v98, v34
  v_cvt_pk_bf16_f32 v138, v150, v151
  v_lshlrev_b32 v150, 16, v138
  v_and_b32 v151, 0xffff0000, v138
  v_add_f32 v136, v136, v150
  v_add_f32 v137, v137, v151
  v_cvt_pk_bf16_f32 v138, v136, v137
  v_lshlrev_b32 v136, 16, v138
  v_and_b32 v137, 0xffff0000, v138
  v_mul_f32 v150, v98, v26
  v_mul_f32 v151, v106, v26
  v_cvt_pk_bf16_f32 v138, v150, v151
  v_lshlrev_b32 v150, 16, v138
  v_and_b32 v151, 0xffff0000, v138
  v_add_f32 v136, v136, v150
  v_add_f32 v137, v137, v151
  v_cvt_pk_bf16_f32 v138, v136, v137
  v_lshlrev_b32 v136, 16, v138
  v_and_b32 v137, 0xffff0000, v138
  v_mul_f32 v150, v106, v18
  v_mul_f32 v151, v114, v18
  v_cvt_pk_bf16_f32 v138, v150, v151
  v_lshlrev_b32 v150, 16, v138
  v_and_b32 v151, 0xffff0000, v138
  v_add_f32 v136, v136, v150
  v_add_f32 v137, v137, v151
  v_cvt_pk_bf16_f32 v138, v136, v137
  v_lshlrev_b32 v136, 16, v138
  v_and_b32 v137, 0xffff0000, v138
  v_mul_f32 v136, v136, v122
  v_mul_f32 v137, v137, v130
  v_cvt_pk_bf16_f32 v141, v137, v136
  ds_write_b32 v13, v141 offset:10880
  v_mul_f32 v136, v83, v43
  v_mul_f32 v137, v91, v43
  v_cvt_pk_bf16_f32 v138, v136, v137
  v_lshlrev_b32 v136, 16, v138
  v_and_b32 v137, 0xffff0000, v138
  v_mul_f32 v150, v91, v35
  v_mul_f32 v151, v99, v35
  v_cvt_pk_bf16_f32 v138, v150, v151
  v_lshlrev_b32 v150, 16, v138
  v_and_b32 v151, 0xffff0000, v138
  v_add_f32 v136, v136, v150
  v_add_f32 v137, v137, v151
  v_cvt_pk_bf16_f32 v138, v136, v137
  v_lshlrev_b32 v136, 16, v138
  v_and_b32 v137, 0xffff0000, v138
  v_mul_f32 v150, v99, v27
  v_mul_f32 v151, v107, v27
  v_cvt_pk_bf16_f32 v138, v150, v151
  v_lshlrev_b32 v150, 16, v138
  v_and_b32 v151, 0xffff0000, v138
  v_add_f32 v136, v136, v150
  v_add_f32 v137, v137, v151
  v_cvt_pk_bf16_f32 v138, v136, v137
  v_lshlrev_b32 v136, 16, v138
  v_and_b32 v137, 0xffff0000, v138
  v_mul_f32 v150, v107, v19
  v_mul_f32 v151, v115, v19
  v_cvt_pk_bf16_f32 v138, v150, v151
  v_lshlrev_b32 v150, 16, v138
  v_and_b32 v151, 0xffff0000, v138
  v_add_f32 v136, v136, v150
  v_add_f32 v137, v137, v151
  v_cvt_pk_bf16_f32 v138, v136, v137
  v_lshlrev_b32 v136, 16, v138
  v_and_b32 v137, 0xffff0000, v138
  v_mul_f32 v136, v136, v123
  v_mul_f32 v137, v137, v131
  v_cvt_pk_bf16_f32 v142, v137, v136
  ds_write_b32 v13, v142 offset:16064
  v_mul_f32 v136, v84, v44
  v_mul_f32 v137, v92, v44
  v_cvt_pk_bf16_f32 v138, v136, v137
  v_lshlrev_b32 v136, 16, v138
  v_and_b32 v137, 0xffff0000, v138
  v_mul_f32 v150, v92, v36
  v_mul_f32 v151, v100, v36
  v_cvt_pk_bf16_f32 v138, v150, v151
  v_lshlrev_b32 v150, 16, v138
  v_and_b32 v151, 0xffff0000, v138
  v_add_f32 v136, v136, v150
  v_add_f32 v137, v137, v151
  v_cvt_pk_bf16_f32 v138, v136, v137
  v_lshlrev_b32 v136, 16, v138
  v_and_b32 v137, 0xffff0000, v138
  v_mul_f32 v150, v100, v28
  v_mul_f32 v151, v108, v28
  v_cvt_pk_bf16_f32 v138, v150, v151
  v_lshlrev_b32 v150, 16, v138
  v_and_b32 v151, 0xffff0000, v138
  v_add_f32 v136, v136, v150
  v_add_f32 v137, v137, v151
  v_cvt_pk_bf16_f32 v138, v136, v137
  v_lshlrev_b32 v136, 16, v138
  v_and_b32 v137, 0xffff0000, v138
  v_mul_f32 v150, v108, v20
  v_mul_f32 v151, v116, v20
  v_cvt_pk_bf16_f32 v138, v150, v151
  v_lshlrev_b32 v150, 16, v138
  v_and_b32 v151, 0xffff0000, v138
  v_add_f32 v136, v136, v150
  v_add_f32 v137, v137, v151
  v_cvt_pk_bf16_f32 v138, v136, v137
  v_lshlrev_b32 v136, 16, v138
  v_and_b32 v137, 0xffff0000, v138
  v_mul_f32 v136, v136, v124
  v_mul_f32 v137, v137, v132
  v_cvt_pk_bf16_f32 v139, v137, v136
  ds_write_b32 v13, v139 offset:21248
  v_mul_f32 v136, v85, v45
  v_mul_f32 v137, v93, v45
  v_cvt_pk_bf16_f32 v138, v136, v137
  v_lshlrev_b32 v136, 16, v138
  v_and_b32 v137, 0xffff0000, v138
  v_mul_f32 v150, v93, v37
  v_mul_f32 v151, v101, v37
  v_cvt_pk_bf16_f32 v138, v150, v151
  v_lshlrev_b32 v150, 16, v138
  v_and_b32 v151, 0xffff0000, v138
  v_add_f32 v136, v136, v150
  v_add_f32 v137, v137, v151
  v_cvt_pk_bf16_f32 v138, v136, v137
  v_lshlrev_b32 v136, 16, v138
  v_and_b32 v137, 0xffff0000, v138
  v_mul_f32 v150, v101, v29
  v_mul_f32 v151, v109, v29
  v_cvt_pk_bf16_f32 v138, v150, v151
  v_lshlrev_b32 v150, 16, v138
  v_and_b32 v151, 0xffff0000, v138
  v_add_f32 v136, v136, v150
  v_add_f32 v137, v137, v151
  v_cvt_pk_bf16_f32 v138, v136, v137
  v_lshlrev_b32 v136, 16, v138
  v_and_b32 v137, 0xffff0000, v138
  v_mul_f32 v150, v109, v21
  v_mul_f32 v151, v117, v21
  v_cvt_pk_bf16_f32 v138, v150, v151
  v_lshlrev_b32 v150, 16, v138
  v_and_b32 v151, 0xffff0000, v138
  v_add_f32 v136, v136, v150
  v_add_f32 v137, v137, v151
  v_cvt_pk_bf16_f32 v138, v136, v137
  v_lshlrev_b32 v136, 16, v138
  v_and_b32 v137, 0xffff0000, v138
  v_mul_f32 v136, v136, v125
  v_mul_f32 v137, v137, v133
  v_cvt_pk_bf16_f32 v140, v137, v136
  ds_write_b32 v13, v140 offset:26432
  v_mul_f32 v136, v86, v46
  v_mul_f32 v137, v94, v46
  v_cvt_pk_bf16_f32 v138, v136, v137
  v_lshlrev_b32 v136, 16, v138
  v_and_b32 v137, 0xffff0000, v138
  v_mul_f32 v150, v94, v38
  v_mul_f32 v151, v102, v38
  v_cvt_pk_bf16_f32 v138, v150, v151
  v_lshlrev_b32 v150, 16, v138
  v_and_b32 v151, 0xffff0000, v138
  v_add_f32 v136, v136, v150
  v_add_f32 v137, v137, v151
  v_cvt_pk_bf16_f32 v138, v136, v137
  v_lshlrev_b32 v136, 16, v138
  v_and_b32 v137, 0xffff0000, v138
  v_mul_f32 v150, v102, v30
  v_mul_f32 v151, v110, v30
  v_cvt_pk_bf16_f32 v138, v150, v151
  v_lshlrev_b32 v150, 16, v138
  v_and_b32 v151, 0xffff0000, v138
  v_add_f32 v136, v136, v150
  v_add_f32 v137, v137, v151
  v_cvt_pk_bf16_f32 v138, v136, v137
  v_lshlrev_b32 v136, 16, v138
  v_and_b32 v137, 0xffff0000, v138
  v_mul_f32 v150, v110, v22
  v_mul_f32 v151, v118, v22
  v_cvt_pk_bf16_f32 v138, v150, v151
  v_lshlrev_b32 v150, 16, v138
  v_and_b32 v151, 0xffff0000, v138
  v_add_f32 v136, v136, v150
  v_add_f32 v137, v137, v151
  v_cvt_pk_bf16_f32 v138, v136, v137
  v_lshlrev_b32 v136, 16, v138
  v_and_b32 v137, 0xffff0000, v138
  v_mul_f32 v136, v136, v126
  v_mul_f32 v137, v137, v134
  v_cvt_pk_bf16_f32 v141, v137, v136
  ds_write_b32 v13, v141 offset:31616
  v_mul_f32 v136, v87, v47
  v_mul_f32 v137, v95, v47
  v_cvt_pk_bf16_f32 v138, v136, v137
  v_lshlrev_b32 v136, 16, v138
  v_and_b32 v137, 0xffff0000, v138
  v_mul_f32 v150, v95, v39
  v_mul_f32 v151, v103, v39
  v_cvt_pk_bf16_f32 v138, v150, v151
  v_lshlrev_b32 v150, 16, v138
  v_and_b32 v151, 0xffff0000, v138
  v_add_f32 v136, v136, v150
  v_add_f32 v137, v137, v151
  v_cvt_pk_bf16_f32 v138, v136, v137
  v_lshlrev_b32 v136, 16, v138
  v_and_b32 v137, 0xffff0000, v138
  v_mul_f32 v150, v103, v31
  v_mul_f32 v151, v111, v31
  v_cvt_pk_bf16_f32 v138, v150, v151
  v_lshlrev_b32 v150, 16, v138
  v_and_b32 v151, 0xffff0000, v138
  v_add_f32 v136, v136, v150
  v_add_f32 v137, v137, v151
  v_cvt_pk_bf16_f32 v138, v136, v137
  v_lshlrev_b32 v136, 16, v138
  v_and_b32 v137, 0xffff0000, v138
  v_mul_f32 v150, v111, v23
  v_mul_f32 v151, v119, v23
  v_cvt_pk_bf16_f32 v138, v150, v151
  v_lshlrev_b32 v150, 16, v138
  v_and_b32 v151, 0xffff0000, v138
  v_add_f32 v136, v136, v150
  v_add_f32 v137, v137, v151
  v_cvt_pk_bf16_f32 v138, v136, v137
  v_lshlrev_b32 v136, 16, v138
  v_and_b32 v137, 0xffff0000, v138
  v_mul_f32 v136, v136, v127
  v_mul_f32 v137, v137, v135
  v_cvt_pk_bf16_f32 v142, v137, v136
  ds_write_b32 v13, v142 offset:36800
  v_add_u32 v12, 262144, v12
  v_add_u32 v144, 0, v12
  v_add_u32 v145, 1024, v12
  v_add_u32 v146, 2048, v12
  v_add_u32 v147, 3072, v12
  v_add_u32 v148, 4096, v12
  buffer_load_dwordx4 v[48:51], v144, s[8:11], 0 offen
  buffer_load_dwordx4 v[52:55], v145, s[8:11], 0 offen
  buffer_load_dwordx4 v[56:59], v146, s[8:11], 0 offen
  buffer_load_dwordx4 v[60:63], v147, s[8:11], 0 offen
  buffer_load_dwordx4 v[64:67], v148, s[8:11], 0 offen
  buffer_load_dwordx4 v[68:71], v147, s[12:15], 0 offen
  buffer_load_dwordx4 v[72:75], v148, s[12:15], 0 offen
  s_waitcnt vmcnt(0)
  v_lshlrev_b32 v80, 16, v48
  v_and_b32 v81, 0xffff0000, v48
  v_lshlrev_b32 v82, 16, v49
  v_and_b32 v83, 0xffff0000, v49
  v_lshlrev_b32 v84, 16, v50
  v_and_b32 v85, 0xffff0000, v50
  v_lshlrev_b32 v86, 16, v51
  v_and_b32 v87, 0xffff0000, v51
  v_lshlrev_b32 v88, 16, v52
  v_and_b32 v89, 0xffff0000, v52
  v_lshlrev_b32 v90, 16, v53
  v_and_b32 v91, 0xffff0000, v53
  v_lshlrev_b32 v92, 16, v54
  v_and_b32 v93, 0xffff0000, v54
  v_lshlrev_b32 v94, 16, v55
  v_and_b32 v95, 0xffff0000, v55
  v_lshlrev_b32 v96, 16, v56
  v_and_b32 v97, 0xffff0000, v56
  v_lshlrev_b32 v98, 16, v57
  v_and_b32 v99, 0xffff0000, v57
  v_lshlrev_b32 v100, 16, v58
  v_and_b32 v101, 0xffff0000, v58
  v_lshlrev_b32 v102, 16, v59
  v_and_b32 v103, 0xffff0000, v59
  v_lshlrev_b32 v104, 16, v60
  v_and_b32 v105, 0xffff0000, v60
  v_lshlrev_b32 v106, 16, v61
  v_and_b32 v107, 0xffff0000, v61
  v_lshlrev_b32 v108, 16, v62
  v_and_b32 v109, 0xffff0000, v62
  v_lshlrev_b32 v110, 16, v63
  v_and_b32 v111, 0xffff0000, v63
  v_lshlrev_b32 v112, 16, v64
  v_and_b32 v113, 0xffff0000, v64
  v_lshlrev_b32 v114, 16, v65
  v_and_b32 v115, 0xffff0000, v65
  v_lshlrev_b32 v116, 16, v66
  v_and_b32 v117, 0xffff0000, v66
  v_lshlrev_b32 v118, 16, v67
  v_and_b32 v119, 0xffff0000, v67
  v_lshlrev_b32 v120, 16, v68
  v_and_b32 v121, 0xffff0000, v68
  v_lshlrev_b32 v122, 16, v69
  v_and_b32 v123, 0xffff0000, v69
  v_lshlrev_b32 v124, 16, v70
  v_and_b32 v125, 0xffff0000, v70
  v_lshlrev_b32 v126, 16, v71
  v_and_b32 v127, 0xffff0000, v71
  v_lshlrev_b32 v128, 16, v72
  v_and_b32 v129, 0xffff0000, v72
  v_lshlrev_b32 v130, 16, v73
  v_and_b32 v131, 0xffff0000, v73
  v_lshlrev_b32 v132, 16, v74
  v_and_b32 v133, 0xffff0000, v74
  v_lshlrev_b32 v134, 16, v75
  v_and_b32 v135, 0xffff0000, v75
  v_mul_f32 v136, v80, v40
  v_mul_f32 v137, v88, v40
  v_cvt_pk_bf16_f32 v138, v136, v137
  v_lshlrev_b32 v136, 16, v138
  v_and_b32 v137, 0xffff0000, v138
  v_mul_f32 v150, v88, v32
  v_mul_f32 v151, v96, v32
  v_cvt_pk_bf16_f32 v138, v150, v151
  v_lshlrev_b32 v150, 16, v138
  v_and_b32 v151, 0xffff0000, v138
  v_add_f32 v136, v136, v150
  v_add_f32 v137, v137, v151
  v_cvt_pk_bf16_f32 v138, v136, v137
  v_lshlrev_b32 v136, 16, v138
  v_and_b32 v137, 0xffff0000, v138
  v_mul_f32 v150, v96, v24
  v_mul_f32 v151, v104, v24
  v_cvt_pk_bf16_f32 v138, v150, v151
  v_lshlrev_b32 v150, 16, v138
  v_and_b32 v151, 0xffff0000, v138
  v_add_f32 v136, v136, v150
  v_add_f32 v137, v137, v151
  v_cvt_pk_bf16_f32 v138, v136, v137
  v_lshlrev_b32 v136, 16, v138
  v_and_b32 v137, 0xffff0000, v138
  v_mul_f32 v150, v104, v16
  v_mul_f32 v151, v112, v16
  v_cvt_pk_bf16_f32 v138, v150, v151
  v_lshlrev_b32 v150, 16, v138
  v_and_b32 v151, 0xffff0000, v138
  v_add_f32 v136, v136, v150
  v_add_f32 v137, v137, v151
  v_cvt_pk_bf16_f32 v138, v136, v137
  v_lshlrev_b32 v136, 16, v138
  v_and_b32 v137, 0xffff0000, v138
  v_mul_f32 v136, v136, v120
  v_mul_f32 v137, v137, v128
  v_cvt_pk_bf16_f32 v139, v137, v136
  ds_write_b32 v13, v139 offset:1024
  v_mul_f32 v136, v81, v41
  v_mul_f32 v137, v89, v41
  v_cvt_pk_bf16_f32 v138, v136, v137
  v_lshlrev_b32 v136, 16, v138
  v_and_b32 v137, 0xffff0000, v138
  v_mul_f32 v150, v89, v33
  v_mul_f32 v151, v97, v33
  v_cvt_pk_bf16_f32 v138, v150, v151
  v_lshlrev_b32 v150, 16, v138
  v_and_b32 v151, 0xffff0000, v138
  v_add_f32 v136, v136, v150
  v_add_f32 v137, v137, v151
  v_cvt_pk_bf16_f32 v138, v136, v137
  v_lshlrev_b32 v136, 16, v138
  v_and_b32 v137, 0xffff0000, v138
  v_mul_f32 v150, v97, v25
  v_mul_f32 v151, v105, v25
  v_cvt_pk_bf16_f32 v138, v150, v151
  v_lshlrev_b32 v150, 16, v138
  v_and_b32 v151, 0xffff0000, v138
  v_add_f32 v136, v136, v150
  v_add_f32 v137, v137, v151
  v_cvt_pk_bf16_f32 v138, v136, v137
  v_lshlrev_b32 v136, 16, v138
  v_and_b32 v137, 0xffff0000, v138
  v_mul_f32 v150, v105, v17
  v_mul_f32 v151, v113, v17
  v_cvt_pk_bf16_f32 v138, v150, v151
  v_lshlrev_b32 v150, 16, v138
  v_and_b32 v151, 0xffff0000, v138
  v_add_f32 v136, v136, v150
  v_add_f32 v137, v137, v151
  v_cvt_pk_bf16_f32 v138, v136, v137
  v_lshlrev_b32 v136, 16, v138
  v_and_b32 v137, 0xffff0000, v138
  v_mul_f32 v136, v136, v121
  v_mul_f32 v137, v137, v129
  v_cvt_pk_bf16_f32 v140, v137, v136
  ds_write_b32 v13, v140 offset:6208
  v_mul_f32 v136, v82, v42
  v_mul_f32 v137, v90, v42
  v_cvt_pk_bf16_f32 v138, v136, v137
  v_lshlrev_b32 v136, 16, v138
  v_and_b32 v137, 0xffff0000, v138
  v_mul_f32 v150, v90, v34
  v_mul_f32 v151, v98, v34
  v_cvt_pk_bf16_f32 v138, v150, v151
  v_lshlrev_b32 v150, 16, v138
  v_and_b32 v151, 0xffff0000, v138
  v_add_f32 v136, v136, v150
  v_add_f32 v137, v137, v151
  v_cvt_pk_bf16_f32 v138, v136, v137
  v_lshlrev_b32 v136, 16, v138
  v_and_b32 v137, 0xffff0000, v138
  v_mul_f32 v150, v98, v26
  v_mul_f32 v151, v106, v26
  v_cvt_pk_bf16_f32 v138, v150, v151
  v_lshlrev_b32 v150, 16, v138
  v_and_b32 v151, 0xffff0000, v138
  v_add_f32 v136, v136, v150
  v_add_f32 v137, v137, v151
  v_cvt_pk_bf16_f32 v138, v136, v137
  v_lshlrev_b32 v136, 16, v138
  v_and_b32 v137, 0xffff0000, v138
  v_mul_f32 v150, v106, v18
  v_mul_f32 v151, v114, v18
  v_cvt_pk_bf16_f32 v138, v150, v151
  v_lshlrev_b32 v150, 16, v138
  v_and_b32 v151, 0xffff0000, v138
  v_add_f32 v136, v136, v150
  v_add_f32 v137, v137, v151
  v_cvt_pk_bf16_f32 v138, v136, v137
  v_lshlrev_b32 v136, 16, v138
  v_and_b32 v137, 0xffff0000, v138
  v_mul_f32 v136, v136, v122
  v_mul_f32 v137, v137, v130
  v_cvt_pk_bf16_f32 v141, v137, v136
  ds_write_b32 v13, v141 offset:11392
  v_mul_f32 v136, v83, v43
  v_mul_f32 v137, v91, v43
  v_cvt_pk_bf16_f32 v138, v136, v137
  v_lshlrev_b32 v136, 16, v138
  v_and_b32 v137, 0xffff0000, v138
  v_mul_f32 v150, v91, v35
  v_mul_f32 v151, v99, v35
  v_cvt_pk_bf16_f32 v138, v150, v151
  v_lshlrev_b32 v150, 16, v138
  v_and_b32 v151, 0xffff0000, v138
  v_add_f32 v136, v136, v150
  v_add_f32 v137, v137, v151
  v_cvt_pk_bf16_f32 v138, v136, v137
  v_lshlrev_b32 v136, 16, v138
  v_and_b32 v137, 0xffff0000, v138
  v_mul_f32 v150, v99, v27
  v_mul_f32 v151, v107, v27
  v_cvt_pk_bf16_f32 v138, v150, v151
  v_lshlrev_b32 v150, 16, v138
  v_and_b32 v151, 0xffff0000, v138
  v_add_f32 v136, v136, v150
  v_add_f32 v137, v137, v151
  v_cvt_pk_bf16_f32 v138, v136, v137
  v_lshlrev_b32 v136, 16, v138
  v_and_b32 v137, 0xffff0000, v138
  v_mul_f32 v150, v107, v19
  v_mul_f32 v151, v115, v19
  v_cvt_pk_bf16_f32 v138, v150, v151
  v_lshlrev_b32 v150, 16, v138
  v_and_b32 v151, 0xffff0000, v138
  v_add_f32 v136, v136, v150
  v_add_f32 v137, v137, v151
  v_cvt_pk_bf16_f32 v138, v136, v137
  v_lshlrev_b32 v136, 16, v138
  v_and_b32 v137, 0xffff0000, v138
  v_mul_f32 v136, v136, v123
  v_mul_f32 v137, v137, v131
  v_cvt_pk_bf16_f32 v142, v137, v136
  ds_write_b32 v13, v142 offset:16576
  v_mul_f32 v136, v84, v44
  v_mul_f32 v137, v92, v44
  v_cvt_pk_bf16_f32 v138, v136, v137
  v_lshlrev_b32 v136, 16, v138
  v_and_b32 v137, 0xffff0000, v138
  v_mul_f32 v150, v92, v36
  v_mul_f32 v151, v100, v36
  v_cvt_pk_bf16_f32 v138, v150, v151
  v_lshlrev_b32 v150, 16, v138
  v_and_b32 v151, 0xffff0000, v138
  v_add_f32 v136, v136, v150
  v_add_f32 v137, v137, v151
  v_cvt_pk_bf16_f32 v138, v136, v137
  v_lshlrev_b32 v136, 16, v138
  v_and_b32 v137, 0xffff0000, v138
  v_mul_f32 v150, v100, v28
  v_mul_f32 v151, v108, v28
  v_cvt_pk_bf16_f32 v138, v150, v151
  v_lshlrev_b32 v150, 16, v138
  v_and_b32 v151, 0xffff0000, v138
  v_add_f32 v136, v136, v150
  v_add_f32 v137, v137, v151
  v_cvt_pk_bf16_f32 v138, v136, v137
  v_lshlrev_b32 v136, 16, v138
  v_and_b32 v137, 0xffff0000, v138
  v_mul_f32 v150, v108, v20
  v_mul_f32 v151, v116, v20
  v_cvt_pk_bf16_f32 v138, v150, v151
  v_lshlrev_b32 v150, 16, v138
  v_and_b32 v151, 0xffff0000, v138
  v_add_f32 v136, v136, v150
  v_add_f32 v137, v137, v151
  v_cvt_pk_bf16_f32 v138, v136, v137
  v_lshlrev_b32 v136, 16, v138
  v_and_b32 v137, 0xffff0000, v138
  v_mul_f32 v136, v136, v124
  v_mul_f32 v137, v137, v132
  v_cvt_pk_bf16_f32 v139, v137, v136
  ds_write_b32 v13, v139 offset:21760
  v_mul_f32 v136, v85, v45
  v_mul_f32 v137, v93, v45
  v_cvt_pk_bf16_f32 v138, v136, v137
  v_lshlrev_b32 v136, 16, v138
  v_and_b32 v137, 0xffff0000, v138
  v_mul_f32 v150, v93, v37
  v_mul_f32 v151, v101, v37
  v_cvt_pk_bf16_f32 v138, v150, v151
  v_lshlrev_b32 v150, 16, v138
  v_and_b32 v151, 0xffff0000, v138
  v_add_f32 v136, v136, v150
  v_add_f32 v137, v137, v151
  v_cvt_pk_bf16_f32 v138, v136, v137
  v_lshlrev_b32 v136, 16, v138
  v_and_b32 v137, 0xffff0000, v138
  v_mul_f32 v150, v101, v29
  v_mul_f32 v151, v109, v29
  v_cvt_pk_bf16_f32 v138, v150, v151
  v_lshlrev_b32 v150, 16, v138
  v_and_b32 v151, 0xffff0000, v138
  v_add_f32 v136, v136, v150
  v_add_f32 v137, v137, v151
  v_cvt_pk_bf16_f32 v138, v136, v137
  v_lshlrev_b32 v136, 16, v138
  v_and_b32 v137, 0xffff0000, v138
  v_mul_f32 v150, v109, v21
  v_mul_f32 v151, v117, v21
  v_cvt_pk_bf16_f32 v138, v150, v151
  v_lshlrev_b32 v150, 16, v138
  v_and_b32 v151, 0xffff0000, v138
  v_add_f32 v136, v136, v150
  v_add_f32 v137, v137, v151
  v_cvt_pk_bf16_f32 v138, v136, v137
  v_lshlrev_b32 v136, 16, v138
  v_and_b32 v137, 0xffff0000, v138
  v_mul_f32 v136, v136, v125
  v_mul_f32 v137, v137, v133
  v_cvt_pk_bf16_f32 v140, v137, v136
  ds_write_b32 v13, v140 offset:26944
  v_mul_f32 v136, v86, v46
  v_mul_f32 v137, v94, v46
  v_cvt_pk_bf16_f32 v138, v136, v137
  v_lshlrev_b32 v136, 16, v138
  v_and_b32 v137, 0xffff0000, v138
  v_mul_f32 v150, v94, v38
  v_mul_f32 v151, v102, v38
  v_cvt_pk_bf16_f32 v138, v150, v151
  v_lshlrev_b32 v150, 16, v138
  v_and_b32 v151, 0xffff0000, v138
  v_add_f32 v136, v136, v150
  v_add_f32 v137, v137, v151
  v_cvt_pk_bf16_f32 v138, v136, v137
  v_lshlrev_b32 v136, 16, v138
  v_and_b32 v137, 0xffff0000, v138
  v_mul_f32 v150, v102, v30
  v_mul_f32 v151, v110, v30
  v_cvt_pk_bf16_f32 v138, v150, v151
  v_lshlrev_b32 v150, 16, v138
  v_and_b32 v151, 0xffff0000, v138
  v_add_f32 v136, v136, v150
  v_add_f32 v137, v137, v151
  v_cvt_pk_bf16_f32 v138, v136, v137
  v_lshlrev_b32 v136, 16, v138
  v_and_b32 v137, 0xffff0000, v138
  v_mul_f32 v150, v110, v22
  v_mul_f32 v151, v118, v22
  v_cvt_pk_bf16_f32 v138, v150, v151
  v_lshlrev_b32 v150, 16, v138
  v_and_b32 v151, 0xffff0000, v138
  v_add_f32 v136, v136, v150
  v_add_f32 v137, v137, v151
  v_cvt_pk_bf16_f32 v138, v136, v137
  v_lshlrev_b32 v136, 16, v138
  v_and_b32 v137, 0xffff0000, v138
  v_mul_f32 v136, v136, v126
  v_mul_f32 v137, v137, v134
  v_cvt_pk_bf16_f32 v141, v137, v136
  ds_write_b32 v13, v141 offset:32128
  v_mul_f32 v136, v87, v47
  v_mul_f32 v137, v95, v47
  v_cvt_pk_bf16_f32 v138, v136, v137
  v_lshlrev_b32 v136, 16, v138
  v_and_b32 v137, 0xffff0000, v138
  v_mul_f32 v150, v95, v39
  v_mul_f32 v151, v103, v39
  v_cvt_pk_bf16_f32 v138, v150, v151
  v_lshlrev_b32 v150, 16, v138
  v_and_b32 v151, 0xffff0000, v138
  v_add_f32 v136, v136, v150
  v_add_f32 v137, v137, v151
  v_cvt_pk_bf16_f32 v138, v136, v137
  v_lshlrev_b32 v136, 16, v138
  v_and_b32 v137, 0xffff0000, v138
  v_mul_f32 v150, v103, v31
  v_mul_f32 v151, v111, v31
  v_cvt_pk_bf16_f32 v138, v150, v151
  v_lshlrev_b32 v150, 16, v138
  v_and_b32 v151, 0xffff0000, v138
  v_add_f32 v136, v136, v150
  v_add_f32 v137, v137, v151
  v_cvt_pk_bf16_f32 v138, v136, v137
  v_lshlrev_b32 v136, 16, v138
  v_and_b32 v137, 0xffff0000, v138
  v_mul_f32 v150, v111, v23
  v_mul_f32 v151, v119, v23
  v_cvt_pk_bf16_f32 v138, v150, v151
  v_lshlrev_b32 v150, 16, v138
  v_and_b32 v151, 0xffff0000, v138
  v_add_f32 v136, v136, v150
  v_add_f32 v137, v137, v151
  v_cvt_pk_bf16_f32 v138, v136, v137
  v_lshlrev_b32 v136, 16, v138
  v_and_b32 v137, 0xffff0000, v138
  v_mul_f32 v136, v136, v127
  v_mul_f32 v137, v137, v135
  v_cvt_pk_bf16_f32 v142, v137, v136
  ds_write_b32 v13, v142 offset:37312
  v_add_u32 v12, 262144, v12
  v_add_u32 v144, 0, v12
  v_add_u32 v145, 1024, v12
  v_add_u32 v146, 2048, v12
  v_add_u32 v147, 3072, v12
  v_add_u32 v148, 4096, v12
  buffer_load_dwordx4 v[48:51], v144, s[8:11], 0 offen
  buffer_load_dwordx4 v[52:55], v145, s[8:11], 0 offen
  buffer_load_dwordx4 v[56:59], v146, s[8:11], 0 offen
  buffer_load_dwordx4 v[60:63], v147, s[8:11], 0 offen
  buffer_load_dwordx4 v[64:67], v148, s[8:11], 0 offen
  buffer_load_dwordx4 v[68:71], v147, s[12:15], 0 offen
  buffer_load_dwordx4 v[72:75], v148, s[12:15], 0 offen
  s_waitcnt vmcnt(0)
  v_lshlrev_b32 v80, 16, v48
  v_and_b32 v81, 0xffff0000, v48
  v_lshlrev_b32 v82, 16, v49
  v_and_b32 v83, 0xffff0000, v49
  v_lshlrev_b32 v84, 16, v50
  v_and_b32 v85, 0xffff0000, v50
  v_lshlrev_b32 v86, 16, v51
  v_and_b32 v87, 0xffff0000, v51
  v_lshlrev_b32 v88, 16, v52
  v_and_b32 v89, 0xffff0000, v52
  v_lshlrev_b32 v90, 16, v53
  v_and_b32 v91, 0xffff0000, v53
  v_lshlrev_b32 v92, 16, v54
  v_and_b32 v93, 0xffff0000, v54
  v_lshlrev_b32 v94, 16, v55
  v_and_b32 v95, 0xffff0000, v55
  v_lshlrev_b32 v96, 16, v56
  v_and_b32 v97, 0xffff0000, v56
  v_lshlrev_b32 v98, 16, v57
  v_and_b32 v99, 0xffff0000, v57
  v_lshlrev_b32 v100, 16, v58
  v_and_b32 v101, 0xffff0000, v58
  v_lshlrev_b32 v102, 16, v59
  v_and_b32 v103, 0xffff0000, v59
  v_lshlrev_b32 v104, 16, v60
  v_and_b32 v105, 0xffff0000, v60
  v_lshlrev_b32 v106, 16, v61
  v_and_b32 v107, 0xffff0000, v61
  v_lshlrev_b32 v108, 16, v62
  v_and_b32 v109, 0xffff0000, v62
  v_lshlrev_b32 v110, 16, v63
  v_and_b32 v111, 0xffff0000, v63
  v_lshlrev_b32 v112, 16, v64
  v_and_b32 v113, 0xffff0000, v64
  v_lshlrev_b32 v114, 16, v65
  v_and_b32 v115, 0xffff0000, v65
  v_lshlrev_b32 v116, 16, v66
  v_and_b32 v117, 0xffff0000, v66
  v_lshlrev_b32 v118, 16, v67
  v_and_b32 v119, 0xffff0000, v67
  v_lshlrev_b32 v120, 16, v68
  v_and_b32 v121, 0xffff0000, v68
  v_lshlrev_b32 v122, 16, v69
  v_and_b32 v123, 0xffff0000, v69
  v_lshlrev_b32 v124, 16, v70
  v_and_b32 v125, 0xffff0000, v70
  v_lshlrev_b32 v126, 16, v71
  v_and_b32 v127, 0xffff0000, v71
  v_lshlrev_b32 v128, 16, v72
  v_and_b32 v129, 0xffff0000, v72
  v_lshlrev_b32 v130, 16, v73
  v_and_b32 v131, 0xffff0000, v73
  v_lshlrev_b32 v132, 16, v74
  v_and_b32 v133, 0xffff0000, v74
  v_lshlrev_b32 v134, 16, v75
  v_and_b32 v135, 0xffff0000, v75
  v_mul_f32 v136, v80, v40
  v_mul_f32 v137, v88, v40
  v_cvt_pk_bf16_f32 v138, v136, v137
  v_lshlrev_b32 v136, 16, v138
  v_and_b32 v137, 0xffff0000, v138
  v_mul_f32 v150, v88, v32
  v_mul_f32 v151, v96, v32
  v_cvt_pk_bf16_f32 v138, v150, v151
  v_lshlrev_b32 v150, 16, v138
  v_and_b32 v151, 0xffff0000, v138
  v_add_f32 v136, v136, v150
  v_add_f32 v137, v137, v151
  v_cvt_pk_bf16_f32 v138, v136, v137
  v_lshlrev_b32 v136, 16, v138
  v_and_b32 v137, 0xffff0000, v138
  v_mul_f32 v150, v96, v24
  v_mul_f32 v151, v104, v24
  v_cvt_pk_bf16_f32 v138, v150, v151
  v_lshlrev_b32 v150, 16, v138
  v_and_b32 v151, 0xffff0000, v138
  v_add_f32 v136, v136, v150
  v_add_f32 v137, v137, v151
  v_cvt_pk_bf16_f32 v138, v136, v137
  v_lshlrev_b32 v136, 16, v138
  v_and_b32 v137, 0xffff0000, v138
  v_mul_f32 v150, v104, v16
  v_mul_f32 v151, v112, v16
  v_cvt_pk_bf16_f32 v138, v150, v151
  v_lshlrev_b32 v150, 16, v138
  v_and_b32 v151, 0xffff0000, v138
  v_add_f32 v136, v136, v150
  v_add_f32 v137, v137, v151
  v_cvt_pk_bf16_f32 v138, v136, v137
  v_lshlrev_b32 v136, 16, v138
  v_and_b32 v137, 0xffff0000, v138
  v_mul_f32 v136, v136, v120
  v_mul_f32 v137, v137, v128
  v_cvt_pk_bf16_f32 v139, v137, v136
  ds_write_b32 v13, v139 offset:1536
  v_mul_f32 v136, v81, v41
  v_mul_f32 v137, v89, v41
  v_cvt_pk_bf16_f32 v138, v136, v137
  v_lshlrev_b32 v136, 16, v138
  v_and_b32 v137, 0xffff0000, v138
  v_mul_f32 v150, v89, v33
  v_mul_f32 v151, v97, v33
  v_cvt_pk_bf16_f32 v138, v150, v151
  v_lshlrev_b32 v150, 16, v138
  v_and_b32 v151, 0xffff0000, v138
  v_add_f32 v136, v136, v150
  v_add_f32 v137, v137, v151
  v_cvt_pk_bf16_f32 v138, v136, v137
  v_lshlrev_b32 v136, 16, v138
  v_and_b32 v137, 0xffff0000, v138
  v_mul_f32 v150, v97, v25
  v_mul_f32 v151, v105, v25
  v_cvt_pk_bf16_f32 v138, v150, v151
  v_lshlrev_b32 v150, 16, v138
  v_and_b32 v151, 0xffff0000, v138
  v_add_f32 v136, v136, v150
  v_add_f32 v137, v137, v151
  v_cvt_pk_bf16_f32 v138, v136, v137
  v_lshlrev_b32 v136, 16, v138
  v_and_b32 v137, 0xffff0000, v138
  v_mul_f32 v150, v105, v17
  v_mul_f32 v151, v113, v17
  v_cvt_pk_bf16_f32 v138, v150, v151
  v_lshlrev_b32 v150, 16, v138
  v_and_b32 v151, 0xffff0000, v138
  v_add_f32 v136, v136, v150
  v_add_f32 v137, v137, v151
  v_cvt_pk_bf16_f32 v138, v136, v137
  v_lshlrev_b32 v136, 16, v138
  v_and_b32 v137, 0xffff0000, v138
  v_mul_f32 v136, v136, v121
  v_mul_f32 v137, v137, v129
  v_cvt_pk_bf16_f32 v140, v137, v136
  ds_write_b32 v13, v140 offset:6720
  v_mul_f32 v136, v82, v42
  v_mul_f32 v137, v90, v42
  v_cvt_pk_bf16_f32 v138, v136, v137
  v_lshlrev_b32 v136, 16, v138
  v_and_b32 v137, 0xffff0000, v138
  v_mul_f32 v150, v90, v34
  v_mul_f32 v151, v98, v34
  v_cvt_pk_bf16_f32 v138, v150, v151
  v_lshlrev_b32 v150, 16, v138
  v_and_b32 v151, 0xffff0000, v138
  v_add_f32 v136, v136, v150
  v_add_f32 v137, v137, v151
  v_cvt_pk_bf16_f32 v138, v136, v137
  v_lshlrev_b32 v136, 16, v138
  v_and_b32 v137, 0xffff0000, v138
  v_mul_f32 v150, v98, v26
  v_mul_f32 v151, v106, v26
  v_cvt_pk_bf16_f32 v138, v150, v151
  v_lshlrev_b32 v150, 16, v138
  v_and_b32 v151, 0xffff0000, v138
  v_add_f32 v136, v136, v150
  v_add_f32 v137, v137, v151
  v_cvt_pk_bf16_f32 v138, v136, v137
  v_lshlrev_b32 v136, 16, v138
  v_and_b32 v137, 0xffff0000, v138
  v_mul_f32 v150, v106, v18
  v_mul_f32 v151, v114, v18
  v_cvt_pk_bf16_f32 v138, v150, v151
  v_lshlrev_b32 v150, 16, v138
  v_and_b32 v151, 0xffff0000, v138
  v_add_f32 v136, v136, v150
  v_add_f32 v137, v137, v151
  v_cvt_pk_bf16_f32 v138, v136, v137
  v_lshlrev_b32 v136, 16, v138
  v_and_b32 v137, 0xffff0000, v138
  v_mul_f32 v136, v136, v122
  v_mul_f32 v137, v137, v130
  v_cvt_pk_bf16_f32 v141, v137, v136
  ds_write_b32 v13, v141 offset:11904
  v_mul_f32 v136, v83, v43
  v_mul_f32 v137, v91, v43
  v_cvt_pk_bf16_f32 v138, v136, v137
  v_lshlrev_b32 v136, 16, v138
  v_and_b32 v137, 0xffff0000, v138
  v_mul_f32 v150, v91, v35
  v_mul_f32 v151, v99, v35
  v_cvt_pk_bf16_f32 v138, v150, v151
  v_lshlrev_b32 v150, 16, v138
  v_and_b32 v151, 0xffff0000, v138
  v_add_f32 v136, v136, v150
  v_add_f32 v137, v137, v151
  v_cvt_pk_bf16_f32 v138, v136, v137
  v_lshlrev_b32 v136, 16, v138
  v_and_b32 v137, 0xffff0000, v138
  v_mul_f32 v150, v99, v27
  v_mul_f32 v151, v107, v27
  v_cvt_pk_bf16_f32 v138, v150, v151
  v_lshlrev_b32 v150, 16, v138
  v_and_b32 v151, 0xffff0000, v138
  v_add_f32 v136, v136, v150
  v_add_f32 v137, v137, v151
  v_cvt_pk_bf16_f32 v138, v136, v137
  v_lshlrev_b32 v136, 16, v138
  v_and_b32 v137, 0xffff0000, v138
  v_mul_f32 v150, v107, v19
  v_mul_f32 v151, v115, v19
  v_cvt_pk_bf16_f32 v138, v150, v151
  v_lshlrev_b32 v150, 16, v138
  v_and_b32 v151, 0xffff0000, v138
  v_add_f32 v136, v136, v150
  v_add_f32 v137, v137, v151
  v_cvt_pk_bf16_f32 v138, v136, v137
  v_lshlrev_b32 v136, 16, v138
  v_and_b32 v137, 0xffff0000, v138
  v_mul_f32 v136, v136, v123
  v_mul_f32 v137, v137, v131
  v_cvt_pk_bf16_f32 v142, v137, v136
  ds_write_b32 v13, v142 offset:17088
  v_mul_f32 v136, v84, v44
  v_mul_f32 v137, v92, v44
  v_cvt_pk_bf16_f32 v138, v136, v137
  v_lshlrev_b32 v136, 16, v138
  v_and_b32 v137, 0xffff0000, v138
  v_mul_f32 v150, v92, v36
  v_mul_f32 v151, v100, v36
  v_cvt_pk_bf16_f32 v138, v150, v151
  v_lshlrev_b32 v150, 16, v138
  v_and_b32 v151, 0xffff0000, v138
  v_add_f32 v136, v136, v150
  v_add_f32 v137, v137, v151
  v_cvt_pk_bf16_f32 v138, v136, v137
  v_lshlrev_b32 v136, 16, v138
  v_and_b32 v137, 0xffff0000, v138
  v_mul_f32 v150, v100, v28
  v_mul_f32 v151, v108, v28
  v_cvt_pk_bf16_f32 v138, v150, v151
  v_lshlrev_b32 v150, 16, v138
  v_and_b32 v151, 0xffff0000, v138
  v_add_f32 v136, v136, v150
  v_add_f32 v137, v137, v151
  v_cvt_pk_bf16_f32 v138, v136, v137
  v_lshlrev_b32 v136, 16, v138
  v_and_b32 v137, 0xffff0000, v138
  v_mul_f32 v150, v108, v20
  v_mul_f32 v151, v116, v20
  v_cvt_pk_bf16_f32 v138, v150, v151
  v_lshlrev_b32 v150, 16, v138
  v_and_b32 v151, 0xffff0000, v138
  v_add_f32 v136, v136, v150
  v_add_f32 v137, v137, v151
  v_cvt_pk_bf16_f32 v138, v136, v137
  v_lshlrev_b32 v136, 16, v138
  v_and_b32 v137, 0xffff0000, v138
  v_mul_f32 v136, v136, v124
  v_mul_f32 v137, v137, v132
  v_cvt_pk_bf16_f32 v139, v137, v136
  ds_write_b32 v13, v139 offset:22272
  v_mul_f32 v136, v85, v45
  v_mul_f32 v137, v93, v45
  v_cvt_pk_bf16_f32 v138, v136, v137
  v_lshlrev_b32 v136, 16, v138
  v_and_b32 v137, 0xffff0000, v138
  v_mul_f32 v150, v93, v37
  v_mul_f32 v151, v101, v37
  v_cvt_pk_bf16_f32 v138, v150, v151
  v_lshlrev_b32 v150, 16, v138
  v_and_b32 v151, 0xffff0000, v138
  v_add_f32 v136, v136, v150
  v_add_f32 v137, v137, v151
  v_cvt_pk_bf16_f32 v138, v136, v137
  v_lshlrev_b32 v136, 16, v138
  v_and_b32 v137, 0xffff0000, v138
  v_mul_f32 v150, v101, v29
  v_mul_f32 v151, v109, v29
  v_cvt_pk_bf16_f32 v138, v150, v151
  v_lshlrev_b32 v150, 16, v138
  v_and_b32 v151, 0xffff0000, v138
  v_add_f32 v136, v136, v150
  v_add_f32 v137, v137, v151
  v_cvt_pk_bf16_f32 v138, v136, v137
  v_lshlrev_b32 v136, 16, v138
  v_and_b32 v137, 0xffff0000, v138
  v_mul_f32 v150, v109, v21
  v_mul_f32 v151, v117, v21
  v_cvt_pk_bf16_f32 v138, v150, v151
  v_lshlrev_b32 v150, 16, v138
  v_and_b32 v151, 0xffff0000, v138
  v_add_f32 v136, v136, v150
  v_add_f32 v137, v137, v151
  v_cvt_pk_bf16_f32 v138, v136, v137
  v_lshlrev_b32 v136, 16, v138
  v_and_b32 v137, 0xffff0000, v138
  v_mul_f32 v136, v136, v125
  v_mul_f32 v137, v137, v133
  v_cvt_pk_bf16_f32 v140, v137, v136
  ds_write_b32 v13, v140 offset:27456
  v_mul_f32 v136, v86, v46
  v_mul_f32 v137, v94, v46
  v_cvt_pk_bf16_f32 v138, v136, v137
  v_lshlrev_b32 v136, 16, v138
  v_and_b32 v137, 0xffff0000, v138
  v_mul_f32 v150, v94, v38
  v_mul_f32 v151, v102, v38
  v_cvt_pk_bf16_f32 v138, v150, v151
  v_lshlrev_b32 v150, 16, v138
  v_and_b32 v151, 0xffff0000, v138
  v_add_f32 v136, v136, v150
  v_add_f32 v137, v137, v151
  v_cvt_pk_bf16_f32 v138, v136, v137
  v_lshlrev_b32 v136, 16, v138
  v_and_b32 v137, 0xffff0000, v138
  v_mul_f32 v150, v102, v30
  v_mul_f32 v151, v110, v30
  v_cvt_pk_bf16_f32 v138, v150, v151
  v_lshlrev_b32 v150, 16, v138
  v_and_b32 v151, 0xffff0000, v138
  v_add_f32 v136, v136, v150
  v_add_f32 v137, v137, v151
  v_cvt_pk_bf16_f32 v138, v136, v137
  v_lshlrev_b32 v136, 16, v138
  v_and_b32 v137, 0xffff0000, v138
  v_mul_f32 v150, v110, v22
  v_mul_f32 v151, v118, v22
  v_cvt_pk_bf16_f32 v138, v150, v151
  v_lshlrev_b32 v150, 16, v138
  v_and_b32 v151, 0xffff0000, v138
  v_add_f32 v136, v136, v150
  v_add_f32 v137, v137, v151
  v_cvt_pk_bf16_f32 v138, v136, v137
  v_lshlrev_b32 v136, 16, v138
  v_and_b32 v137, 0xffff0000, v138
  v_mul_f32 v136, v136, v126
  v_mul_f32 v137, v137, v134
  v_cvt_pk_bf16_f32 v141, v137, v136
  ds_write_b32 v13, v141 offset:32640
  v_mul_f32 v136, v87, v47
  v_mul_f32 v137, v95, v47
  v_cvt_pk_bf16_f32 v138, v136, v137
  v_lshlrev_b32 v136, 16, v138
  v_and_b32 v137, 0xffff0000, v138
  v_mul_f32 v150, v95, v39
  v_mul_f32 v151, v103, v39
  v_cvt_pk_bf16_f32 v138, v150, v151
  v_lshlrev_b32 v150, 16, v138
  v_and_b32 v151, 0xffff0000, v138
  v_add_f32 v136, v136, v150
  v_add_f32 v137, v137, v151
  v_cvt_pk_bf16_f32 v138, v136, v137
  v_lshlrev_b32 v136, 16, v138
  v_and_b32 v137, 0xffff0000, v138
  v_mul_f32 v150, v103, v31
  v_mul_f32 v151, v111, v31
  v_cvt_pk_bf16_f32 v138, v150, v151
  v_lshlrev_b32 v150, 16, v138
  v_and_b32 v151, 0xffff0000, v138
  v_add_f32 v136, v136, v150
  v_add_f32 v137, v137, v151
  v_cvt_pk_bf16_f32 v138, v136, v137
  v_lshlrev_b32 v136, 16, v138
  v_and_b32 v137, 0xffff0000, v138
  v_mul_f32 v150, v111, v23
  v_mul_f32 v151, v119, v23
  v_cvt_pk_bf16_f32 v138, v150, v151
  v_lshlrev_b32 v150, 16, v138
  v_and_b32 v151, 0xffff0000, v138
  v_add_f32 v136, v136, v150
  v_add_f32 v137, v137, v151
  v_cvt_pk_bf16_f32 v138, v136, v137
  v_lshlrev_b32 v136, 16, v138
  v_and_b32 v137, 0xffff0000, v138
  v_mul_f32 v136, v136, v127
  v_mul_f32 v137, v137, v135
  v_cvt_pk_bf16_f32 v142, v137, v136
  ds_write_b32 v13, v142 offset:37824
  v_add_u32 v12, 262144, v12
  v_add_u32 v144, 0, v12
  v_add_u32 v145, 1024, v12
  v_add_u32 v146, 2048, v12
  v_add_u32 v147, 3072, v12
  v_add_u32 v148, 4096, v12
  buffer_load_dwordx4 v[48:51], v144, s[8:11], 0 offen
  buffer_load_dwordx4 v[52:55], v145, s[8:11], 0 offen
  buffer_load_dwordx4 v[56:59], v146, s[8:11], 0 offen
  buffer_load_dwordx4 v[60:63], v147, s[8:11], 0 offen
  buffer_load_dwordx4 v[64:67], v148, s[8:11], 0 offen
  buffer_load_dwordx4 v[68:71], v147, s[12:15], 0 offen
  buffer_load_dwordx4 v[72:75], v148, s[12:15], 0 offen
  s_waitcnt vmcnt(0)
  v_lshlrev_b32 v80, 16, v48
  v_and_b32 v81, 0xffff0000, v48
  v_lshlrev_b32 v82, 16, v49
  v_and_b32 v83, 0xffff0000, v49
  v_lshlrev_b32 v84, 16, v50
  v_and_b32 v85, 0xffff0000, v50
  v_lshlrev_b32 v86, 16, v51
  v_and_b32 v87, 0xffff0000, v51
  v_lshlrev_b32 v88, 16, v52
  v_and_b32 v89, 0xffff0000, v52
  v_lshlrev_b32 v90, 16, v53
  v_and_b32 v91, 0xffff0000, v53
  v_lshlrev_b32 v92, 16, v54
  v_and_b32 v93, 0xffff0000, v54
  v_lshlrev_b32 v94, 16, v55
  v_and_b32 v95, 0xffff0000, v55
  v_lshlrev_b32 v96, 16, v56
  v_and_b32 v97, 0xffff0000, v56
  v_lshlrev_b32 v98, 16, v57
  v_and_b32 v99, 0xffff0000, v57
  v_lshlrev_b32 v100, 16, v58
  v_and_b32 v101, 0xffff0000, v58
  v_lshlrev_b32 v102, 16, v59
  v_and_b32 v103, 0xffff0000, v59
  v_lshlrev_b32 v104, 16, v60
  v_and_b32 v105, 0xffff0000, v60
  v_lshlrev_b32 v106, 16, v61
  v_and_b32 v107, 0xffff0000, v61
  v_lshlrev_b32 v108, 16, v62
  v_and_b32 v109, 0xffff0000, v62
  v_lshlrev_b32 v110, 16, v63
  v_and_b32 v111, 0xffff0000, v63
  v_lshlrev_b32 v112, 16, v64
  v_and_b32 v113, 0xffff0000, v64
  v_lshlrev_b32 v114, 16, v65
  v_and_b32 v115, 0xffff0000, v65
  v_lshlrev_b32 v116, 16, v66
  v_and_b32 v117, 0xffff0000, v66
  v_lshlrev_b32 v118, 16, v67
  v_and_b32 v119, 0xffff0000, v67
  v_lshlrev_b32 v120, 16, v68
  v_and_b32 v121, 0xffff0000, v68
  v_lshlrev_b32 v122, 16, v69
  v_and_b32 v123, 0xffff0000, v69
  v_lshlrev_b32 v124, 16, v70
  v_and_b32 v125, 0xffff0000, v70
  v_lshlrev_b32 v126, 16, v71
  v_and_b32 v127, 0xffff0000, v71
  v_lshlrev_b32 v128, 16, v72
  v_and_b32 v129, 0xffff0000, v72
  v_lshlrev_b32 v130, 16, v73
  v_and_b32 v131, 0xffff0000, v73
  v_lshlrev_b32 v132, 16, v74
  v_and_b32 v133, 0xffff0000, v74
  v_lshlrev_b32 v134, 16, v75
  v_and_b32 v135, 0xffff0000, v75
  v_mul_f32 v136, v80, v40
  v_mul_f32 v137, v88, v40
  v_cvt_pk_bf16_f32 v138, v136, v137
  v_lshlrev_b32 v136, 16, v138
  v_and_b32 v137, 0xffff0000, v138
  v_mul_f32 v150, v88, v32
  v_mul_f32 v151, v96, v32
  v_cvt_pk_bf16_f32 v138, v150, v151
  v_lshlrev_b32 v150, 16, v138
  v_and_b32 v151, 0xffff0000, v138
  v_add_f32 v136, v136, v150
  v_add_f32 v137, v137, v151
  v_cvt_pk_bf16_f32 v138, v136, v137
  v_lshlrev_b32 v136, 16, v138
  v_and_b32 v137, 0xffff0000, v138
  v_mul_f32 v150, v96, v24
  v_mul_f32 v151, v104, v24
  v_cvt_pk_bf16_f32 v138, v150, v151
  v_lshlrev_b32 v150, 16, v138
  v_and_b32 v151, 0xffff0000, v138
  v_add_f32 v136, v136, v150
  v_add_f32 v137, v137, v151
  v_cvt_pk_bf16_f32 v138, v136, v137
  v_lshlrev_b32 v136, 16, v138
  v_and_b32 v137, 0xffff0000, v138
  v_mul_f32 v150, v104, v16
  v_mul_f32 v151, v112, v16
  v_cvt_pk_bf16_f32 v138, v150, v151
  v_lshlrev_b32 v150, 16, v138
  v_and_b32 v151, 0xffff0000, v138
  v_add_f32 v136, v136, v150
  v_add_f32 v137, v137, v151
  v_cvt_pk_bf16_f32 v138, v136, v137
  v_lshlrev_b32 v136, 16, v138
  v_and_b32 v137, 0xffff0000, v138
  v_mul_f32 v136, v136, v120
  v_mul_f32 v137, v137, v128
  v_cvt_pk_bf16_f32 v139, v137, v136
  ds_write_b32 v13, v139 offset:2048
  v_mul_f32 v136, v81, v41
  v_mul_f32 v137, v89, v41
  v_cvt_pk_bf16_f32 v138, v136, v137
  v_lshlrev_b32 v136, 16, v138
  v_and_b32 v137, 0xffff0000, v138
  v_mul_f32 v150, v89, v33
  v_mul_f32 v151, v97, v33
  v_cvt_pk_bf16_f32 v138, v150, v151
  v_lshlrev_b32 v150, 16, v138
  v_and_b32 v151, 0xffff0000, v138
  v_add_f32 v136, v136, v150
  v_add_f32 v137, v137, v151
  v_cvt_pk_bf16_f32 v138, v136, v137
  v_lshlrev_b32 v136, 16, v138
  v_and_b32 v137, 0xffff0000, v138
  v_mul_f32 v150, v97, v25
  v_mul_f32 v151, v105, v25
  v_cvt_pk_bf16_f32 v138, v150, v151
  v_lshlrev_b32 v150, 16, v138
  v_and_b32 v151, 0xffff0000, v138
  v_add_f32 v136, v136, v150
  v_add_f32 v137, v137, v151
  v_cvt_pk_bf16_f32 v138, v136, v137
  v_lshlrev_b32 v136, 16, v138
  v_and_b32 v137, 0xffff0000, v138
  v_mul_f32 v150, v105, v17
  v_mul_f32 v151, v113, v17
  v_cvt_pk_bf16_f32 v138, v150, v151
  v_lshlrev_b32 v150, 16, v138
  v_and_b32 v151, 0xffff0000, v138
  v_add_f32 v136, v136, v150
  v_add_f32 v137, v137, v151
  v_cvt_pk_bf16_f32 v138, v136, v137
  v_lshlrev_b32 v136, 16, v138
  v_and_b32 v137, 0xffff0000, v138
  v_mul_f32 v136, v136, v121
  v_mul_f32 v137, v137, v129
  v_cvt_pk_bf16_f32 v140, v137, v136
  ds_write_b32 v13, v140 offset:7232
  v_mul_f32 v136, v82, v42
  v_mul_f32 v137, v90, v42
  v_cvt_pk_bf16_f32 v138, v136, v137
  v_lshlrev_b32 v136, 16, v138
  v_and_b32 v137, 0xffff0000, v138
  v_mul_f32 v150, v90, v34
  v_mul_f32 v151, v98, v34
  v_cvt_pk_bf16_f32 v138, v150, v151
  v_lshlrev_b32 v150, 16, v138
  v_and_b32 v151, 0xffff0000, v138
  v_add_f32 v136, v136, v150
  v_add_f32 v137, v137, v151
  v_cvt_pk_bf16_f32 v138, v136, v137
  v_lshlrev_b32 v136, 16, v138
  v_and_b32 v137, 0xffff0000, v138
  v_mul_f32 v150, v98, v26
  v_mul_f32 v151, v106, v26
  v_cvt_pk_bf16_f32 v138, v150, v151
  v_lshlrev_b32 v150, 16, v138
  v_and_b32 v151, 0xffff0000, v138
  v_add_f32 v136, v136, v150
  v_add_f32 v137, v137, v151
  v_cvt_pk_bf16_f32 v138, v136, v137
  v_lshlrev_b32 v136, 16, v138
  v_and_b32 v137, 0xffff0000, v138
  v_mul_f32 v150, v106, v18
  v_mul_f32 v151, v114, v18
  v_cvt_pk_bf16_f32 v138, v150, v151
  v_lshlrev_b32 v150, 16, v138
  v_and_b32 v151, 0xffff0000, v138
  v_add_f32 v136, v136, v150
  v_add_f32 v137, v137, v151
  v_cvt_pk_bf16_f32 v138, v136, v137
  v_lshlrev_b32 v136, 16, v138
  v_and_b32 v137, 0xffff0000, v138
  v_mul_f32 v136, v136, v122
  v_mul_f32 v137, v137, v130
  v_cvt_pk_bf16_f32 v141, v137, v136
  ds_write_b32 v13, v141 offset:12416
  v_mul_f32 v136, v83, v43
  v_mul_f32 v137, v91, v43
  v_cvt_pk_bf16_f32 v138, v136, v137
  v_lshlrev_b32 v136, 16, v138
  v_and_b32 v137, 0xffff0000, v138
  v_mul_f32 v150, v91, v35
  v_mul_f32 v151, v99, v35
  v_cvt_pk_bf16_f32 v138, v150, v151
  v_lshlrev_b32 v150, 16, v138
  v_and_b32 v151, 0xffff0000, v138
  v_add_f32 v136, v136, v150
  v_add_f32 v137, v137, v151
  v_cvt_pk_bf16_f32 v138, v136, v137
  v_lshlrev_b32 v136, 16, v138
  v_and_b32 v137, 0xffff0000, v138
  v_mul_f32 v150, v99, v27
  v_mul_f32 v151, v107, v27
  v_cvt_pk_bf16_f32 v138, v150, v151
  v_lshlrev_b32 v150, 16, v138
  v_and_b32 v151, 0xffff0000, v138
  v_add_f32 v136, v136, v150
  v_add_f32 v137, v137, v151
  v_cvt_pk_bf16_f32 v138, v136, v137
  v_lshlrev_b32 v136, 16, v138
  v_and_b32 v137, 0xffff0000, v138
  v_mul_f32 v150, v107, v19
  v_mul_f32 v151, v115, v19
  v_cvt_pk_bf16_f32 v138, v150, v151
  v_lshlrev_b32 v150, 16, v138
  v_and_b32 v151, 0xffff0000, v138
  v_add_f32 v136, v136, v150
  v_add_f32 v137, v137, v151
  v_cvt_pk_bf16_f32 v138, v136, v137
  v_lshlrev_b32 v136, 16, v138
  v_and_b32 v137, 0xffff0000, v138
  v_mul_f32 v136, v136, v123
  v_mul_f32 v137, v137, v131
  v_cvt_pk_bf16_f32 v142, v137, v136
  ds_write_b32 v13, v142 offset:17600
  v_mul_f32 v136, v84, v44
  v_mul_f32 v137, v92, v44
  v_cvt_pk_bf16_f32 v138, v136, v137
  v_lshlrev_b32 v136, 16, v138
  v_and_b32 v137, 0xffff0000, v138
  v_mul_f32 v150, v92, v36
  v_mul_f32 v151, v100, v36
  v_cvt_pk_bf16_f32 v138, v150, v151
  v_lshlrev_b32 v150, 16, v138
  v_and_b32 v151, 0xffff0000, v138
  v_add_f32 v136, v136, v150
  v_add_f32 v137, v137, v151
  v_cvt_pk_bf16_f32 v138, v136, v137
  v_lshlrev_b32 v136, 16, v138
  v_and_b32 v137, 0xffff0000, v138
  v_mul_f32 v150, v100, v28
  v_mul_f32 v151, v108, v28
  v_cvt_pk_bf16_f32 v138, v150, v151
  v_lshlrev_b32 v150, 16, v138
  v_and_b32 v151, 0xffff0000, v138
  v_add_f32 v136, v136, v150
  v_add_f32 v137, v137, v151
  v_cvt_pk_bf16_f32 v138, v136, v137
  v_lshlrev_b32 v136, 16, v138
  v_and_b32 v137, 0xffff0000, v138
  v_mul_f32 v150, v108, v20
  v_mul_f32 v151, v116, v20
  v_cvt_pk_bf16_f32 v138, v150, v151
  v_lshlrev_b32 v150, 16, v138
  v_and_b32 v151, 0xffff0000, v138
  v_add_f32 v136, v136, v150
  v_add_f32 v137, v137, v151
  v_cvt_pk_bf16_f32 v138, v136, v137
  v_lshlrev_b32 v136, 16, v138
  v_and_b32 v137, 0xffff0000, v138
  v_mul_f32 v136, v136, v124
  v_mul_f32 v137, v137, v132
  v_cvt_pk_bf16_f32 v139, v137, v136
  ds_write_b32 v13, v139 offset:22784
  v_mul_f32 v136, v85, v45
  v_mul_f32 v137, v93, v45
  v_cvt_pk_bf16_f32 v138, v136, v137
  v_lshlrev_b32 v136, 16, v138
  v_and_b32 v137, 0xffff0000, v138
  v_mul_f32 v150, v93, v37
  v_mul_f32 v151, v101, v37
  v_cvt_pk_bf16_f32 v138, v150, v151
  v_lshlrev_b32 v150, 16, v138
  v_and_b32 v151, 0xffff0000, v138
  v_add_f32 v136, v136, v150
  v_add_f32 v137, v137, v151
  v_cvt_pk_bf16_f32 v138, v136, v137
  v_lshlrev_b32 v136, 16, v138
  v_and_b32 v137, 0xffff0000, v138
  v_mul_f32 v150, v101, v29
  v_mul_f32 v151, v109, v29
  v_cvt_pk_bf16_f32 v138, v150, v151
  v_lshlrev_b32 v150, 16, v138
  v_and_b32 v151, 0xffff0000, v138
  v_add_f32 v136, v136, v150
  v_add_f32 v137, v137, v151
  v_cvt_pk_bf16_f32 v138, v136, v137
  v_lshlrev_b32 v136, 16, v138
  v_and_b32 v137, 0xffff0000, v138
  v_mul_f32 v150, v109, v21
  v_mul_f32 v151, v117, v21
  v_cvt_pk_bf16_f32 v138, v150, v151
  v_lshlrev_b32 v150, 16, v138
  v_and_b32 v151, 0xffff0000, v138
  v_add_f32 v136, v136, v150
  v_add_f32 v137, v137, v151
  v_cvt_pk_bf16_f32 v138, v136, v137
  v_lshlrev_b32 v136, 16, v138
  v_and_b32 v137, 0xffff0000, v138
  v_mul_f32 v136, v136, v125
  v_mul_f32 v137, v137, v133
  v_cvt_pk_bf16_f32 v140, v137, v136
  ds_write_b32 v13, v140 offset:27968
  v_mul_f32 v136, v86, v46
  v_mul_f32 v137, v94, v46
  v_cvt_pk_bf16_f32 v138, v136, v137
  v_lshlrev_b32 v136, 16, v138
  v_and_b32 v137, 0xffff0000, v138
  v_mul_f32 v150, v94, v38
  v_mul_f32 v151, v102, v38
  v_cvt_pk_bf16_f32 v138, v150, v151
  v_lshlrev_b32 v150, 16, v138
  v_and_b32 v151, 0xffff0000, v138
  v_add_f32 v136, v136, v150
  v_add_f32 v137, v137, v151
  v_cvt_pk_bf16_f32 v138, v136, v137
  v_lshlrev_b32 v136, 16, v138
  v_and_b32 v137, 0xffff0000, v138
  v_mul_f32 v150, v102, v30
  v_mul_f32 v151, v110, v30
  v_cvt_pk_bf16_f32 v138, v150, v151
  v_lshlrev_b32 v150, 16, v138
  v_and_b32 v151, 0xffff0000, v138
  v_add_f32 v136, v136, v150
  v_add_f32 v137, v137, v151
  v_cvt_pk_bf16_f32 v138, v136, v137
  v_lshlrev_b32 v136, 16, v138
  v_and_b32 v137, 0xffff0000, v138
  v_mul_f32 v150, v110, v22
  v_mul_f32 v151, v118, v22
  v_cvt_pk_bf16_f32 v138, v150, v151
  v_lshlrev_b32 v150, 16, v138
  v_and_b32 v151, 0xffff0000, v138
  v_add_f32 v136, v136, v150
  v_add_f32 v137, v137, v151
  v_cvt_pk_bf16_f32 v138, v136, v137
  v_lshlrev_b32 v136, 16, v138
  v_and_b32 v137, 0xffff0000, v138
  v_mul_f32 v136, v136, v126
  v_mul_f32 v137, v137, v134
  v_cvt_pk_bf16_f32 v141, v137, v136
  ds_write_b32 v13, v141 offset:33152
  v_mul_f32 v136, v87, v47
  v_mul_f32 v137, v95, v47
  v_cvt_pk_bf16_f32 v138, v136, v137
  v_lshlrev_b32 v136, 16, v138
  v_and_b32 v137, 0xffff0000, v138
  v_mul_f32 v150, v95, v39
  v_mul_f32 v151, v103, v39
  v_cvt_pk_bf16_f32 v138, v150, v151
  v_lshlrev_b32 v150, 16, v138
  v_and_b32 v151, 0xffff0000, v138
  v_add_f32 v136, v136, v150
  v_add_f32 v137, v137, v151
  v_cvt_pk_bf16_f32 v138, v136, v137
  v_lshlrev_b32 v136, 16, v138
  v_and_b32 v137, 0xffff0000, v138
  v_mul_f32 v150, v103, v31
  v_mul_f32 v151, v111, v31
  v_cvt_pk_bf16_f32 v138, v150, v151
  v_lshlrev_b32 v150, 16, v138
  v_and_b32 v151, 0xffff0000, v138
  v_add_f32 v136, v136, v150
  v_add_f32 v137, v137, v151
  v_cvt_pk_bf16_f32 v138, v136, v137
  v_lshlrev_b32 v136, 16, v138
  v_and_b32 v137, 0xffff0000, v138
  v_mul_f32 v150, v111, v23
  v_mul_f32 v151, v119, v23
  v_cvt_pk_bf16_f32 v138, v150, v151
  v_lshlrev_b32 v150, 16, v138
  v_and_b32 v151, 0xffff0000, v138
  v_add_f32 v136, v136, v150
  v_add_f32 v137, v137, v151
  v_cvt_pk_bf16_f32 v138, v136, v137
  v_lshlrev_b32 v136, 16, v138
  v_and_b32 v137, 0xffff0000, v138
  v_mul_f32 v136, v136, v127
  v_mul_f32 v137, v137, v135
  v_cvt_pk_bf16_f32 v142, v137, v136
  ds_write_b32 v13, v142 offset:38336
  v_add_u32 v12, 262144, v12
  v_add_u32 v144, 0, v12
  v_add_u32 v145, 1024, v12
  v_add_u32 v146, 2048, v12
  v_add_u32 v147, 3072, v12
  v_add_u32 v148, 4096, v12
  buffer_load_dwordx4 v[48:51], v144, s[8:11], 0 offen
  buffer_load_dwordx4 v[52:55], v145, s[8:11], 0 offen
  buffer_load_dwordx4 v[56:59], v146, s[8:11], 0 offen
  buffer_load_dwordx4 v[60:63], v147, s[8:11], 0 offen
  buffer_load_dwordx4 v[64:67], v148, s[8:11], 0 offen
  buffer_load_dwordx4 v[68:71], v147, s[12:15], 0 offen
  buffer_load_dwordx4 v[72:75], v148, s[12:15], 0 offen
  s_waitcnt vmcnt(0)
  v_lshlrev_b32 v80, 16, v48
  v_and_b32 v81, 0xffff0000, v48
  v_lshlrev_b32 v82, 16, v49
  v_and_b32 v83, 0xffff0000, v49
  v_lshlrev_b32 v84, 16, v50
  v_and_b32 v85, 0xffff0000, v50
  v_lshlrev_b32 v86, 16, v51
  v_and_b32 v87, 0xffff0000, v51
  v_lshlrev_b32 v88, 16, v52
  v_and_b32 v89, 0xffff0000, v52
  v_lshlrev_b32 v90, 16, v53
  v_and_b32 v91, 0xffff0000, v53
  v_lshlrev_b32 v92, 16, v54
  v_and_b32 v93, 0xffff0000, v54
  v_lshlrev_b32 v94, 16, v55
  v_and_b32 v95, 0xffff0000, v55
  v_lshlrev_b32 v96, 16, v56
  v_and_b32 v97, 0xffff0000, v56
  v_lshlrev_b32 v98, 16, v57
  v_and_b32 v99, 0xffff0000, v57
  v_lshlrev_b32 v100, 16, v58
  v_and_b32 v101, 0xffff0000, v58
  v_lshlrev_b32 v102, 16, v59
  v_and_b32 v103, 0xffff0000, v59
  v_lshlrev_b32 v104, 16, v60
  v_and_b32 v105, 0xffff0000, v60
  v_lshlrev_b32 v106, 16, v61
  v_and_b32 v107, 0xffff0000, v61
  v_lshlrev_b32 v108, 16, v62
  v_and_b32 v109, 0xffff0000, v62
  v_lshlrev_b32 v110, 16, v63
  v_and_b32 v111, 0xffff0000, v63
  v_lshlrev_b32 v112, 16, v64
  v_and_b32 v113, 0xffff0000, v64
  v_lshlrev_b32 v114, 16, v65
  v_and_b32 v115, 0xffff0000, v65
  v_lshlrev_b32 v116, 16, v66
  v_and_b32 v117, 0xffff0000, v66
  v_lshlrev_b32 v118, 16, v67
  v_and_b32 v119, 0xffff0000, v67
  v_lshlrev_b32 v120, 16, v68
  v_and_b32 v121, 0xffff0000, v68
  v_lshlrev_b32 v122, 16, v69
  v_and_b32 v123, 0xffff0000, v69
  v_lshlrev_b32 v124, 16, v70
  v_and_b32 v125, 0xffff0000, v70
  v_lshlrev_b32 v126, 16, v71
  v_and_b32 v127, 0xffff0000, v71
  v_lshlrev_b32 v128, 16, v72
  v_and_b32 v129, 0xffff0000, v72
  v_lshlrev_b32 v130, 16, v73
  v_and_b32 v131, 0xffff0000, v73
  v_lshlrev_b32 v132, 16, v74
  v_and_b32 v133, 0xffff0000, v74
  v_lshlrev_b32 v134, 16, v75
  v_and_b32 v135, 0xffff0000, v75
  v_mul_f32 v136, v80, v40
  v_mul_f32 v137, v88, v40
  v_cvt_pk_bf16_f32 v138, v136, v137
  v_lshlrev_b32 v136, 16, v138
  v_and_b32 v137, 0xffff0000, v138
  v_mul_f32 v150, v88, v32
  v_mul_f32 v151, v96, v32
  v_cvt_pk_bf16_f32 v138, v150, v151
  v_lshlrev_b32 v150, 16, v138
  v_and_b32 v151, 0xffff0000, v138
  v_add_f32 v136, v136, v150
  v_add_f32 v137, v137, v151
  v_cvt_pk_bf16_f32 v138, v136, v137
  v_lshlrev_b32 v136, 16, v138
  v_and_b32 v137, 0xffff0000, v138
  v_mul_f32 v150, v96, v24
  v_mul_f32 v151, v104, v24
  v_cvt_pk_bf16_f32 v138, v150, v151
  v_lshlrev_b32 v150, 16, v138
  v_and_b32 v151, 0xffff0000, v138
  v_add_f32 v136, v136, v150
  v_add_f32 v137, v137, v151
  v_cvt_pk_bf16_f32 v138, v136, v137
  v_lshlrev_b32 v136, 16, v138
  v_and_b32 v137, 0xffff0000, v138
  v_mul_f32 v150, v104, v16
  v_mul_f32 v151, v112, v16
  v_cvt_pk_bf16_f32 v138, v150, v151
  v_lshlrev_b32 v150, 16, v138
  v_and_b32 v151, 0xffff0000, v138
  v_add_f32 v136, v136, v150
  v_add_f32 v137, v137, v151
  v_cvt_pk_bf16_f32 v138, v136, v137
  v_lshlrev_b32 v136, 16, v138
  v_and_b32 v137, 0xffff0000, v138
  v_mul_f32 v136, v136, v120
  v_mul_f32 v137, v137, v128
  v_cvt_pk_bf16_f32 v139, v137, v136
  ds_write_b32 v13, v139 offset:2560
  v_mul_f32 v136, v81, v41
  v_mul_f32 v137, v89, v41
  v_cvt_pk_bf16_f32 v138, v136, v137
  v_lshlrev_b32 v136, 16, v138
  v_and_b32 v137, 0xffff0000, v138
  v_mul_f32 v150, v89, v33
  v_mul_f32 v151, v97, v33
  v_cvt_pk_bf16_f32 v138, v150, v151
  v_lshlrev_b32 v150, 16, v138
  v_and_b32 v151, 0xffff0000, v138
  v_add_f32 v136, v136, v150
  v_add_f32 v137, v137, v151
  v_cvt_pk_bf16_f32 v138, v136, v137
  v_lshlrev_b32 v136, 16, v138
  v_and_b32 v137, 0xffff0000, v138
  v_mul_f32 v150, v97, v25
  v_mul_f32 v151, v105, v25
  v_cvt_pk_bf16_f32 v138, v150, v151
  v_lshlrev_b32 v150, 16, v138
  v_and_b32 v151, 0xffff0000, v138
  v_add_f32 v136, v136, v150
  v_add_f32 v137, v137, v151
  v_cvt_pk_bf16_f32 v138, v136, v137
  v_lshlrev_b32 v136, 16, v138
  v_and_b32 v137, 0xffff0000, v138
  v_mul_f32 v150, v105, v17
  v_mul_f32 v151, v113, v17
  v_cvt_pk_bf16_f32 v138, v150, v151
  v_lshlrev_b32 v150, 16, v138
  v_and_b32 v151, 0xffff0000, v138
  v_add_f32 v136, v136, v150
  v_add_f32 v137, v137, v151
  v_cvt_pk_bf16_f32 v138, v136, v137
  v_lshlrev_b32 v136, 16, v138
  v_and_b32 v137, 0xffff0000, v138
  v_mul_f32 v136, v136, v121
  v_mul_f32 v137, v137, v129
  v_cvt_pk_bf16_f32 v140, v137, v136
  ds_write_b32 v13, v140 offset:7744
  v_mul_f32 v136, v82, v42
  v_mul_f32 v137, v90, v42
  v_cvt_pk_bf16_f32 v138, v136, v137
  v_lshlrev_b32 v136, 16, v138
  v_and_b32 v137, 0xffff0000, v138
  v_mul_f32 v150, v90, v34
  v_mul_f32 v151, v98, v34
  v_cvt_pk_bf16_f32 v138, v150, v151
  v_lshlrev_b32 v150, 16, v138
  v_and_b32 v151, 0xffff0000, v138
  v_add_f32 v136, v136, v150
  v_add_f32 v137, v137, v151
  v_cvt_pk_bf16_f32 v138, v136, v137
  v_lshlrev_b32 v136, 16, v138
  v_and_b32 v137, 0xffff0000, v138
  v_mul_f32 v150, v98, v26
  v_mul_f32 v151, v106, v26
  v_cvt_pk_bf16_f32 v138, v150, v151
  v_lshlrev_b32 v150, 16, v138
  v_and_b32 v151, 0xffff0000, v138
  v_add_f32 v136, v136, v150
  v_add_f32 v137, v137, v151
  v_cvt_pk_bf16_f32 v138, v136, v137
  v_lshlrev_b32 v136, 16, v138
  v_and_b32 v137, 0xffff0000, v138
  v_mul_f32 v150, v106, v18
  v_mul_f32 v151, v114, v18
  v_cvt_pk_bf16_f32 v138, v150, v151
  v_lshlrev_b32 v150, 16, v138
  v_and_b32 v151, 0xffff0000, v138
  v_add_f32 v136, v136, v150
  v_add_f32 v137, v137, v151
  v_cvt_pk_bf16_f32 v138, v136, v137
  v_lshlrev_b32 v136, 16, v138
  v_and_b32 v137, 0xffff0000, v138
  v_mul_f32 v136, v136, v122
  v_mul_f32 v137, v137, v130
  v_cvt_pk_bf16_f32 v141, v137, v136
  ds_write_b32 v13, v141 offset:12928
  v_mul_f32 v136, v83, v43
  v_mul_f32 v137, v91, v43
  v_cvt_pk_bf16_f32 v138, v136, v137
  v_lshlrev_b32 v136, 16, v138
  v_and_b32 v137, 0xffff0000, v138
  v_mul_f32 v150, v91, v35
  v_mul_f32 v151, v99, v35
  v_cvt_pk_bf16_f32 v138, v150, v151
  v_lshlrev_b32 v150, 16, v138
  v_and_b32 v151, 0xffff0000, v138
  v_add_f32 v136, v136, v150
  v_add_f32 v137, v137, v151
  v_cvt_pk_bf16_f32 v138, v136, v137
  v_lshlrev_b32 v136, 16, v138
  v_and_b32 v137, 0xffff0000, v138
  v_mul_f32 v150, v99, v27
  v_mul_f32 v151, v107, v27
  v_cvt_pk_bf16_f32 v138, v150, v151
  v_lshlrev_b32 v150, 16, v138
  v_and_b32 v151, 0xffff0000, v138
  v_add_f32 v136, v136, v150
  v_add_f32 v137, v137, v151
  v_cvt_pk_bf16_f32 v138, v136, v137
  v_lshlrev_b32 v136, 16, v138
  v_and_b32 v137, 0xffff0000, v138
  v_mul_f32 v150, v107, v19
  v_mul_f32 v151, v115, v19
  v_cvt_pk_bf16_f32 v138, v150, v151
  v_lshlrev_b32 v150, 16, v138
  v_and_b32 v151, 0xffff0000, v138
  v_add_f32 v136, v136, v150
  v_add_f32 v137, v137, v151
  v_cvt_pk_bf16_f32 v138, v136, v137
  v_lshlrev_b32 v136, 16, v138
  v_and_b32 v137, 0xffff0000, v138
  v_mul_f32 v136, v136, v123
  v_mul_f32 v137, v137, v131
  v_cvt_pk_bf16_f32 v142, v137, v136
  ds_write_b32 v13, v142 offset:18112
  v_mul_f32 v136, v84, v44
  v_mul_f32 v137, v92, v44
  v_cvt_pk_bf16_f32 v138, v136, v137
  v_lshlrev_b32 v136, 16, v138
  v_and_b32 v137, 0xffff0000, v138
  v_mul_f32 v150, v92, v36
  v_mul_f32 v151, v100, v36
  v_cvt_pk_bf16_f32 v138, v150, v151
  v_lshlrev_b32 v150, 16, v138
  v_and_b32 v151, 0xffff0000, v138
  v_add_f32 v136, v136, v150
  v_add_f32 v137, v137, v151
  v_cvt_pk_bf16_f32 v138, v136, v137
  v_lshlrev_b32 v136, 16, v138
  v_and_b32 v137, 0xffff0000, v138
  v_mul_f32 v150, v100, v28
  v_mul_f32 v151, v108, v28
  v_cvt_pk_bf16_f32 v138, v150, v151
  v_lshlrev_b32 v150, 16, v138
  v_and_b32 v151, 0xffff0000, v138
  v_add_f32 v136, v136, v150
  v_add_f32 v137, v137, v151
  v_cvt_pk_bf16_f32 v138, v136, v137
  v_lshlrev_b32 v136, 16, v138
  v_and_b32 v137, 0xffff0000, v138
  v_mul_f32 v150, v108, v20
  v_mul_f32 v151, v116, v20
  v_cvt_pk_bf16_f32 v138, v150, v151
  v_lshlrev_b32 v150, 16, v138
  v_and_b32 v151, 0xffff0000, v138
  v_add_f32 v136, v136, v150
  v_add_f32 v137, v137, v151
  v_cvt_pk_bf16_f32 v138, v136, v137
  v_lshlrev_b32 v136, 16, v138
  v_and_b32 v137, 0xffff0000, v138
  v_mul_f32 v136, v136, v124
  v_mul_f32 v137, v137, v132
  v_cvt_pk_bf16_f32 v139, v137, v136
  ds_write_b32 v13, v139 offset:23296
  v_mul_f32 v136, v85, v45
  v_mul_f32 v137, v93, v45
  v_cvt_pk_bf16_f32 v138, v136, v137
  v_lshlrev_b32 v136, 16, v138
  v_and_b32 v137, 0xffff0000, v138
  v_mul_f32 v150, v93, v37
  v_mul_f32 v151, v101, v37
  v_cvt_pk_bf16_f32 v138, v150, v151
  v_lshlrev_b32 v150, 16, v138
  v_and_b32 v151, 0xffff0000, v138
  v_add_f32 v136, v136, v150
  v_add_f32 v137, v137, v151
  v_cvt_pk_bf16_f32 v138, v136, v137
  v_lshlrev_b32 v136, 16, v138
  v_and_b32 v137, 0xffff0000, v138
  v_mul_f32 v150, v101, v29
  v_mul_f32 v151, v109, v29
  v_cvt_pk_bf16_f32 v138, v150, v151
  v_lshlrev_b32 v150, 16, v138
  v_and_b32 v151, 0xffff0000, v138
  v_add_f32 v136, v136, v150
  v_add_f32 v137, v137, v151
  v_cvt_pk_bf16_f32 v138, v136, v137
  v_lshlrev_b32 v136, 16, v138
  v_and_b32 v137, 0xffff0000, v138
  v_mul_f32 v150, v109, v21
  v_mul_f32 v151, v117, v21
  v_cvt_pk_bf16_f32 v138, v150, v151
  v_lshlrev_b32 v150, 16, v138
  v_and_b32 v151, 0xffff0000, v138
  v_add_f32 v136, v136, v150
  v_add_f32 v137, v137, v151
  v_cvt_pk_bf16_f32 v138, v136, v137
  v_lshlrev_b32 v136, 16, v138
  v_and_b32 v137, 0xffff0000, v138
  v_mul_f32 v136, v136, v125
  v_mul_f32 v137, v137, v133
  v_cvt_pk_bf16_f32 v140, v137, v136
  ds_write_b32 v13, v140 offset:28480
  v_mul_f32 v136, v86, v46
  v_mul_f32 v137, v94, v46
  v_cvt_pk_bf16_f32 v138, v136, v137
  v_lshlrev_b32 v136, 16, v138
  v_and_b32 v137, 0xffff0000, v138
  v_mul_f32 v150, v94, v38
  v_mul_f32 v151, v102, v38
  v_cvt_pk_bf16_f32 v138, v150, v151
  v_lshlrev_b32 v150, 16, v138
  v_and_b32 v151, 0xffff0000, v138
  v_add_f32 v136, v136, v150
  v_add_f32 v137, v137, v151
  v_cvt_pk_bf16_f32 v138, v136, v137
  v_lshlrev_b32 v136, 16, v138
  v_and_b32 v137, 0xffff0000, v138
  v_mul_f32 v150, v102, v30
  v_mul_f32 v151, v110, v30
  v_cvt_pk_bf16_f32 v138, v150, v151
  v_lshlrev_b32 v150, 16, v138
  v_and_b32 v151, 0xffff0000, v138
  v_add_f32 v136, v136, v150
  v_add_f32 v137, v137, v151
  v_cvt_pk_bf16_f32 v138, v136, v137
  v_lshlrev_b32 v136, 16, v138
  v_and_b32 v137, 0xffff0000, v138
  v_mul_f32 v150, v110, v22
  v_mul_f32 v151, v118, v22
  v_cvt_pk_bf16_f32 v138, v150, v151
  v_lshlrev_b32 v150, 16, v138
  v_and_b32 v151, 0xffff0000, v138
  v_add_f32 v136, v136, v150
  v_add_f32 v137, v137, v151
  v_cvt_pk_bf16_f32 v138, v136, v137
  v_lshlrev_b32 v136, 16, v138
  v_and_b32 v137, 0xffff0000, v138
  v_mul_f32 v136, v136, v126
  v_mul_f32 v137, v137, v134
  v_cvt_pk_bf16_f32 v141, v137, v136
  ds_write_b32 v13, v141 offset:33664
  v_mul_f32 v136, v87, v47
  v_mul_f32 v137, v95, v47
  v_cvt_pk_bf16_f32 v138, v136, v137
  v_lshlrev_b32 v136, 16, v138
  v_and_b32 v137, 0xffff0000, v138
  v_mul_f32 v150, v95, v39
  v_mul_f32 v151, v103, v39
  v_cvt_pk_bf16_f32 v138, v150, v151
  v_lshlrev_b32 v150, 16, v138
  v_and_b32 v151, 0xffff0000, v138
  v_add_f32 v136, v136, v150
  v_add_f32 v137, v137, v151
  v_cvt_pk_bf16_f32 v138, v136, v137
  v_lshlrev_b32 v136, 16, v138
  v_and_b32 v137, 0xffff0000, v138
  v_mul_f32 v150, v103, v31
  v_mul_f32 v151, v111, v31
  v_cvt_pk_bf16_f32 v138, v150, v151
  v_lshlrev_b32 v150, 16, v138
  v_and_b32 v151, 0xffff0000, v138
  v_add_f32 v136, v136, v150
  v_add_f32 v137, v137, v151
  v_cvt_pk_bf16_f32 v138, v136, v137
  v_lshlrev_b32 v136, 16, v138
  v_and_b32 v137, 0xffff0000, v138
  v_mul_f32 v150, v111, v23
  v_mul_f32 v151, v119, v23
  v_cvt_pk_bf16_f32 v138, v150, v151
  v_lshlrev_b32 v150, 16, v138
  v_and_b32 v151, 0xffff0000, v138
  v_add_f32 v136, v136, v150
  v_add_f32 v137, v137, v151
  v_cvt_pk_bf16_f32 v138, v136, v137
  v_lshlrev_b32 v136, 16, v138
  v_and_b32 v137, 0xffff0000, v138
  v_mul_f32 v136, v136, v127
  v_mul_f32 v137, v137, v135
  v_cvt_pk_bf16_f32 v142, v137, v136
  ds_write_b32 v13, v142 offset:38848
  v_add_u32 v12, 262144, v12
  v_add_u32 v144, 0, v12
  v_add_u32 v145, 1024, v12
  v_add_u32 v146, 2048, v12
  v_add_u32 v147, 3072, v12
  v_add_u32 v148, 4096, v12
  buffer_load_dwordx4 v[48:51], v144, s[8:11], 0 offen
  buffer_load_dwordx4 v[52:55], v145, s[8:11], 0 offen
  buffer_load_dwordx4 v[56:59], v146, s[8:11], 0 offen
  buffer_load_dwordx4 v[60:63], v147, s[8:11], 0 offen
  buffer_load_dwordx4 v[64:67], v148, s[8:11], 0 offen
  buffer_load_dwordx4 v[68:71], v147, s[12:15], 0 offen
  buffer_load_dwordx4 v[72:75], v148, s[12:15], 0 offen
  s_waitcnt vmcnt(0)
  v_lshlrev_b32 v80, 16, v48
  v_and_b32 v81, 0xffff0000, v48
  v_lshlrev_b32 v82, 16, v49
  v_and_b32 v83, 0xffff0000, v49
  v_lshlrev_b32 v84, 16, v50
  v_and_b32 v85, 0xffff0000, v50
  v_lshlrev_b32 v86, 16, v51
  v_and_b32 v87, 0xffff0000, v51
  v_lshlrev_b32 v88, 16, v52
  v_and_b32 v89, 0xffff0000, v52
  v_lshlrev_b32 v90, 16, v53
  v_and_b32 v91, 0xffff0000, v53
  v_lshlrev_b32 v92, 16, v54
  v_and_b32 v93, 0xffff0000, v54
  v_lshlrev_b32 v94, 16, v55
  v_and_b32 v95, 0xffff0000, v55
  v_lshlrev_b32 v96, 16, v56
  v_and_b32 v97, 0xffff0000, v56
  v_lshlrev_b32 v98, 16, v57
  v_and_b32 v99, 0xffff0000, v57
  v_lshlrev_b32 v100, 16, v58
  v_and_b32 v101, 0xffff0000, v58
  v_lshlrev_b32 v102, 16, v59
  v_and_b32 v103, 0xffff0000, v59
  v_lshlrev_b32 v104, 16, v60
  v_and_b32 v105, 0xffff0000, v60
  v_lshlrev_b32 v106, 16, v61
  v_and_b32 v107, 0xffff0000, v61
  v_lshlrev_b32 v108, 16, v62
  v_and_b32 v109, 0xffff0000, v62
  v_lshlrev_b32 v110, 16, v63
  v_and_b32 v111, 0xffff0000, v63
  v_lshlrev_b32 v112, 16, v64
  v_and_b32 v113, 0xffff0000, v64
  v_lshlrev_b32 v114, 16, v65
  v_and_b32 v115, 0xffff0000, v65
  v_lshlrev_b32 v116, 16, v66
  v_and_b32 v117, 0xffff0000, v66
  v_lshlrev_b32 v118, 16, v67
  v_and_b32 v119, 0xffff0000, v67
  v_lshlrev_b32 v120, 16, v68
  v_and_b32 v121, 0xffff0000, v68
  v_lshlrev_b32 v122, 16, v69
  v_and_b32 v123, 0xffff0000, v69
  v_lshlrev_b32 v124, 16, v70
  v_and_b32 v125, 0xffff0000, v70
  v_lshlrev_b32 v126, 16, v71
  v_and_b32 v127, 0xffff0000, v71
  v_lshlrev_b32 v128, 16, v72
  v_and_b32 v129, 0xffff0000, v72
  v_lshlrev_b32 v130, 16, v73
  v_and_b32 v131, 0xffff0000, v73
  v_lshlrev_b32 v132, 16, v74
  v_and_b32 v133, 0xffff0000, v74
  v_lshlrev_b32 v134, 16, v75
  v_and_b32 v135, 0xffff0000, v75
  v_mul_f32 v136, v80, v40
  v_mul_f32 v137, v88, v40
  v_cvt_pk_bf16_f32 v138, v136, v137
  v_lshlrev_b32 v136, 16, v138
  v_and_b32 v137, 0xffff0000, v138
  v_mul_f32 v150, v88, v32
  v_mul_f32 v151, v96, v32
  v_cvt_pk_bf16_f32 v138, v150, v151
  v_lshlrev_b32 v150, 16, v138
  v_and_b32 v151, 0xffff0000, v138
  v_add_f32 v136, v136, v150
  v_add_f32 v137, v137, v151
  v_cvt_pk_bf16_f32 v138, v136, v137
  v_lshlrev_b32 v136, 16, v138
  v_and_b32 v137, 0xffff0000, v138
  v_mul_f32 v150, v96, v24
  v_mul_f32 v151, v104, v24
  v_cvt_pk_bf16_f32 v138, v150, v151
  v_lshlrev_b32 v150, 16, v138
  v_and_b32 v151, 0xffff0000, v138
  v_add_f32 v136, v136, v150
  v_add_f32 v137, v137, v151
  v_cvt_pk_bf16_f32 v138, v136, v137
  v_lshlrev_b32 v136, 16, v138
  v_and_b32 v137, 0xffff0000, v138
  v_mul_f32 v150, v104, v16
  v_mul_f32 v151, v112, v16
  v_cvt_pk_bf16_f32 v138, v150, v151
  v_lshlrev_b32 v150, 16, v138
  v_and_b32 v151, 0xffff0000, v138
  v_add_f32 v136, v136, v150
  v_add_f32 v137, v137, v151
  v_cvt_pk_bf16_f32 v138, v136, v137
  v_lshlrev_b32 v136, 16, v138
  v_and_b32 v137, 0xffff0000, v138
  v_mul_f32 v136, v136, v120
  v_mul_f32 v137, v137, v128
  v_cvt_pk_bf16_f32 v139, v137, v136
  ds_write_b32 v13, v139 offset:3072
  v_mul_f32 v136, v81, v41
  v_mul_f32 v137, v89, v41
  v_cvt_pk_bf16_f32 v138, v136, v137
  v_lshlrev_b32 v136, 16, v138
  v_and_b32 v137, 0xffff0000, v138
  v_mul_f32 v150, v89, v33
  v_mul_f32 v151, v97, v33
  v_cvt_pk_bf16_f32 v138, v150, v151
  v_lshlrev_b32 v150, 16, v138
  v_and_b32 v151, 0xffff0000, v138
  v_add_f32 v136, v136, v150
  v_add_f32 v137, v137, v151
  v_cvt_pk_bf16_f32 v138, v136, v137
  v_lshlrev_b32 v136, 16, v138
  v_and_b32 v137, 0xffff0000, v138
  v_mul_f32 v150, v97, v25
  v_mul_f32 v151, v105, v25
  v_cvt_pk_bf16_f32 v138, v150, v151
  v_lshlrev_b32 v150, 16, v138
  v_and_b32 v151, 0xffff0000, v138
  v_add_f32 v136, v136, v150
  v_add_f32 v137, v137, v151
  v_cvt_pk_bf16_f32 v138, v136, v137
  v_lshlrev_b32 v136, 16, v138
  v_and_b32 v137, 0xffff0000, v138
  v_mul_f32 v150, v105, v17
  v_mul_f32 v151, v113, v17
  v_cvt_pk_bf16_f32 v138, v150, v151
  v_lshlrev_b32 v150, 16, v138
  v_and_b32 v151, 0xffff0000, v138
  v_add_f32 v136, v136, v150
  v_add_f32 v137, v137, v151
  v_cvt_pk_bf16_f32 v138, v136, v137
  v_lshlrev_b32 v136, 16, v138
  v_and_b32 v137, 0xffff0000, v138
  v_mul_f32 v136, v136, v121
  v_mul_f32 v137, v137, v129
  v_cvt_pk_bf16_f32 v140, v137, v136
  ds_write_b32 v13, v140 offset:8256
  v_mul_f32 v136, v82, v42
  v_mul_f32 v137, v90, v42
  v_cvt_pk_bf16_f32 v138, v136, v137
  v_lshlrev_b32 v136, 16, v138
  v_and_b32 v137, 0xffff0000, v138
  v_mul_f32 v150, v90, v34
  v_mul_f32 v151, v98, v34
  v_cvt_pk_bf16_f32 v138, v150, v151
  v_lshlrev_b32 v150, 16, v138
  v_and_b32 v151, 0xffff0000, v138
  v_add_f32 v136, v136, v150
  v_add_f32 v137, v137, v151
  v_cvt_pk_bf16_f32 v138, v136, v137
  v_lshlrev_b32 v136, 16, v138
  v_and_b32 v137, 0xffff0000, v138
  v_mul_f32 v150, v98, v26
  v_mul_f32 v151, v106, v26
  v_cvt_pk_bf16_f32 v138, v150, v151
  v_lshlrev_b32 v150, 16, v138
  v_and_b32 v151, 0xffff0000, v138
  v_add_f32 v136, v136, v150
  v_add_f32 v137, v137, v151
  v_cvt_pk_bf16_f32 v138, v136, v137
  v_lshlrev_b32 v136, 16, v138
  v_and_b32 v137, 0xffff0000, v138
  v_mul_f32 v150, v106, v18
  v_mul_f32 v151, v114, v18
  v_cvt_pk_bf16_f32 v138, v150, v151
  v_lshlrev_b32 v150, 16, v138
  v_and_b32 v151, 0xffff0000, v138
  v_add_f32 v136, v136, v150
  v_add_f32 v137, v137, v151
  v_cvt_pk_bf16_f32 v138, v136, v137
  v_lshlrev_b32 v136, 16, v138
  v_and_b32 v137, 0xffff0000, v138
  v_mul_f32 v136, v136, v122
  v_mul_f32 v137, v137, v130
  v_cvt_pk_bf16_f32 v141, v137, v136
  ds_write_b32 v13, v141 offset:13440
  v_mul_f32 v136, v83, v43
  v_mul_f32 v137, v91, v43
  v_cvt_pk_bf16_f32 v138, v136, v137
  v_lshlrev_b32 v136, 16, v138
  v_and_b32 v137, 0xffff0000, v138
  v_mul_f32 v150, v91, v35
  v_mul_f32 v151, v99, v35
  v_cvt_pk_bf16_f32 v138, v150, v151
  v_lshlrev_b32 v150, 16, v138
  v_and_b32 v151, 0xffff0000, v138
  v_add_f32 v136, v136, v150
  v_add_f32 v137, v137, v151
  v_cvt_pk_bf16_f32 v138, v136, v137
  v_lshlrev_b32 v136, 16, v138
  v_and_b32 v137, 0xffff0000, v138
  v_mul_f32 v150, v99, v27
  v_mul_f32 v151, v107, v27
  v_cvt_pk_bf16_f32 v138, v150, v151
  v_lshlrev_b32 v150, 16, v138
  v_and_b32 v151, 0xffff0000, v138
  v_add_f32 v136, v136, v150
  v_add_f32 v137, v137, v151
  v_cvt_pk_bf16_f32 v138, v136, v137
  v_lshlrev_b32 v136, 16, v138
  v_and_b32 v137, 0xffff0000, v138
  v_mul_f32 v150, v107, v19
  v_mul_f32 v151, v115, v19
  v_cvt_pk_bf16_f32 v138, v150, v151
  v_lshlrev_b32 v150, 16, v138
  v_and_b32 v151, 0xffff0000, v138
  v_add_f32 v136, v136, v150
  v_add_f32 v137, v137, v151
  v_cvt_pk_bf16_f32 v138, v136, v137
  v_lshlrev_b32 v136, 16, v138
  v_and_b32 v137, 0xffff0000, v138
  v_mul_f32 v136, v136, v123
  v_mul_f32 v137, v137, v131
  v_cvt_pk_bf16_f32 v142, v137, v136
  ds_write_b32 v13, v142 offset:18624
  v_mul_f32 v136, v84, v44
  v_mul_f32 v137, v92, v44
  v_cvt_pk_bf16_f32 v138, v136, v137
  v_lshlrev_b32 v136, 16, v138
  v_and_b32 v137, 0xffff0000, v138
  v_mul_f32 v150, v92, v36
  v_mul_f32 v151, v100, v36
  v_cvt_pk_bf16_f32 v138, v150, v151
  v_lshlrev_b32 v150, 16, v138
  v_and_b32 v151, 0xffff0000, v138
  v_add_f32 v136, v136, v150
  v_add_f32 v137, v137, v151
  v_cvt_pk_bf16_f32 v138, v136, v137
  v_lshlrev_b32 v136, 16, v138
  v_and_b32 v137, 0xffff0000, v138
  v_mul_f32 v150, v100, v28
  v_mul_f32 v151, v108, v28
  v_cvt_pk_bf16_f32 v138, v150, v151
  v_lshlrev_b32 v150, 16, v138
  v_and_b32 v151, 0xffff0000, v138
  v_add_f32 v136, v136, v150
  v_add_f32 v137, v137, v151
  v_cvt_pk_bf16_f32 v138, v136, v137
  v_lshlrev_b32 v136, 16, v138
  v_and_b32 v137, 0xffff0000, v138
  v_mul_f32 v150, v108, v20
  v_mul_f32 v151, v116, v20
  v_cvt_pk_bf16_f32 v138, v150, v151
  v_lshlrev_b32 v150, 16, v138
  v_and_b32 v151, 0xffff0000, v138
  v_add_f32 v136, v136, v150
  v_add_f32 v137, v137, v151
  v_cvt_pk_bf16_f32 v138, v136, v137
  v_lshlrev_b32 v136, 16, v138
  v_and_b32 v137, 0xffff0000, v138
  v_mul_f32 v136, v136, v124
  v_mul_f32 v137, v137, v132
  v_cvt_pk_bf16_f32 v139, v137, v136
  ds_write_b32 v13, v139 offset:23808
  v_mul_f32 v136, v85, v45
  v_mul_f32 v137, v93, v45
  v_cvt_pk_bf16_f32 v138, v136, v137
  v_lshlrev_b32 v136, 16, v138
  v_and_b32 v137, 0xffff0000, v138
  v_mul_f32 v150, v93, v37
  v_mul_f32 v151, v101, v37
  v_cvt_pk_bf16_f32 v138, v150, v151
  v_lshlrev_b32 v150, 16, v138
  v_and_b32 v151, 0xffff0000, v138
  v_add_f32 v136, v136, v150
  v_add_f32 v137, v137, v151
  v_cvt_pk_bf16_f32 v138, v136, v137
  v_lshlrev_b32 v136, 16, v138
  v_and_b32 v137, 0xffff0000, v138
  v_mul_f32 v150, v101, v29
  v_mul_f32 v151, v109, v29
  v_cvt_pk_bf16_f32 v138, v150, v151
  v_lshlrev_b32 v150, 16, v138
  v_and_b32 v151, 0xffff0000, v138
  v_add_f32 v136, v136, v150
  v_add_f32 v137, v137, v151
  v_cvt_pk_bf16_f32 v138, v136, v137
  v_lshlrev_b32 v136, 16, v138
  v_and_b32 v137, 0xffff0000, v138
  v_mul_f32 v150, v109, v21
  v_mul_f32 v151, v117, v21
  v_cvt_pk_bf16_f32 v138, v150, v151
  v_lshlrev_b32 v150, 16, v138
  v_and_b32 v151, 0xffff0000, v138
  v_add_f32 v136, v136, v150
  v_add_f32 v137, v137, v151
  v_cvt_pk_bf16_f32 v138, v136, v137
  v_lshlrev_b32 v136, 16, v138
  v_and_b32 v137, 0xffff0000, v138
  v_mul_f32 v136, v136, v125
  v_mul_f32 v137, v137, v133
  v_cvt_pk_bf16_f32 v140, v137, v136
  ds_write_b32 v13, v140 offset:28992
  v_mul_f32 v136, v86, v46
  v_mul_f32 v137, v94, v46
  v_cvt_pk_bf16_f32 v138, v136, v137
  v_lshlrev_b32 v136, 16, v138
  v_and_b32 v137, 0xffff0000, v138
  v_mul_f32 v150, v94, v38
  v_mul_f32 v151, v102, v38
  v_cvt_pk_bf16_f32 v138, v150, v151
  v_lshlrev_b32 v150, 16, v138
  v_and_b32 v151, 0xffff0000, v138
  v_add_f32 v136, v136, v150
  v_add_f32 v137, v137, v151
  v_cvt_pk_bf16_f32 v138, v136, v137
  v_lshlrev_b32 v136, 16, v138
  v_and_b32 v137, 0xffff0000, v138
  v_mul_f32 v150, v102, v30
  v_mul_f32 v151, v110, v30
  v_cvt_pk_bf16_f32 v138, v150, v151
  v_lshlrev_b32 v150, 16, v138
  v_and_b32 v151, 0xffff0000, v138
  v_add_f32 v136, v136, v150
  v_add_f32 v137, v137, v151
  v_cvt_pk_bf16_f32 v138, v136, v137
  v_lshlrev_b32 v136, 16, v138
  v_and_b32 v137, 0xffff0000, v138
  v_mul_f32 v150, v110, v22
  v_mul_f32 v151, v118, v22
  v_cvt_pk_bf16_f32 v138, v150, v151
  v_lshlrev_b32 v150, 16, v138
  v_and_b32 v151, 0xffff0000, v138
  v_add_f32 v136, v136, v150
  v_add_f32 v137, v137, v151
  v_cvt_pk_bf16_f32 v138, v136, v137
  v_lshlrev_b32 v136, 16, v138
  v_and_b32 v137, 0xffff0000, v138
  v_mul_f32 v136, v136, v126
  v_mul_f32 v137, v137, v134
  v_cvt_pk_bf16_f32 v141, v137, v136
  ds_write_b32 v13, v141 offset:34176
  v_mul_f32 v136, v87, v47
  v_mul_f32 v137, v95, v47
  v_cvt_pk_bf16_f32 v138, v136, v137
  v_lshlrev_b32 v136, 16, v138
  v_and_b32 v137, 0xffff0000, v138
  v_mul_f32 v150, v95, v39
  v_mul_f32 v151, v103, v39
  v_cvt_pk_bf16_f32 v138, v150, v151
  v_lshlrev_b32 v150, 16, v138
  v_and_b32 v151, 0xffff0000, v138
  v_add_f32 v136, v136, v150
  v_add_f32 v137, v137, v151
  v_cvt_pk_bf16_f32 v138, v136, v137
  v_lshlrev_b32 v136, 16, v138
  v_and_b32 v137, 0xffff0000, v138
  v_mul_f32 v150, v103, v31
  v_mul_f32 v151, v111, v31
  v_cvt_pk_bf16_f32 v138, v150, v151
  v_lshlrev_b32 v150, 16, v138
  v_and_b32 v151, 0xffff0000, v138
  v_add_f32 v136, v136, v150
  v_add_f32 v137, v137, v151
  v_cvt_pk_bf16_f32 v138, v136, v137
  v_lshlrev_b32 v136, 16, v138
  v_and_b32 v137, 0xffff0000, v138
  v_mul_f32 v150, v111, v23
  v_mul_f32 v151, v119, v23
  v_cvt_pk_bf16_f32 v138, v150, v151
  v_lshlrev_b32 v150, 16, v138
  v_and_b32 v151, 0xffff0000, v138
  v_add_f32 v136, v136, v150
  v_add_f32 v137, v137, v151
  v_cvt_pk_bf16_f32 v138, v136, v137
  v_lshlrev_b32 v136, 16, v138
  v_and_b32 v137, 0xffff0000, v138
  v_mul_f32 v136, v136, v127
  v_mul_f32 v137, v137, v135
  v_cvt_pk_bf16_f32 v142, v137, v136
  ds_write_b32 v13, v142 offset:39360
  v_add_u32 v12, 262144, v12
  v_add_u32 v144, 0, v12
  v_add_u32 v145, 1024, v12
  v_add_u32 v146, 2048, v12
  v_add_u32 v147, 3072, v12
  v_add_u32 v148, 4096, v12
  buffer_load_dwordx4 v[48:51], v144, s[8:11], 0 offen
  buffer_load_dwordx4 v[52:55], v145, s[8:11], 0 offen
  buffer_load_dwordx4 v[56:59], v146, s[8:11], 0 offen
  buffer_load_dwordx4 v[60:63], v147, s[8:11], 0 offen
  buffer_load_dwordx4 v[64:67], v148, s[8:11], 0 offen
  buffer_load_dwordx4 v[68:71], v147, s[12:15], 0 offen
  buffer_load_dwordx4 v[72:75], v148, s[12:15], 0 offen
  s_waitcnt vmcnt(0)
  v_lshlrev_b32 v80, 16, v48
  v_and_b32 v81, 0xffff0000, v48
  v_lshlrev_b32 v82, 16, v49
  v_and_b32 v83, 0xffff0000, v49
  v_lshlrev_b32 v84, 16, v50
  v_and_b32 v85, 0xffff0000, v50
  v_lshlrev_b32 v86, 16, v51
  v_and_b32 v87, 0xffff0000, v51
  v_lshlrev_b32 v88, 16, v52
  v_and_b32 v89, 0xffff0000, v52
  v_lshlrev_b32 v90, 16, v53
  v_and_b32 v91, 0xffff0000, v53
  v_lshlrev_b32 v92, 16, v54
  v_and_b32 v93, 0xffff0000, v54
  v_lshlrev_b32 v94, 16, v55
  v_and_b32 v95, 0xffff0000, v55
  v_lshlrev_b32 v96, 16, v56
  v_and_b32 v97, 0xffff0000, v56
  v_lshlrev_b32 v98, 16, v57
  v_and_b32 v99, 0xffff0000, v57
  v_lshlrev_b32 v100, 16, v58
  v_and_b32 v101, 0xffff0000, v58
  v_lshlrev_b32 v102, 16, v59
  v_and_b32 v103, 0xffff0000, v59
  v_lshlrev_b32 v104, 16, v60
  v_and_b32 v105, 0xffff0000, v60
  v_lshlrev_b32 v106, 16, v61
  v_and_b32 v107, 0xffff0000, v61
  v_lshlrev_b32 v108, 16, v62
  v_and_b32 v109, 0xffff0000, v62
  v_lshlrev_b32 v110, 16, v63
  v_and_b32 v111, 0xffff0000, v63
  v_lshlrev_b32 v112, 16, v64
  v_and_b32 v113, 0xffff0000, v64
  v_lshlrev_b32 v114, 16, v65
  v_and_b32 v115, 0xffff0000, v65
  v_lshlrev_b32 v116, 16, v66
  v_and_b32 v117, 0xffff0000, v66
  v_lshlrev_b32 v118, 16, v67
  v_and_b32 v119, 0xffff0000, v67
  v_lshlrev_b32 v120, 16, v68
  v_and_b32 v121, 0xffff0000, v68
  v_lshlrev_b32 v122, 16, v69
  v_and_b32 v123, 0xffff0000, v69
  v_lshlrev_b32 v124, 16, v70
  v_and_b32 v125, 0xffff0000, v70
  v_lshlrev_b32 v126, 16, v71
  v_and_b32 v127, 0xffff0000, v71
  v_lshlrev_b32 v128, 16, v72
  v_and_b32 v129, 0xffff0000, v72
  v_lshlrev_b32 v130, 16, v73
  v_and_b32 v131, 0xffff0000, v73
  v_lshlrev_b32 v132, 16, v74
  v_and_b32 v133, 0xffff0000, v74
  v_lshlrev_b32 v134, 16, v75
  v_and_b32 v135, 0xffff0000, v75
  v_mul_f32 v136, v80, v40
  v_mul_f32 v137, v88, v40
  v_cvt_pk_bf16_f32 v138, v136, v137
  v_lshlrev_b32 v136, 16, v138
  v_and_b32 v137, 0xffff0000, v138
  v_mul_f32 v150, v88, v32
  v_mul_f32 v151, v96, v32
  v_cvt_pk_bf16_f32 v138, v150, v151
  v_lshlrev_b32 v150, 16, v138
  v_and_b32 v151, 0xffff0000, v138
  v_add_f32 v136, v136, v150
  v_add_f32 v137, v137, v151
  v_cvt_pk_bf16_f32 v138, v136, v137
  v_lshlrev_b32 v136, 16, v138
  v_and_b32 v137, 0xffff0000, v138
  v_mul_f32 v150, v96, v24
  v_mul_f32 v151, v104, v24
  v_cvt_pk_bf16_f32 v138, v150, v151
  v_lshlrev_b32 v150, 16, v138
  v_and_b32 v151, 0xffff0000, v138
  v_add_f32 v136, v136, v150
  v_add_f32 v137, v137, v151
  v_cvt_pk_bf16_f32 v138, v136, v137
  v_lshlrev_b32 v136, 16, v138
  v_and_b32 v137, 0xffff0000, v138
  v_mul_f32 v150, v104, v16
  v_mul_f32 v151, v112, v16
  v_cvt_pk_bf16_f32 v138, v150, v151
  v_lshlrev_b32 v150, 16, v138
  v_and_b32 v151, 0xffff0000, v138
  v_add_f32 v136, v136, v150
  v_add_f32 v137, v137, v151
  v_cvt_pk_bf16_f32 v138, v136, v137
  v_lshlrev_b32 v136, 16, v138
  v_and_b32 v137, 0xffff0000, v138
  v_mul_f32 v136, v136, v120
  v_mul_f32 v137, v137, v128
  v_cvt_pk_bf16_f32 v139, v137, v136
  ds_write_b32 v13, v139 offset:3584
  v_mul_f32 v136, v81, v41
  v_mul_f32 v137, v89, v41
  v_cvt_pk_bf16_f32 v138, v136, v137
  v_lshlrev_b32 v136, 16, v138
  v_and_b32 v137, 0xffff0000, v138
  v_mul_f32 v150, v89, v33
  v_mul_f32 v151, v97, v33
  v_cvt_pk_bf16_f32 v138, v150, v151
  v_lshlrev_b32 v150, 16, v138
  v_and_b32 v151, 0xffff0000, v138
  v_add_f32 v136, v136, v150
  v_add_f32 v137, v137, v151
  v_cvt_pk_bf16_f32 v138, v136, v137
  v_lshlrev_b32 v136, 16, v138
  v_and_b32 v137, 0xffff0000, v138
  v_mul_f32 v150, v97, v25
  v_mul_f32 v151, v105, v25
  v_cvt_pk_bf16_f32 v138, v150, v151
  v_lshlrev_b32 v150, 16, v138
  v_and_b32 v151, 0xffff0000, v138
  v_add_f32 v136, v136, v150
  v_add_f32 v137, v137, v151
  v_cvt_pk_bf16_f32 v138, v136, v137
  v_lshlrev_b32 v136, 16, v138
  v_and_b32 v137, 0xffff0000, v138
  v_mul_f32 v150, v105, v17
  v_mul_f32 v151, v113, v17
  v_cvt_pk_bf16_f32 v138, v150, v151
  v_lshlrev_b32 v150, 16, v138
  v_and_b32 v151, 0xffff0000, v138
  v_add_f32 v136, v136, v150
  v_add_f32 v137, v137, v151
  v_cvt_pk_bf16_f32 v138, v136, v137
  v_lshlrev_b32 v136, 16, v138
  v_and_b32 v137, 0xffff0000, v138
  v_mul_f32 v136, v136, v121
  v_mul_f32 v137, v137, v129
  v_cvt_pk_bf16_f32 v140, v137, v136
  ds_write_b32 v13, v140 offset:8768
  v_mul_f32 v136, v82, v42
  v_mul_f32 v137, v90, v42
  v_cvt_pk_bf16_f32 v138, v136, v137
  v_lshlrev_b32 v136, 16, v138
  v_and_b32 v137, 0xffff0000, v138
  v_mul_f32 v150, v90, v34
  v_mul_f32 v151, v98, v34
  v_cvt_pk_bf16_f32 v138, v150, v151
  v_lshlrev_b32 v150, 16, v138
  v_and_b32 v151, 0xffff0000, v138
  v_add_f32 v136, v136, v150
  v_add_f32 v137, v137, v151
  v_cvt_pk_bf16_f32 v138, v136, v137
  v_lshlrev_b32 v136, 16, v138
  v_and_b32 v137, 0xffff0000, v138
  v_mul_f32 v150, v98, v26
  v_mul_f32 v151, v106, v26
  v_cvt_pk_bf16_f32 v138, v150, v151
  v_lshlrev_b32 v150, 16, v138
  v_and_b32 v151, 0xffff0000, v138
  v_add_f32 v136, v136, v150
  v_add_f32 v137, v137, v151
  v_cvt_pk_bf16_f32 v138, v136, v137
  v_lshlrev_b32 v136, 16, v138
  v_and_b32 v137, 0xffff0000, v138
  v_mul_f32 v150, v106, v18
  v_mul_f32 v151, v114, v18
  v_cvt_pk_bf16_f32 v138, v150, v151
  v_lshlrev_b32 v150, 16, v138
  v_and_b32 v151, 0xffff0000, v138
  v_add_f32 v136, v136, v150
  v_add_f32 v137, v137, v151
  v_cvt_pk_bf16_f32 v138, v136, v137
  v_lshlrev_b32 v136, 16, v138
  v_and_b32 v137, 0xffff0000, v138
  v_mul_f32 v136, v136, v122
  v_mul_f32 v137, v137, v130
  v_cvt_pk_bf16_f32 v141, v137, v136
  ds_write_b32 v13, v141 offset:13952
  v_mul_f32 v136, v83, v43
  v_mul_f32 v137, v91, v43
  v_cvt_pk_bf16_f32 v138, v136, v137
  v_lshlrev_b32 v136, 16, v138
  v_and_b32 v137, 0xffff0000, v138
  v_mul_f32 v150, v91, v35
  v_mul_f32 v151, v99, v35
  v_cvt_pk_bf16_f32 v138, v150, v151
  v_lshlrev_b32 v150, 16, v138
  v_and_b32 v151, 0xffff0000, v138
  v_add_f32 v136, v136, v150
  v_add_f32 v137, v137, v151
  v_cvt_pk_bf16_f32 v138, v136, v137
  v_lshlrev_b32 v136, 16, v138
  v_and_b32 v137, 0xffff0000, v138
  v_mul_f32 v150, v99, v27
  v_mul_f32 v151, v107, v27
  v_cvt_pk_bf16_f32 v138, v150, v151
  v_lshlrev_b32 v150, 16, v138
  v_and_b32 v151, 0xffff0000, v138
  v_add_f32 v136, v136, v150
  v_add_f32 v137, v137, v151
  v_cvt_pk_bf16_f32 v138, v136, v137
  v_lshlrev_b32 v136, 16, v138
  v_and_b32 v137, 0xffff0000, v138
  v_mul_f32 v150, v107, v19
  v_mul_f32 v151, v115, v19
  v_cvt_pk_bf16_f32 v138, v150, v151
  v_lshlrev_b32 v150, 16, v138
  v_and_b32 v151, 0xffff0000, v138
  v_add_f32 v136, v136, v150
  v_add_f32 v137, v137, v151
  v_cvt_pk_bf16_f32 v138, v136, v137
  v_lshlrev_b32 v136, 16, v138
  v_and_b32 v137, 0xffff0000, v138
  v_mul_f32 v136, v136, v123
  v_mul_f32 v137, v137, v131
  v_cvt_pk_bf16_f32 v142, v137, v136
  ds_write_b32 v13, v142 offset:19136
  v_mul_f32 v136, v84, v44
  v_mul_f32 v137, v92, v44
  v_cvt_pk_bf16_f32 v138, v136, v137
  v_lshlrev_b32 v136, 16, v138
  v_and_b32 v137, 0xffff0000, v138
  v_mul_f32 v150, v92, v36
  v_mul_f32 v151, v100, v36
  v_cvt_pk_bf16_f32 v138, v150, v151
  v_lshlrev_b32 v150, 16, v138
  v_and_b32 v151, 0xffff0000, v138
  v_add_f32 v136, v136, v150
  v_add_f32 v137, v137, v151
  v_cvt_pk_bf16_f32 v138, v136, v137
  v_lshlrev_b32 v136, 16, v138
  v_and_b32 v137, 0xffff0000, v138
  v_mul_f32 v150, v100, v28
  v_mul_f32 v151, v108, v28
  v_cvt_pk_bf16_f32 v138, v150, v151
  v_lshlrev_b32 v150, 16, v138
  v_and_b32 v151, 0xffff0000, v138
  v_add_f32 v136, v136, v150
  v_add_f32 v137, v137, v151
  v_cvt_pk_bf16_f32 v138, v136, v137
  v_lshlrev_b32 v136, 16, v138
  v_and_b32 v137, 0xffff0000, v138
  v_mul_f32 v150, v108, v20
  v_mul_f32 v151, v116, v20
  v_cvt_pk_bf16_f32 v138, v150, v151
  v_lshlrev_b32 v150, 16, v138
  v_and_b32 v151, 0xffff0000, v138
  v_add_f32 v136, v136, v150
  v_add_f32 v137, v137, v151
  v_cvt_pk_bf16_f32 v138, v136, v137
  v_lshlrev_b32 v136, 16, v138
  v_and_b32 v137, 0xffff0000, v138
  v_mul_f32 v136, v136, v124
  v_mul_f32 v137, v137, v132
  v_cvt_pk_bf16_f32 v139, v137, v136
  ds_write_b32 v13, v139 offset:24320
  v_mul_f32 v136, v85, v45
  v_mul_f32 v137, v93, v45
  v_cvt_pk_bf16_f32 v138, v136, v137
  v_lshlrev_b32 v136, 16, v138
  v_and_b32 v137, 0xffff0000, v138
  v_mul_f32 v150, v93, v37
  v_mul_f32 v151, v101, v37
  v_cvt_pk_bf16_f32 v138, v150, v151
  v_lshlrev_b32 v150, 16, v138
  v_and_b32 v151, 0xffff0000, v138
  v_add_f32 v136, v136, v150
  v_add_f32 v137, v137, v151
  v_cvt_pk_bf16_f32 v138, v136, v137
  v_lshlrev_b32 v136, 16, v138
  v_and_b32 v137, 0xffff0000, v138
  v_mul_f32 v150, v101, v29
  v_mul_f32 v151, v109, v29
  v_cvt_pk_bf16_f32 v138, v150, v151
  v_lshlrev_b32 v150, 16, v138
  v_and_b32 v151, 0xffff0000, v138
  v_add_f32 v136, v136, v150
  v_add_f32 v137, v137, v151
  v_cvt_pk_bf16_f32 v138, v136, v137
  v_lshlrev_b32 v136, 16, v138
  v_and_b32 v137, 0xffff0000, v138
  v_mul_f32 v150, v109, v21
  v_mul_f32 v151, v117, v21
  v_cvt_pk_bf16_f32 v138, v150, v151
  v_lshlrev_b32 v150, 16, v138
  v_and_b32 v151, 0xffff0000, v138
  v_add_f32 v136, v136, v150
  v_add_f32 v137, v137, v151
  v_cvt_pk_bf16_f32 v138, v136, v137
  v_lshlrev_b32 v136, 16, v138
  v_and_b32 v137, 0xffff0000, v138
  v_mul_f32 v136, v136, v125
  v_mul_f32 v137, v137, v133
  v_cvt_pk_bf16_f32 v140, v137, v136
  ds_write_b32 v13, v140 offset:29504
  v_mul_f32 v136, v86, v46
  v_mul_f32 v137, v94, v46
  v_cvt_pk_bf16_f32 v138, v136, v137
  v_lshlrev_b32 v136, 16, v138
  v_and_b32 v137, 0xffff0000, v138
  v_mul_f32 v150, v94, v38
  v_mul_f32 v151, v102, v38
  v_cvt_pk_bf16_f32 v138, v150, v151
  v_lshlrev_b32 v150, 16, v138
  v_and_b32 v151, 0xffff0000, v138
  v_add_f32 v136, v136, v150
  v_add_f32 v137, v137, v151
  v_cvt_pk_bf16_f32 v138, v136, v137
  v_lshlrev_b32 v136, 16, v138
  v_and_b32 v137, 0xffff0000, v138
  v_mul_f32 v150, v102, v30
  v_mul_f32 v151, v110, v30
  v_cvt_pk_bf16_f32 v138, v150, v151
  v_lshlrev_b32 v150, 16, v138
  v_and_b32 v151, 0xffff0000, v138
  v_add_f32 v136, v136, v150
  v_add_f32 v137, v137, v151
  v_cvt_pk_bf16_f32 v138, v136, v137
  v_lshlrev_b32 v136, 16, v138
  v_and_b32 v137, 0xffff0000, v138
  v_mul_f32 v150, v110, v22
  v_mul_f32 v151, v118, v22
  v_cvt_pk_bf16_f32 v138, v150, v151
  v_lshlrev_b32 v150, 16, v138
  v_and_b32 v151, 0xffff0000, v138
  v_add_f32 v136, v136, v150
  v_add_f32 v137, v137, v151
  v_cvt_pk_bf16_f32 v138, v136, v137
  v_lshlrev_b32 v136, 16, v138
  v_and_b32 v137, 0xffff0000, v138
  v_mul_f32 v136, v136, v126
  v_mul_f32 v137, v137, v134
  v_cvt_pk_bf16_f32 v141, v137, v136
  ds_write_b32 v13, v141 offset:34688
  v_mul_f32 v136, v87, v47
  v_mul_f32 v137, v95, v47
  v_cvt_pk_bf16_f32 v138, v136, v137
  v_lshlrev_b32 v136, 16, v138
  v_and_b32 v137, 0xffff0000, v138
  v_mul_f32 v150, v95, v39
  v_mul_f32 v151, v103, v39
  v_cvt_pk_bf16_f32 v138, v150, v151
  v_lshlrev_b32 v150, 16, v138
  v_and_b32 v151, 0xffff0000, v138
  v_add_f32 v136, v136, v150
  v_add_f32 v137, v137, v151
  v_cvt_pk_bf16_f32 v138, v136, v137
  v_lshlrev_b32 v136, 16, v138
  v_and_b32 v137, 0xffff0000, v138
  v_mul_f32 v150, v103, v31
  v_mul_f32 v151, v111, v31
  v_cvt_pk_bf16_f32 v138, v150, v151
  v_lshlrev_b32 v150, 16, v138
  v_and_b32 v151, 0xffff0000, v138
  v_add_f32 v136, v136, v150
  v_add_f32 v137, v137, v151
  v_cvt_pk_bf16_f32 v138, v136, v137
  v_lshlrev_b32 v136, 16, v138
  v_and_b32 v137, 0xffff0000, v138
  v_mul_f32 v150, v111, v23
  v_mul_f32 v151, v119, v23
  v_cvt_pk_bf16_f32 v138, v150, v151
  v_lshlrev_b32 v150, 16, v138
  v_and_b32 v151, 0xffff0000, v138
  v_add_f32 v136, v136, v150
  v_add_f32 v137, v137, v151
  v_cvt_pk_bf16_f32 v138, v136, v137
  v_lshlrev_b32 v136, 16, v138
  v_and_b32 v137, 0xffff0000, v138
  v_mul_f32 v136, v136, v127
  v_mul_f32 v137, v137, v135
  v_cvt_pk_bf16_f32 v142, v137, v136
  ds_write_b32 v13, v142 offset:39872
  v_add_u32 v12, 262144, v12
  v_lshlrev_b32 v2, 4, v1
  v_subrev_u32 v2, 16, v2
  v_lshlrev_b32 v3, 4, v1
  v_add_u32 v3, 82992, v3
  v_and_b32 v4, 15, v0
  v_lshrrev_b32 v5, 4, v0
  v_and_b32 v6, 7, v4
  v_mul_u32_u24 v6, 4160, v6
  v_lshrrev_b32 v7, 3, v4
  v_add_u32 v7, v7, v5
  v_lshlrev_b32 v7, 4, v7
  s_and_b32 s32, s28, 1
  s_lshl_b32 s32, s32, 5
  s_add_u32 s32, s32, 82944
  v_add3_u32 v8, v6, v7, s32
  v_add_u32 v9, 1, v4
  v_lshlrev_b32 v9, 6, v9
  v_lshlrev_b32 v10, 4, v5
  v_add_u32 v9, v9, v10
  v_add_u32 v10, 16, v4
  v_lshlrev_b32 v10, 6, v10
  s_and_b32 s32, s28, 1
  s_lshl_b32 s32, s32, 5
  s_sub_u32 s32, 56, s32
  v_lshlrev_b32 v11, 3, v5
  v_sub_u32 v11, s32, v11
  v_add_u32 v10, v10, v11
  s_mov_b32 s30, 0
  s_lshl_b32 s32, s29, 16
  s_lshl_b32 s33, s30, 12
  s_add_u32 s32, s32, s33
  v_add_u32 v12, s32, v2
  v_add_u32 v13, 16, v12
  buffer_load_dwordx4 v[160:163], v12, s[20:23], 0 offen
  buffer_load_dwordx4 v[164:167], v13, s[20:23], 0 offen
  s_waitcnt lgkmcnt(0)
  s_barrier
L_w2chF:
  s_waitcnt vmcnt(0)
  v_cmp_eq_u32 vcc, 0, v1
  s_nop 1
  v_cndmask_b32 v160, v160, 0, vcc
  v_cndmask_b32 v161, v161, 0, vcc
  v_cndmask_b32 v162, v162, 0, vcc
  v_cndmask_b32 v163, v163, 0, vcc
  v_alignbit_b32 v176, v161, v160, 16
  v_alignbit_b32 v177, v162, v161, 16
  v_alignbit_b32 v178, v163, v162, 16
  v_alignbit_b32 v179, v164, v163, 16
  ds_write_b128 v3, v[176:179] offset:0
  v_mov_b32 v172, v161
  v_mov_b32 v173, v162
  v_mov_b32 v174, v163
  v_mov_b32 v175, v164
  ds_write_b128 v3, v[172:175] offset:4160
  v_alignbit_b32 v180, v162, v161, 16
  v_alignbit_b32 v181, v163, v162, 16
  v_alignbit_b32 v182, v164, v163, 16
  v_alignbit_b32 v183, v165, v164, 16
  ds_write_b128 v3, v[180:183] offset:8320
  ds_write_b128 v3, v[162:165] offset:12480
  v_alignbit_b32 v176, v163, v162, 16
  v_alignbit_b32 v177, v164, v163, 16
  v_alignbit_b32 v178, v165, v164, 16
  v_alignbit_b32 v179, v166, v165, 16
  ds_write_b128 v3, v[176:179] offset:16640
  v_mov_b32 v172, v163
  v_mov_b32 v173, v164
  v_mov_b32 v174, v165
  v_mov_b32 v175, v166
  ds_write_b128 v3, v[172:175] offset:20800
  v_alignbit_b32 v180, v164, v163, 16
  v_alignbit_b32 v181, v165, v164, 16
  v_alignbit_b32 v182, v166, v165, 16
  v_alignbit_b32 v183, v167, v166, 16
  ds_write_b128 v3, v[180:183] offset:24960
  ds_write_b128 v3, v[164:167] offset:29120
  s_waitcnt lgkmcnt(0)
  s_barrier
  s_add_u32 s30, s30, 1
  s_cmp_ge_u32 s30, 16
  s_cbranch_scc1 L_w2nhF
  s_lshl_b32 s32, s29, 16
  s_lshl_b32 s33, s30, 12
  s_add_u32 s32, s32, s33
  v_add_u32 v12, s32, v2
  v_add_u32 v13, 16, v12
  buffer_load_dwordx4 v[160:163], v12, s[20:23], 0 offen
  buffer_load_dwordx4 v[164:167], v13, s[20:23], 0 offen
L_w2nhF:
  s_sub_u32 s32, s30, 1
  s_mov_b32 m0, s32
  s_nop 0
  s_movrels_b32 s58, s36
  s_cmp_ge_u32 s28, 2
  s_cbranch_scc1 L_w2v2F
  ds_read_b64 v[208:209], v10 offset:3072
  s_waitcnt lgkmcnt(0)
  v_lshlrev_b32 v203, 16, v208
  v_and_b32 v202, 0xffff0000, v208
  v_lshlrev_b32 v201, 16, v209
  v_and_b32 v200, 0xffff0000, v209
  v_mul_f32 v192, s58, v200
  v_mul_f32 v193, s58, v201
  v_mul_f32 v194, s58, v202
  v_mul_f32 v195, s58, v203
  v_cvt_pk_bf16_f32 v208, v192, v193
  v_cvt_pk_bf16_f32 v209, v194, v195
  v_lshlrev_b32 v192, 16, v208
  v_and_b32 v193, 0xffff0000, v208
  v_lshlrev_b32 v194, 16, v209
  v_and_b32 v195, 0xffff0000, v209
  v_mov_b32 v200, 0
  v_mov_b32 v201, 0
  v_mov_b32 v202, 0
  v_mov_b32 v203, 0
  ds_read_b64 v[208:209], v10 offset:0
  s_waitcnt lgkmcnt(0)
  v_lshlrev_b32 v207, 16, v208
  v_and_b32 v206, 0xffff0000, v208
  v_lshlrev_b32 v205, 16, v209
  v_and_b32 v204, 0xffff0000, v209
  v_mul_f32 v196, s58, v204
  v_mul_f32 v197, s58, v205
  v_mul_f32 v198, s58, v206
  v_mul_f32 v199, s58, v207
  v_cvt_pk_bf16_f32 v208, v196, v197
  v_cvt_pk_bf16_f32 v209, v198, v199
  v_lshlrev_b32 v196, 16, v208
  v_and_b32 v197, 0xffff0000, v208
  v_lshlrev_b32 v198, 16, v209
  v_and_b32 v199, 0xffff0000, v209
  v_mov_b32 v204, 0
  v_mov_b32 v205, 0
  v_mov_b32 v206, 0
  v_mov_b32 v207, 0
  ds_read_b128 v[208:211], v8 offset:0
  ds_read_b128 v[224:227], v9 offset:4032
  ds_read_b128 v[240:243], v9 offset:960
  ds_read_b128 v[212:215], v8 offset:64
  ds_read_b128 v[228:231], v9 offset:3968
  ds_read_b128 v[244:247], v9 offset:896
  ds_read_b128 v[216:219], v8 offset:128
  ds_read_b128 v[232:235], v9 offset:3904
  ds_read_b128 v[248:251], v9 offset:832
  ds_read_b128 v[220:223], v8 offset:192
  ds_read_b128 v[236:239], v9 offset:3840
  ds_read_b128 v[252:255], v9 offset:768
  s_waitcnt lgkmcnt(9)
  v_mfma_f32_16x16x32_bf16 v[200:203], v[208:211], v[224:227], v[200:203]
  v_mfma_f32_16x16x32_bf16 v[204:207], v[208:211], v[240:243], v[204:207]
  ds_read_b128 v[208:211], v8 offset:256
  ds_read_b128 v[224:227], v9 offset:3776
  ds_read_b128 v[240:243], v9 offset:704
  s_waitcnt lgkmcnt(9)
  v_mfma_f32_16x16x32_bf16 v[200:203], v[212:215], v[228:231], v[200:203]
  v_mfma_f32_16x16x32_bf16 v[204:207], v[212:215], v[244:247], v[204:207]
  ds_read_b128 v[212:215], v8 offset:320
  ds_read_b128 v[228:231], v9 offset:3712
  ds_read_b128 v[244:247], v9 offset:640
  s_waitcnt lgkmcnt(9)
  v_mfma_f32_16x16x32_bf16 v[200:203], v[216:219], v[232:235], v[200:203]
  v_mfma_f32_16x16x32_bf16 v[204:207], v[216:219], v[248:251], v[204:207]
  ds_read_b128 v[216:219], v8 offset:384
  ds_read_b128 v[232:235], v9 offset:3648
  ds_read_b128 v[248:251], v9 offset:576
  s_waitcnt lgkmcnt(9)
  v_mfma_f32_16x16x32_bf16 v[200:203], v[220:223], v[236:239], v[200:203]
  v_mfma_f32_16x16x32_bf16 v[204:207], v[220:223], v[252:255], v[204:207]
  ds_read_b128 v[220:223], v8 offset:448
  ds_read_b128 v[236:239], v9 offset:3584
  ds_read_b128 v[252:255], v9 offset:512
  s_waitcnt lgkmcnt(9)
  v_mfma_f32_16x16x32_bf16 v[200:203], v[208:211], v[224:227], v[200:203]
  v_mfma_f32_16x16x32_bf16 v[204:207], v[208:211], v[240:243], v[204:207]
  ds_read_b128 v[208:211], v8 offset:512
  ds_read_b128 v[224:227], v9 offset:3520
  ds_read_b128 v[240:243], v9 offset:448
  s_waitcnt lgkmcnt(9)
  v_mfma_f32_16x16x32_bf16 v[200:203], v[212:215], v[228:231], v[200:203]
  v_mfma_f32_16x16x32_bf16 v[204:207], v[212:215], v[244:247], v[204:207]
  ds_read_b128 v[212:215], v8 offset:576
  ds_read_b128 v[228:231], v9 offset:3456
  ds_read_b128 v[244:247], v9 offset:384
  s_waitcnt lgkmcnt(9)
  v_mfma_f32_16x16x32_bf16 v[200:203], v[216:219], v[232:235], v[200:203]
  v_mfma_f32_16x16x32_bf16 v[204:207], v[216:219], v[248:251], v[204:207]
  ds_read_b128 v[216:219], v8 offset:640
  ds_read_b128 v[232:235], v9 offset:3392
  ds_read_b128 v[248:251], v9 offset:320
  s_waitcnt lgkmcnt(9)
  v_mfma_f32_16x16x32_bf16 v[200:203], v[220:223], v[236:239], v[200:203]
  v_mfma_f32_16x16x32_bf16 v[204:207], v[220:223], v[252:255], v[204:207]
  ds_read_b128 v[220:223], v8 offset:704
  ds_read_b128 v[236:239], v9 offset:3328
  ds_read_b128 v[252:255], v9 offset:256
  s_waitcnt lgkmcnt(9)
  v_mfma_f32_16x16x32_bf16 v[200:203], v[208:211], v[224:227], v[200:203]
  v_mfma_f32_16x16x32_bf16 v[204:207], v[208:211], v[240:243], v[204:207]
  ds_read_b128 v[208:211], v8 offset:768
  ds_read_b128 v[224:227], v9 offset:3264
  ds_read_b128 v[240:243], v9 offset:192
  s_waitcnt lgkmcnt(9)
  v_mfma_f32_16x16x32_bf16 v[200:203], v[212:215], v[228:231], v[200:203]
  v_mfma_f32_16x16x32_bf16 v[204:207], v[212:215], v[244:247], v[204:207]
  ds_read_b128 v[212:215], v8 offset:832
  ds_read_b128 v[228:231], v9 offset:3200
  ds_read_b128 v[244:247], v9 offset:128
  s_waitcnt lgkmcnt(9)
  v_mfma_f32_16x16x32_bf16 v[200:203], v[216:219], v[232:235], v[200:203]
  v_mfma_f32_16x16x32_bf16 v[204:207], v[216:219], v[248:251], v[204:207]
  ds_read_b128 v[216:219], v8 offset:896
  ds_read_b128 v[232:235], v9 offset:3136
  ds_read_b128 v[248:251], v9 offset:64
  s_waitcnt lgkmcnt(9)
  v_mfma_f32_16x16x32_bf16 v[200:203], v[220:223], v[236:239], v[200:203]
  v_mfma_f32_16x16x32_bf16 v[204:207], v[220:223], v[252:255], v[204:207]
  ds_read_b128 v[220:223], v8 offset:960
  ds_read_b128 v[236:239], v9 offset:3072
  ds_read_b128 v[252:255], v9 offset:0
  s_waitcnt lgkmcnt(9)
  v_mfma_f32_16x16x32_bf16 v[200:203], v[208:211], v[224:227], v[200:203]
  v_mfma_f32_16x16x32_bf16 v[204:207], v[208:211], v[240:243], v[204:207]
  ds_read_b128 v[208:211], v8 offset:1024
  ds_read_b128 v[224:227], v9 offset:3008
  s_waitcnt lgkmcnt(8)
  v_mfma_f32_16x16x32_bf16 v[200:203], v[212:215], v[228:231], v[200:203]
  v_mfma_f32_16x16x32_bf16 v[204:207], v[212:215], v[244:247], v[204:207]
  ds_read_b128 v[212:215], v8 offset:1088
  ds_read_b128 v[228:231], v9 offset:2944
  s_waitcnt lgkmcnt(7)
  v_mfma_f32_16x16x32_bf16 v[200:203], v[216:219], v[232:235], v[200:203]
  v_mfma_f32_16x16x32_bf16 v[204:207], v[216:219], v[248:251], v[204:207]
  ds_read_b128 v[216:219], v8 offset:1152
  ds_read_b128 v[232:235], v9 offset:2880
  s_waitcnt lgkmcnt(6)
  v_mfma_f32_16x16x32_bf16 v[200:203], v[220:223], v[236:239], v[200:203]
  v_mfma_f32_16x16x32_bf16 v[204:207], v[220:223], v[252:255], v[204:207]
  ds_read_b128 v[220:223], v8 offset:1216
  ds_read_b128 v[236:239], v9 offset:2816
  s_waitcnt lgkmcnt(6)
  v_mfma_f32_16x16x32_bf16 v[200:203], v[208:211], v[224:227], v[200:203]
  ds_read_b128 v[208:211], v8 offset:1280
  ds_read_b128 v[224:227], v9 offset:2752
  s_waitcnt lgkmcnt(6)
  v_mfma_f32_16x16x32_bf16 v[200:203], v[212:215], v[228:231], v[200:203]
  ds_read_b128 v[212:215], v8 offset:1344
  ds_read_b128 v[228:231], v9 offset:2688
  s_waitcnt lgkmcnt(6)
  v_mfma_f32_16x16x32_bf16 v[200:203], v[216:219], v[232:235], v[200:203]
  ds_read_b128 v[216:219], v8 offset:1408
  ds_read_b128 v[232:235], v9 offset:2624
  s_waitcnt lgkmcnt(6)
  v_mfma_f32_16x16x32_bf16 v[200:203], v[220:223], v[236:239], v[200:203]
  ds_read_b128 v[220:223], v8 offset:1472
  ds_read_b128 v[236:239], v9 offset:2560
  s_waitcnt lgkmcnt(6)
  v_mfma_f32_16x16x32_bf16 v[200:203], v[208:211], v[224:227], v[200:203]
  ds_read_b128 v[208:211], v8 offset:1536
  ds_read_b128 v[224:227], v9 offset:2496
  s_waitcnt lgkmcnt(6)
  v_mfma_f32_16x16x32_bf16 v[200:203], v[212:215], v[228:231], v[200:203]
  ds_read_b128 v[212:215], v8 offset:1600
  ds_read_b128 v[228:231], v9 offset:2432
  s_waitcnt lgkmcnt(6)
  v_mfma_f32_16x16x32_bf16 v[200:203], v[216:219], v[232:235], v[200:203]
  ds_read_b128 v[216:219], v8 offset:1664
  ds_read_b128 v[232:235], v9 offset:2368
  s_waitcnt lgkmcnt(6)
  v_mfma_f32_16x16x32_bf16 v[200:203], v[220:223], v[236:239], v[200:203]
  ds_read_b128 v[220:223], v8 offset:1728
  ds_read_b128 v[236:239], v9 offset:2304
  s_waitcnt lgkmcnt(6)
  v_mfma_f32_16x16x32_bf16 v[200:203], v[208:211], v[224:227], v[200:203]
  ds_read_b128 v[208:211], v8 offset:1792
  ds_read_b128 v[224:227], v9 offset:2240
  s_waitcnt lgkmcnt(6)
  v_mfma_f32_16x16x32_bf16 v[200:203], v[212:215], v[228:231], v[200:203]
  ds_read_b128 v[212:215], v8 offset:1856
  ds_read_b128 v[228:231], v9 offset:2176
  s_waitcnt lgkmcnt(6)
  v_mfma_f32_16x16x32_bf16 v[200:203], v[216:219], v[232:235], v[200:203]
  ds_read_b128 v[216:219], v8 offset:1920
  ds_read_b128 v[232:235], v9 offset:2112
  s_waitcnt lgkmcnt(6)
  v_mfma_f32_16x16x32_bf16 v[200:203], v[220:223], v[236:239], v[200:203]
  ds_read_b128 v[220:223], v8 offset:1984
  ds_read_b128 v[236:239], v9 offset:2048
  s_waitcnt lgkmcnt(6)
  v_mfma_f32_16x16x32_bf16 v[200:203], v[208:211], v[224:227], v[200:203]
  ds_read_b128 v[208:211], v8 offset:2048
  ds_read_b128 v[224:227], v9 offset:1984
  s_waitcnt lgkmcnt(6)
  v_mfma_f32_16x16x32_bf16 v[200:203], v[212:215], v[228:231], v[200:203]
  ds_read_b128 v[212:215], v8 offset:2112
  ds_read_b128 v[228:231], v9 offset:1920
  s_waitcnt lgkmcnt(6)
  v_mfma_f32_16x16x32_bf16 v[200:203], v[216:219], v[232:235], v[200:203]
  ds_read_b128 v[216:219], v8 offset:2176
  ds_read_b128 v[232:235], v9 offset:1856
  s_waitcnt lgkmcnt(6)
  v_mfma_f32_16x16x32_bf16 v[200:203], v[220:223], v[236:239], v[200:203]
  ds_read_b128 v[220:223], v8 offset:2240
  ds_read_b128 v[236:239], v9 offset:1792
  s_waitcnt lgkmcnt(6)
  v_mfma_f32_16x16x32_bf16 v[200:203], v[208:211], v[224:227], v[200:203]
  ds_read_b128 v[208:211], v8 offset:2304
  ds_read_b128 v[224:227], v9 offset:1728
  s_waitcnt lgkmcnt(6)
  v_mfma_f32_16x16x32_bf16 v[200:203], v[212:215], v[228:231], v[200:203]
  ds_read_b128 v[212:215], v8 offset:2368
  ds_read_b128 v[228:231], v9 offset:1664
  s_waitcnt lgkmcnt(6)
  v_mfma_f32_16x16x32_bf16 v[200:203], v[216:219], v[232:235], v[200:203]
  ds_read_b128 v[216:219], v8 offset:2432
  ds_read_b128 v[232:235], v9 offset:1600
  s_waitcnt lgkmcnt(6)
  v_mfma_f32_16x16x32_bf16 v[200:203], v[220:223], v[236:239], v[200:203]
  ds_read_b128 v[220:223], v8 offset:2496
  ds_read_b128 v[236:239], v9 offset:1536
  s_waitcnt lgkmcnt(6)
  v_mfma_f32_16x16x32_bf16 v[200:203], v[208:211], v[224:227], v[200:203]
  ds_read_b128 v[208:211], v8 offset:2560
  ds_read_b128 v[224:227], v9 offset:1472
  s_waitcnt lgkmcnt(6)
  v_mfma_f32_16x16x32_bf16 v[200:203], v[212:215], v[228:231], v[200:203]
  ds_read_b128 v[212:215], v8 offset:2624
  ds_read_b128 v[228:231], v9 offset:1408
  s_waitcnt lgkmcnt(6)
  v_mfma_f32_16x16x32_bf16 v[200:203], v[216:219], v[232:235], v[200:203]
  ds_read_b128 v[216:219], v8 offset:2688
  ds_read_b128 v[232:235], v9 offset:1344
  s_waitcnt lgkmcnt(6)
  v_mfma_f32_16x16x32_bf16 v[200:203], v[220:223], v[236:239], v[200:203]
  ds_read_b128 v[220:223], v8 offset:2752
  ds_read_b128 v[236:239], v9 offset:1280
  s_waitcnt lgkmcnt(6)
  v_mfma_f32_16x16x32_bf16 v[200:203], v[208:211], v[224:227], v[200:203]
  ds_read_b128 v[208:211], v8 offset:2816
  ds_read_b128 v[224:227], v9 offset:1216
  s_waitcnt lgkmcnt(6)
  v_mfma_f32_16x16x32_bf16 v[200:203], v[212:215], v[228:231], v[200:203]
  ds_read_b128 v[212:215], v8 offset:2880
  ds_read_b128 v[228:231], v9 offset:1152
  s_waitcnt lgkmcnt(6)
  v_mfma_f32_16x16x32_bf16 v[200:203], v[216:219], v[232:235], v[200:203]
  ds_read_b128 v[216:219], v8 offset:2944
  ds_read_b128 v[232:235], v9 offset:1088
  s_waitcnt lgkmcnt(6)
  v_mfma_f32_16x16x32_bf16 v[200:203], v[220:223], v[236:239], v[200:203]
  ds_read_b128 v[220:223], v8 offset:3008
  ds_read_b128 v[236:239], v9 offset:1024
  s_waitcnt lgkmcnt(6)
  v_mfma_f32_16x16x32_bf16 v[200:203], v[208:211], v[224:227], v[200:203]
  ds_read_b128 v[208:211], v8 offset:3072
  ds_read_b128 v[224:227], v9 offset:960
  s_waitcnt lgkmcnt(6)
  v_mfma_f32_16x16x32_bf16 v[200:203], v[212:215], v[228:231], v[200:203]
  ds_read_b128 v[212:215], v8 offset:3136
  ds_read_b128 v[228:231], v9 offset:896
  s_waitcnt lgkmcnt(6)
  v_mfma_f32_16x16x32_bf16 v[200:203], v[216:219], v[232:235], v[200:203]
  ds_read_b128 v[216:219], v8 offset:3200
  ds_read_b128 v[232:235], v9 offset:832
  s_waitcnt lgkmcnt(6)
  v_mfma_f32_16x16x32_bf16 v[200:203], v[220:223], v[236:239], v[200:203]
  ds_read_b128 v[220:223], v8 offset:3264
  ds_read_b128 v[236:239], v9 offset:768
  s_waitcnt lgkmcnt(6)
  v_mfma_f32_16x16x32_bf16 v[200:203], v[208:211], v[224:227], v[200:203]
  ds_read_b128 v[208:211], v8 offset:3328
  ds_read_b128 v[224:227], v9 offset:704
  s_waitcnt lgkmcnt(6)
  v_mfma_f32_16x16x32_bf16 v[200:203], v[212:215], v[228:231], v[200:203]
  ds_read_b128 v[212:215], v8 offset:3392
  ds_read_b128 v[228:231], v9 offset:640
  s_waitcnt lgkmcnt(6)
  v_mfma_f32_16x16x32_bf16 v[200:203], v[216:219], v[232:235], v[200:203]
  ds_read_b128 v[216:219], v8 offset:3456
  ds_read_b128 v[232:235], v9 offset:576
  s_waitcnt lgkmcnt(6)
  v_mfma_f32_16x16x32_bf16 v[200:203], v[220:223], v[236:239], v[200:203]
  ds_read_b128 v[220:223], v8 offset:3520
  ds_read_b128 v[236:239], v9 offset:512
  s_waitcnt lgkmcnt(6)
  v_mfma_f32_16x16x32_bf16 v[200:203], v[208:211], v[224:227], v[200:203]
  ds_read_b128 v[208:211], v8 offset:3584
  ds_read_b128 v[224:227], v9 offset:448
  s_waitcnt lgkmcnt(6)
  v_mfma_f32_16x16x32_bf16 v[200:203], v[212:215], v[228:231], v[200:203]
  ds_read_b128 v[212:215], v8 offset:3648
  ds_read_b128 v[228:231], v9 offset:384
  s_waitcnt lgkmcnt(6)
  v_mfma_f32_16x16x32_bf16 v[200:203], v[216:219], v[232:235], v[200:203]
  ds_read_b128 v[216:219], v8 offset:3712
  ds_read_b128 v[232:235], v9 offset:320
  s_waitcnt lgkmcnt(6)
  v_mfma_f32_16x16x32_bf16 v[200:203], v[220:223], v[236:239], v[200:203]
  ds_read_b128 v[220:223], v8 offset:3776
  ds_read_b128 v[236:239], v9 offset:256
  s_waitcnt lgkmcnt(6)
  v_mfma_f32_16x16x32_bf16 v[200:203], v[208:211], v[224:227], v[200:203]
  ds_read_b128 v[208:211], v8 offset:3840
  ds_read_b128 v[224:227], v9 offset:192
  s_waitcnt lgkmcnt(6)
  v_mfma_f32_16x16x32_bf16 v[200:203], v[212:215], v[228:231], v[200:203]
  ds_read_b128 v[212:215], v8 offset:3904
  ds_read_b128 v[228:231], v9 offset:128
  s_waitcnt lgkmcnt(6)
  v_mfma_f32_16x16x32_bf16 v[200:203], v[216:219], v[232:235], v[200:203]
  ds_read_b128 v[216:219], v8 offset:3968
  ds_read_b128 v[232:235], v9 offset:64
  s_waitcnt lgkmcnt(6)
  v_mfma_f32_16x16x32_bf16 v[200:203], v[220:223], v[236:239], v[200:203]
  ds_read_b128 v[220:223], v8 offset:4032
  ds_read_b128 v[236:239], v9 offset:0
  s_waitcnt lgkmcnt(6)
  v_mfma_f32_16x16x32_bf16 v[200:203], v[208:211], v[224:227], v[200:203]
  s_waitcnt lgkmcnt(4)
  v_mfma_f32_16x16x32_bf16 v[200:203], v[212:215], v[228:231], v[200:203]
  s_waitcnt lgkmcnt(2)
  v_mfma_f32_16x16x32_bf16 v[200:203], v[216:219], v[232:235], v[200:203]
  s_waitcnt lgkmcnt(0)
  v_mfma_f32_16x16x32_bf16 v[200:203], v[220:223], v[236:239], v[200:203]
  v_mov_b32 v14, 3072
  v_mov_b32 v15, 0
  s_nop 5
  s_branch L_w2jF
L_w2v2F:
  ds_read_b64 v[208:209], v10 offset:2048
  s_waitcnt lgkmcnt(0)
  v_lshlrev_b32 v203, 16, v208
  v_and_b32 v202, 0xffff0000, v208
  v_lshlrev_b32 v201, 16, v209
  v_and_b32 v200, 0xffff0000, v209
  v_mul_f32 v192, s58, v200
  v_mul_f32 v193, s58, v201
  v_mul_f32 v194, s58, v202
  v_mul_f32 v195, s58, v203
  v_cvt_pk_bf16_f32 v208, v192, v193
  v_cvt_pk_bf16_f32 v209, v194, v195
  v_lshlrev_b32 v192, 16, v208
  v_and_b32 v193, 0xffff0000, v208
  v_lshlrev_b32 v194, 16, v209
  v_and_b32 v195, 0xffff0000, v209
  v_mov_b32 v200, 0
  v_mov_b32 v201, 0
  v_mov_b32 v202, 0
  v_mov_b32 v203, 0
  ds_read_b64 v[208:209], v10 offset:1024
  s_waitcnt lgkmcnt(0)
  v_lshlrev_b32 v207, 16, v208
  v_and_b32 v206, 0xffff0000, v208
  v_lshlrev_b32 v205, 16, v209
  v_and_b32 v204, 0xffff0000, v209
  v_mul_f32 v196, s58, v204
  v_mul_f32 v197, s58, v205
  v_mul_f32 v198, s58, v206
  v_mul_f32 v199, s58, v207
  v_cvt_pk_bf16_f32 v208, v196, v197
  v_cvt_pk_bf16_f32 v209, v198, v199
  v_lshlrev_b32 v196, 16, v208
  v_and_b32 v197, 0xffff0000, v208
  v_lshlrev_b32 v198, 16, v209
  v_and_b32 v199, 0xffff0000, v209
  v_mov_b32 v204, 0
  v_mov_b32 v205, 0
  v_mov_b32 v206, 0
  v_mov_b32 v207, 0
  ds_read_b128 v[208:211], v8 offset:0
  ds_read_b128 v[224:227], v9 offset:3008
  ds_read_b128 v[240:243], v9 offset:1984
  ds_read_b128 v[212:215], v8 offset:64
  ds_read_b128 v[228:231], v9 offset:2944
  ds_read_b128 v[244:247], v9 offset:1920
  ds_read_b128 v[216:219], v8 offset:128
  ds_read_b128 v[232:235], v9 offset:2880
  ds_read_b128 v[248:251], v9 offset:1856
  ds_read_b128 v[220:223], v8 offset:192
  ds_read_b128 v[236:239], v9 offset:2816
  ds_read_b128 v[252:255], v9 offset:1792
  s_waitcnt lgkmcnt(9)
  v_mfma_f32_16x16x32_bf16 v[200:203], v[208:211], v[224:227], v[200:203]
  v_mfma_f32_16x16x32_bf16 v[204:207], v[208:211], v[240:243], v[204:207]
  ds_read_b128 v[208:211], v8 offset:256
  ds_read_b128 v[224:227], v9 offset:2752
  ds_read_b128 v[240:243], v9 offset:1728
  s_waitcnt lgkmcnt(9)
  v_mfma_f32_16x16x32_bf16 v[200:203], v[212:215], v[228:231], v[200:203]
  v_mfma_f32_16x16x32_bf16 v[204:207], v[212:215], v[244:247], v[204:207]
  ds_read_b128 v[212:215], v8 offset:320
  ds_read_b128 v[228:231], v9 offset:2688
  ds_read_b128 v[244:247], v9 offset:1664
  s_waitcnt lgkmcnt(9)
  v_mfma_f32_16x16x32_bf16 v[200:203], v[216:219], v[232:235], v[200:203]
  v_mfma_f32_16x16x32_bf16 v[204:207], v[216:219], v[248:251], v[204:207]
  ds_read_b128 v[216:219], v8 offset:384
  ds_read_b128 v[232:235], v9 offset:2624
  ds_read_b128 v[248:251], v9 offset:1600
  s_waitcnt lgkmcnt(9)
  v_mfma_f32_16x16x32_bf16 v[200:203], v[220:223], v[236:239], v[200:203]
  v_mfma_f32_16x16x32_bf16 v[204:207], v[220:223], v[252:255], v[204:207]
  ds_read_b128 v[220:223], v8 offset:448
  ds_read_b128 v[236:239], v9 offset:2560
  ds_read_b128 v[252:255], v9 offset:1536
  s_waitcnt lgkmcnt(9)
  v_mfma_f32_16x16x32_bf16 v[200:203], v[208:211], v[224:227], v[200:203]
  v_mfma_f32_16x16x32_bf16 v[204:207], v[208:211], v[240:243], v[204:207]
  ds_read_b128 v[208:211], v8 offset:512
  ds_read_b128 v[224:227], v9 offset:2496
  ds_read_b128 v[240:243], v9 offset:1472
  s_waitcnt lgkmcnt(9)
  v_mfma_f32_16x16x32_bf16 v[200:203], v[212:215], v[228:231], v[200:203]
  v_mfma_f32_16x16x32_bf16 v[204:207], v[212:215], v[244:247], v[204:207]
  ds_read_b128 v[212:215], v8 offset:576
  ds_read_b128 v[228:231], v9 offset:2432
  ds_read_b128 v[244:247], v9 offset:1408
  s_waitcnt lgkmcnt(9)
  v_mfma_f32_16x16x32_bf16 v[200:203], v[216:219], v[232:235], v[200:203]
  v_mfma_f32_16x16x32_bf16 v[204:207], v[216:219], v[248:251], v[204:207]
  ds_read_b128 v[216:219], v8 offset:640
  ds_read_b128 v[232:235], v9 offset:2368
  ds_read_b128 v[248:251], v9 offset:1344
  s_waitcnt lgkmcnt(9)
  v_mfma_f32_16x16x32_bf16 v[200:203], v[220:223], v[236:239], v[200:203]
  v_mfma_f32_16x16x32_bf16 v[204:207], v[220:223], v[252:255], v[204:207]
  ds_read_b128 v[220:223], v8 offset:704
  ds_read_b128 v[236:239], v9 offset:2304
  ds_read_b128 v[252:255], v9 offset:1280
  s_waitcnt lgkmcnt(9)
  v_mfma_f32_16x16x32_bf16 v[200:203], v[208:211], v[224:227], v[200:203]
  v_mfma_f32_16x16x32_bf16 v[204:207], v[208:211], v[240:243], v[204:207]
  ds_read_b128 v[208:211], v8 offset:768
  ds_read_b128 v[224:227], v9 offset:2240
  ds_read_b128 v[240:243], v9 offset:1216
  s_waitcnt lgkmcnt(9)
  v_mfma_f32_16x16x32_bf16 v[200:203], v[212:215], v[228:231], v[200:203]
  v_mfma_f32_16x16x32_bf16 v[204:207], v[212:215], v[244:247], v[204:207]
  ds_read_b128 v[212:215], v8 offset:832
  ds_read_b128 v[228:231], v9 offset:2176
  ds_read_b128 v[244:247], v9 offset:1152
  s_waitcnt lgkmcnt(9)
  v_mfma_f32_16x16x32_bf16 v[200:203], v[216:219], v[232:235], v[200:203]
  v_mfma_f32_16x16x32_bf16 v[204:207], v[216:219], v[248:251], v[204:207]
  ds_read_b128 v[216:219], v8 offset:896
  ds_read_b128 v[232:235], v9 offset:2112
  ds_read_b128 v[248:251], v9 offset:1088
  s_waitcnt lgkmcnt(9)
  v_mfma_f32_16x16x32_bf16 v[200:203], v[220:223], v[236:239], v[200:203]
  v_mfma_f32_16x16x32_bf16 v[204:207], v[220:223], v[252:255], v[204:207]
  ds_read_b128 v[220:223], v8 offset:960
  ds_read_b128 v[236:239], v9 offset:2048
  ds_read_b128 v[252:255], v9 offset:1024
  s_waitcnt lgkmcnt(9)
  v_mfma_f32_16x16x32_bf16 v[200:203], v[208:211], v[224:227], v[200:203]
  v_mfma_f32_16x16x32_bf16 v[204:207], v[208:211], v[240:243], v[204:207]
  ds_read_b128 v[208:211], v8 offset:1024
  ds_read_b128 v[224:227], v9 offset:1984
  ds_read_b128 v[240:243], v9 offset:960
  s_waitcnt lgkmcnt(9)
  v_mfma_f32_16x16x32_bf16 v[200:203], v[212:215], v[228:231], v[200:203]
  v_mfma_f32_16x16x32_bf16 v[204:207], v[212:215], v[244:247], v[204:207]
  ds_read_b128 v[212:215], v8 offset:1088
  ds_read_b128 v[228:231], v9 offset:1920
  ds_read_b128 v[244:247], v9 offset:896
  s_waitcnt lgkmcnt(9)
  v_mfma_f32_16x16x32_bf16 v[200:203], v[216:219], v[232:235], v[200:203]
  v_mfma_f32_16x16x32_bf16 v[204:207], v[216:219], v[248:251], v[204:207]
  ds_read_b128 v[216:219], v8 offset:1152
  ds_read_b128 v[232:235], v9 offset:1856
  ds_read_b128 v[248:251], v9 offset:832
  s_waitcnt lgkmcnt(9)
  v_mfma_f32_16x16x32_bf16 v[200:203], v[220:223], v[236:239], v[200:203]
  v_mfma_f32_16x16x32_bf16 v[204:207], v[220:223], v[252:255], v[204:207]
  ds_read_b128 v[220:223], v8 offset:1216
  ds_read_b128 v[236:239], v9 offset:1792
  ds_read_b128 v[252:255], v9 offset:768
  s_waitcnt lgkmcnt(9)
  v_mfma_f32_16x16x32_bf16 v[200:203], v[208:211], v[224:227], v[200:203]
  v_mfma_f32_16x16x32_bf16 v[204:207], v[208:211], v[240:243], v[204:207]
  ds_read_b128 v[208:211], v8 offset:1280
  ds_read_b128 v[224:227], v9 offset:1728
  ds_read_b128 v[240:243], v9 offset:704
  s_waitcnt lgkmcnt(9)
  v_mfma_f32_16x16x32_bf16 v[200:203], v[212:215], v[228:231], v[200:203]
  v_mfma_f32_16x16x32_bf16 v[204:207], v[212:215], v[244:247], v[204:207]
  ds_read_b128 v[212:215], v8 offset:1344
  ds_read_b128 v[228:231], v9 offset:1664
  ds_read_b128 v[244:247], v9 offset:640
  s_waitcnt lgkmcnt(9)
  v_mfma_f32_16x16x32_bf16 v[200:203], v[216:219], v[232:235], v[200:203]
  v_mfma_f32_16x16x32_bf16 v[204:207], v[216:219], v[248:251], v[204:207]
  ds_read_b128 v[216:219], v8 offset:1408
  ds_read_b128 v[232:235], v9 offset:1600
  ds_read_b128 v[248:251], v9 offset:576
  s_waitcnt lgkmcnt(9)
  v_mfma_f32_16x16x32_bf16 v[200:203], v[220:223], v[236:239], v[200:203]
  v_mfma_f32_16x16x32_bf16 v[204:207], v[220:223], v[252:255], v[204:207]
  ds_read_b128 v[220:223], v8 offset:1472
  ds_read_b128 v[236:239], v9 offset:1536
  ds_read_b128 v[252:255], v9 offset:512
  s_waitcnt lgkmcnt(9)
  v_mfma_f32_16x16x32_bf16 v[200:203], v[208:211], v[224:227], v[200:203]
  v_mfma_f32_16x16x32_bf16 v[204:207], v[208:211], v[240:243], v[204:207]
  ds_read_b128 v[208:211], v8 offset:1536
  ds_read_b128 v[224:227], v9 offset:1472
  ds_read_b128 v[240:243], v9 offset:448
  s_waitcnt lgkmcnt(9)
  v_mfma_f32_16x16x32_bf16 v[200:203], v[212:215], v[228:231], v[200:203]
  v_mfma_f32_16x16x32_bf16 v[204:207], v[212:215], v[244:247], v[204:207]
  ds_read_b128 v[212:215], v8 offset:1600
  ds_read_b128 v[228:231], v9 offset:1408
  ds_read_b128 v[244:247], v9 offset:384
  s_waitcnt lgkmcnt(9)
  v_mfma_f32_16x16x32_bf16 v[200:203], v[216:219], v[232:235], v[200:203]
  v_mfma_f32_16x16x32_bf16 v[204:207], v[216:219], v[248:251], v[204:207]
  ds_read_b128 v[216:219], v8 offset:1664
  ds_read_b128 v[232:235], v9 offset:1344
  ds_read_b128 v[248:251], v9 offset:320
  s_waitcnt lgkmcnt(9)
  v_mfma_f32_16x16x32_bf16 v[200:203], v[220:223], v[236:239], v[200:203]
  v_mfma_f32_16x16x32_bf16 v[204:207], v[220:223], v[252:255], v[204:207]
  ds_read_b128 v[220:223], v8 offset:1728
  ds_read_b128 v[236:239], v9 offset:1280
  ds_read_b128 v[252:255], v9 offset:256
  s_waitcnt lgkmcnt(9)
  v_mfma_f32_16x16x32_bf16 v[200:203], v[208:211], v[224:227], v[200:203]
  v_mfma_f32_16x16x32_bf16 v[204:207], v[208:211], v[240:243], v[204:207]
  ds_read_b128 v[208:211], v8 offset:1792
  ds_read_b128 v[224:227], v9 offset:1216
  ds_read_b128 v[240:243], v9 offset:192
  s_waitcnt lgkmcnt(9)
  v_mfma_f32_16x16x32_bf16 v[200:203], v[212:215], v[228:231], v[200:203]
  v_mfma_f32_16x16x32_bf16 v[204:207], v[212:215], v[244:247], v[204:207]
  ds_read_b128 v[212:215], v8 offset:1856
  ds_read_b128 v[228:231], v9 offset:1152
  ds_read_b128 v[244:247], v9 offset:128
  s_waitcnt lgkmcnt(9)
  v_mfma_f32_16x16x32_bf16 v[200:203], v[216:219], v[232:235], v[200:203]
  v_mfma_f32_16x16x32_bf16 v[204:207], v[216:219], v[248:251], v[204:207]
  ds_read_b128 v[216:219], v8 offset:1920
  ds_read_b128 v[232:235], v9 offset:1088
  ds_read_b128 v[248:251], v9 offset:64
  s_waitcnt lgkmcnt(9)
  v_mfma_f32_16x16x32_bf16 v[200:203], v[220:223], v[236:239], v[200:203]
  v_mfma_f32_16x16x32_bf16 v[204:207], v[220:223], v[252:255], v[204:207]
  ds_read_b128 v[220:223], v8 offset:1984
  ds_read_b128 v[236:239], v9 offset:1024
  ds_read_b128 v[252:255], v9 offset:0
  s_waitcnt lgkmcnt(9)
  v_mfma_f32_16x16x32_bf16 v[200:203], v[208:211], v[224:227], v[200:203]
  v_mfma_f32_16x16x32_bf16 v[204:207], v[208:211], v[240:243], v[204:207]
  ds_read_b128 v[208:211], v8 offset:2048
  ds_read_b128 v[224:227], v9 offset:960
  s_waitcnt lgkmcnt(8)
  v_mfma_f32_16x16x32_bf16 v[200:203], v[212:215], v[228:231], v[200:203]
  v_mfma_f32_16x16x32_bf16 v[204:207], v[212:215], v[244:247], v[204:207]
  ds_read_b128 v[212:215], v8 offset:2112
  ds_read_b128 v[228:231], v9 offset:896
  s_waitcnt lgkmcnt(7)
  v_mfma_f32_16x16x32_bf16 v[200:203], v[216:219], v[232:235], v[200:203]
  v_mfma_f32_16x16x32_bf16 v[204:207], v[216:219], v[248:251], v[204:207]
  ds_read_b128 v[216:219], v8 offset:2176
  ds_read_b128 v[232:235], v9 offset:832
  s_waitcnt lgkmcnt(6)
  v_mfma_f32_16x16x32_bf16 v[200:203], v[220:223], v[236:239], v[200:203]
  v_mfma_f32_16x16x32_bf16 v[204:207], v[220:223], v[252:255], v[204:207]
  ds_read_b128 v[220:223], v8 offset:2240
  ds_read_b128 v[236:239], v9 offset:768
  s_waitcnt lgkmcnt(6)
  v_mfma_f32_16x16x32_bf16 v[200:203], v[208:211], v[224:227], v[200:203]
  ds_read_b128 v[208:211], v8 offset:2304
  ds_read_b128 v[224:227], v9 offset:704
  s_waitcnt lgkmcnt(6)
  v_mfma_f32_16x16x32_bf16 v[200:203], v[212:215], v[228:231], v[200:203]
  ds_read_b128 v[212:215], v8 offset:2368
  ds_read_b128 v[228:231], v9 offset:640
  s_waitcnt lgkmcnt(6)
  v_mfma_f32_16x16x32_bf16 v[200:203], v[216:219], v[232:235], v[200:203]
  ds_read_b128 v[216:219], v8 offset:2432
  ds_read_b128 v[232:235], v9 offset:576
  s_waitcnt lgkmcnt(6)
  v_mfma_f32_16x16x32_bf16 v[200:203], v[220:223], v[236:239], v[200:203]
  ds_read_b128 v[220:223], v8 offset:2496
  ds_read_b128 v[236:239], v9 offset:512
  s_waitcnt lgkmcnt(6)
  v_mfma_f32_16x16x32_bf16 v[200:203], v[208:211], v[224:227], v[200:203]
  ds_read_b128 v[208:211], v8 offset:2560
  ds_read_b128 v[224:227], v9 offset:448
  s_waitcnt lgkmcnt(6)
  v_mfma_f32_16x16x32_bf16 v[200:203], v[212:215], v[228:231], v[200:203]
  ds_read_b128 v[212:215], v8 offset:2624
  ds_read_b128 v[228:231], v9 offset:384
  s_waitcnt lgkmcnt(6)
  v_mfma_f32_16x16x32_bf16 v[200:203], v[216:219], v[232:235], v[200:203]
  ds_read_b128 v[216:219], v8 offset:2688
  ds_read_b128 v[232:235], v9 offset:320
  s_waitcnt lgkmcnt(6)
  v_mfma_f32_16x16x32_bf16 v[200:203], v[220:223], v[236:239], v[200:203]
  ds_read_b128 v[220:223], v8 offset:2752
  ds_read_b128 v[236:239], v9 offset:256
  s_waitcnt lgkmcnt(6)
  v_mfma_f32_16x16x32_bf16 v[200:203], v[208:211], v[224:227], v[200:203]
  ds_read_b128 v[208:211], v8 offset:2816
  ds_read_b128 v[224:227], v9 offset:192
  s_waitcnt lgkmcnt(6)
  v_mfma_f32_16x16x32_bf16 v[200:203], v[212:215], v[228:231], v[200:203]
  ds_read_b128 v[212:215], v8 offset:2880
  ds_read_b128 v[228:231], v9 offset:128
  s_waitcnt lgkmcnt(6)
  v_mfma_f32_16x16x32_bf16 v[200:203], v[216:219], v[232:235], v[200:203]
  ds_read_b128 v[216:219], v8 offset:2944
  ds_read_b128 v[232:235], v9 offset:64
  s_waitcnt lgkmcnt(6)
  v_mfma_f32_16x16x32_bf16 v[200:203], v[220:223], v[236:239], v[200:203]
  ds_read_b128 v[220:223], v8 offset:3008
  ds_read_b128 v[236:239], v9 offset:0
  s_waitcnt lgkmcnt(6)
  v_mfma_f32_16x16x32_bf16 v[200:203], v[208:211], v[224:227], v[200:203]
  s_waitcnt lgkmcnt(4)
  v_mfma_f32_16x16x32_bf16 v[200:203], v[212:215], v[228:231], v[200:203]
  s_waitcnt lgkmcnt(2)
  v_mfma_f32_16x16x32_bf16 v[200:203], v[216:219], v[232:235], v[200:203]
  s_waitcnt lgkmcnt(0)
  v_mfma_f32_16x16x32_bf16 v[200:203], v[220:223], v[236:239], v[200:203]
  v_mov_b32 v14, 2048
  v_mov_b32 v15, 1024
  s_nop 5
L_w2jF:
  s_nop 7
  v_cvt_pk_bf16_f32 v208, v200, v201
  v_cvt_pk_bf16_f32 v209, v202, v203
  v_lshlrev_b32 v200, 16, v208
  v_and_b32 v201, 0xffff0000, v208
  v_lshlrev_b32 v202, 16, v209
  v_and_b32 v203, 0xffff0000, v209
  v_add_f32 v200, v200, v192
  v_add_f32 v201, v201, v193
  v_add_f32 v202, v202, v194
  v_add_f32 v203, v203, v195
  v_cvt_pk_bf16_f32 v208, v204, v205
  v_cvt_pk_bf16_f32 v209, v206, v207
  v_lshlrev_b32 v204, 16, v208
  v_and_b32 v205, 0xffff0000, v208
  v_lshlrev_b32 v206, 16, v209
  v_and_b32 v207, 0xffff0000, v209
  v_add_f32 v204, v204, v196
  v_add_f32 v205, v205, v197
  v_add_f32 v206, v206, v198
  v_add_f32 v207, v207, v199
  v_cvt_pk_bf16_f32 v208, v203, v202
  v_cvt_pk_bf16_f32 v209, v201, v200
  v_cvt_pk_bf16_f32 v210, v207, v206
  v_cvt_pk_bf16_f32 v211, v205, v204
  v_add_u32 v14, v14, v10
  v_add_u32 v15, v15, v10
  s_barrier
  ds_write_b64 v14, v[208:209]
  ds_write_b64 v15, v[210:211]
  v_add_u32 v9, 5184, v9
  v_add_u32 v10, 5184, v10
  s_cmp_lt_u32 s30, 16
  s_nop 0
  s_cbranch_scc1 L_w2chF
  s_waitcnt lgkmcnt(0)
  s_barrier
  v_bfe_u32 v4, v0, 2, 2
  v_mul_u32_u24 v4, 5184, v4
  v_and_b32 v5, 3, v0
  v_lshlrev_b32 v5, 3, v5
  v_lshrrev_b32 v6, 4, v0
  v_lshlrev_b32 v6, 5, v6
  v_add3_u32 v4, v4, v5, v6
  s_lshl_b32 s32, s28, 7
  s_add_u32 s32, s32, 1024
  v_add_u32 v4, s32, v4
  v_lshrrev_b32 v5, 5, v0
  v_lshlrev_b32 v5, 5, v5
  v_and_b32 v6, 31, v0
  v_sub_u32 v6, 31, v6
  v_add_u32 v5, v5, v6
  s_lshl_b32 s32, s28, 6
  v_add_u32 v5, s32, v5
  v_lshlrev_b32 v6, 10, v5
  s_lshl_b32 s32, s29, 5
  v_add_u32 v6, s32, v6
  v_lshlrev_b32 v7, 11, v5
  v_add_u32 v7, s32, v7
  ds_read_b64_tr_b16 v[32:33], v4 offset:0
  ds_read_b64_tr_b16 v[34:35], v4 offset:20736
  ds_read_b64_tr_b16 v[36:37], v4 offset:41472
  ds_read_b64_tr_b16 v[38:39], v4 offset:62208
  buffer_load_dwordx4 v[40:43], v6, s[16:19], 0 offen
  buffer_load_dwordx4 v[44:47], v6, s[16:19], 0 offen offset:16
  s_waitcnt vmcnt(0) lgkmcnt(0)
  v_lshlrev_b32 v48, 16, v32
  v_and_b32 v49, 0xffff0000, v32
  v_lshlrev_b32 v64, 16, v40
  v_and_b32 v65, 0xffff0000, v40
  v_lshlrev_b32 v50, 16, v33
  v_and_b32 v51, 0xffff0000, v33
  v_lshlrev_b32 v66, 16, v41
  v_and_b32 v67, 0xffff0000, v41
  v_lshlrev_b32 v52, 16, v34
  v_and_b32 v53, 0xffff0000, v34
  v_lshlrev_b32 v68, 16, v42
  v_and_b32 v69, 0xffff0000, v42
  v_lshlrev_b32 v54, 16, v35
  v_and_b32 v55, 0xffff0000, v35
  v_lshlrev_b32 v70, 16, v43
  v_and_b32 v71, 0xffff0000, v43
  v_lshlrev_b32 v56, 16, v36
  v_and_b32 v57, 0xffff0000, v36
  v_lshlrev_b32 v72, 16, v44
  v_and_b32 v73, 0xffff0000, v44
  v_lshlrev_b32 v58, 16, v37
  v_and_b32 v59, 0xffff0000, v37
  v_lshlrev_b32 v74, 16, v45
  v_and_b32 v75, 0xffff0000, v45
  v_lshlrev_b32 v60, 16, v38
  v_and_b32 v61, 0xffff0000, v38
  v_lshlrev_b32 v76, 16, v46
  v_and_b32 v77, 0xffff0000, v46
  v_lshlrev_b32 v62, 16, v39
  v_and_b32 v63, 0xffff0000, v39
  v_lshlrev_b32 v78, 16, v47
  v_and_b32 v79, 0xffff0000, v47
  v_mul_f32 v48, v48, v64
  v_mul_f32 v49, v49, v65
  v_mul_f32 v50, v50, v66
  v_mul_f32 v51, v51, v67
  v_mul_f32 v52, v52, v68
  v_mul_f32 v53, v53, v69
  v_mul_f32 v54, v54, v70
  v_mul_f32 v55, v55, v71
  v_mul_f32 v56, v56, v72
  v_mul_f32 v57, v57, v73
  v_mul_f32 v58, v58, v74
  v_mul_f32 v59, v59, v75
  v_mul_f32 v60, v60, v76
  v_mul_f32 v61, v61, v77
  v_mul_f32 v62, v62, v78
  v_mul_f32 v63, v63, v79
  v_cvt_pk_bf16_f32 v80, v48, v49
  v_cvt_pk_bf16_f32 v81, v50, v51
  v_cvt_pk_bf16_f32 v82, v52, v53
  v_cvt_pk_bf16_f32 v83, v54, v55
  v_cvt_pk_bf16_f32 v84, v56, v57
  v_cvt_pk_bf16_f32 v85, v58, v59
  v_cvt_pk_bf16_f32 v86, v60, v61
  v_cvt_pk_bf16_f32 v87, v62, v63
  buffer_store_dwordx4 v[80:83], v7, s[24:27], 0 offen
  buffer_store_dwordx4 v[84:87], v7, s[24:27], 0 offen offset:16
  v_add_u32 v6, 262144, v6
  v_add_u32 v4, 512, v4
  s_nop 1
  v_add_u32 v7, 524288, v7
  s_nop 1
  ds_read_b64_tr_b16 v[32:33], v4 offset:0
  ds_read_b64_tr_b16 v[34:35], v4 offset:20736
  ds_read_b64_tr_b16 v[36:37], v4 offset:41472
  ds_read_b64_tr_b16 v[38:39], v4 offset:62208
  buffer_load_dwordx4 v[40:43], v6, s[16:19], 0 offen
  buffer_load_dwordx4 v[44:47], v6, s[16:19], 0 offen offset:16
  s_waitcnt vmcnt(0) lgkmcnt(0)
  v_lshlrev_b32 v48, 16, v32
  v_and_b32 v49, 0xffff0000, v32
  v_lshlrev_b32 v64, 16, v40
  v_and_b32 v65, 0xffff0000, v40
  v_lshlrev_b32 v50, 16, v33
  v_and_b32 v51, 0xffff0000, v33
  v_lshlrev_b32 v66, 16, v41
  v_and_b32 v67, 0xffff0000, v41
  v_lshlrev_b32 v52, 16, v34
  v_and_b32 v53, 0xffff0000, v34
  v_lshlrev_b32 v68, 16, v42
  v_and_b32 v69, 0xffff0000, v42
  v_lshlrev_b32 v54, 16, v35
  v_and_b32 v55, 0xffff0000, v35
  v_lshlrev_b32 v70, 16, v43
  v_and_b32 v71, 0xffff0000, v43
  v_lshlrev_b32 v56, 16, v36
  v_and_b32 v57, 0xffff0000, v36
  v_lshlrev_b32 v72, 16, v44
  v_and_b32 v73, 0xffff0000, v44
  v_lshlrev_b32 v58, 16, v37
  v_and_b32 v59, 0xffff0000, v37
  v_lshlrev_b32 v74, 16, v45
  v_and_b32 v75, 0xffff0000, v45
  v_lshlrev_b32 v60, 16, v38
  v_and_b32 v61, 0xffff0000, v38
  v_lshlrev_b32 v76, 16, v46
  v_and_b32 v77, 0xffff0000, v46
  v_lshlrev_b32 v62, 16, v39
  v_and_b32 v63, 0xffff0000, v39
  v_lshlrev_b32 v78, 16, v47
  v_and_b32 v79, 0xffff0000, v47
  v_mul_f32 v48, v48, v64
  v_mul_f32 v49, v49, v65
  v_mul_f32 v50, v50, v66
  v_mul_f32 v51, v51, v67
  v_mul_f32 v52, v52, v68
  v_mul_f32 v53, v53, v69
  v_mul_f32 v54, v54, v70
  v_mul_f32 v55, v55, v71
  v_mul_f32 v56, v56, v72
  v_mul_f32 v57, v57, v73
  v_mul_f32 v58, v58, v74
  v_mul_f32 v59, v59, v75
  v_mul_f32 v60, v60, v76
  v_mul_f32 v61, v61, v77
  v_mul_f32 v62, v62, v78
  v_mul_f32 v63, v63, v79
  v_cvt_pk_bf16_f32 v80, v48, v49
  v_cvt_pk_bf16_f32 v81, v50, v51
  v_cvt_pk_bf16_f32 v82, v52, v53
  v_cvt_pk_bf16_f32 v83, v54, v55
  v_cvt_pk_bf16_f32 v84, v56, v57
  v_cvt_pk_bf16_f32 v85, v58, v59
  v_cvt_pk_bf16_f32 v86, v60, v61
  v_cvt_pk_bf16_f32 v87, v62, v63
  buffer_store_dwordx4 v[80:83], v7, s[24:27], 0 offen
  buffer_store_dwordx4 v[84:87], v7, s[24:27], 0 offen offset:16
  v_add_u32 v6, 262144, v6
  v_add_u32 v4, 512, v4
  s_nop 1
  v_add_u32 v7, 524288, v7
  s_nop 1
  ds_read_b64_tr_b16 v[32:33], v4 offset:0
  ds_read_b64_tr_b16 v[34:35], v4 offset:20736
  ds_read_b64_tr_b16 v[36:37], v4 offset:41472
  ds_read_b64_tr_b16 v[38:39], v4 offset:62208
  buffer_load_dwordx4 v[40:43], v6, s[16:19], 0 offen
  buffer_load_dwordx4 v[44:47], v6, s[16:19], 0 offen offset:16
  s_waitcnt vmcnt(0) lgkmcnt(0)
  v_lshlrev_b32 v48, 16, v32
  v_and_b32 v49, 0xffff0000, v32
  v_lshlrev_b32 v64, 16, v40
  v_and_b32 v65, 0xffff0000, v40
  v_lshlrev_b32 v50, 16, v33
  v_and_b32 v51, 0xffff0000, v33
  v_lshlrev_b32 v66, 16, v41
  v_and_b32 v67, 0xffff0000, v41
  v_lshlrev_b32 v52, 16, v34
  v_and_b32 v53, 0xffff0000, v34
  v_lshlrev_b32 v68, 16, v42
  v_and_b32 v69, 0xffff0000, v42
  v_lshlrev_b32 v54, 16, v35
  v_and_b32 v55, 0xffff0000, v35
  v_lshlrev_b32 v70, 16, v43
  v_and_b32 v71, 0xffff0000, v43
  v_lshlrev_b32 v56, 16, v36
  v_and_b32 v57, 0xffff0000, v36
  v_lshlrev_b32 v72, 16, v44
  v_and_b32 v73, 0xffff0000, v44
  v_lshlrev_b32 v58, 16, v37
  v_and_b32 v59, 0xffff0000, v37
  v_lshlrev_b32 v74, 16, v45
  v_and_b32 v75, 0xffff0000, v45
  v_lshlrev_b32 v60, 16, v38
  v_and_b32 v61, 0xffff0000, v38
  v_lshlrev_b32 v76, 16, v46
  v_and_b32 v77, 0xffff0000, v46
  v_lshlrev_b32 v62, 16, v39
  v_and_b32 v63, 0xffff0000, v39
  v_lshlrev_b32 v78, 16, v47
  v_and_b32 v79, 0xffff0000, v47
  v_mul_f32 v48, v48, v64
  v_mul_f32 v49, v49, v65
  v_mul_f32 v50, v50, v66
  v_mul_f32 v51, v51, v67
  v_mul_f32 v52, v52, v68
  v_mul_f32 v53, v53, v69
  v_mul_f32 v54, v54, v70
  v_mul_f32 v55, v55, v71
  v_mul_f32 v56, v56, v72
  v_mul_f32 v57, v57, v73
  v_mul_f32 v58, v58, v74
  v_mul_f32 v59, v59, v75
  v_mul_f32 v60, v60, v76
  v_mul_f32 v61, v61, v77
  v_mul_f32 v62, v62, v78
  v_mul_f32 v63, v63, v79
  v_cvt_pk_bf16_f32 v80, v48, v49
  v_cvt_pk_bf16_f32 v81, v50, v51
  v_cvt_pk_bf16_f32 v82, v52, v53
  v_cvt_pk_bf16_f32 v83, v54, v55
  v_cvt_pk_bf16_f32 v84, v56, v57
  v_cvt_pk_bf16_f32 v85, v58, v59
  v_cvt_pk_bf16_f32 v86, v60, v61
  v_cvt_pk_bf16_f32 v87, v62, v63
  buffer_store_dwordx4 v[80:83], v7, s[24:27], 0 offen
  buffer_store_dwordx4 v[84:87], v7, s[24:27], 0 offen offset:16
  v_add_u32 v6, 262144, v6
  v_add_u32 v4, 512, v4
  s_nop 1
  v_add_u32 v7, 524288, v7
  s_nop 1
  ds_read_b64_tr_b16 v[32:33], v4 offset:0
  ds_read_b64_tr_b16 v[34:35], v4 offset:20736
  ds_read_b64_tr_b16 v[36:37], v4 offset:41472
  ds_read_b64_tr_b16 v[38:39], v4 offset:62208
  buffer_load_dwordx4 v[40:43], v6, s[16:19], 0 offen
  buffer_load_dwordx4 v[44:47], v6, s[16:19], 0 offen offset:16
  s_waitcnt vmcnt(0) lgkmcnt(0)
  v_lshlrev_b32 v48, 16, v32
  v_and_b32 v49, 0xffff0000, v32
  v_lshlrev_b32 v64, 16, v40
  v_and_b32 v65, 0xffff0000, v40
  v_lshlrev_b32 v50, 16, v33
  v_and_b32 v51, 0xffff0000, v33
  v_lshlrev_b32 v66, 16, v41
  v_and_b32 v67, 0xffff0000, v41
  v_lshlrev_b32 v52, 16, v34
  v_and_b32 v53, 0xffff0000, v34
  v_lshlrev_b32 v68, 16, v42
  v_and_b32 v69, 0xffff0000, v42
  v_lshlrev_b32 v54, 16, v35
  v_and_b32 v55, 0xffff0000, v35
  v_lshlrev_b32 v70, 16, v43
  v_and_b32 v71, 0xffff0000, v43
  v_lshlrev_b32 v56, 16, v36
  v_and_b32 v57, 0xffff0000, v36
  v_lshlrev_b32 v72, 16, v44
  v_and_b32 v73, 0xffff0000, v44
  v_lshlrev_b32 v58, 16, v37
  v_and_b32 v59, 0xffff0000, v37
  v_lshlrev_b32 v74, 16, v45
  v_and_b32 v75, 0xffff0000, v45
  v_lshlrev_b32 v60, 16, v38
  v_and_b32 v61, 0xffff0000, v38
  v_lshlrev_b32 v76, 16, v46
  v_and_b32 v77, 0xffff0000, v46
  v_lshlrev_b32 v62, 16, v39
  v_and_b32 v63, 0xffff0000, v39
  v_lshlrev_b32 v78, 16, v47
  v_and_b32 v79, 0xffff0000, v47
  v_mul_f32 v48, v48, v64
  v_mul_f32 v49, v49, v65
  v_mul_f32 v50, v50, v66
  v_mul_f32 v51, v51, v67
  v_mul_f32 v52, v52, v68
  v_mul_f32 v53, v53, v69
  v_mul_f32 v54, v54, v70
  v_mul_f32 v55, v55, v71
  v_mul_f32 v56, v56, v72
  v_mul_f32 v57, v57, v73
  v_mul_f32 v58, v58, v74
  v_mul_f32 v59, v59, v75
  v_mul_f32 v60, v60, v76
  v_mul_f32 v61, v61, v77
  v_mul_f32 v62, v62, v78
  v_mul_f32 v63, v63, v79
  v_cvt_pk_bf16_f32 v80, v48, v49
  v_cvt_pk_bf16_f32 v81, v50, v51
  v_cvt_pk_bf16_f32 v82, v52, v53
  v_cvt_pk_bf16_f32 v83, v54, v55
  v_cvt_pk_bf16_f32 v84, v56, v57
  v_cvt_pk_bf16_f32 v85, v58, v59
  v_cvt_pk_bf16_f32 v86, v60, v61
  v_cvt_pk_bf16_f32 v87, v62, v63
  buffer_store_dwordx4 v[80:83], v7, s[24:27], 0 offen
  buffer_store_dwordx4 v[84:87], v7, s[24:27], 0 offen offset:16
  v_add_u32 v6, 262144, v6
  v_add_u32 v4, 512, v4
  s_nop 1
  v_add_u32 v7, 524288, v7
  s_nop 1
  ds_read_b64_tr_b16 v[32:33], v4 offset:0
  ds_read_b64_tr_b16 v[34:35], v4 offset:20736
  ds_read_b64_tr_b16 v[36:37], v4 offset:41472
  ds_read_b64_tr_b16 v[38:39], v4 offset:62208
  buffer_load_dwordx4 v[40:43], v6, s[16:19], 0 offen
  buffer_load_dwordx4 v[44:47], v6, s[16:19], 0 offen offset:16
  s_waitcnt vmcnt(0) lgkmcnt(0)
  v_lshlrev_b32 v48, 16, v32
  v_and_b32 v49, 0xffff0000, v32
  v_lshlrev_b32 v64, 16, v40
  v_and_b32 v65, 0xffff0000, v40
  v_lshlrev_b32 v50, 16, v33
  v_and_b32 v51, 0xffff0000, v33
  v_lshlrev_b32 v66, 16, v41
  v_and_b32 v67, 0xffff0000, v41
  v_lshlrev_b32 v52, 16, v34
  v_and_b32 v53, 0xffff0000, v34
  v_lshlrev_b32 v68, 16, v42
  v_and_b32 v69, 0xffff0000, v42
  v_lshlrev_b32 v54, 16, v35
  v_and_b32 v55, 0xffff0000, v35
  v_lshlrev_b32 v70, 16, v43
  v_and_b32 v71, 0xffff0000, v43
  v_lshlrev_b32 v56, 16, v36
  v_and_b32 v57, 0xffff0000, v36
  v_lshlrev_b32 v72, 16, v44
  v_and_b32 v73, 0xffff0000, v44
  v_lshlrev_b32 v58, 16, v37
  v_and_b32 v59, 0xffff0000, v37
  v_lshlrev_b32 v74, 16, v45
  v_and_b32 v75, 0xffff0000, v45
  v_lshlrev_b32 v60, 16, v38
  v_and_b32 v61, 0xffff0000, v38
  v_lshlrev_b32 v76, 16, v46
  v_and_b32 v77, 0xffff0000, v46
  v_lshlrev_b32 v62, 16, v39
  v_and_b32 v63, 0xffff0000, v39
  v_lshlrev_b32 v78, 16, v47
  v_and_b32 v79, 0xffff0000, v47
  v_mul_f32 v48, v48, v64
  v_mul_f32 v49, v49, v65
  v_mul_f32 v50, v50, v66
  v_mul_f32 v51, v51, v67
  v_mul_f32 v52, v52, v68
  v_mul_f32 v53, v53, v69
  v_mul_f32 v54, v54, v70
  v_mul_f32 v55, v55, v71
  v_mul_f32 v56, v56, v72
  v_mul_f32 v57, v57, v73
  v_mul_f32 v58, v58, v74
  v_mul_f32 v59, v59, v75
  v_mul_f32 v60, v60, v76
  v_mul_f32 v61, v61, v77
  v_mul_f32 v62, v62, v78
  v_mul_f32 v63, v63, v79
  v_cvt_pk_bf16_f32 v80, v48, v49
  v_cvt_pk_bf16_f32 v81, v50, v51
  v_cvt_pk_bf16_f32 v82, v52, v53
  v_cvt_pk_bf16_f32 v83, v54, v55
  v_cvt_pk_bf16_f32 v84, v56, v57
  v_cvt_pk_bf16_f32 v85, v58, v59
  v_cvt_pk_bf16_f32 v86, v60, v61
  v_cvt_pk_bf16_f32 v87, v62, v63
  buffer_store_dwordx4 v[80:83], v7, s[24:27], 0 offen
  buffer_store_dwordx4 v[84:87], v7, s[24:27], 0 offen offset:16
  v_add_u32 v6, 262144, v6
  v_add_u32 v4, 512, v4
  s_nop 1
  v_add_u32 v7, 524288, v7
  s_nop 1
  ds_read_b64_tr_b16 v[32:33], v4 offset:0
  ds_read_b64_tr_b16 v[34:35], v4 offset:20736
  ds_read_b64_tr_b16 v[36:37], v4 offset:41472
  ds_read_b64_tr_b16 v[38:39], v4 offset:62208
  buffer_load_dwordx4 v[40:43], v6, s[16:19], 0 offen
  buffer_load_dwordx4 v[44:47], v6, s[16:19], 0 offen offset:16
  s_waitcnt vmcnt(0) lgkmcnt(0)
  v_lshlrev_b32 v48, 16, v32
  v_and_b32 v49, 0xffff0000, v32
  v_lshlrev_b32 v64, 16, v40
  v_and_b32 v65, 0xffff0000, v40
  v_lshlrev_b32 v50, 16, v33
  v_and_b32 v51, 0xffff0000, v33
  v_lshlrev_b32 v66, 16, v41
  v_and_b32 v67, 0xffff0000, v41
  v_lshlrev_b32 v52, 16, v34
  v_and_b32 v53, 0xffff0000, v34
  v_lshlrev_b32 v68, 16, v42
  v_and_b32 v69, 0xffff0000, v42
  v_lshlrev_b32 v54, 16, v35
  v_and_b32 v55, 0xffff0000, v35
  v_lshlrev_b32 v70, 16, v43
  v_and_b32 v71, 0xffff0000, v43
  v_lshlrev_b32 v56, 16, v36
  v_and_b32 v57, 0xffff0000, v36
  v_lshlrev_b32 v72, 16, v44
  v_and_b32 v73, 0xffff0000, v44
  v_lshlrev_b32 v58, 16, v37
  v_and_b32 v59, 0xffff0000, v37
  v_lshlrev_b32 v74, 16, v45
  v_and_b32 v75, 0xffff0000, v45
  v_lshlrev_b32 v60, 16, v38
  v_and_b32 v61, 0xffff0000, v38
  v_lshlrev_b32 v76, 16, v46
  v_and_b32 v77, 0xffff0000, v46
  v_lshlrev_b32 v62, 16, v39
  v_and_b32 v63, 0xffff0000, v39
  v_lshlrev_b32 v78, 16, v47
  v_and_b32 v79, 0xffff0000, v47
  v_mul_f32 v48, v48, v64
  v_mul_f32 v49, v49, v65
  v_mul_f32 v50, v50, v66
  v_mul_f32 v51, v51, v67
  v_mul_f32 v52, v52, v68
  v_mul_f32 v53, v53, v69
  v_mul_f32 v54, v54, v70
  v_mul_f32 v55, v55, v71
  v_mul_f32 v56, v56, v72
  v_mul_f32 v57, v57, v73
  v_mul_f32 v58, v58, v74
  v_mul_f32 v59, v59, v75
  v_mul_f32 v60, v60, v76
  v_mul_f32 v61, v61, v77
  v_mul_f32 v62, v62, v78
  v_mul_f32 v63, v63, v79
  v_cvt_pk_bf16_f32 v80, v48, v49
  v_cvt_pk_bf16_f32 v81, v50, v51
  v_cvt_pk_bf16_f32 v82, v52, v53
  v_cvt_pk_bf16_f32 v83, v54, v55
  v_cvt_pk_bf16_f32 v84, v56, v57
  v_cvt_pk_bf16_f32 v85, v58, v59
  v_cvt_pk_bf16_f32 v86, v60, v61
  v_cvt_pk_bf16_f32 v87, v62, v63
  buffer_store_dwordx4 v[80:83], v7, s[24:27], 0 offen
  buffer_store_dwordx4 v[84:87], v7, s[24:27], 0 offen offset:16
  v_add_u32 v6, 262144, v6
  v_add_u32 v4, 512, v4
  s_nop 1
  v_add_u32 v7, 524288, v7
  s_nop 1
  ds_read_b64_tr_b16 v[32:33], v4 offset:0
  ds_read_b64_tr_b16 v[34:35], v4 offset:20736
  ds_read_b64_tr_b16 v[36:37], v4 offset:41472
  ds_read_b64_tr_b16 v[38:39], v4 offset:62208
  buffer_load_dwordx4 v[40:43], v6, s[16:19], 0 offen
  buffer_load_dwordx4 v[44:47], v6, s[16:19], 0 offen offset:16
  s_waitcnt vmcnt(0) lgkmcnt(0)
  v_lshlrev_b32 v48, 16, v32
  v_and_b32 v49, 0xffff0000, v32
  v_lshlrev_b32 v64, 16, v40
  v_and_b32 v65, 0xffff0000, v40
  v_lshlrev_b32 v50, 16, v33
  v_and_b32 v51, 0xffff0000, v33
  v_lshlrev_b32 v66, 16, v41
  v_and_b32 v67, 0xffff0000, v41
  v_lshlrev_b32 v52, 16, v34
  v_and_b32 v53, 0xffff0000, v34
  v_lshlrev_b32 v68, 16, v42
  v_and_b32 v69, 0xffff0000, v42
  v_lshlrev_b32 v54, 16, v35
  v_and_b32 v55, 0xffff0000, v35
  v_lshlrev_b32 v70, 16, v43
  v_and_b32 v71, 0xffff0000, v43
  v_lshlrev_b32 v56, 16, v36
  v_and_b32 v57, 0xffff0000, v36
  v_lshlrev_b32 v72, 16, v44
  v_and_b32 v73, 0xffff0000, v44
  v_lshlrev_b32 v58, 16, v37
  v_and_b32 v59, 0xffff0000, v37
  v_lshlrev_b32 v74, 16, v45
  v_and_b32 v75, 0xffff0000, v45
  v_lshlrev_b32 v60, 16, v38
  v_and_b32 v61, 0xffff0000, v38
  v_lshlrev_b32 v76, 16, v46
  v_and_b32 v77, 0xffff0000, v46
  v_lshlrev_b32 v62, 16, v39
  v_and_b32 v63, 0xffff0000, v39
  v_lshlrev_b32 v78, 16, v47
  v_and_b32 v79, 0xffff0000, v47
  v_mul_f32 v48, v48, v64
  v_mul_f32 v49, v49, v65
  v_mul_f32 v50, v50, v66
  v_mul_f32 v51, v51, v67
  v_mul_f32 v52, v52, v68
  v_mul_f32 v53, v53, v69
  v_mul_f32 v54, v54, v70
  v_mul_f32 v55, v55, v71
  v_mul_f32 v56, v56, v72
  v_mul_f32 v57, v57, v73
  v_mul_f32 v58, v58, v74
  v_mul_f32 v59, v59, v75
  v_mul_f32 v60, v60, v76
  v_mul_f32 v61, v61, v77
  v_mul_f32 v62, v62, v78
  v_mul_f32 v63, v63, v79
  v_cvt_pk_bf16_f32 v80, v48, v49
  v_cvt_pk_bf16_f32 v81, v50, v51
  v_cvt_pk_bf16_f32 v82, v52, v53
  v_cvt_pk_bf16_f32 v83, v54, v55
  v_cvt_pk_bf16_f32 v84, v56, v57
  v_cvt_pk_bf16_f32 v85, v58, v59
  v_cvt_pk_bf16_f32 v86, v60, v61
  v_cvt_pk_bf16_f32 v87, v62, v63
  buffer_store_dwordx4 v[80:83], v7, s[24:27], 0 offen
  buffer_store_dwordx4 v[84:87], v7, s[24:27], 0 offen offset:16
  v_add_u32 v6, 262144, v6
  v_add_u32 v4, 512, v4
  s_nop 1
  v_add_u32 v7, 524288, v7
  s_nop 1
  ds_read_b64_tr_b16 v[32:33], v4 offset:0
  ds_read_b64_tr_b16 v[34:35], v4 offset:20736
  ds_read_b64_tr_b16 v[36:37], v4 offset:41472
  ds_read_b64_tr_b16 v[38:39], v4 offset:62208
  buffer_load_dwordx4 v[40:43], v6, s[16:19], 0 offen
  buffer_load_dwordx4 v[44:47], v6, s[16:19], 0 offen offset:16
  s_waitcnt vmcnt(0) lgkmcnt(0)
  v_lshlrev_b32 v48, 16, v32
  v_and_b32 v49, 0xffff0000, v32
  v_lshlrev_b32 v64, 16, v40
  v_and_b32 v65, 0xffff0000, v40
  v_lshlrev_b32 v50, 16, v33
  v_and_b32 v51, 0xffff0000, v33
  v_lshlrev_b32 v66, 16, v41
  v_and_b32 v67, 0xffff0000, v41
  v_lshlrev_b32 v52, 16, v34
  v_and_b32 v53, 0xffff0000, v34
  v_lshlrev_b32 v68, 16, v42
  v_and_b32 v69, 0xffff0000, v42
  v_lshlrev_b32 v54, 16, v35
  v_and_b32 v55, 0xffff0000, v35
  v_lshlrev_b32 v70, 16, v43
  v_and_b32 v71, 0xffff0000, v43
  v_lshlrev_b32 v56, 16, v36
  v_and_b32 v57, 0xffff0000, v36
  v_lshlrev_b32 v72, 16, v44
  v_and_b32 v73, 0xffff0000, v44
  v_lshlrev_b32 v58, 16, v37
  v_and_b32 v59, 0xffff0000, v37
  v_lshlrev_b32 v74, 16, v45
  v_and_b32 v75, 0xffff0000, v45
  v_lshlrev_b32 v60, 16, v38
  v_and_b32 v61, 0xffff0000, v38
  v_lshlrev_b32 v76, 16, v46
  v_and_b32 v77, 0xffff0000, v46
  v_lshlrev_b32 v62, 16, v39
  v_and_b32 v63, 0xffff0000, v39
  v_lshlrev_b32 v78, 16, v47
  v_and_b32 v79, 0xffff0000, v47
  v_mul_f32 v48, v48, v64
  v_mul_f32 v49, v49, v65
  v_mul_f32 v50, v50, v66
  v_mul_f32 v51, v51, v67
  v_mul_f32 v52, v52, v68
  v_mul_f32 v53, v53, v69
  v_mul_f32 v54, v54, v70
  v_mul_f32 v55, v55, v71
  v_mul_f32 v56, v56, v72
  v_mul_f32 v57, v57, v73
  v_mul_f32 v58, v58, v74
  v_mul_f32 v59, v59, v75
  v_mul_f32 v60, v60, v76
  v_mul_f32 v61, v61, v77
  v_mul_f32 v62, v62, v78
  v_mul_f32 v63, v63, v79
  v_cvt_pk_bf16_f32 v80, v48, v49
  v_cvt_pk_bf16_f32 v81, v50, v51
  v_cvt_pk_bf16_f32 v82, v52, v53
  v_cvt_pk_bf16_f32 v83, v54, v55
  v_cvt_pk_bf16_f32 v84, v56, v57
  v_cvt_pk_bf16_f32 v85, v58, v59
  v_cvt_pk_bf16_f32 v86, v60, v61
  v_cvt_pk_bf16_f32 v87, v62, v63
  buffer_store_dwordx4 v[80:83], v7, s[24:27], 0 offen
  buffer_store_dwordx4 v[84:87], v7, s[24:27], 0 offen offset:16
  v_add_u32 v6, 262144, v6
  v_add_u32 v4, 512, v4
  s_nop 1
  v_add_u32 v7, 524288, v7
  s_nop 1
  s_branch L_endF
L_w4role:
  s_and_b32 s29, s91, 7
  s_cmp_lt_u32 s91, 8
  s_cselect_b32 s30, s90, 7
  s_barrier
  v_mov_b32 v9, 16
  s_nop 1
L_wiw4:
  global_load_dword v10, v9, s[6:7] sc1
  s_waitcnt vmcnt(0)
  v_cmp_gt_u32 vcc, 256, v10
  s_nop 4
  s_cbranch_vccz L_widw4
  s_sleep 8
  s_branch L_wiw4
L_widw4:
  s_load_dwordx2 s[12:13], s[0:1], 88
  s_load_dwordx2 s[16:17], s[0:1], 104
  s_mov_b32 s14, 0x400000
  s_mov_b32 s15, 0x20000
  s_mov_b32 s18, 0x400000
  s_mov_b32 s19, 0x20000
  v_lshlrev_b32 v1, 4, v0
  v_and_b32 v20, 15, v0
  v_lshrrev_b32 v21, 4, v0
  v_lshrrev_b32 v22, 3, v0
  v_bfe_u32 v23, v0, 4, 2
  v_lshlrev_b32 v23, 1, v23
  v_and_b32 v24, 7, v0
  v_xor_b32 v23, v23, v24
  v_lshlrev_b32 v23, 4, v23
  v_lshlrev_b32 v22, 10, v22
  v_add_u32 v2, v22, v23
  v_bfe_u32 v22, v0, 2, 2
  v_lshlrev_b32 v23, 2, v21
  v_add_u32 v23, v23, v22
  v_lshrrev_b32 v24, 1, v23
  v_and_b32 v24, 3, v24
  v_lshlrev_b32 v24, 1, v24
  v_lshlrev_b32 v23, 7, v23
  v_and_b32 v25, 1, v0
  v_lshlrev_b32 v25, 3, v25
  v_add_u32 v23, v23, v25
  s_lshl_b32 s32, s28, 15
  v_add_u32 v23, s32, v23
  v_bfe_u32 v25, v0, 1, 1
  v_add_u32 v26, 0, v25
  v_xor_b32 v26, v26, v24
  v_lshlrev_b32 v26, 4, v26
  v_add_u32 v8, v23, v26
  v_add_u32 v26, 2, v25
  v_xor_b32 v26, v26, v24
  v_lshlrev_b32 v26, 4, v26
  v_add_u32 v9, v23, v26
  v_add_u32 v26, 4, v25
  v_xor_b32 v26, v26, v24
  v_lshlrev_b32 v26, 4, v26
  v_add_u32 v10, v23, v26
  v_add_u32 v26, 6, v25
  v_xor_b32 v26, v26, v24
  v_lshlrev_b32 v26, 4, v26
  v_add_u32 v11, v23, v26
  v_add_u32 v4, s32, v1
  s_lshl_b32 s33, s28, 12
  s_add_u32 s33, s33, 131072
  v_add_u32 v5, s33, v1
  s_lshl_b32 s33, s28, 10
  s_add_u32 s33, s33, 131072
  v_add_u32 v6, s33, v1
  v_lshlrev_b32 v22, 11, v20
  v_lshlrev_b32 v23, 3, v21
  s_lshl_b32 s33, s29, 7
  s_lshl_b32 s34, s28, 5
  s_add_u32 s33, s33, s34
  s_add_u32 s33, s33, 1024
  v_add3_u32 v7, v22, v23, s33
  s_waitcnt lgkmcnt(0)
  s_lshl_b32 s32, s28, 20
  s_lshl_b32 s33, s29, 7
  s_add_u32 s32, s32, s33
  s_add_u32 s32, s32, 0
  s_lshl_b32 s36, s28, 15
  s_add_u32 s36, s36, 0
  s_add_u32 m0, s36, 0
  s_add_u32 s34, s32, 0
  buffer_load_dwordx4 v2, s[12:15], s34 offen lds
  s_add_u32 m0, s36, 1024
  s_add_u32 s34, s32, 8192
  buffer_load_dwordx4 v2, s[12:15], s34 offen lds
  s_add_u32 m0, s36, 2048
  s_add_u32 s34, s32, 16384
  buffer_load_dwordx4 v2, s[12:15], s34 offen lds
  s_add_u32 m0, s36, 3072
  s_add_u32 s34, s32, 24576
  buffer_load_dwordx4 v2, s[12:15], s34 offen lds
  s_add_u32 m0, s36, 4096
  s_add_u32 s34, s32, 32768
  buffer_load_dwordx4 v2, s[12:15], s34 offen lds
  s_add_u32 m0, s36, 5120
  s_add_u32 s34, s32, 40960
  buffer_load_dwordx4 v2, s[12:15], s34 offen lds
  s_add_u32 m0, s36, 6144
  s_add_u32 s34, s32, 49152
  buffer_load_dwordx4 v2, s[12:15], s34 offen lds
  s_add_u32 m0, s36, 7168
  s_add_u32 s34, s32, 57344
  buffer_load_dwordx4 v2, s[12:15], s34 offen lds
  s_add_u32 m0, s36, 8192
  s_add_u32 s34, s32, 65536
  buffer_load_dwordx4 v2, s[12:15], s34 offen lds
  s_add_u32 m0, s36, 9216
  s_add_u32 s34, s32, 73728
  buffer_load_dwordx4 v2, s[12:15], s34 offen lds
  s_add_u32 m0, s36, 10240
  s_add_u32 s34, s32, 81920
  buffer_load_dwordx4 v2, s[12:15], s34 offen lds
  s_add_u32 m0, s36, 11264
  s_add_u32 s34, s32, 90112
  buffer_load_dwordx4 v2, s[12:15], s34 offen lds
  s_add_u32 m0, s36, 12288
  s_add_u32 s34, s32, 98304
  buffer_load_dwordx4 v2, s[12:15], s34 offen lds
  s_add_u32 m0, s36, 13312
  s_add_u32 s34, s32, 106496
  buffer_load_dwordx4 v2, s[12:15], s34 offen lds
  s_add_u32 m0, s36, 14336
  s_add_u32 s34, s32, 114688
  buffer_load_dwordx4 v2, s[12:15], s34 offen lds
  s_add_u32 m0, s36, 15360
  s_add_u32 s34, s32, 122880
  buffer_load_dwordx4 v2, s[12:15], s34 offen lds
  s_lshl_b32 s32, s28, 20
  s_lshl_b32 s33, s29, 7
  s_add_u32 s32, s32, s33
  s_add_u32 s32, s32, 131072
  s_lshl_b32 s36, s28, 15
  s_add_u32 s36, s36, 16384
  s_add_u32 m0, s36, 0
  s_add_u32 s34, s32, 0
  buffer_load_dwordx4 v2, s[12:15], s34 offen lds
  s_add_u32 m0, s36, 1024
  s_add_u32 s34, s32, 8192
  buffer_load_dwordx4 v2, s[12:15], s34 offen lds
  s_add_u32 m0, s36, 2048
  s_add_u32 s34, s32, 16384
  buffer_load_dwordx4 v2, s[12:15], s34 offen lds
  s_add_u32 m0, s36, 3072
  s_add_u32 s34, s32, 24576
  buffer_load_dwordx4 v2, s[12:15], s34 offen lds
  s_add_u32 m0, s36, 4096
  s_add_u32 s34, s32, 32768
  buffer_load_dwordx4 v2, s[12:15], s34 offen lds
  s_add_u32 m0, s36, 5120
  s_add_u32 s34, s32, 40960
  buffer_load_dwordx4 v2, s[12:15], s34 offen lds
  s_add_u32 m0, s36, 6144
  s_add_u32 s34, s32, 49152
  buffer_load_dwordx4 v2, s[12:15], s34 offen lds
  s_add_u32 m0, s36, 7168
  s_add_u32 s34, s32, 57344
  buffer_load_dwordx4 v2, s[12:15], s34 offen lds
  s_add_u32 m0, s36, 8192
  s_add_u32 s34, s32, 65536
  buffer_load_dwordx4 v2, s[12:15], s34 offen lds
  s_add_u32 m0, s36, 9216
  s_add_u32 s34, s32, 73728
  buffer_load_dwordx4 v2, s[12:15], s34 offen lds
  s_add_u32 m0, s36, 10240
  s_add_u32 s34, s32, 81920
  buffer_load_dwordx4 v2, s[12:15], s34 offen lds
  s_add_u32 m0, s36, 11264
  s_add_u32 s34, s32, 90112
  buffer_load_dwordx4 v2, s[12:15], s34 offen lds
  s_add_u32 m0, s36, 12288
  s_add_u32 s34, s32, 98304
  buffer_load_dwordx4 v2, s[12:15], s34 offen lds
  s_add_u32 m0, s36, 13312
  s_add_u32 s34, s32, 106496
  buffer_load_dwordx4 v2, s[12:15], s34 offen lds
  s_add_u32 m0, s36, 14336
  s_add_u32 s34, s32, 114688
  buffer_load_dwordx4 v2, s[12:15], s34 offen lds
  s_add_u32 m0, s36, 15360
  s_add_u32 s34, s32, 122880
  buffer_load_dwordx4 v2, s[12:15], s34 offen lds
  s_waitcnt vmcnt(16)
  ds_read_b64_tr_b16 a[0:1], v8 offset:0
  ds_read_b64_tr_b16 a[2:3], v8 offset:2048
  ds_read_b64_tr_b16 a[4:5], v9 offset:0
  ds_read_b64_tr_b16 a[6:7], v9 offset:2048
  ds_read_b64_tr_b16 a[8:9], v10 offset:0
  ds_read_b64_tr_b16 a[10:11], v10 offset:2048
  ds_read_b64_tr_b16 a[12:13], v11 offset:0
  ds_read_b64_tr_b16 a[14:15], v11 offset:2048
  ds_read_b64_tr_b16 a[16:17], v8 offset:4096
  ds_read_b64_tr_b16 a[18:19], v8 offset:6144
  ds_read_b64_tr_b16 a[20:21], v9 offset:4096
  ds_read_b64_tr_b16 a[22:23], v9 offset:6144
  ds_read_b64_tr_b16 a[24:25], v10 offset:4096
  ds_read_b64_tr_b16 a[26:27], v10 offset:6144
  ds_read_b64_tr_b16 a[28:29], v11 offset:4096
  ds_read_b64_tr_b16 a[30:31], v11 offset:6144
  ds_read_b64_tr_b16 a[32:33], v8 offset:8192
  ds_read_b64_tr_b16 a[34:35], v8 offset:10240
  ds_read_b64_tr_b16 a[36:37], v9 offset:8192
  ds_read_b64_tr_b16 a[38:39], v9 offset:10240
  ds_read_b64_tr_b16 a[40:41], v10 offset:8192
  ds_read_b64_tr_b16 a[42:43], v10 offset:10240
  ds_read_b64_tr_b16 a[44:45], v11 offset:8192
  ds_read_b64_tr_b16 a[46:47], v11 offset:10240
  ds_read_b64_tr_b16 a[48:49], v8 offset:12288
  ds_read_b64_tr_b16 a[50:51], v8 offset:14336
  ds_read_b64_tr_b16 a[52:53], v9 offset:12288
  ds_read_b64_tr_b16 a[54:55], v9 offset:14336
  ds_read_b64_tr_b16 a[56:57], v10 offset:12288
  ds_read_b64_tr_b16 a[58:59], v10 offset:14336
  ds_read_b64_tr_b16 a[60:61], v11 offset:12288
  ds_read_b64_tr_b16 a[62:63], v11 offset:14336
  s_waitcnt lgkmcnt(0)
  s_lshl_b32 s32, s28, 20
  s_lshl_b32 s33, s29, 7
  s_add_u32 s32, s32, s33
  s_add_u32 s32, s32, 262144
  s_lshl_b32 s36, s28, 15
  s_add_u32 s36, s36, 0
  s_add_u32 m0, s36, 0
  s_add_u32 s34, s32, 0
  buffer_load_dwordx4 v2, s[12:15], s34 offen lds
  s_add_u32 m0, s36, 1024
  s_add_u32 s34, s32, 8192
  buffer_load_dwordx4 v2, s[12:15], s34 offen lds
  s_add_u32 m0, s36, 2048
  s_add_u32 s34, s32, 16384
  buffer_load_dwordx4 v2, s[12:15], s34 offen lds
  s_add_u32 m0, s36, 3072
  s_add_u32 s34, s32, 24576
  buffer_load_dwordx4 v2, s[12:15], s34 offen lds
  s_add_u32 m0, s36, 4096
  s_add_u32 s34, s32, 32768
  buffer_load_dwordx4 v2, s[12:15], s34 offen lds
  s_add_u32 m0, s36, 5120
  s_add_u32 s34, s32, 40960
  buffer_load_dwordx4 v2, s[12:15], s34 offen lds
  s_add_u32 m0, s36, 6144
  s_add_u32 s34, s32, 49152
  buffer_load_dwordx4 v2, s[12:15], s34 offen lds
  s_add_u32 m0, s36, 7168
  s_add_u32 s34, s32, 57344
  buffer_load_dwordx4 v2, s[12:15], s34 offen lds
  s_add_u32 m0, s36, 8192
  s_add_u32 s34, s32, 65536
  buffer_load_dwordx4 v2, s[12:15], s34 offen lds
  s_add_u32 m0, s36, 9216
  s_add_u32 s34, s32, 73728
  buffer_load_dwordx4 v2, s[12:15], s34 offen lds
  s_add_u32 m0, s36, 10240
  s_add_u32 s34, s32, 81920
  buffer_load_dwordx4 v2, s[12:15], s34 offen lds
  s_add_u32 m0, s36, 11264
  s_add_u32 s34, s32, 90112
  buffer_load_dwordx4 v2, s[12:15], s34 offen lds
  s_add_u32 m0, s36, 12288
  s_add_u32 s34, s32, 98304
  buffer_load_dwordx4 v2, s[12:15], s34 offen lds
  s_add_u32 m0, s36, 13312
  s_add_u32 s34, s32, 106496
  buffer_load_dwordx4 v2, s[12:15], s34 offen lds
  s_add_u32 m0, s36, 14336
  s_add_u32 s34, s32, 114688
  buffer_load_dwordx4 v2, s[12:15], s34 offen lds
  s_add_u32 m0, s36, 15360
  s_add_u32 s34, s32, 122880
  buffer_load_dwordx4 v2, s[12:15], s34 offen lds
  s_waitcnt vmcnt(16)
  ds_read_b64_tr_b16 a[64:65], v8 offset:16384
  ds_read_b64_tr_b16 a[66:67], v8 offset:18432
  ds_read_b64_tr_b16 a[68:69], v9 offset:16384
  ds_read_b64_tr_b16 a[70:71], v9 offset:18432
  ds_read_b64_tr_b16 a[72:73], v10 offset:16384
  ds_read_b64_tr_b16 a[74:75], v10 offset:18432
  ds_read_b64_tr_b16 a[76:77], v11 offset:16384
  ds_read_b64_tr_b16 a[78:79], v11 offset:18432
  ds_read_b64_tr_b16 a[80:81], v8 offset:20480
  ds_read_b64_tr_b16 a[82:83], v8 offset:22528
  ds_read_b64_tr_b16 a[84:85], v9 offset:20480
  ds_read_b64_tr_b16 a[86:87], v9 offset:22528
  ds_read_b64_tr_b16 a[88:89], v10 offset:20480
  ds_read_b64_tr_b16 a[90:91], v10 offset:22528
  ds_read_b64_tr_b16 a[92:93], v11 offset:20480
  ds_read_b64_tr_b16 a[94:95], v11 offset:22528
  ds_read_b64_tr_b16 a[96:97], v8 offset:24576
  ds_read_b64_tr_b16 a[98:99], v8 offset:26624
  ds_read_b64_tr_b16 a[100:101], v9 offset:24576
  ds_read_b64_tr_b16 a[102:103], v9 offset:26624
  ds_read_b64_tr_b16 a[104:105], v10 offset:24576
  ds_read_b64_tr_b16 a[106:107], v10 offset:26624
  ds_read_b64_tr_b16 a[108:109], v11 offset:24576
  ds_read_b64_tr_b16 a[110:111], v11 offset:26624
  ds_read_b64_tr_b16 a[112:113], v8 offset:28672
  ds_read_b64_tr_b16 a[114:115], v8 offset:30720
  ds_read_b64_tr_b16 a[116:117], v9 offset:28672
  ds_read_b64_tr_b16 a[118:119], v9 offset:30720
  ds_read_b64_tr_b16 a[120:121], v10 offset:28672
  ds_read_b64_tr_b16 a[122:123], v10 offset:30720
  ds_read_b64_tr_b16 a[124:125], v11 offset:28672
  ds_read_b64_tr_b16 a[126:127], v11 offset:30720
  s_waitcnt lgkmcnt(0)
  s_lshl_b32 s32, s28, 20
  s_lshl_b32 s33, s29, 7
  s_add_u32 s32, s32, s33
  s_add_u32 s32, s32, 393216
  s_lshl_b32 s36, s28, 15
  s_add_u32 s36, s36, 16384
  s_add_u32 m0, s36, 0
  s_add_u32 s34, s32, 0
  buffer_load_dwordx4 v2, s[12:15], s34 offen lds
  s_add_u32 m0, s36, 1024
  s_add_u32 s34, s32, 8192
  buffer_load_dwordx4 v2, s[12:15], s34 offen lds
  s_add_u32 m0, s36, 2048
  s_add_u32 s34, s32, 16384
  buffer_load_dwordx4 v2, s[12:15], s34 offen lds
  s_add_u32 m0, s36, 3072
  s_add_u32 s34, s32, 24576
  buffer_load_dwordx4 v2, s[12:15], s34 offen lds
  s_add_u32 m0, s36, 4096
  s_add_u32 s34, s32, 32768
  buffer_load_dwordx4 v2, s[12:15], s34 offen lds
  s_add_u32 m0, s36, 5120
  s_add_u32 s34, s32, 40960
  buffer_load_dwordx4 v2, s[12:15], s34 offen lds
  s_add_u32 m0, s36, 6144
  s_add_u32 s34, s32, 49152
  buffer_load_dwordx4 v2, s[12:15], s34 offen lds
  s_add_u32 m0, s36, 7168
  s_add_u32 s34, s32, 57344
  buffer_load_dwordx4 v2, s[12:15], s34 offen lds
  s_add_u32 m0, s36, 8192
  s_add_u32 s34, s32, 65536
  buffer_load_dwordx4 v2, s[12:15], s34 offen lds
  s_add_u32 m0, s36, 9216
  s_add_u32 s34, s32, 73728
  buffer_load_dwordx4 v2, s[12:15], s34 offen lds
  s_add_u32 m0, s36, 10240
  s_add_u32 s34, s32, 81920
  buffer_load_dwordx4 v2, s[12:15], s34 offen lds
  s_add_u32 m0, s36, 11264
  s_add_u32 s34, s32, 90112
  buffer_load_dwordx4 v2, s[12:15], s34 offen lds
  s_add_u32 m0, s36, 12288
  s_add_u32 s34, s32, 98304
  buffer_load_dwordx4 v2, s[12:15], s34 offen lds
  s_add_u32 m0, s36, 13312
  s_add_u32 s34, s32, 106496
  buffer_load_dwordx4 v2, s[12:15], s34 offen lds
  s_add_u32 m0, s36, 14336
  s_add_u32 s34, s32, 114688
  buffer_load_dwordx4 v2, s[12:15], s34 offen lds
  s_add_u32 m0, s36, 15360
  s_add_u32 s34, s32, 122880
  buffer_load_dwordx4 v2, s[12:15], s34 offen lds
  s_waitcnt vmcnt(16)
  ds_read_b64_tr_b16 a[128:129], v8 offset:0
  ds_read_b64_tr_b16 a[130:131], v8 offset:2048
  ds_read_b64_tr_b16 a[132:133], v9 offset:0
  ds_read_b64_tr_b16 a[134:135], v9 offset:2048
  ds_read_b64_tr_b16 a[136:137], v10 offset:0
  ds_read_b64_tr_b16 a[138:139], v10 offset:2048
  ds_read_b64_tr_b16 a[140:141], v11 offset:0
  ds_read_b64_tr_b16 a[142:143], v11 offset:2048
  ds_read_b64_tr_b16 a[144:145], v8 offset:4096
  ds_read_b64_tr_b16 a[146:147], v8 offset:6144
  ds_read_b64_tr_b16 a[148:149], v9 offset:4096
  ds_read_b64_tr_b16 a[150:151], v9 offset:6144
  ds_read_b64_tr_b16 a[152:153], v10 offset:4096
  ds_read_b64_tr_b16 a[154:155], v10 offset:6144
  ds_read_b64_tr_b16 a[156:157], v11 offset:4096
  ds_read_b64_tr_b16 a[158:159], v11 offset:6144
  ds_read_b64_tr_b16 a[160:161], v8 offset:8192
  ds_read_b64_tr_b16 a[162:163], v8 offset:10240
  ds_read_b64_tr_b16 a[164:165], v9 offset:8192
  ds_read_b64_tr_b16 a[166:167], v9 offset:10240
  ds_read_b64_tr_b16 a[168:169], v10 offset:8192
  ds_read_b64_tr_b16 a[170:171], v10 offset:10240
  ds_read_b64_tr_b16 a[172:173], v11 offset:8192
  ds_read_b64_tr_b16 a[174:175], v11 offset:10240
  ds_read_b64_tr_b16 a[176:177], v8 offset:12288
  ds_read_b64_tr_b16 a[178:179], v8 offset:14336
  ds_read_b64_tr_b16 a[180:181], v9 offset:12288
  ds_read_b64_tr_b16 a[182:183], v9 offset:14336
  ds_read_b64_tr_b16 a[184:185], v10 offset:12288
  ds_read_b64_tr_b16 a[186:187], v10 offset:14336
  ds_read_b64_tr_b16 a[188:189], v11 offset:12288
  ds_read_b64_tr_b16 a[190:191], v11 offset:14336
  s_waitcnt lgkmcnt(0)
  s_lshl_b32 s32, s28, 20
  s_lshl_b32 s33, s29, 7
  s_add_u32 s32, s32, s33
  s_add_u32 s32, s32, 524288
  s_lshl_b32 s36, s28, 15
  s_add_u32 s36, s36, 0
  s_add_u32 m0, s36, 0
  s_add_u32 s34, s32, 0
  buffer_load_dwordx4 v2, s[12:15], s34 offen lds
  s_add_u32 m0, s36, 1024
  s_add_u32 s34, s32, 8192
  buffer_load_dwordx4 v2, s[12:15], s34 offen lds
  s_add_u32 m0, s36, 2048
  s_add_u32 s34, s32, 16384
  buffer_load_dwordx4 v2, s[12:15], s34 offen lds
  s_add_u32 m0, s36, 3072
  s_add_u32 s34, s32, 24576
  buffer_load_dwordx4 v2, s[12:15], s34 offen lds
  s_add_u32 m0, s36, 4096
  s_add_u32 s34, s32, 32768
  buffer_load_dwordx4 v2, s[12:15], s34 offen lds
  s_add_u32 m0, s36, 5120
  s_add_u32 s34, s32, 40960
  buffer_load_dwordx4 v2, s[12:15], s34 offen lds
  s_add_u32 m0, s36, 6144
  s_add_u32 s34, s32, 49152
  buffer_load_dwordx4 v2, s[12:15], s34 offen lds
  s_add_u32 m0, s36, 7168
  s_add_u32 s34, s32, 57344
  buffer_load_dwordx4 v2, s[12:15], s34 offen lds
  s_add_u32 m0, s36, 8192
  s_add_u32 s34, s32, 65536
  buffer_load_dwordx4 v2, s[12:15], s34 offen lds
  s_add_u32 m0, s36, 9216
  s_add_u32 s34, s32, 73728
  buffer_load_dwordx4 v2, s[12:15], s34 offen lds
  s_add_u32 m0, s36, 10240
  s_add_u32 s34, s32, 81920
  buffer_load_dwordx4 v2, s[12:15], s34 offen lds
  s_add_u32 m0, s36, 11264
  s_add_u32 s34, s32, 90112
  buffer_load_dwordx4 v2, s[12:15], s34 offen lds
  s_add_u32 m0, s36, 12288
  s_add_u32 s34, s32, 98304
  buffer_load_dwordx4 v2, s[12:15], s34 offen lds
  s_add_u32 m0, s36, 13312
  s_add_u32 s34, s32, 106496
  buffer_load_dwordx4 v2, s[12:15], s34 offen lds
  s_add_u32 m0, s36, 14336
  s_add_u32 s34, s32, 114688
  buffer_load_dwordx4 v2, s[12:15], s34 offen lds
  s_add_u32 m0, s36, 15360
  s_add_u32 s34, s32, 122880
  buffer_load_dwordx4 v2, s[12:15], s34 offen lds
  s_waitcnt vmcnt(16)
  ds_read_b64_tr_b16 a[192:193], v8 offset:16384
  ds_read_b64_tr_b16 a[194:195], v8 offset:18432
  ds_read_b64_tr_b16 a[196:197], v9 offset:16384
  ds_read_b64_tr_b16 a[198:199], v9 offset:18432
  ds_read_b64_tr_b16 a[200:201], v10 offset:16384
  ds_read_b64_tr_b16 a[202:203], v10 offset:18432
  ds_read_b64_tr_b16 a[204:205], v11 offset:16384
  ds_read_b64_tr_b16 a[206:207], v11 offset:18432
  ds_read_b64_tr_b16 a[208:209], v8 offset:20480
  ds_read_b64_tr_b16 a[210:211], v8 offset:22528
  ds_read_b64_tr_b16 a[212:213], v9 offset:20480
  ds_read_b64_tr_b16 a[214:215], v9 offset:22528
  ds_read_b64_tr_b16 a[216:217], v10 offset:20480
  ds_read_b64_tr_b16 a[218:219], v10 offset:22528
  ds_read_b64_tr_b16 a[220:221], v11 offset:20480
  ds_read_b64_tr_b16 a[222:223], v11 offset:22528
  ds_read_b64_tr_b16 a[224:225], v8 offset:24576
  ds_read_b64_tr_b16 a[226:227], v8 offset:26624
  ds_read_b64_tr_b16 a[228:229], v9 offset:24576
  ds_read_b64_tr_b16 a[230:231], v9 offset:26624
  ds_read_b64_tr_b16 a[232:233], v10 offset:24576
  ds_read_b64_tr_b16 a[234:235], v10 offset:26624
  ds_read_b64_tr_b16 a[236:237], v11 offset:24576
  ds_read_b64_tr_b16 a[238:239], v11 offset:26624
  ds_read_b64_tr_b16 a[240:241], v8 offset:28672
  ds_read_b64_tr_b16 a[242:243], v8 offset:30720
  ds_read_b64_tr_b16 a[244:245], v9 offset:28672
  ds_read_b64_tr_b16 a[246:247], v9 offset:30720
  ds_read_b64_tr_b16 a[248:249], v10 offset:28672
  ds_read_b64_tr_b16 a[250:251], v10 offset:30720
  ds_read_b64_tr_b16 a[252:253], v11 offset:28672
  ds_read_b64_tr_b16 a[254:255], v11 offset:30720
  s_waitcnt lgkmcnt(0)
  s_lshl_b32 s32, s28, 20
  s_lshl_b32 s33, s29, 7
  s_add_u32 s32, s32, s33
  s_add_u32 s32, s32, 655360
  s_lshl_b32 s36, s28, 15
  s_add_u32 s36, s36, 16384
  s_add_u32 m0, s36, 0
  s_add_u32 s34, s32, 0
  buffer_load_dwordx4 v2, s[12:15], s34 offen lds
  s_add_u32 m0, s36, 1024
  s_add_u32 s34, s32, 8192
  buffer_load_dwordx4 v2, s[12:15], s34 offen lds
  s_add_u32 m0, s36, 2048
  s_add_u32 s34, s32, 16384
  buffer_load_dwordx4 v2, s[12:15], s34 offen lds
  s_add_u32 m0, s36, 3072
  s_add_u32 s34, s32, 24576
  buffer_load_dwordx4 v2, s[12:15], s34 offen lds
  s_add_u32 m0, s36, 4096
  s_add_u32 s34, s32, 32768
  buffer_load_dwordx4 v2, s[12:15], s34 offen lds
  s_add_u32 m0, s36, 5120
  s_add_u32 s34, s32, 40960
  buffer_load_dwordx4 v2, s[12:15], s34 offen lds
  s_add_u32 m0, s36, 6144
  s_add_u32 s34, s32, 49152
  buffer_load_dwordx4 v2, s[12:15], s34 offen lds
  s_add_u32 m0, s36, 7168
  s_add_u32 s34, s32, 57344
  buffer_load_dwordx4 v2, s[12:15], s34 offen lds
  s_add_u32 m0, s36, 8192
  s_add_u32 s34, s32, 65536
  buffer_load_dwordx4 v2, s[12:15], s34 offen lds
  s_add_u32 m0, s36, 9216
  s_add_u32 s34, s32, 73728
  buffer_load_dwordx4 v2, s[12:15], s34 offen lds
  s_add_u32 m0, s36, 10240
  s_add_u32 s34, s32, 81920
  buffer_load_dwordx4 v2, s[12:15], s34 offen lds
  s_add_u32 m0, s36, 11264
  s_add_u32 s34, s32, 90112
  buffer_load_dwordx4 v2, s[12:15], s34 offen lds
  s_add_u32 m0, s36, 12288
  s_add_u32 s34, s32, 98304
  buffer_load_dwordx4 v2, s[12:15], s34 offen lds
  s_add_u32 m0, s36, 13312
  s_add_u32 s34, s32, 106496
  buffer_load_dwordx4 v2, s[12:15], s34 offen lds
  s_add_u32 m0, s36, 14336
  s_add_u32 s34, s32, 114688
  buffer_load_dwordx4 v2, s[12:15], s34 offen lds
  s_add_u32 m0, s36, 15360
  s_add_u32 s34, s32, 122880
  buffer_load_dwordx4 v2, s[12:15], s34 offen lds
  s_waitcnt vmcnt(16)
  ds_read_b64_tr_b16 v[128:129], v8 offset:0
  ds_read_b64_tr_b16 v[130:131], v8 offset:2048
  ds_read_b64_tr_b16 v[132:133], v9 offset:0
  ds_read_b64_tr_b16 v[134:135], v9 offset:2048
  ds_read_b64_tr_b16 v[136:137], v10 offset:0
  ds_read_b64_tr_b16 v[138:139], v10 offset:2048
  ds_read_b64_tr_b16 v[140:141], v11 offset:0
  ds_read_b64_tr_b16 v[142:143], v11 offset:2048
  ds_read_b64_tr_b16 v[144:145], v8 offset:4096
  ds_read_b64_tr_b16 v[146:147], v8 offset:6144
  ds_read_b64_tr_b16 v[148:149], v9 offset:4096
  ds_read_b64_tr_b16 v[150:151], v9 offset:6144
  ds_read_b64_tr_b16 v[152:153], v10 offset:4096
  ds_read_b64_tr_b16 v[154:155], v10 offset:6144
  ds_read_b64_tr_b16 v[156:157], v11 offset:4096
  ds_read_b64_tr_b16 v[158:159], v11 offset:6144
  ds_read_b64_tr_b16 v[160:161], v8 offset:8192
  ds_read_b64_tr_b16 v[162:163], v8 offset:10240
  ds_read_b64_tr_b16 v[164:165], v9 offset:8192
  ds_read_b64_tr_b16 v[166:167], v9 offset:10240
  ds_read_b64_tr_b16 v[168:169], v10 offset:8192
  ds_read_b64_tr_b16 v[170:171], v10 offset:10240
  ds_read_b64_tr_b16 v[172:173], v11 offset:8192
  ds_read_b64_tr_b16 v[174:175], v11 offset:10240
  ds_read_b64_tr_b16 v[176:177], v8 offset:12288
  ds_read_b64_tr_b16 v[178:179], v8 offset:14336
  ds_read_b64_tr_b16 v[180:181], v9 offset:12288
  ds_read_b64_tr_b16 v[182:183], v9 offset:14336
  ds_read_b64_tr_b16 v[184:185], v10 offset:12288
  ds_read_b64_tr_b16 v[186:187], v10 offset:14336
  ds_read_b64_tr_b16 v[188:189], v11 offset:12288
  ds_read_b64_tr_b16 v[190:191], v11 offset:14336
  s_waitcnt lgkmcnt(0)
  s_lshl_b32 s32, s28, 20
  s_lshl_b32 s33, s29, 7
  s_add_u32 s32, s32, s33
  s_add_u32 s32, s32, 786432
  s_lshl_b32 s36, s28, 15
  s_add_u32 s36, s36, 0
  s_add_u32 m0, s36, 0
  s_add_u32 s34, s32, 0
  buffer_load_dwordx4 v2, s[12:15], s34 offen lds
  s_add_u32 m0, s36, 1024
  s_add_u32 s34, s32, 8192
  buffer_load_dwordx4 v2, s[12:15], s34 offen lds
  s_add_u32 m0, s36, 2048
  s_add_u32 s34, s32, 16384
  buffer_load_dwordx4 v2, s[12:15], s34 offen lds
  s_add_u32 m0, s36, 3072
  s_add_u32 s34, s32, 24576
  buffer_load_dwordx4 v2, s[12:15], s34 offen lds
  s_add_u32 m0, s36, 4096
  s_add_u32 s34, s32, 32768
  buffer_load_dwordx4 v2, s[12:15], s34 offen lds
  s_add_u32 m0, s36, 5120
  s_add_u32 s34, s32, 40960
  buffer_load_dwordx4 v2, s[12:15], s34 offen lds
  s_add_u32 m0, s36, 6144
  s_add_u32 s34, s32, 49152
  buffer_load_dwordx4 v2, s[12:15], s34 offen lds
  s_add_u32 m0, s36, 7168
  s_add_u32 s34, s32, 57344
  buffer_load_dwordx4 v2, s[12:15], s34 offen lds
  s_add_u32 m0, s36, 8192
  s_add_u32 s34, s32, 65536
  buffer_load_dwordx4 v2, s[12:15], s34 offen lds
  s_add_u32 m0, s36, 9216
  s_add_u32 s34, s32, 73728
  buffer_load_dwordx4 v2, s[12:15], s34 offen lds
  s_add_u32 m0, s36, 10240
  s_add_u32 s34, s32, 81920
  buffer_load_dwordx4 v2, s[12:15], s34 offen lds
  s_add_u32 m0, s36, 11264
  s_add_u32 s34, s32, 90112
  buffer_load_dwordx4 v2, s[12:15], s34 offen lds
  s_add_u32 m0, s36, 12288
  s_add_u32 s34, s32, 98304
  buffer_load_dwordx4 v2, s[12:15], s34 offen lds
  s_add_u32 m0, s36, 13312
  s_add_u32 s34, s32, 106496
  buffer_load_dwordx4 v2, s[12:15], s34 offen lds
  s_add_u32 m0, s36, 14336
  s_add_u32 s34, s32, 114688
  buffer_load_dwordx4 v2, s[12:15], s34 offen lds
  s_add_u32 m0, s36, 15360
  s_add_u32 s34, s32, 122880
  buffer_load_dwordx4 v2, s[12:15], s34 offen lds
  s_waitcnt vmcnt(16)
  ds_read_b64_tr_b16 v[192:193], v8 offset:16384
  ds_read_b64_tr_b16 v[194:195], v8 offset:18432
  ds_read_b64_tr_b16 v[196:197], v9 offset:16384
  ds_read_b64_tr_b16 v[198:199], v9 offset:18432
  ds_read_b64_tr_b16 v[200:201], v10 offset:16384
  ds_read_b64_tr_b16 v[202:203], v10 offset:18432
  ds_read_b64_tr_b16 v[204:205], v11 offset:16384
  ds_read_b64_tr_b16 v[206:207], v11 offset:18432
  ds_read_b64_tr_b16 v[208:209], v8 offset:20480
  ds_read_b64_tr_b16 v[210:211], v8 offset:22528
  ds_read_b64_tr_b16 v[212:213], v9 offset:20480
  ds_read_b64_tr_b16 v[214:215], v9 offset:22528
  ds_read_b64_tr_b16 v[216:217], v10 offset:20480
  ds_read_b64_tr_b16 v[218:219], v10 offset:22528
  ds_read_b64_tr_b16 v[220:221], v11 offset:20480
  ds_read_b64_tr_b16 v[222:223], v11 offset:22528
  ds_read_b64_tr_b16 v[224:225], v8 offset:24576
  ds_read_b64_tr_b16 v[226:227], v8 offset:26624
  ds_read_b64_tr_b16 v[228:229], v9 offset:24576
  ds_read_b64_tr_b16 v[230:231], v9 offset:26624
  ds_read_b64_tr_b16 v[232:233], v10 offset:24576
  ds_read_b64_tr_b16 v[234:235], v10 offset:26624
  ds_read_b64_tr_b16 v[236:237], v11 offset:24576
  ds_read_b64_tr_b16 v[238:239], v11 offset:26624
  ds_read_b64_tr_b16 v[240:241], v8 offset:28672
  ds_read_b64_tr_b16 v[242:243], v8 offset:30720
  ds_read_b64_tr_b16 v[244:245], v9 offset:28672
  ds_read_b64_tr_b16 v[246:247], v9 offset:30720
  ds_read_b64_tr_b16 v[248:249], v10 offset:28672
  ds_read_b64_tr_b16 v[250:251], v10 offset:30720
  ds_read_b64_tr_b16 v[252:253], v11 offset:28672
  ds_read_b64_tr_b16 v[254:255], v11 offset:30720
  s_waitcnt lgkmcnt(0)
  s_lshl_b32 s32, s28, 20
  s_lshl_b32 s33, s29, 7
  s_add_u32 s32, s32, s33
  s_add_u32 s32, s32, 917504
  s_lshl_b32 s36, s28, 15
  s_add_u32 s36, s36, 16384
  s_add_u32 m0, s36, 0
  s_add_u32 s34, s32, 0
  buffer_load_dwordx4 v2, s[12:15], s34 offen lds
  s_add_u32 m0, s36, 1024
  s_add_u32 s34, s32, 8192
  buffer_load_dwordx4 v2, s[12:15], s34 offen lds
  s_add_u32 m0, s36, 2048
  s_add_u32 s34, s32, 16384
  buffer_load_dwordx4 v2, s[12:15], s34 offen lds
  s_add_u32 m0, s36, 3072
  s_add_u32 s34, s32, 24576
  buffer_load_dwordx4 v2, s[12:15], s34 offen lds
  s_add_u32 m0, s36, 4096
  s_add_u32 s34, s32, 32768
  buffer_load_dwordx4 v2, s[12:15], s34 offen lds
  s_add_u32 m0, s36, 5120
  s_add_u32 s34, s32, 40960
  buffer_load_dwordx4 v2, s[12:15], s34 offen lds
  s_add_u32 m0, s36, 6144
  s_add_u32 s34, s32, 49152
  buffer_load_dwordx4 v2, s[12:15], s34 offen lds
  s_add_u32 m0, s36, 7168
  s_add_u32 s34, s32, 57344
  buffer_load_dwordx4 v2, s[12:15], s34 offen lds
  s_add_u32 m0, s36, 8192
  s_add_u32 s34, s32, 65536
  buffer_load_dwordx4 v2, s[12:15], s34 offen lds
  s_add_u32 m0, s36, 9216
  s_add_u32 s34, s32, 73728
  buffer_load_dwordx4 v2, s[12:15], s34 offen lds
  s_add_u32 m0, s36, 10240
  s_add_u32 s34, s32, 81920
  buffer_load_dwordx4 v2, s[12:15], s34 offen lds
  s_add_u32 m0, s36, 11264
  s_add_u32 s34, s32, 90112
  buffer_load_dwordx4 v2, s[12:15], s34 offen lds
  s_add_u32 m0, s36, 12288
  s_add_u32 s34, s32, 98304
  buffer_load_dwordx4 v2, s[12:15], s34 offen lds
  s_add_u32 m0, s36, 13312
  s_add_u32 s34, s32, 106496
  buffer_load_dwordx4 v2, s[12:15], s34 offen lds
  s_add_u32 m0, s36, 14336
  s_add_u32 s34, s32, 114688
  buffer_load_dwordx4 v2, s[12:15], s34 offen lds
  s_add_u32 m0, s36, 15360
  s_add_u32 s34, s32, 122880
  buffer_load_dwordx4 v2, s[12:15], s34 offen lds
  s_waitcnt vmcnt(16)
  ds_read_b64_tr_b16 v[60:61], v8 offset:0
  ds_read_b64_tr_b16 v[62:63], v8 offset:2048
  ds_read_b64_tr_b16 v[64:65], v9 offset:0
  ds_read_b64_tr_b16 v[66:67], v9 offset:2048
  ds_read_b64_tr_b16 v[68:69], v10 offset:0
  ds_read_b64_tr_b16 v[70:71], v10 offset:2048
  ds_read_b64_tr_b16 v[72:73], v11 offset:0
  ds_read_b64_tr_b16 v[74:75], v11 offset:2048
  ds_read_b64_tr_b16 v[76:77], v8 offset:4096
  ds_read_b64_tr_b16 v[78:79], v8 offset:6144
  ds_read_b64_tr_b16 v[80:81], v9 offset:4096
  ds_read_b64_tr_b16 v[82:83], v9 offset:6144
  ds_read_b64_tr_b16 v[84:85], v10 offset:4096
  ds_read_b64_tr_b16 v[86:87], v10 offset:6144
  ds_read_b64_tr_b16 v[88:89], v11 offset:4096
  ds_read_b64_tr_b16 v[90:91], v11 offset:6144
  ds_read_b64_tr_b16 v[92:93], v8 offset:8192
  ds_read_b64_tr_b16 v[94:95], v8 offset:10240
  ds_read_b64_tr_b16 v[96:97], v9 offset:8192
  ds_read_b64_tr_b16 v[98:99], v9 offset:10240
  ds_read_b64_tr_b16 v[100:101], v10 offset:8192
  ds_read_b64_tr_b16 v[102:103], v10 offset:10240
  ds_read_b64_tr_b16 v[104:105], v11 offset:8192
  ds_read_b64_tr_b16 v[106:107], v11 offset:10240
  ds_read_b64_tr_b16 v[108:109], v8 offset:12288
  ds_read_b64_tr_b16 v[110:111], v8 offset:14336
  ds_read_b64_tr_b16 v[112:113], v9 offset:12288
  ds_read_b64_tr_b16 v[114:115], v9 offset:14336
  ds_read_b64_tr_b16 v[116:117], v10 offset:12288
  ds_read_b64_tr_b16 v[118:119], v10 offset:14336
  ds_read_b64_tr_b16 v[120:121], v11 offset:12288
  ds_read_b64_tr_b16 v[122:123], v11 offset:14336
  s_waitcnt lgkmcnt(0)
  ds_write_b128 v4, v[60:63] offset:0
  ds_write_b128 v4, v[64:67] offset:1024
  ds_write_b128 v4, v[68:71] offset:2048
  ds_write_b128 v4, v[72:75] offset:3072
  ds_write_b128 v4, v[76:79] offset:4096
  ds_write_b128 v4, v[80:83] offset:5120
  ds_write_b128 v4, v[84:87] offset:6144
  ds_write_b128 v4, v[88:91] offset:7168
  ds_write_b128 v4, v[92:95] offset:8192
  ds_write_b128 v4, v[96:99] offset:9216
  ds_write_b128 v4, v[100:103] offset:10240
  ds_write_b128 v4, v[104:107] offset:11264
  ds_write_b128 v4, v[108:111] offset:12288
  ds_write_b128 v4, v[112:115] offset:13312
  ds_write_b128 v4, v[116:119] offset:14336
  ds_write_b128 v4, v[120:123] offset:15360
  s_waitcnt lgkmcnt(0)
  s_waitcnt vmcnt(0)
  ds_read_b64_tr_b16 v[60:61], v8 offset:16384
  ds_read_b64_tr_b16 v[62:63], v8 offset:18432
  ds_read_b64_tr_b16 v[64:65], v9 offset:16384
  ds_read_b64_tr_b16 v[66:67], v9 offset:18432
  ds_read_b64_tr_b16 v[68:69], v10 offset:16384
  ds_read_b64_tr_b16 v[70:71], v10 offset:18432
  ds_read_b64_tr_b16 v[72:73], v11 offset:16384
  ds_read_b64_tr_b16 v[74:75], v11 offset:18432
  ds_read_b64_tr_b16 v[76:77], v8 offset:20480
  ds_read_b64_tr_b16 v[78:79], v8 offset:22528
  ds_read_b64_tr_b16 v[80:81], v9 offset:20480
  ds_read_b64_tr_b16 v[82:83], v9 offset:22528
  ds_read_b64_tr_b16 v[84:85], v10 offset:20480
  ds_read_b64_tr_b16 v[86:87], v10 offset:22528
  ds_read_b64_tr_b16 v[88:89], v11 offset:20480
  ds_read_b64_tr_b16 v[90:91], v11 offset:22528
  ds_read_b64_tr_b16 v[92:93], v8 offset:24576
  ds_read_b64_tr_b16 v[94:95], v8 offset:26624
  ds_read_b64_tr_b16 v[96:97], v9 offset:24576
  ds_read_b64_tr_b16 v[98:99], v9 offset:26624
  ds_read_b64_tr_b16 v[100:101], v10 offset:24576
  ds_read_b64_tr_b16 v[102:103], v10 offset:26624
  ds_read_b64_tr_b16 v[104:105], v11 offset:24576
  ds_read_b64_tr_b16 v[106:107], v11 offset:26624
  ds_read_b64_tr_b16 v[108:109], v8 offset:28672
  ds_read_b64_tr_b16 v[110:111], v8 offset:30720
  ds_read_b64_tr_b16 v[112:113], v9 offset:28672
  ds_read_b64_tr_b16 v[114:115], v9 offset:30720
  ds_read_b64_tr_b16 v[116:117], v10 offset:28672
  ds_read_b64_tr_b16 v[118:119], v10 offset:30720
  ds_read_b64_tr_b16 v[120:121], v11 offset:28672
  ds_read_b64_tr_b16 v[122:123], v11 offset:30720
  s_waitcnt lgkmcnt(0)
  ds_write_b128 v4, v[60:63] offset:16384
  ds_write_b128 v4, v[64:67] offset:17408
  ds_write_b128 v4, v[68:71] offset:18432
  ds_write_b128 v4, v[72:75] offset:19456
  ds_write_b128 v4, v[76:79] offset:20480
  ds_write_b128 v4, v[80:83] offset:21504
  ds_write_b128 v4, v[84:87] offset:22528
  ds_write_b128 v4, v[88:91] offset:23552
  ds_write_b128 v4, v[92:95] offset:24576
  ds_write_b128 v4, v[96:99] offset:25600
  ds_write_b128 v4, v[100:103] offset:26624
  ds_write_b128 v4, v[104:107] offset:27648
  ds_write_b128 v4, v[108:111] offset:28672
  ds_write_b128 v4, v[112:115] offset:29696
  ds_write_b128 v4, v[116:119] offset:30720
  ds_write_b128 v4, v[120:123] offset:31744
  s_waitcnt lgkmcnt(0)
  s_mov_b32 s31, s30
  v_and_b32 v126, 7, v0
  s_lshl_b32 s3, s97, 3
  v_add_u32 v126, s3, v126
  v_lshlrev_b32 v126, 8, v126
  s_nop 1
L_w4l:
  s_lshr_b32 s3, s31, 1
  s_lshl_b32 s3, s3, 13
  s_and_b32 s4, s31, 1
  s_lshl_b32 s4, s4, 7
  s_add_u32 s3, s3, s4
  s_add_u32 s3, s3, 720896
L_pfw4:
  buffer_load_dword v127, v126, s[8:11], s3 offen sc1
  s_waitcnt vmcnt(0)
  v_cmp_eq_u32 vcc, 0, v127
  s_nop 4
  s_cbranch_vccz L_pfdw4
  s_sleep 2
  s_branch L_pfw4
L_pfdw4:
  s_lshr_b32 s32, s31, 1
  s_lshl_b32 s32, s32, 18
  s_and_b32 s33, s31, 1
  s_lshl_b32 s33, s33, 10
  s_add_u32 s32, s32, s33
  s_lshl_b32 s33, s28, 16
  s_add_u32 s32, s32, s33
  s_add_u32 s35, s32, 67108864
  s_barrier
  s_lshl_b32 s36, s28, 13
  s_add_u32 s36, s36, 131072
  s_add_u32 s32, s35, 0
  buffer_load_dwordx4 v[28:31], v1, s[8:11], s32 offen sc1
  s_add_u32 s32, s35, 2048
  buffer_load_dwordx4 v[32:35], v1, s[8:11], s32 offen sc1
  s_add_u32 s32, s35, 4096
  buffer_load_dwordx4 v[36:39], v1, s[8:11], s32 offen sc1
  s_add_u32 s32, s35, 6144
  buffer_load_dwordx4 v[40:43], v1, s[8:11], s32 offen sc1
  s_add_u32 s32, s35, 8192
  buffer_load_dwordx4 v[44:47], v1, s[8:11], s32 offen sc1
  s_add_u32 s32, s35, 10240
  buffer_load_dwordx4 v[48:51], v1, s[8:11], s32 offen sc1
  s_add_u32 s32, s35, 12288
  buffer_load_dwordx4 v[52:55], v1, s[8:11], s32 offen sc1
  s_add_u32 s32, s35, 14336
  buffer_load_dwordx4 v[56:59], v1, s[8:11], s32 offen sc1
  s_add_u32 s32, s35, 16384
  buffer_load_dwordx4 v[60:63], v1, s[8:11], s32 offen sc1
  s_add_u32 s32, s35, 18432
  buffer_load_dwordx4 v[64:67], v1, s[8:11], s32 offen sc1
  s_add_u32 s32, s35, 20480
  buffer_load_dwordx4 v[68:71], v1, s[8:11], s32 offen sc1
  s_add_u32 s32, s35, 22528
  buffer_load_dwordx4 v[72:75], v1, s[8:11], s32 offen sc1
  s_add_u32 s32, s35, 24576
  buffer_load_dwordx4 v[76:79], v1, s[8:11], s32 offen sc1
  s_add_u32 s32, s35, 26624
  buffer_load_dwordx4 v[80:83], v1, s[8:11], s32 offen sc1
  s_add_u32 s32, s35, 28672
  buffer_load_dwordx4 v[84:87], v1, s[8:11], s32 offen sc1
  s_add_u32 s32, s35, 30720
  buffer_load_dwordx4 v[88:91], v1, s[8:11], s32 offen sc1
  s_add_u32 s32, s35, 32768
  buffer_load_dwordx4 v[92:95], v1, s[8:11], s32 offen sc1
  s_add_u32 s32, s35, 34816
  buffer_load_dwordx4 v[96:99], v1, s[8:11], s32 offen sc1
  s_add_u32 s32, s35, 36864
  buffer_load_dwordx4 v[100:103], v1, s[8:11], s32 offen sc1
  s_add_u32 s32, s35, 38912
  buffer_load_dwordx4 v[104:107], v1, s[8:11], s32 offen sc1
  s_add_u32 s32, s35, 40960
  buffer_load_dwordx4 v[108:111], v1, s[8:11], s32 offen sc1
  s_add_u32 s32, s35, 43008
  buffer_load_dwordx4 v[112:115], v1, s[8:11], s32 offen sc1
  s_add_u32 s32, s35, 45056
  buffer_load_dwordx4 v[116:119], v1, s[8:11], s32 offen sc1
  s_add_u32 s32, s35, 47104
  buffer_load_dwordx4 v[120:123], v1, s[8:11], s32 offen sc1
  s_add_u32 m0, s36, 0
  s_add_u32 s32, s35, 49152
  buffer_load_dwordx4 v1, s[8:11], s32 offen sc1 lds
  s_add_u32 m0, s36, 1024
  s_add_u32 s32, s35, 51200
  buffer_load_dwordx4 v1, s[8:11], s32 offen sc1 lds
  s_add_u32 m0, s36, 2048
  s_add_u32 s32, s35, 53248
  buffer_load_dwordx4 v1, s[8:11], s32 offen sc1 lds
  s_add_u32 m0, s36, 3072
  s_add_u32 s32, s35, 55296
  buffer_load_dwordx4 v1, s[8:11], s32 offen sc1 lds
  s_add_u32 m0, s36, 4096
  s_add_u32 s32, s35, 57344
  buffer_load_dwordx4 v1, s[8:11], s32 offen sc1 lds
  s_add_u32 m0, s36, 5120
  s_add_u32 s32, s35, 59392
  buffer_load_dwordx4 v1, s[8:11], s32 offen sc1 lds
  s_add_u32 m0, s36, 6144
  s_add_u32 s32, s35, 61440
  buffer_load_dwordx4 v1, s[8:11], s32 offen sc1 lds
  s_add_u32 m0, s36, 7168
  s_add_u32 s32, s35, 63488
  buffer_load_dwordx4 v1, s[8:11], s32 offen sc1 lds
  s_sub_u32 s33, s36, 0
  v_add_u32 v124, s36, v1
  s_waitcnt vmcnt(31)
  v_mfma_f32_16x16x32_bf16 v[12:15], a[0:3], v[28:31], 0
  v_mfma_f32_16x16x32_bf16 v[16:19], a[4:7], v[28:31], 0
  v_mfma_f32_16x16x32_bf16 v[20:23], a[8:11], v[28:31], 0
  v_mfma_f32_16x16x32_bf16 v[24:27], a[12:15], v[28:31], 0
  s_waitcnt vmcnt(30)
  v_mfma_f32_16x16x32_bf16 v[12:15], a[16:19], v[32:35], v[12:15]
  v_mfma_f32_16x16x32_bf16 v[16:19], a[20:23], v[32:35], v[16:19]
  v_mfma_f32_16x16x32_bf16 v[20:23], a[24:27], v[32:35], v[20:23]
  v_mfma_f32_16x16x32_bf16 v[24:27], a[28:31], v[32:35], v[24:27]
  s_waitcnt vmcnt(29)
  v_mfma_f32_16x16x32_bf16 v[12:15], a[32:35], v[36:39], v[12:15]
  v_mfma_f32_16x16x32_bf16 v[16:19], a[36:39], v[36:39], v[16:19]
  v_mfma_f32_16x16x32_bf16 v[20:23], a[40:43], v[36:39], v[20:23]
  v_mfma_f32_16x16x32_bf16 v[24:27], a[44:47], v[36:39], v[24:27]
  s_waitcnt vmcnt(28)
  v_mfma_f32_16x16x32_bf16 v[12:15], a[48:51], v[40:43], v[12:15]
  v_mfma_f32_16x16x32_bf16 v[16:19], a[52:55], v[40:43], v[16:19]
  v_mfma_f32_16x16x32_bf16 v[20:23], a[56:59], v[40:43], v[20:23]
  v_mfma_f32_16x16x32_bf16 v[24:27], a[60:63], v[40:43], v[24:27]
  s_waitcnt vmcnt(27)
  v_mfma_f32_16x16x32_bf16 v[12:15], a[64:67], v[44:47], v[12:15]
  v_mfma_f32_16x16x32_bf16 v[16:19], a[68:71], v[44:47], v[16:19]
  v_mfma_f32_16x16x32_bf16 v[20:23], a[72:75], v[44:47], v[20:23]
  v_mfma_f32_16x16x32_bf16 v[24:27], a[76:79], v[44:47], v[24:27]
  s_waitcnt vmcnt(26)
  v_mfma_f32_16x16x32_bf16 v[12:15], a[80:83], v[48:51], v[12:15]
  v_mfma_f32_16x16x32_bf16 v[16:19], a[84:87], v[48:51], v[16:19]
  v_mfma_f32_16x16x32_bf16 v[20:23], a[88:91], v[48:51], v[20:23]
  v_mfma_f32_16x16x32_bf16 v[24:27], a[92:95], v[48:51], v[24:27]
  s_waitcnt vmcnt(25)
  v_mfma_f32_16x16x32_bf16 v[12:15], a[96:99], v[52:55], v[12:15]
  v_mfma_f32_16x16x32_bf16 v[16:19], a[100:103], v[52:55], v[16:19]
  v_mfma_f32_16x16x32_bf16 v[20:23], a[104:107], v[52:55], v[20:23]
  v_mfma_f32_16x16x32_bf16 v[24:27], a[108:111], v[52:55], v[24:27]
  s_waitcnt vmcnt(24)
  v_mfma_f32_16x16x32_bf16 v[12:15], a[112:115], v[56:59], v[12:15]
  v_mfma_f32_16x16x32_bf16 v[16:19], a[116:119], v[56:59], v[16:19]
  v_mfma_f32_16x16x32_bf16 v[20:23], a[120:123], v[56:59], v[20:23]
  v_mfma_f32_16x16x32_bf16 v[24:27], a[124:127], v[56:59], v[24:27]
  s_waitcnt vmcnt(23)
  v_mfma_f32_16x16x32_bf16 v[12:15], a[128:131], v[60:63], v[12:15]
  v_mfma_f32_16x16x32_bf16 v[16:19], a[132:135], v[60:63], v[16:19]
  v_mfma_f32_16x16x32_bf16 v[20:23], a[136:139], v[60:63], v[20:23]
  v_mfma_f32_16x16x32_bf16 v[24:27], a[140:143], v[60:63], v[24:27]
  s_waitcnt vmcnt(22)
  v_mfma_f32_16x16x32_bf16 v[12:15], a[144:147], v[64:67], v[12:15]
  v_mfma_f32_16x16x32_bf16 v[16:19], a[148:151], v[64:67], v[16:19]
  v_mfma_f32_16x16x32_bf16 v[20:23], a[152:155], v[64:67], v[20:23]
  v_mfma_f32_16x16x32_bf16 v[24:27], a[156:159], v[64:67], v[24:27]
  s_waitcnt vmcnt(21)
  v_mfma_f32_16x16x32_bf16 v[12:15], a[160:163], v[68:71], v[12:15]
  v_mfma_f32_16x16x32_bf16 v[16:19], a[164:167], v[68:71], v[16:19]
  v_mfma_f32_16x16x32_bf16 v[20:23], a[168:171], v[68:71], v[20:23]
  v_mfma_f32_16x16x32_bf16 v[24:27], a[172:175], v[68:71], v[24:27]
  s_waitcnt vmcnt(20)
  v_mfma_f32_16x16x32_bf16 v[12:15], a[176:179], v[72:75], v[12:15]
  v_mfma_f32_16x16x32_bf16 v[16:19], a[180:183], v[72:75], v[16:19]
  v_mfma_f32_16x16x32_bf16 v[20:23], a[184:187], v[72:75], v[20:23]
  v_mfma_f32_16x16x32_bf16 v[24:27], a[188:191], v[72:75], v[24:27]
  s_waitcnt vmcnt(19)
  v_mfma_f32_16x16x32_bf16 v[12:15], a[192:195], v[76:79], v[12:15]
  v_mfma_f32_16x16x32_bf16 v[16:19], a[196:199], v[76:79], v[16:19]
  v_mfma_f32_16x16x32_bf16 v[20:23], a[200:203], v[76:79], v[20:23]
  v_mfma_f32_16x16x32_bf16 v[24:27], a[204:207], v[76:79], v[24:27]
  s_waitcnt vmcnt(18)
  v_mfma_f32_16x16x32_bf16 v[12:15], a[208:211], v[80:83], v[12:15]
  v_mfma_f32_16x16x32_bf16 v[16:19], a[212:215], v[80:83], v[16:19]
  v_mfma_f32_16x16x32_bf16 v[20:23], a[216:219], v[80:83], v[20:23]
  v_mfma_f32_16x16x32_bf16 v[24:27], a[220:223], v[80:83], v[24:27]
  s_waitcnt vmcnt(17)
  v_mfma_f32_16x16x32_bf16 v[12:15], a[224:227], v[84:87], v[12:15]
  v_mfma_f32_16x16x32_bf16 v[16:19], a[228:231], v[84:87], v[16:19]
  v_mfma_f32_16x16x32_bf16 v[20:23], a[232:235], v[84:87], v[20:23]
  v_mfma_f32_16x16x32_bf16 v[24:27], a[236:239], v[84:87], v[24:27]
  s_waitcnt vmcnt(16)
  v_mfma_f32_16x16x32_bf16 v[12:15], a[240:243], v[88:91], v[12:15]
  v_mfma_f32_16x16x32_bf16 v[16:19], a[244:247], v[88:91], v[16:19]
  v_mfma_f32_16x16x32_bf16 v[20:23], a[248:251], v[88:91], v[20:23]
  v_mfma_f32_16x16x32_bf16 v[24:27], a[252:255], v[88:91], v[24:27]
  s_waitcnt vmcnt(0)
  ds_read_b128 v[60:63], v124 offset:0
  ds_read_b128 v[64:67], v124 offset:1024
  ds_read_b128 v[68:71], v124 offset:2048
  ds_read_b128 v[72:75], v124 offset:3072
  ds_read_b128 v[76:79], v124 offset:4096
  ds_read_b128 v[80:83], v124 offset:5120
  ds_read_b128 v[84:87], v124 offset:6144
  ds_read_b128 v[88:91], v124 offset:7168
  v_mfma_f32_16x16x32_bf16 v[12:15], v[128:131], v[92:95], v[12:15]
  v_mfma_f32_16x16x32_bf16 v[16:19], v[132:135], v[92:95], v[16:19]
  v_mfma_f32_16x16x32_bf16 v[20:23], v[136:139], v[92:95], v[20:23]
  v_mfma_f32_16x16x32_bf16 v[24:27], v[140:143], v[92:95], v[24:27]
  v_mfma_f32_16x16x32_bf16 v[12:15], v[144:147], v[96:99], v[12:15]
  v_mfma_f32_16x16x32_bf16 v[16:19], v[148:151], v[96:99], v[16:19]
  v_mfma_f32_16x16x32_bf16 v[20:23], v[152:155], v[96:99], v[20:23]
  v_mfma_f32_16x16x32_bf16 v[24:27], v[156:159], v[96:99], v[24:27]
  v_mfma_f32_16x16x32_bf16 v[12:15], v[160:163], v[100:103], v[12:15]
  v_mfma_f32_16x16x32_bf16 v[16:19], v[164:167], v[100:103], v[16:19]
  v_mfma_f32_16x16x32_bf16 v[20:23], v[168:171], v[100:103], v[20:23]
  v_mfma_f32_16x16x32_bf16 v[24:27], v[172:175], v[100:103], v[24:27]
  v_mfma_f32_16x16x32_bf16 v[12:15], v[176:179], v[104:107], v[12:15]
  v_mfma_f32_16x16x32_bf16 v[16:19], v[180:183], v[104:107], v[16:19]
  v_mfma_f32_16x16x32_bf16 v[20:23], v[184:187], v[104:107], v[20:23]
  v_mfma_f32_16x16x32_bf16 v[24:27], v[188:191], v[104:107], v[24:27]
  v_mfma_f32_16x16x32_bf16 v[12:15], v[192:195], v[108:111], v[12:15]
  v_mfma_f32_16x16x32_bf16 v[16:19], v[196:199], v[108:111], v[16:19]
  v_mfma_f32_16x16x32_bf16 v[20:23], v[200:203], v[108:111], v[20:23]
  v_mfma_f32_16x16x32_bf16 v[24:27], v[204:207], v[108:111], v[24:27]
  v_mfma_f32_16x16x32_bf16 v[12:15], v[208:211], v[112:115], v[12:15]
  v_mfma_f32_16x16x32_bf16 v[16:19], v[212:215], v[112:115], v[16:19]
  v_mfma_f32_16x16x32_bf16 v[20:23], v[216:219], v[112:115], v[20:23]
  v_mfma_f32_16x16x32_bf16 v[24:27], v[220:223], v[112:115], v[24:27]
  v_mfma_f32_16x16x32_bf16 v[12:15], v[224:227], v[116:119], v[12:15]
  v_mfma_f32_16x16x32_bf16 v[16:19], v[228:231], v[116:119], v[16:19]
  v_mfma_f32_16x16x32_bf16 v[20:23], v[232:235], v[116:119], v[20:23]
  v_mfma_f32_16x16x32_bf16 v[24:27], v[236:239], v[116:119], v[24:27]
  v_mfma_f32_16x16x32_bf16 v[12:15], v[240:243], v[120:123], v[12:15]
  v_mfma_f32_16x16x32_bf16 v[16:19], v[244:247], v[120:123], v[16:19]
  v_mfma_f32_16x16x32_bf16 v[20:23], v[248:251], v[120:123], v[20:23]
  v_mfma_f32_16x16x32_bf16 v[24:27], v[252:255], v[120:123], v[24:27]
  ds_read_b128 v[28:31], v4 offset:0
  ds_read_b128 v[32:35], v4 offset:1024
  ds_read_b128 v[36:39], v4 offset:2048
  ds_read_b128 v[40:43], v4 offset:3072
  ds_read_b128 v[44:47], v4 offset:4096
  ds_read_b128 v[48:51], v4 offset:5120
  ds_read_b128 v[52:55], v4 offset:6144
  ds_read_b128 v[56:59], v4 offset:7168
  s_waitcnt lgkmcnt(4)
  v_mfma_f32_16x16x32_bf16 v[12:15], v[28:31], v[60:63], v[12:15]
  v_mfma_f32_16x16x32_bf16 v[16:19], v[32:35], v[60:63], v[16:19]
  v_mfma_f32_16x16x32_bf16 v[20:23], v[36:39], v[60:63], v[20:23]
  v_mfma_f32_16x16x32_bf16 v[24:27], v[40:43], v[60:63], v[24:27]
  ds_read_b128 v[28:31], v4 offset:8192
  ds_read_b128 v[32:35], v4 offset:9216
  ds_read_b128 v[36:39], v4 offset:10240
  ds_read_b128 v[40:43], v4 offset:11264
  s_waitcnt lgkmcnt(4)
  v_mfma_f32_16x16x32_bf16 v[12:15], v[44:47], v[64:67], v[12:15]
  v_mfma_f32_16x16x32_bf16 v[16:19], v[48:51], v[64:67], v[16:19]
  v_mfma_f32_16x16x32_bf16 v[20:23], v[52:55], v[64:67], v[20:23]
  v_mfma_f32_16x16x32_bf16 v[24:27], v[56:59], v[64:67], v[24:27]
  ds_read_b128 v[44:47], v4 offset:12288
  ds_read_b128 v[48:51], v4 offset:13312
  ds_read_b128 v[52:55], v4 offset:14336
  ds_read_b128 v[56:59], v4 offset:15360
  s_waitcnt lgkmcnt(4)
  v_mfma_f32_16x16x32_bf16 v[12:15], v[28:31], v[68:71], v[12:15]
  v_mfma_f32_16x16x32_bf16 v[16:19], v[32:35], v[68:71], v[16:19]
  v_mfma_f32_16x16x32_bf16 v[20:23], v[36:39], v[68:71], v[20:23]
  v_mfma_f32_16x16x32_bf16 v[24:27], v[40:43], v[68:71], v[24:27]
  ds_read_b128 v[28:31], v4 offset:16384
  ds_read_b128 v[32:35], v4 offset:17408
  ds_read_b128 v[36:39], v4 offset:18432
  ds_read_b128 v[40:43], v4 offset:19456
  s_waitcnt lgkmcnt(4)
  v_mfma_f32_16x16x32_bf16 v[12:15], v[44:47], v[72:75], v[12:15]
  v_mfma_f32_16x16x32_bf16 v[16:19], v[48:51], v[72:75], v[16:19]
  v_mfma_f32_16x16x32_bf16 v[20:23], v[52:55], v[72:75], v[20:23]
  v_mfma_f32_16x16x32_bf16 v[24:27], v[56:59], v[72:75], v[24:27]
  ds_read_b128 v[44:47], v4 offset:20480
  ds_read_b128 v[48:51], v4 offset:21504
  ds_read_b128 v[52:55], v4 offset:22528
  ds_read_b128 v[56:59], v4 offset:23552
  s_waitcnt lgkmcnt(4)
  v_mfma_f32_16x16x32_bf16 v[12:15], v[28:31], v[76:79], v[12:15]
  v_mfma_f32_16x16x32_bf16 v[16:19], v[32:35], v[76:79], v[16:19]
  v_mfma_f32_16x16x32_bf16 v[20:23], v[36:39], v[76:79], v[20:23]
  v_mfma_f32_16x16x32_bf16 v[24:27], v[40:43], v[76:79], v[24:27]
  ds_read_b128 v[28:31], v4 offset:24576
  ds_read_b128 v[32:35], v4 offset:25600
  ds_read_b128 v[36:39], v4 offset:26624
  ds_read_b128 v[40:43], v4 offset:27648
  s_waitcnt lgkmcnt(4)
  v_mfma_f32_16x16x32_bf16 v[12:15], v[44:47], v[80:83], v[12:15]
  v_mfma_f32_16x16x32_bf16 v[16:19], v[48:51], v[80:83], v[16:19]
  v_mfma_f32_16x16x32_bf16 v[20:23], v[52:55], v[80:83], v[20:23]
  v_mfma_f32_16x16x32_bf16 v[24:27], v[56:59], v[80:83], v[24:27]
  ds_read_b128 v[44:47], v4 offset:28672
  ds_read_b128 v[48:51], v4 offset:29696
  ds_read_b128 v[52:55], v4 offset:30720
  ds_read_b128 v[56:59], v4 offset:31744
  s_waitcnt lgkmcnt(4)
  v_mfma_f32_16x16x32_bf16 v[12:15], v[28:31], v[84:87], v[12:15]
  v_mfma_f32_16x16x32_bf16 v[16:19], v[32:35], v[84:87], v[16:19]
  v_mfma_f32_16x16x32_bf16 v[20:23], v[36:39], v[84:87], v[20:23]
  v_mfma_f32_16x16x32_bf16 v[24:27], v[40:43], v[84:87], v[24:27]
  s_waitcnt lgkmcnt(0)
  v_mfma_f32_16x16x32_bf16 v[12:15], v[44:47], v[88:91], v[12:15]
  v_mfma_f32_16x16x32_bf16 v[16:19], v[48:51], v[88:91], v[16:19]
  v_mfma_f32_16x16x32_bf16 v[20:23], v[52:55], v[88:91], v[20:23]
  v_mfma_f32_16x16x32_bf16 v[24:27], v[56:59], v[88:91], v[24:27]
  s_barrier
  s_nop 3
  ds_write_b128 v5, v[12:15] offset:0
  ds_write_b128 v5, v[16:19] offset:1024
  ds_write_b128 v5, v[20:23] offset:2048
  ds_write_b128 v5, v[24:27] offset:3072
  s_waitcnt lgkmcnt(0)
  s_barrier
  ds_read_b128 v[28:31], v6 offset:0
  ds_read_b128 v[32:35], v6 offset:4096
  ds_read_b128 v[36:39], v6 offset:8192
  ds_read_b128 v[40:43], v6 offset:12288
  s_waitcnt lgkmcnt(0)
  v_add_f32 v28, v28, v32
  v_add_f32 v36, v36, v40
  v_add_f32 v29, v29, v33
  v_add_f32 v37, v37, v41
  v_add_f32 v30, v30, v34
  v_add_f32 v38, v38, v42
  v_add_f32 v31, v31, v35
  v_add_f32 v39, v39, v43
  v_add_f32 v28, v28, v36
  v_add_f32 v29, v29, v37
  v_add_f32 v30, v30, v38
  v_add_f32 v31, v31, v39
  v_cvt_pk_bf16_f32 v28, v28, v29
  v_cvt_pk_bf16_f32 v29, v30, v31
  s_lshl_b32 s32, s31, 15
  buffer_store_dwordx2 v[28:29], v7, s[16:19], s32 offen
  s_add_u32 s31, s31, 8
  s_cmp_lt_u32 s31, 128
  s_cbranch_scc1 L_w4l
L_endF:
  s_waitcnt vmcnt(0)
  s_endpgm
.section .rodata,"a"
.p2align 6
.amdhsa_kernel concat_heads__ssm_conv_h3__memory_aug_recurrent_mem_tr__prompt_kernel
  .amdhsa_next_free_vgpr 512
  .amdhsa_next_free_sgpr 102
  .amdhsa_accum_offset 256
  .amdhsa_group_segment_fixed_size 0
  .amdhsa_kernarg_size 128
  .amdhsa_user_sgpr_count 2
  .amdhsa_user_sgpr_kernarg_segment_ptr 1
  .amdhsa_system_sgpr_workgroup_id_x 1
.end_amdhsa_kernel
```
